```python
import torch

def _softmax(x, axis=-1):
    return torch.softmax(x, dim=axis)
def _gelu(x):
    return torch.nn.functional.gelu(x, approximate="tanh")
def _silu(x):
    return torch.nn.functional.silu(x)
def _sigmoid(x):
    return torch.sigmoid(x)
def _layernorm(x, axis=-1, eps=1e-5):
    m = x.mean(dim=axis, keepdim=True)
    v = x.var(dim=axis, keepdim=True, unbiased=False)
    return (x - m) / torch.sqrt(v + eps)
def _scatter_add(tgt, idx, src, axis=0):
    return tgt.clone().index_add_(axis, idx, src)
def _segment_sum(src, seg, n):
    out = torch.zeros((n,) + src.shape[1:], dtype=src.dtype)
    return out.index_add_(0, seg, src)
def _pad(x, pw):
    flat = tuple(v for pair in reversed(pw) for v in pair)
    return torch.nn.functional.pad(x, flat)

kernel_name = 'gated_mix__compressed_kv_cla__moe_arch_mod__prompt'

def setup_inputs():

    _w = (lambda a: (lambda t: t.to(torch.bfloat16) if t.is_floating_point() else t)(torch.as_tensor(a)))
    def _A_setup():
        B, H, Sq, Sk, D, M = 1, 32, 2048, 2048, 128, 576
        Dc = 4 * D
        return {
            "x": _w((lambda *s: torch.randn(*s, dtype=torch.bfloat16) * 0.05)(B, Sq, M)),
            "c_kv": _w((lambda *s: torch.randn(*s, dtype=torch.bfloat16) * 0.8)(B, Sk, Dc)),
            "w_q": _w((lambda *s: torch.randn(*s, dtype=torch.bfloat16) * 6.4)(M, H, D) * (M ** -0.5)),
            "w_uk": _w((lambda *s: torch.randn(*s, dtype=torch.bfloat16) * 6.4)(Dc, H, D) * (Dc ** -0.5)),
            "w_uv": _w((lambda *s: torch.randn(*s, dtype=torch.bfloat16) * 0.8)(Dc, H, D) * (Dc ** -0.5)),
            "w_o": _w((lambda *s: torch.randn(*s, dtype=torch.bfloat16) * 0.8)(H, D, M) * ((H * D) ** -0.5)),
        }
    _A_in = _A_setup()

    def _B_setup():
        B, S, D, F, C = 1, 2048, 576, 4608, 1
        return {
            "x": _w((lambda *s: torch.randn(*s, dtype=torch.bfloat16) * 0.05)(B, S, D)),
            "w_r": _w((lambda *s: torch.randn(*s, dtype=torch.bfloat16) * 3.2)(D)),
            "w_gate": _w((lambda *s: torch.randn(*s, dtype=torch.bfloat16) * 0.2)(D, F)),
            "w_up": _w((lambda *s: torch.randn(*s, dtype=torch.bfloat16) * 0.2)(D, F)),
            "w_down": _w((lambda *s: torch.randn(*s, dtype=torch.bfloat16) * 0.2)(F, D)),
        }
    _B_in = _B_setup()

    return {
        "A_x": _A_in["x"],
        "A_c_kv": _A_in["c_kv"],
        "A_w_q": _A_in["w_q"],
        "A_w_uk": _A_in["w_uk"],
        "A_w_uv": _A_in["w_uv"],
        "A_w_o": _A_in["w_o"],
        "B_x": _B_in["x"],
        "B_w_r": _B_in["w_r"],
        "B_w_gate": _B_in["w_gate"],
        "B_w_up": _B_in["w_up"],
        "B_w_down": _B_in["w_down"],
        "gate_w": _w((lambda *s: torch.randn(*s, dtype=torch.bfloat16) * 0.05)(576) * 16.0),
    }

def reference(A_x, A_c_kv, A_w_q, A_w_uk, A_w_uv, A_w_o, B_x, B_w_r, B_w_gate, B_w_up, B_w_down, gate_w):
    def _A_ref(x, c_kv, w_q, w_uk, w_uv, w_o):
        B, Sq, M = x.shape[0], x.shape[1], x.shape[2]
        Sk = c_kv.shape[1]
        H, D = w_q.shape[1], w_q.shape[2]
        q = torch.einsum("bqm,mhd->bhqd", x, w_q)
        k = torch.einsum("bkc,chd->bhkd", c_kv, w_uk)
        v = torch.einsum("bkc,chd->bhkd", c_kv, w_uv)
        scores = torch.einsum("bhqd,bhkd->bhqk", q, k) * (D ** -0.5)
        off = Sk - Sq
        qi = torch.arange(Sq)[:, None]
        kj = torch.arange(Sk)[None, :]
        cmask = kj <= (qi + off)
        scores = torch.where(cmask[None, None], scores, -1e9)
        p = _softmax(scores, axis=-1)
        ctx = torch.einsum("bhqk,bhkd->bhqd", p, v)
        return torch.einsum("bhqd,hdm->bqm", ctx, w_o)

    def _B_ref(x, w_r, w_gate, w_up, w_down):
        B, S, D = x.shape
        C = 1
        r = x @ w_r
        idx = torch.argsort(-r, axis=-1)[:, :C]
        idx_e = (lambda x, n, axis: torch.repeat_interleave(x, n, dim=axis))(idx.reshape(B, C, 1), D, axis=2)
        x_sel = (lambda x, i, axis: torch.take_along_dim(x, i, dim=axis))(x, idx_e, axis=1)
        g = _silu(x_sel @ w_gate)
        u = x_sel @ w_up
        y = (g * u) @ w_down
        r_sel = _sigmoid((lambda x, i, axis: torch.take_along_dim(x, i, dim=axis))(r, idx, axis=1))
        y = y * r_sel.reshape(B, C, 1)
        b_off = (torch.arange(B) * S).reshape(B, 1)
        flat_idx = (idx + b_off).reshape(B * C)
        zero = (x * 0.0).reshape(B * S, D)
        upd = _scatter_add(zero, flat_idx, y.reshape(B * C, D), axis=0)
        return x + upd.reshape(B, S, D)

    x = A_x
    g = _sigmoid((x * gate_w).sum(-1, keepdims=True))
    a = _A_ref(x, A_c_kv, A_w_q, A_w_uk, A_w_uv, A_w_o)
    b = _B_ref(x, B_w_r, B_w_gate, B_w_up, B_w_down)
    return g * a + (1 - g) * b
```

```asm
; @launch grid=(256,1,1) block=(256,1,1) lds=163840
.amdgcn_target "amdgcn-amd-amdhsa--gfx950"
.text
.globl gated_mix__compressed_kv_cla__moe_arch_mod__prompt_kernel
.p2align 8
.type gated_mix__compressed_kv_cla__moe_arch_mod__prompt_kernel,@function
gated_mix__compressed_kv_cla__moe_arch_mod__prompt_kernel:
 s_cmp_ge_u32 s2, 256
 s_cbranch_scc1 L_end
 s_load_dwordx16 s[64:79], s[0:1], 0
 s_load_dwordx8 s[80:87], s[0:1], 64
 s_load_dwordx4 s[88:91], s[0:1], 96
 s_load_dwordx2 s[92:93], s[0:1], 112
 v_lshrrev_b32 v16, 6, v0
 v_and_b32 v23, 63, v0
 s_and_b32 s61, s2, 7
 v_readfirstlane_b32 s60, v16
 s_lshr_b32 s62, s2, 3
 s_and_b32 s62, s62, 3
 s_lshr_b32 s63, s2, 5
 s_lshl_b32 s3, s61, 2
 s_add_u32 s3, s3, s62
 v_lshlrev_b32 v14, 4, v23
 s_mov_b32 s6, 73400320
 s_mov_b32 s7, 0x20000
 s_mov_b32 s10, 2359296
 s_mov_b32 s11, 0x20000
 s_mov_b32 s14, 2097152
 s_mov_b32 s15, 0x20000
 s_mov_b32 s18, 4194304
 s_mov_b32 s19, 0x20000
 s_mov_b32 s22, 4194304
 s_mov_b32 s23, 0x20000
 s_mov_b32 s26, 4718592
 s_mov_b32 s27, 0x20000
 s_mov_b32 s30, 4718592
 s_mov_b32 s31, 0x20000
 s_mov_b32 s34, 2359296
 s_mov_b32 s35, 0x20000
 s_mov_b32 s38, 256
 s_mov_b32 s39, 0x20000
 s_mov_b32 s42, 1152
 s_mov_b32 s43, 0x20000
 s_mov_b32 s46, 1152
 s_mov_b32 s47, 0x20000
 s_mov_b32 s50, 5308416
 s_mov_b32 s51, 0x20000
 s_mov_b32 s54, 5308416
 s_mov_b32 s55, 0x20000
 s_mov_b32 s58, 5308416
 s_mov_b32 s59, 0x20000
 v_lshrrev_b32 v24, 3, v23
 v_lshrrev_b32 v25, 4, v23
 v_and_b32 v26, 7, v23
 v_xor_b32 v26, v26, v25
 v_lshlrev_b32 v26, 4, v26
 s_lshl_b32 s94, s63, 15
 s_lshl_b32 s95, s60, 19
 s_add_u32 s94, s94, s95
 v_lshl_add_u32 v27, v24, 10, v26
 v_add_u32 v0, s94, v27
 v_xor_b32 v1, 64, v0
 v_bfe_u32 v27, v23, 1, 3
 v_xor_b32 v27, v27, v25
 v_lshlrev_b32 v27, 5, v27
 v_and_b32 v28, 1, v23
 v_lshl_add_u32 v27, v28, 4, v27
 v_lshl_add_u32 v27, v25, 13, v27
 s_lshl_b32 s94, s60, 17
 s_lshl_b32 s95, s3, 8
 s_add_u32 s94, s94, s95
 v_add_u32 v2, s94, v27
 v_xor_b32 v3, 0x80, v2
 s_lshl_b32 s94, s63, 7
 s_lshl_b32 s95, s60, 5
 s_add_u32 s94, s94, s95
 v_add_u32 v27, s94, v24
 v_mul_u32_u24 v27, 0x480, v27
 v_add_u32 v17, v27, v26
 v_xor_b32 v18, 64, v17
 s_waitcnt lgkmcnt(0)
 s_mov_b64 s[12:13], s[66:67]
 s_mov_b64 s[16:17], s[70:71]
 s_mov_b64 s[20:21], s[72:73]
 s_mov_b64 s[8:9], s[64:65]
 s_mov_b64 s[24:25], s[68:69]
 s_mov_b64 s[28:29], s[74:75]
 s_mov_b64 s[40:41], s[78:79]
 s_mov_b64 s[48:49], s[80:81]
 s_mov_b64 s[52:53], s[82:83]
 s_mov_b64 s[56:57], s[84:85]
 s_mov_b64 s[44:45], s[86:87]
 s_mov_b64 s[32:33], s[88:89]
 s_mov_b64 s[36:37], s[90:91]
 s_mov_b64 s[4:5], s[92:93]
 s_mov_b32 s64, 7168
 s_mov_b32 s65, 14336
 s_mov_b32 s66, 21504
 s_mov_b32 s67, 262144
 s_mov_b32 s68, 269312
 s_mov_b32 s69, 276480
 s_mov_b32 s70, 283648
 s_mov_b32 s71, 31744
 s_mov_b32 s72, 63488
 s_mov_b32 s73, 95232
 s_lshl_b32 s81, s60, 13
 s_lshl_b32 s82, s60, 12
 s_add_u32 m0, s81, 32768
 s_nop 0
 buffer_load_dwordx4 v0, s[12:15], 0 offen offset:0 lds
 buffer_load_dwordx4 v1, s[12:15], s64 offen offset:1024 lds
 buffer_load_dwordx4 v0, s[12:15], s65 offen offset:2048 lds
 buffer_load_dwordx4 v1, s[12:15], s66 offen offset:3072 lds
 s_add_u32 m0, s81, 36864
 s_nop 0
 buffer_load_dwordx4 v0, s[12:15], s67 offen offset:0 lds
 buffer_load_dwordx4 v1, s[12:15], s68 offen offset:1024 lds
 buffer_load_dwordx4 v0, s[12:15], s69 offen offset:2048 lds
 buffer_load_dwordx4 v1, s[12:15], s70 offen offset:3072 lds
 s_add_u32 m0, s82, 98304
 s_nop 0
 buffer_load_dwordx4 v2, s[16:19], 0 offen offset:0 lds
 buffer_load_dwordx4 v2, s[16:19], s71 offen offset:1024 lds
 buffer_load_dwordx4 v3, s[16:19], s72 offen offset:2048 lds
 buffer_load_dwordx4 v3, s[16:19], s73 offen offset:3072 lds
 s_add_u32 m0, s82, 114688
 s_nop 0
 buffer_load_dwordx4 v2, s[20:23], 0 offen offset:0 lds
 buffer_load_dwordx4 v2, s[20:23], s71 offen offset:1024 lds
 buffer_load_dwordx4 v3, s[20:23], s72 offen offset:2048 lds
 buffer_load_dwordx4 v3, s[20:23], s73 offen offset:3072 lds
 v_add_u32 v0, 0x80, v0
 v_add_u32 v1, 0x80, v1
 v_add_u32 v2, 0x80000, v2
 v_add_u32 v3, 0x80000, v3
 v_and_b32 v24, 31, v23
 v_lshlrev_b32 v24, 4, v24
 v_lshrrev_b32 v25, 5, v23
 s_lshl_b32 s94, s2, 3
 s_lshl_b32 s95, s60, 1
 s_add_u32 s94, s94, s95
 v_add_u32 v25, s94, v25
 v_mul_u32_u24 v27, 0x480, v25
 v_add_u32 v27, v27, v24
 v_cmp_gt_u32 vcc, 0x80, v24
 v_mov_b32 v26, 2147483632
 v_add_u32 v76, 0x400, v27
 v_cndmask_b32 v76, v26, v76, vcc
 buffer_load_dwordx4 v[28:31], v27, s[8:11], 0 offen
 buffer_load_dwordx4 v[32:35], v27, s[8:11], 0 offen offset:512
 buffer_load_dwordx4 v[36:39], v76, s[8:11], 0 offen
 buffer_load_dwordx4 v[40:43], v24, s[40:43], 0 offen offset:0
 buffer_load_dwordx4 v[44:47], v24, s[40:43], 0 offen offset:512
 buffer_load_dwordx4 v[48:51], v24, s[40:43], 0 offen offset:1024
 buffer_load_dwordx4 v[52:55], v24, s[44:47], 0 offen offset:0
 buffer_load_dwordx4 v[56:59], v24, s[44:47], 0 offen offset:512
 buffer_load_dwordx4 v[60:63], v24, s[44:47], 0 offen offset:1024
 s_getpc_b64 s[40:41]
L_pc:
 s_mov_b32 s42, L_end-L_pc
 s_lshr_b32 s94, s2, 3
 s_lshl_b32 s94, s94, 2
 s_add_u32 s94, s94, s60
 s_lshl_b32 s94, s94, 10
 v_min_u32 v64, 7, v23
 v_lshlrev_b32 v64, 7, v64
 buffer_load_dword a100, v64, s[40:43], s94 offen
 s_cmp_eq_u32 s60, 2
 s_cselect_b64 s[40:41], s[16:17], s[20:21]
 s_cmp_lt_u32 s60, 2
 s_cselect_b64 s[40:41], s[12:13], s[40:41]
 s_cselect_b32 s42, s14, s18
 s_mov_b32 s94, 0x80000
 s_cselect_b32 s89, 0x80, s94
 s_mov_b32 s88, s89
 s_lshl_b32 s94, s62, 1
 s_add_u32 s94, s94, s60
 s_lshl_b32 s94, s94, 3
 s_add_u32 s94, s94, s63
 s_lshl_b32 s94, s94, 15
 v_lshlrev_b32 v64, 10, v23
 v_add_u32 v64, s94, v64
 v_cmp_gt_u32 vcc, 32, v23
 v_bfe_u32 v65, v23, 1, 3
 v_lshlrev_b32 v65, 13, v65
 v_cndmask_b32 v64, v26, v64, vcc
 v_and_b32 v66, 1, v23
 v_lshl_add_u32 v65, v66, 7, v65
 v_cmp_gt_u32 vcc, 16, v23
 s_lshl_b32 s94, s63, 16
 s_lshl_b32 s95, s3, 8
 s_add_u32 s94, s94, s95
 v_add_u32 v65, s94, v65
 v_cndmask_b32 v65, v26, v65, vcc
 s_cmp_lt_u32 s60, 2
 s_cselect_b64 vcc, -1, 0
 v_cndmask_b32 v16, v65, v64, vcc
 buffer_load_dword a100, v16, s[40:43], s88 offen
 s_add_u32 s88, s88, s89
 buffer_load_dword a100, v16, s[40:43], s88 offen
 s_add_u32 s88, s88, s89
 v_and_b32 v64, 15, v23
 v_lshrrev_b32 v65, 4, v23
 v_bfe_u32 v66, v23, 1, 3
 v_xor_b32 v66, v66, v65
 v_lshlrev_b32 v66, 4, v66
 v_lshl_add_u32 v66, v64, 7, v66
 s_and_b32 s94, s60, 1
 s_lshl_b32 s94, s94, 12
 s_add_u32 s94, s94, 32768
 v_add_u32 v4, s94, v66
 v_xor_b32 v5, 64, v4
 v_add_u32 v20, s81, v66
 v_xor_b32 v21, 64, v20
 v_bfe_u32 v66, v23, 2, 2
 v_and_b32 v67, 1, v65
 v_lshl_add_u32 v67, v67, 2, v66
 v_lshl_add_u32 v68, v65, 3, v66
 v_lshlrev_b32 v68, 8, v68
 v_and_b32 v69, 3, v23
 v_lshl_add_u32 v68, v69, 3, v68
 s_lshr_b32 s94, s60, 1
 s_lshl_b32 s94, s94, 14
 s_add_u32 s94, s94, 98304
 v_add_u32 v68, s94, v68
 v_xor_b32 v69, 0, v67
 v_lshl_add_u32 v6, v69, 5, v68
 v_xor_b32 v69, 1, v67
 v_lshl_add_u32 v7, v69, 5, v68
 v_xor_b32 v69, 2, v67
 v_lshl_add_u32 v8, v69, 5, v68
 v_xor_b32 v69, 3, v67
 v_lshl_add_u32 v9, v69, 5, v68
 v_xor_b32 v69, 4, v67
 v_lshl_add_u32 v10, v69, 5, v68
 v_xor_b32 v69, 5, v67
 v_lshl_add_u32 v11, v69, 5, v68
 v_xor_b32 v69, 6, v67
 v_lshl_add_u32 v12, v69, 5, v68
 v_xor_b32 v69, 7, v67
 v_lshl_add_u32 v13, v69, 5, v68
 s_lshl_b32 s94, s63, 1
 s_sub_u32 s94, 15, s94
 s_mul_i32 s94, s94, 147456
 s_mov_b32 s74, 8192
 s_mov_b32 s75, 16384
 s_mov_b32 s76, 24576
 s_add_u32 s77, s94, 0
 s_add_u32 s78, s94, 8192
 s_add_u32 s79, s94, 16384
 s_add_u32 s80, s94, 24576
 s_getreg_b32 s0, hwreg(HW_REG_XCC_ID, 0, 4)
 s_or_b32 s0, s0, 0x80
 v_mov_b32 v19, s0
 v_mov_b32 v72, 0
 v_mov_b32 v73, 0
 v_mov_b32 v74, 0
 v_mov_b32 v75, 0
 s_lshl_b32 s94, s2, 6
 s_add_u32 s94, s94, 71368704
 v_lshlrev_b32 v70, 14, v23
 v_add_u32 v70, s94, v70
 s_cmp_eq_u32 s60, 0
 s_cselect_b32 s95, 7, 0
 v_cmp_gt_u32 vcc, s95, v23
 s_nop 1
 v_cndmask_b32 v70, v26, v70, vcc
 buffer_store_dword v72, v70, s[4:7], 0 offen sc1
 s_lshl_b32 s94, s2, 12
 s_lshl_b32 s95, s60, 10
 s_add_u32 s94, s94, s95
 s_add_u32 s94, s94, 71319552
 s_cmp_lt_u32 s2, 8
 s_cselect_b32 s94, s94, 2147483632
 v_add_u32 v71, s94, v14
 buffer_store_dwordx4 v[72:75], v71, s[4:7], 0 offen sc1
 s_add_u32 m0, s81, 65536
 s_nop 0
 buffer_load_dwordx4 v0, s[12:15], 0 offen offset:0 lds
 buffer_load_dwordx4 v1, s[12:15], s64 offen offset:1024 lds
 buffer_load_dwordx4 v0, s[12:15], s65 offen offset:2048 lds
 buffer_load_dwordx4 v1, s[12:15], s66 offen offset:3072 lds
 s_add_u32 m0, s81, 69632
 s_nop 0
 buffer_load_dwordx4 v0, s[12:15], s67 offen offset:0 lds
 buffer_load_dwordx4 v1, s[12:15], s68 offen offset:1024 lds
 buffer_load_dwordx4 v0, s[12:15], s69 offen offset:2048 lds
 buffer_load_dwordx4 v1, s[12:15], s70 offen offset:3072 lds
 s_add_u32 m0, s82, 131072
 s_nop 0
 s_waitcnt vmcnt(22)
 s_barrier
 ds_read_b64_tr_b16 a[160:161], v6 offset:0
 ds_read_b64_tr_b16 a[162:163], v6 offset:1024
 ds_read_b128 a[128:131], v4 offset:0
 ds_read_b64_tr_b16 a[164:165], v7 offset:0
 ds_read_b64_tr_b16 a[166:167], v7 offset:1024
 ds_read_b128 a[132:135], v4 offset:2048
 ds_read_b64_tr_b16 a[168:169], v8 offset:0
 ds_read_b64_tr_b16 a[170:171], v8 offset:1024
 ds_read_b128 a[136:139], v4 offset:8192
 ds_read_b64_tr_b16 a[172:173], v9 offset:0
 ds_read_b64_tr_b16 a[174:175], v9 offset:1024
 ds_read_b128 a[140:143], v4 offset:10240
 ds_read_b64_tr_b16 a[176:177], v10 offset:0
 ds_read_b64_tr_b16 a[178:179], v10 offset:1024
 ds_read_b128 a[144:147], v4 offset:16384
 ds_read_b64_tr_b16 a[180:181], v11 offset:0
 ds_read_b64_tr_b16 a[182:183], v11 offset:1024
 ds_read_b128 a[148:151], v4 offset:18432
 ds_read_b64_tr_b16 a[184:185], v12 offset:0
 ds_read_b64_tr_b16 a[186:187], v12 offset:1024
 ds_read_b128 a[152:155], v4 offset:24576
 ds_read_b64_tr_b16 a[188:189], v13 offset:0
 ds_read_b64_tr_b16 a[190:191], v13 offset:1024
 ds_read_b128 a[156:159], v4 offset:26624
 s_waitcnt vmcnt(13)
 v_mov_b32 v64, 0
 v_mov_b32 v65, 0
 v_dot2_f32_bf16 v64, v28, v40, v64
 v_dot2_f32_bf16 v65, v28, v52, v65
 v_dot2_f32_bf16 v64, v29, v41, v64
 v_dot2_f32_bf16 v65, v29, v53, v65
 v_dot2_f32_bf16 v64, v30, v42, v64
 v_dot2_f32_bf16 v65, v30, v54, v65
 v_dot2_f32_bf16 v64, v31, v43, v64
 v_dot2_f32_bf16 v65, v31, v55, v65
 v_dot2_f32_bf16 v64, v32, v44, v64
 v_dot2_f32_bf16 v65, v32, v56, v65
 v_dot2_f32_bf16 v64, v33, v45, v64
 v_dot2_f32_bf16 v65, v33, v57, v65
 v_dot2_f32_bf16 v64, v34, v46, v64
 v_dot2_f32_bf16 v65, v34, v58, v65
 v_dot2_f32_bf16 v64, v35, v47, v64
 v_dot2_f32_bf16 v65, v35, v59, v65
 v_dot2_f32_bf16 v64, v36, v48, v64
 v_dot2_f32_bf16 v65, v36, v60, v65
 v_dot2_f32_bf16 v64, v37, v49, v64
 v_dot2_f32_bf16 v65, v37, v61, v65
 v_dot2_f32_bf16 v64, v38, v50, v64
 v_dot2_f32_bf16 v65, v38, v62, v65
 v_dot2_f32_bf16 v64, v39, v51, v64
 v_dot2_f32_bf16 v65, v39, v63, v65
 s_nop 2
 v_add_f32_dpp v64, v64, v64 quad_perm:[1,0,3,2] row_mask:0xf bank_mask:0xf
 v_add_f32_dpp v65, v65, v65 quad_perm:[1,0,3,2] row_mask:0xf bank_mask:0xf
 s_nop 0
 v_add_f32_dpp v64, v64, v64 quad_perm:[2,3,0,1] row_mask:0xf bank_mask:0xf
 v_add_f32_dpp v65, v65, v65 quad_perm:[2,3,0,1] row_mask:0xf bank_mask:0xf
 s_nop 0
 v_add_f32_dpp v64, v64, v64 row_half_mirror row_mask:0xf bank_mask:0xf
 v_add_f32_dpp v65, v65, v65 row_half_mirror row_mask:0xf bank_mask:0xf
 s_nop 0
 v_add_f32_dpp v64, v64, v64 row_mirror row_mask:0xf bank_mask:0xf
 v_add_f32_dpp v65, v65, v65 row_mirror row_mask:0xf bank_mask:0xf
 v_mov_b32 v66, v64
 v_mov_b32 v67, v65
 s_nop 0
 v_permlane16_swap_b32 v64, v66
 v_permlane16_swap_b32 v65, v67
 v_add_f32 v64, v64, v66
 v_add_f32 v65, v65, v67
 v_mul_f32 v65, 0xbfb8aa3b, v65
 v_exp_f32 v65, v65
 v_ashrrev_i32 v66, 31, v64
 v_or_b32 v66, 0x80000000, v66
 v_xor_b32 v66, v66, v64
 v_add_f32 v65, 1.0, v65
 v_rcp_f32 v65, v65
 v_and_b32 v66, 0xfffff800, v66
 v_sub_u32 v67, 0x7ff, v25
 v_or_b32 v66, v66, v67
 v_mov_b32 v67, v66
 v_lshlrev_b32 v68, 2, v25
 v_add_u32 v68, 71303168, v68
 v_permlane32_swap_b32 v66, v67
 v_cmp_eq_u32 vcc, 0, v24
 v_max_u32 v66, v66, v67
 s_nop 0
 v_cndmask_b32 v68, v26, v68, vcc
 buffer_store_dword v65, v68, s[4:7], 0 offen sc1
 s_lshl_b32 s94, s2, 4
 s_lshl_b32 s95, s60, 2
 s_add_u32 s94, s94, s95
 s_add_u32 s94, s94, 71311360
 v_mov_b32 v69, s94
 v_cmp_eq_u32 vcc, 0, v23
 s_nop 1
 v_cndmask_b32 v69, v26, v69, vcc
 buffer_store_dword v66, v69, s[4:7], 0 offen sc1
 s_cmp_ge_u32 s60, 2
 s_cbranch_scc1 L_kv1
 s_waitcnt lgkmcnt(15)
 v_mfma_f32_16x16x32_bf16 v[24:27], a[160:163], a[128:131], 0
 buffer_load_dwordx4 v2, s[16:19], 0 offen offset:0 lds
 v_mfma_f32_16x16x32_bf16 a[120:123], a[160:163], a[132:135], 0
 v_mfma_f32_16x16x32_bf16 v[64:67], a[160:163], a[136:139], 0
 s_waitcnt lgkmcnt(12)
 ds_read_b64_tr_b16 a[224:225], v6 offset:8192
 v_mfma_f32_16x16x32_bf16 v[96:99], a[160:163], a[140:143], 0
 s_waitcnt lgkmcnt(10)
 v_mfma_f32_16x16x32_bf16 v[128:131], a[160:163], a[144:147], 0
 s_waitcnt lgkmcnt(7)
 buffer_load_dwordx4 v2, s[16:19], s71 offen offset:1024 lds
 v_mfma_f32_16x16x32_bf16 v[160:163], a[160:163], a[148:151], 0
 s_waitcnt lgkmcnt(4)
 ds_read_b64_tr_b16 a[226:227], v6 offset:9216
 v_mfma_f32_16x16x32_bf16 v[192:195], a[160:163], a[152:155], 0
 s_waitcnt lgkmcnt(2)
 v_mfma_f32_16x16x32_bf16 v[224:227], a[160:163], a[156:159], 0
 ds_read_b128 a[192:195], v5 offset:0
 v_mfma_f32_16x16x32_bf16 v[28:31], a[164:167], a[128:131], 0
 buffer_load_dwordx4 v3, s[16:19], s72 offen offset:2048 lds
 v_mfma_f32_16x16x32_bf16 a[124:127], a[164:167], a[132:135], 0
 v_mfma_f32_16x16x32_bf16 v[68:71], a[164:167], a[136:139], 0
 ds_read_b64_tr_b16 a[228:229], v7 offset:8192
 v_mfma_f32_16x16x32_bf16 v[100:103], a[164:167], a[140:143], 0
 v_mfma_f32_16x16x32_bf16 v[132:135], a[164:167], a[144:147], 0
 buffer_load_dwordx4 v3, s[16:19], s73 offen offset:3072 lds
 s_add_u32 m0, s82, 147456
 v_mfma_f32_16x16x32_bf16 v[164:167], a[164:167], a[148:151], 0
 ds_read_b64_tr_b16 a[230:231], v7 offset:9216
 v_mfma_f32_16x16x32_bf16 v[196:199], a[164:167], a[152:155], 0
 v_mfma_f32_16x16x32_bf16 v[228:231], a[164:167], a[156:159], 0
 ds_read_b128 a[196:199], v5 offset:2048
 v_mfma_f32_16x16x32_bf16 a[104:107], a[168:171], a[128:131], 0
 buffer_load_dwordx4 v2, s[20:23], 0 offen offset:0 lds
 v_mfma_f32_16x16x32_bf16 v[40:43], a[168:171], a[132:135], 0
 v_mfma_f32_16x16x32_bf16 v[72:75], a[168:171], a[136:139], 0
 ds_read_b64_tr_b16 a[232:233], v8 offset:8192
 v_mfma_f32_16x16x32_bf16 v[104:107], a[168:171], a[140:143], 0
 v_mfma_f32_16x16x32_bf16 v[136:139], a[168:171], a[144:147], 0
 buffer_load_dwordx4 v2, s[20:23], s71 offen offset:1024 lds
 v_mfma_f32_16x16x32_bf16 v[168:171], a[168:171], a[148:151], 0
 ds_read_b64_tr_b16 a[234:235], v8 offset:9216
 v_mfma_f32_16x16x32_bf16 v[200:203], a[168:171], a[152:155], 0
 v_mfma_f32_16x16x32_bf16 v[232:235], a[168:171], a[156:159], 0
 ds_read_b128 a[200:203], v5 offset:8192
 v_mfma_f32_16x16x32_bf16 a[108:111], a[172:175], a[128:131], 0
 buffer_load_dwordx4 v3, s[20:23], s72 offen offset:2048 lds
 v_mfma_f32_16x16x32_bf16 v[44:47], a[172:175], a[132:135], 0
 v_mfma_f32_16x16x32_bf16 v[76:79], a[172:175], a[136:139], 0
 ds_read_b64_tr_b16 a[236:237], v9 offset:8192
 v_mfma_f32_16x16x32_bf16 v[108:111], a[172:175], a[140:143], 0
 v_mfma_f32_16x16x32_bf16 v[140:143], a[172:175], a[144:147], 0
 buffer_load_dwordx4 v3, s[20:23], s73 offen offset:3072 lds
 v_mfma_f32_16x16x32_bf16 v[172:175], a[172:175], a[148:151], 0
 ds_read_b64_tr_b16 a[238:239], v9 offset:9216
 v_mfma_f32_16x16x32_bf16 v[204:207], a[172:175], a[152:155], 0
 v_mfma_f32_16x16x32_bf16 v[236:239], a[172:175], a[156:159], 0
 ds_read_b128 a[204:207], v5 offset:10240
 v_mfma_f32_16x16x32_bf16 a[112:115], a[176:179], a[128:131], 0
 buffer_load_dword a100, v16, s[40:43], s88 offen
 s_add_u32 s88, s88, s89
 v_add_u32 v0, 0x80, v0
 v_add_u32 v1, 0x80, v1
 v_mfma_f32_16x16x32_bf16 v[48:51], a[176:179], a[132:135], 0
 v_add_u32 v2, 0x80000, v2
 v_add_u32 v3, 0x80000, v3
 v_mfma_f32_16x16x32_bf16 v[80:83], a[176:179], a[136:139], 0
 ds_read_b64_tr_b16 a[240:241], v10 offset:8192
 v_mfma_f32_16x16x32_bf16 v[112:115], a[176:179], a[140:143], 0
 v_mfma_f32_16x16x32_bf16 v[144:147], a[176:179], a[144:147], 0
 ds_read_b64_tr_b16 a[242:243], v10 offset:9216
 v_mfma_f32_16x16x32_bf16 v[176:179], a[176:179], a[148:151], 0
 v_mfma_f32_16x16x32_bf16 v[208:211], a[176:179], a[152:155], 0
 ds_read_b128 a[208:211], v5 offset:16384
 v_mfma_f32_16x16x32_bf16 v[240:243], a[176:179], a[156:159], 0
 v_mfma_f32_16x16x32_bf16 a[116:119], a[180:183], a[128:131], 0
 ds_read_b64_tr_b16 a[244:245], v11 offset:8192
 v_mfma_f32_16x16x32_bf16 v[52:55], a[180:183], a[132:135], 0
 v_mfma_f32_16x16x32_bf16 v[84:87], a[180:183], a[136:139], 0
 ds_read_b64_tr_b16 a[246:247], v11 offset:9216
 v_mfma_f32_16x16x32_bf16 v[116:119], a[180:183], a[140:143], 0
 v_mfma_f32_16x16x32_bf16 v[148:151], a[180:183], a[144:147], 0
 ds_read_b128 a[212:215], v5 offset:18432
 v_mfma_f32_16x16x32_bf16 v[180:183], a[180:183], a[148:151], 0
 v_mfma_f32_16x16x32_bf16 v[212:215], a[180:183], a[152:155], 0
 ds_read_b64_tr_b16 a[248:249], v12 offset:8192
 v_mfma_f32_16x16x32_bf16 v[244:247], a[180:183], a[156:159], 0
 v_mfma_f32_16x16x32_bf16 v[32:35], a[184:187], a[128:131], 0
 ds_read_b64_tr_b16 a[250:251], v12 offset:9216
 v_mfma_f32_16x16x32_bf16 v[56:59], a[184:187], a[132:135], 0
 v_mfma_f32_16x16x32_bf16 v[88:91], a[184:187], a[136:139], 0
 ds_read_b128 a[216:219], v5 offset:24576
 v_mfma_f32_16x16x32_bf16 v[120:123], a[184:187], a[140:143], 0
 v_mfma_f32_16x16x32_bf16 v[152:155], a[184:187], a[144:147], 0
 ds_read_b64_tr_b16 a[252:253], v13 offset:8192
 v_mfma_f32_16x16x32_bf16 v[184:187], a[184:187], a[148:151], 0
 v_mfma_f32_16x16x32_bf16 v[216:219], a[184:187], a[152:155], 0
 ds_read_b64_tr_b16 a[254:255], v13 offset:9216
 v_mfma_f32_16x16x32_bf16 v[248:251], a[184:187], a[156:159], 0
 v_mfma_f32_16x16x32_bf16 v[36:39], a[188:191], a[128:131], 0
 ds_read_b128 a[220:223], v5 offset:26624
 v_mfma_f32_16x16x32_bf16 v[60:63], a[188:191], a[132:135], 0
 v_mfma_f32_16x16x32_bf16 v[92:95], a[188:191], a[136:139], 0
 v_mfma_f32_16x16x32_bf16 v[124:127], a[188:191], a[140:143], 0
 v_mfma_f32_16x16x32_bf16 v[156:159], a[188:191], a[144:147], 0
 v_mfma_f32_16x16x32_bf16 v[188:191], a[188:191], a[148:151], 0
 v_mfma_f32_16x16x32_bf16 v[220:223], a[188:191], a[152:155], 0
 v_mfma_f32_16x16x32_bf16 v[252:255], a[188:191], a[156:159], 0
 s_waitcnt lgkmcnt(15)
 v_mfma_f32_16x16x32_bf16 v[24:27], a[224:227], a[192:195], v[24:27]
 v_mfma_f32_16x16x32_bf16 a[120:123], a[224:227], a[196:199], a[120:123]
 v_mfma_f32_16x16x32_bf16 v[64:67], a[224:227], a[200:203], v[64:67]
 s_waitcnt lgkmcnt(12)
 v_mfma_f32_16x16x32_bf16 v[96:99], a[224:227], a[204:207], v[96:99]
 s_waitcnt lgkmcnt(9)
 v_mfma_f32_16x16x32_bf16 v[128:131], a[224:227], a[208:211], v[128:131]
 s_waitcnt lgkmcnt(6)
 v_mfma_f32_16x16x32_bf16 v[160:163], a[224:227], a[212:215], v[160:163]
 s_waitcnt lgkmcnt(3)
 v_mfma_f32_16x16x32_bf16 v[192:195], a[224:227], a[216:219], v[192:195]
 s_waitcnt lgkmcnt(0)
 v_mfma_f32_16x16x32_bf16 v[224:227], a[224:227], a[220:223], v[224:227]
 v_mfma_f32_16x16x32_bf16 v[28:31], a[228:231], a[192:195], v[28:31]
 v_mfma_f32_16x16x32_bf16 a[124:127], a[228:231], a[196:199], a[124:127]
 v_mfma_f32_16x16x32_bf16 v[68:71], a[228:231], a[200:203], v[68:71]
 v_mfma_f32_16x16x32_bf16 v[100:103], a[228:231], a[204:207], v[100:103]
 v_mfma_f32_16x16x32_bf16 v[132:135], a[228:231], a[208:211], v[132:135]
 v_mfma_f32_16x16x32_bf16 v[164:167], a[228:231], a[212:215], v[164:167]
 v_mfma_f32_16x16x32_bf16 v[196:199], a[228:231], a[216:219], v[196:199]
 v_mfma_f32_16x16x32_bf16 v[228:231], a[228:231], a[220:223], v[228:231]
 v_mfma_f32_16x16x32_bf16 a[104:107], a[232:235], a[192:195], a[104:107]
 v_mfma_f32_16x16x32_bf16 v[40:43], a[232:235], a[196:199], v[40:43]
 v_mfma_f32_16x16x32_bf16 v[72:75], a[232:235], a[200:203], v[72:75]
 v_mfma_f32_16x16x32_bf16 v[104:107], a[232:235], a[204:207], v[104:107]
 v_mfma_f32_16x16x32_bf16 v[136:139], a[232:235], a[208:211], v[136:139]
 v_mfma_f32_16x16x32_bf16 v[168:171], a[232:235], a[212:215], v[168:171]
 v_mfma_f32_16x16x32_bf16 v[200:203], a[232:235], a[216:219], v[200:203]
 v_mfma_f32_16x16x32_bf16 v[232:235], a[232:235], a[220:223], v[232:235]
 v_mfma_f32_16x16x32_bf16 a[108:111], a[236:239], a[192:195], a[108:111]
 s_waitcnt vmcnt(1) lgkmcnt(0)
 s_barrier
 v_mfma_f32_16x16x32_bf16 v[44:47], a[236:239], a[196:199], v[44:47]
 s_add_u32 m0, s81, 32768
 ds_read_b64_tr_b16 a[160:161], v6 offset:32768
 v_mfma_f32_16x16x32_bf16 v[76:79], a[236:239], a[200:203], v[76:79]
 buffer_load_dwordx4 v0, s[12:15], 0 offen offset:0 lds
 v_mfma_f32_16x16x32_bf16 v[108:111], a[236:239], a[204:207], v[108:111]
 ds_read_b64_tr_b16 a[162:163], v6 offset:33792
 v_mfma_f32_16x16x32_bf16 v[140:143], a[236:239], a[208:211], v[140:143]
 ds_read_b128 a[128:131], v4 offset:32768
 v_mfma_f32_16x16x32_bf16 v[172:175], a[236:239], a[212:215], v[172:175]
 ds_read_b64_tr_b16 a[164:165], v7 offset:32768
 v_mfma_f32_16x16x32_bf16 v[204:207], a[236:239], a[216:219], v[204:207]
 ds_read_b64_tr_b16 a[166:167], v7 offset:33792
 v_mfma_f32_16x16x32_bf16 v[236:239], a[236:239], a[220:223], v[236:239]
 buffer_load_dwordx4 v1, s[12:15], s64 offen offset:1024 lds
 v_mfma_f32_16x16x32_bf16 a[112:115], a[240:243], a[192:195], a[112:115]
 ds_read_b128 a[132:135], v4 offset:34816
 v_mfma_f32_16x16x32_bf16 v[48:51], a[240:243], a[196:199], v[48:51]
 ds_read_b64_tr_b16 a[168:169], v8 offset:32768
 v_mfma_f32_16x16x32_bf16 v[80:83], a[240:243], a[200:203], v[80:83]
 ds_read_b64_tr_b16 a[170:171], v8 offset:33792
 v_mfma_f32_16x16x32_bf16 v[112:115], a[240:243], a[204:207], v[112:115]
 ds_read_b128 a[136:139], v4 offset:40960
 v_mfma_f32_16x16x32_bf16 v[144:147], a[240:243], a[208:211], v[144:147]
 buffer_load_dwordx4 v0, s[12:15], s65 offen offset:2048 lds
 v_mfma_f32_16x16x32_bf16 v[176:179], a[240:243], a[212:215], v[176:179]
 ds_read_b64_tr_b16 a[172:173], v9 offset:32768
 v_mfma_f32_16x16x32_bf16 v[208:211], a[240:243], a[216:219], v[208:211]
 ds_read_b64_tr_b16 a[174:175], v9 offset:33792
 v_mfma_f32_16x16x32_bf16 v[240:243], a[240:243], a[220:223], v[240:243]
 ds_read_b128 a[140:143], v4 offset:43008
 v_mfma_f32_16x16x32_bf16 a[116:119], a[244:247], a[192:195], a[116:119]
 v_mfma_f32_16x16x32_bf16 v[52:55], a[244:247], a[196:199], v[52:55]
 buffer_load_dwordx4 v1, s[12:15], s66 offen offset:3072 lds
 s_add_u32 m0, s81, 36864
 v_mfma_f32_16x16x32_bf16 v[84:87], a[244:247], a[200:203], v[84:87]
 ds_read_b64_tr_b16 a[176:177], v10 offset:32768
 v_mfma_f32_16x16x32_bf16 v[116:119], a[244:247], a[204:207], v[116:119]
 ds_read_b64_tr_b16 a[178:179], v10 offset:33792
 v_mfma_f32_16x16x32_bf16 v[148:151], a[244:247], a[208:211], v[148:151]
 ds_read_b128 a[144:147], v4 offset:49152
 v_mfma_f32_16x16x32_bf16 v[180:183], a[244:247], a[212:215], v[180:183]
 ds_read_b64_tr_b16 a[180:181], v11 offset:32768
 v_mfma_f32_16x16x32_bf16 v[212:215], a[244:247], a[216:219], v[212:215]
 buffer_load_dwordx4 v0, s[12:15], s67 offen offset:0 lds
 v_mfma_f32_16x16x32_bf16 v[244:247], a[244:247], a[220:223], v[244:247]
 ds_read_b64_tr_b16 a[182:183], v11 offset:33792
 v_mfma_f32_16x16x32_bf16 v[32:35], a[248:251], a[192:195], v[32:35]
 ds_read_b128 a[148:151], v4 offset:51200
 v_mfma_f32_16x16x32_bf16 v[56:59], a[248:251], a[196:199], v[56:59]
 ds_read_b64_tr_b16 a[184:185], v12 offset:32768
 v_mfma_f32_16x16x32_bf16 v[88:91], a[248:251], a[200:203], v[88:91]
 ds_read_b64_tr_b16 a[186:187], v12 offset:33792
 v_mfma_f32_16x16x32_bf16 v[120:123], a[248:251], a[204:207], v[120:123]
 buffer_load_dwordx4 v1, s[12:15], s68 offen offset:1024 lds
 v_mfma_f32_16x16x32_bf16 v[152:155], a[248:251], a[208:211], v[152:155]
 ds_read_b128 a[152:155], v4 offset:57344
 v_mfma_f32_16x16x32_bf16 v[184:187], a[248:251], a[212:215], v[184:187]
 ds_read_b64_tr_b16 a[188:189], v13 offset:32768
 v_mfma_f32_16x16x32_bf16 v[216:219], a[248:251], a[216:219], v[216:219]
 ds_read_b64_tr_b16 a[190:191], v13 offset:33792
 v_mfma_f32_16x16x32_bf16 v[248:251], a[248:251], a[220:223], v[248:251]
 ds_read_b128 a[156:159], v4 offset:59392
 v_mfma_f32_16x16x32_bf16 v[36:39], a[252:255], a[192:195], v[36:39]
 buffer_load_dwordx4 v0, s[12:15], s69 offen offset:2048 lds
 v_mfma_f32_16x16x32_bf16 v[60:63], a[252:255], a[196:199], v[60:63]
 v_mfma_f32_16x16x32_bf16 v[92:95], a[252:255], a[200:203], v[92:95]
 v_mfma_f32_16x16x32_bf16 v[124:127], a[252:255], a[204:207], v[124:127]
 v_mfma_f32_16x16x32_bf16 v[156:159], a[252:255], a[208:211], v[156:159]
 v_mfma_f32_16x16x32_bf16 v[188:191], a[252:255], a[212:215], v[188:191]
 buffer_load_dwordx4 v1, s[12:15], s70 offen offset:3072 lds
 s_add_u32 m0, s82, 98304
 v_mfma_f32_16x16x32_bf16 v[220:223], a[252:255], a[216:219], v[220:223]
 v_mfma_f32_16x16x32_bf16 v[252:255], a[252:255], a[220:223], v[252:255]
 s_waitcnt lgkmcnt(15)
 v_mfma_f32_16x16x32_bf16 v[24:27], a[160:163], a[128:131], v[24:27]
 v_mfma_f32_16x16x32_bf16 a[120:123], a[160:163], a[132:135], a[120:123]
 v_mfma_f32_16x16x32_bf16 v[64:67], a[160:163], a[136:139], v[64:67]
 s_waitcnt lgkmcnt(12)
 buffer_load_dwordx4 v2, s[16:19], 0 offen offset:0 lds
 v_mfma_f32_16x16x32_bf16 v[96:99], a[160:163], a[140:143], v[96:99]
 s_waitcnt lgkmcnt(9)
 ds_read_b64_tr_b16 a[224:225], v6 offset:40960
 v_mfma_f32_16x16x32_bf16 v[128:131], a[160:163], a[144:147], v[128:131]
 s_waitcnt lgkmcnt(7)
 ds_read_b64_tr_b16 a[226:227], v6 offset:41984
 v_mfma_f32_16x16x32_bf16 v[160:163], a[160:163], a[148:151], v[160:163]
 s_waitcnt lgkmcnt(5)
 v_mfma_f32_16x16x32_bf16 v[192:195], a[160:163], a[152:155], v[192:195]
 s_waitcnt lgkmcnt(2)
 ds_read_b128 a[192:195], v5 offset:32768
 v_mfma_f32_16x16x32_bf16 v[224:227], a[160:163], a[156:159], v[224:227]
 buffer_load_dwordx4 v2, s[16:19], s71 offen offset:1024 lds
 v_mfma_f32_16x16x32_bf16 v[28:31], a[164:167], a[128:131], v[28:31]
 v_mfma_f32_16x16x32_bf16 a[124:127], a[164:167], a[132:135], a[124:127]
 ds_read_b64_tr_b16 a[228:229], v7 offset:40960
 v_mfma_f32_16x16x32_bf16 v[68:71], a[164:167], a[136:139], v[68:71]
 v_mfma_f32_16x16x32_bf16 v[100:103], a[164:167], a[140:143], v[100:103]
 ds_read_b64_tr_b16 a[230:231], v7 offset:41984
 v_mfma_f32_16x16x32_bf16 v[132:135], a[164:167], a[144:147], v[132:135]
 buffer_load_dwordx4 v3, s[16:19], s72 offen offset:2048 lds
 v_mfma_f32_16x16x32_bf16 v[164:167], a[164:167], a[148:151], v[164:167]
 v_mfma_f32_16x16x32_bf16 v[196:199], a[164:167], a[152:155], v[196:199]
 ds_read_b128 a[196:199], v5 offset:34816
 v_mfma_f32_16x16x32_bf16 v[228:231], a[164:167], a[156:159], v[228:231]
 v_mfma_f32_16x16x32_bf16 a[104:107], a[168:171], a[128:131], a[104:107]
 ds_read_b64_tr_b16 a[232:233], v8 offset:40960
 v_mfma_f32_16x16x32_bf16 v[40:43], a[168:171], a[132:135], v[40:43]
 buffer_load_dwordx4 v3, s[16:19], s73 offen offset:3072 lds
 s_add_u32 m0, s82, 114688
 v_mfma_f32_16x16x32_bf16 v[72:75], a[168:171], a[136:139], v[72:75]
 v_mfma_f32_16x16x32_bf16 v[104:107], a[168:171], a[140:143], v[104:107]
 ds_read_b64_tr_b16 a[234:235], v8 offset:41984
 v_mfma_f32_16x16x32_bf16 v[136:139], a[168:171], a[144:147], v[136:139]
 v_mfma_f32_16x16x32_bf16 v[168:171], a[168:171], a[148:151], v[168:171]
 ds_read_b128 a[200:203], v5 offset:40960
 v_mfma_f32_16x16x32_bf16 v[200:203], a[168:171], a[152:155], v[200:203]
 buffer_load_dwordx4 v2, s[20:23], 0 offen offset:0 lds
 v_mfma_f32_16x16x32_bf16 v[232:235], a[168:171], a[156:159], v[232:235]
 ds_read_b64_tr_b16 a[236:237], v9 offset:40960
 v_mfma_f32_16x16x32_bf16 a[108:111], a[172:175], a[128:131], a[108:111]
 v_mfma_f32_16x16x32_bf16 v[44:47], a[172:175], a[132:135], v[44:47]
 ds_read_b64_tr_b16 a[238:239], v9 offset:41984
 v_mfma_f32_16x16x32_bf16 v[76:79], a[172:175], a[136:139], v[76:79]
 v_mfma_f32_16x16x32_bf16 v[108:111], a[172:175], a[140:143], v[108:111]
 buffer_load_dwordx4 v2, s[20:23], s71 offen offset:1024 lds
 v_mfma_f32_16x16x32_bf16 v[140:143], a[172:175], a[144:147], v[140:143]
 ds_read_b128 a[204:207], v5 offset:43008
 v_mfma_f32_16x16x32_bf16 v[172:175], a[172:175], a[148:151], v[172:175]
 v_mfma_f32_16x16x32_bf16 v[204:207], a[172:175], a[152:155], v[204:207]
 ds_read_b64_tr_b16 a[240:241], v10 offset:40960
 v_mfma_f32_16x16x32_bf16 v[236:239], a[172:175], a[156:159], v[236:239]
 v_mfma_f32_16x16x32_bf16 a[112:115], a[176:179], a[128:131], a[112:115]
 buffer_load_dwordx4 v3, s[20:23], s72 offen offset:2048 lds
 v_mfma_f32_16x16x32_bf16 v[48:51], a[176:179], a[132:135], v[48:51]
 ds_read_b64_tr_b16 a[242:243], v10 offset:41984
 v_mfma_f32_16x16x32_bf16 v[80:83], a[176:179], a[136:139], v[80:83]
 v_mfma_f32_16x16x32_bf16 v[112:115], a[176:179], a[140:143], v[112:115]
 ds_read_b128 a[208:211], v5 offset:49152
 v_mfma_f32_16x16x32_bf16 v[144:147], a[176:179], a[144:147], v[144:147]
 v_mfma_f32_16x16x32_bf16 v[176:179], a[176:179], a[148:151], v[176:179]
 buffer_load_dwordx4 v3, s[20:23], s73 offen offset:3072 lds
 v_mfma_f32_16x16x32_bf16 v[208:211], a[176:179], a[152:155], v[208:211]
 ds_read_b64_tr_b16 a[244:245], v11 offset:40960
 v_mfma_f32_16x16x32_bf16 v[240:243], a[176:179], a[156:159], v[240:243]
 v_mfma_f32_16x16x32_bf16 a[116:119], a[180:183], a[128:131], a[116:119]
 ds_read_b64_tr_b16 a[246:247], v11 offset:41984
 v_mfma_f32_16x16x32_bf16 v[52:55], a[180:183], a[132:135], v[52:55]
 ds_read_b128 a[212:215], v5 offset:51200
 v_mfma_f32_16x16x32_bf16 v[84:87], a[180:183], a[136:139], v[84:87]
 v_add_u32 v0, 0x80, v0
 v_add_u32 v1, 0x80, v1
 v_mfma_f32_16x16x32_bf16 v[116:119], a[180:183], a[140:143], v[116:119]
 ds_read_b64_tr_b16 a[248:249], v12 offset:40960
 v_add_u32 v2, 0x80000, v2
 v_add_u32 v3, 0x80000, v3
 v_mfma_f32_16x16x32_bf16 v[148:151], a[180:183], a[144:147], v[148:151]
 v_mfma_f32_16x16x32_bf16 v[180:183], a[180:183], a[148:151], v[180:183]
 ds_read_b64_tr_b16 a[250:251], v12 offset:41984
 v_mfma_f32_16x16x32_bf16 v[212:215], a[180:183], a[152:155], v[212:215]
 v_mfma_f32_16x16x32_bf16 v[244:247], a[180:183], a[156:159], v[244:247]
 ds_read_b128 a[216:219], v5 offset:57344
 v_mfma_f32_16x16x32_bf16 v[32:35], a[184:187], a[128:131], v[32:35]
 s_add_u32 m0, s81, 0
 v_mfma_f32_16x16x32_bf16 v[56:59], a[184:187], a[132:135], v[56:59]
 buffer_load_dwordx4 v17, s[8:11], 0 offen offset:0 lds
 v_mfma_f32_16x16x32_bf16 v[88:91], a[184:187], a[136:139], v[88:91]
 ds_read_b64_tr_b16 a[252:253], v13 offset:40960
 v_mfma_f32_16x16x32_bf16 v[120:123], a[184:187], a[140:143], v[120:123]
 v_mfma_f32_16x16x32_bf16 v[152:155], a[184:187], a[144:147], v[152:155]
 ds_read_b64_tr_b16 a[254:255], v13 offset:41984
 v_mfma_f32_16x16x32_bf16 v[184:187], a[184:187], a[148:151], v[184:187]
 buffer_load_dwordx4 v18, s[8:11], s74 offen offset:1024 lds
 v_mfma_f32_16x16x32_bf16 v[216:219], a[184:187], a[152:155], v[216:219]
 v_mfma_f32_16x16x32_bf16 v[248:251], a[184:187], a[156:159], v[248:251]
 ds_read_b128 a[220:223], v5 offset:59392
 v_mfma_f32_16x16x32_bf16 v[36:39], a[188:191], a[128:131], v[36:39]
 v_mfma_f32_16x16x32_bf16 v[60:63], a[188:191], a[132:135], v[60:63]
 buffer_load_dwordx4 v17, s[8:11], s75 offen offset:2048 lds
 v_mfma_f32_16x16x32_bf16 v[92:95], a[188:191], a[136:139], v[92:95]
 v_mfma_f32_16x16x32_bf16 v[124:127], a[188:191], a[140:143], v[124:127]
 v_mfma_f32_16x16x32_bf16 v[156:159], a[188:191], a[144:147], v[156:159]
 v_mfma_f32_16x16x32_bf16 v[188:191], a[188:191], a[148:151], v[188:191]
 buffer_load_dwordx4 v18, s[8:11], s76 offen offset:3072 lds
 s_add_u32 m0, s81, 4096
 v_mfma_f32_16x16x32_bf16 v[220:223], a[188:191], a[152:155], v[220:223]
 v_mfma_f32_16x16x32_bf16 v[252:255], a[188:191], a[156:159], v[252:255]
 s_waitcnt lgkmcnt(15)
 v_mfma_f32_16x16x32_bf16 v[24:27], a[224:227], a[192:195], v[24:27]
 v_mfma_f32_16x16x32_bf16 a[120:123], a[224:227], a[196:199], a[120:123]
 buffer_load_dwordx4 v17, s[8:11], s77 offen offset:0 lds
 v_mfma_f32_16x16x32_bf16 v[64:67], a[224:227], a[200:203], v[64:67]
 s_waitcnt lgkmcnt(12)
 v_mfma_f32_16x16x32_bf16 v[96:99], a[224:227], a[204:207], v[96:99]
 s_waitcnt lgkmcnt(9)
 v_mfma_f32_16x16x32_bf16 v[128:131], a[224:227], a[208:211], v[128:131]
 s_waitcnt lgkmcnt(6)
 v_mfma_f32_16x16x32_bf16 v[160:163], a[224:227], a[212:215], v[160:163]
 s_waitcnt lgkmcnt(3)
 buffer_load_dwordx4 v18, s[8:11], s78 offen offset:1024 lds
 v_mfma_f32_16x16x32_bf16 v[192:195], a[224:227], a[216:219], v[192:195]
 s_waitcnt lgkmcnt(0)
 v_mfma_f32_16x16x32_bf16 v[224:227], a[224:227], a[220:223], v[224:227]
 v_mfma_f32_16x16x32_bf16 v[28:31], a[228:231], a[192:195], v[28:31]
 v_mfma_f32_16x16x32_bf16 a[124:127], a[228:231], a[196:199], a[124:127]
 buffer_load_dwordx4 v17, s[8:11], s79 offen offset:2048 lds
 v_mfma_f32_16x16x32_bf16 v[68:71], a[228:231], a[200:203], v[68:71]
 v_mfma_f32_16x16x32_bf16 v[100:103], a[228:231], a[204:207], v[100:103]
 v_mfma_f32_16x16x32_bf16 v[132:135], a[228:231], a[208:211], v[132:135]
 v_mfma_f32_16x16x32_bf16 v[164:167], a[228:231], a[212:215], v[164:167]
 buffer_load_dwordx4 v18, s[8:11], s80 offen offset:3072 lds
 v_mfma_f32_16x16x32_bf16 v[196:199], a[228:231], a[216:219], v[196:199]
 v_mfma_f32_16x16x32_bf16 v[228:231], a[228:231], a[220:223], v[228:231]
 v_mfma_f32_16x16x32_bf16 a[104:107], a[232:235], a[192:195], a[104:107]
 v_mfma_f32_16x16x32_bf16 v[40:43], a[232:235], a[196:199], v[40:43]
 buffer_load_dword a100, v16, s[40:43], s88 offen
 s_add_u32 s88, s88, s89
 v_add_u32 v17, 0x80, v17
 v_add_u32 v18, 0x80, v18
 v_mfma_f32_16x16x32_bf16 v[72:75], a[232:235], a[200:203], v[72:75]
 v_mfma_f32_16x16x32_bf16 v[104:107], a[232:235], a[204:207], v[104:107]
 v_mfma_f32_16x16x32_bf16 v[136:139], a[232:235], a[208:211], v[136:139]
 v_mfma_f32_16x16x32_bf16 v[168:171], a[232:235], a[212:215], v[168:171]
 v_mfma_f32_16x16x32_bf16 v[200:203], a[232:235], a[216:219], v[200:203]
 v_mfma_f32_16x16x32_bf16 v[232:235], a[232:235], a[220:223], v[232:235]
 v_mfma_f32_16x16x32_bf16 a[108:111], a[236:239], a[192:195], a[108:111]
 s_waitcnt vmcnt(9) lgkmcnt(0)
 s_barrier
 v_mfma_f32_16x16x32_bf16 v[44:47], a[236:239], a[196:199], v[44:47]
 s_add_u32 m0, s81, 65536
 ds_read_b64_tr_b16 a[160:161], v6 offset:0
 v_mfma_f32_16x16x32_bf16 v[76:79], a[236:239], a[200:203], v[76:79]
 buffer_load_dwordx4 v0, s[12:15], 0 offen offset:0 lds
 v_mfma_f32_16x16x32_bf16 v[108:111], a[236:239], a[204:207], v[108:111]
 ds_read_b64_tr_b16 a[162:163], v6 offset:1024
 v_mfma_f32_16x16x32_bf16 v[140:143], a[236:239], a[208:211], v[140:143]
 ds_read_b128 a[128:131], v4 offset:0
 v_mfma_f32_16x16x32_bf16 v[172:175], a[236:239], a[212:215], v[172:175]
 ds_read_b64_tr_b16 a[164:165], v7 offset:0
 v_mfma_f32_16x16x32_bf16 v[204:207], a[236:239], a[216:219], v[204:207]
 ds_read_b64_tr_b16 a[166:167], v7 offset:1024
 v_mfma_f32_16x16x32_bf16 v[236:239], a[236:239], a[220:223], v[236:239]
 buffer_load_dwordx4 v1, s[12:15], s64 offen offset:1024 lds
 v_mfma_f32_16x16x32_bf16 a[112:115], a[240:243], a[192:195], a[112:115]
 ds_read_b128 a[132:135], v4 offset:2048
 v_mfma_f32_16x16x32_bf16 v[48:51], a[240:243], a[196:199], v[48:51]
 ds_read_b64_tr_b16 a[168:169], v8 offset:0
 v_mfma_f32_16x16x32_bf16 v[80:83], a[240:243], a[200:203], v[80:83]
 ds_read_b64_tr_b16 a[170:171], v8 offset:1024
 v_mfma_f32_16x16x32_bf16 v[112:115], a[240:243], a[204:207], v[112:115]
 ds_read_b128 a[136:139], v4 offset:8192
 v_mfma_f32_16x16x32_bf16 v[144:147], a[240:243], a[208:211], v[144:147]
 buffer_load_dwordx4 v0, s[12:15], s65 offen offset:2048 lds
 v_mfma_f32_16x16x32_bf16 v[176:179], a[240:243], a[212:215], v[176:179]
 ds_read_b64_tr_b16 a[172:173], v9 offset:0
 v_mfma_f32_16x16x32_bf16 v[208:211], a[240:243], a[216:219], v[208:211]
 ds_read_b64_tr_b16 a[174:175], v9 offset:1024
 v_mfma_f32_16x16x32_bf16 v[240:243], a[240:243], a[220:223], v[240:243]
 ds_read_b128 a[140:143], v4 offset:10240
 v_mfma_f32_16x16x32_bf16 a[116:119], a[244:247], a[192:195], a[116:119]
 v_mfma_f32_16x16x32_bf16 v[52:55], a[244:247], a[196:199], v[52:55]
 buffer_load_dwordx4 v1, s[12:15], s66 offen offset:3072 lds
 s_add_u32 m0, s81, 69632
 v_mfma_f32_16x16x32_bf16 v[84:87], a[244:247], a[200:203], v[84:87]
 ds_read_b64_tr_b16 a[176:177], v10 offset:0
 v_mfma_f32_16x16x32_bf16 v[116:119], a[244:247], a[204:207], v[116:119]
 ds_read_b64_tr_b16 a[178:179], v10 offset:1024
 v_mfma_f32_16x16x32_bf16 v[148:151], a[244:247], a[208:211], v[148:151]
 ds_read_b128 a[144:147], v4 offset:16384
 v_mfma_f32_16x16x32_bf16 v[180:183], a[244:247], a[212:215], v[180:183]
 ds_read_b64_tr_b16 a[180:181], v11 offset:0
 v_mfma_f32_16x16x32_bf16 v[212:215], a[244:247], a[216:219], v[212:215]
 buffer_load_dwordx4 v0, s[12:15], s67 offen offset:0 lds
 v_mfma_f32_16x16x32_bf16 v[244:247], a[244:247], a[220:223], v[244:247]
 ds_read_b64_tr_b16 a[182:183], v11 offset:1024
 v_mfma_f32_16x16x32_bf16 v[32:35], a[248:251], a[192:195], v[32:35]
 ds_read_b128 a[148:151], v4 offset:18432
 v_mfma_f32_16x16x32_bf16 v[56:59], a[248:251], a[196:199], v[56:59]
 ds_read_b64_tr_b16 a[184:185], v12 offset:0
 v_mfma_f32_16x16x32_bf16 v[88:91], a[248:251], a[200:203], v[88:91]
 ds_read_b64_tr_b16 a[186:187], v12 offset:1024
 v_mfma_f32_16x16x32_bf16 v[120:123], a[248:251], a[204:207], v[120:123]
 buffer_load_dwordx4 v1, s[12:15], s68 offen offset:1024 lds
 v_mfma_f32_16x16x32_bf16 v[152:155], a[248:251], a[208:211], v[152:155]
 ds_read_b128 a[152:155], v4 offset:24576
 v_mfma_f32_16x16x32_bf16 v[184:187], a[248:251], a[212:215], v[184:187]
 ds_read_b64_tr_b16 a[188:189], v13 offset:0
 v_mfma_f32_16x16x32_bf16 v[216:219], a[248:251], a[216:219], v[216:219]
 ds_read_b64_tr_b16 a[190:191], v13 offset:1024
 v_mfma_f32_16x16x32_bf16 v[248:251], a[248:251], a[220:223], v[248:251]
 ds_read_b128 a[156:159], v4 offset:26624
 v_mfma_f32_16x16x32_bf16 v[36:39], a[252:255], a[192:195], v[36:39]
 buffer_load_dwordx4 v0, s[12:15], s69 offen offset:2048 lds
 v_mfma_f32_16x16x32_bf16 v[60:63], a[252:255], a[196:199], v[60:63]
 v_mfma_f32_16x16x32_bf16 v[92:95], a[252:255], a[200:203], v[92:95]
 v_mfma_f32_16x16x32_bf16 v[124:127], a[252:255], a[204:207], v[124:127]
 v_mfma_f32_16x16x32_bf16 v[156:159], a[252:255], a[208:211], v[156:159]
 v_mfma_f32_16x16x32_bf16 v[188:191], a[252:255], a[212:215], v[188:191]
 buffer_load_dwordx4 v1, s[12:15], s70 offen offset:3072 lds
 s_add_u32 m0, s82, 131072
 v_mfma_f32_16x16x32_bf16 v[220:223], a[252:255], a[216:219], v[220:223]
 v_mfma_f32_16x16x32_bf16 v[252:255], a[252:255], a[220:223], v[252:255]
 s_waitcnt lgkmcnt(15)
 v_mfma_f32_16x16x32_bf16 v[24:27], a[160:163], a[128:131], v[24:27]
 v_mfma_f32_16x16x32_bf16 a[120:123], a[160:163], a[132:135], a[120:123]
 v_mfma_f32_16x16x32_bf16 v[64:67], a[160:163], a[136:139], v[64:67]
 s_waitcnt lgkmcnt(12)
 buffer_load_dwordx4 v2, s[16:19], 0 offen offset:0 lds
 v_mfma_f32_16x16x32_bf16 v[96:99], a[160:163], a[140:143], v[96:99]
 s_waitcnt lgkmcnt(9)
 ds_read_b64_tr_b16 a[224:225], v6 offset:8192
 v_mfma_f32_16x16x32_bf16 v[128:131], a[160:163], a[144:147], v[128:131]
 s_waitcnt lgkmcnt(7)
 ds_read_b64_tr_b16 a[226:227], v6 offset:9216
 v_mfma_f32_16x16x32_bf16 v[160:163], a[160:163], a[148:151], v[160:163]
 s_waitcnt lgkmcnt(5)
 v_mfma_f32_16x16x32_bf16 v[192:195], a[160:163], a[152:155], v[192:195]
 s_waitcnt lgkmcnt(2)
 ds_read_b128 a[192:195], v5 offset:0
 v_mfma_f32_16x16x32_bf16 v[224:227], a[160:163], a[156:159], v[224:227]
 buffer_load_dwordx4 v2, s[16:19], s71 offen offset:1024 lds
 v_mfma_f32_16x16x32_bf16 v[28:31], a[164:167], a[128:131], v[28:31]
 ds_read_b64_tr_b16 a[228:229], v7 offset:8192
 v_mfma_f32_16x16x32_bf16 a[124:127], a[164:167], a[132:135], a[124:127]
 v_mfma_f32_16x16x32_bf16 v[68:71], a[164:167], a[136:139], v[68:71]
 ds_read_b64_tr_b16 a[230:231], v7 offset:9216
 v_mfma_f32_16x16x32_bf16 v[100:103], a[164:167], a[140:143], v[100:103]
 ds_read_b128 a[196:199], v5 offset:2048
 v_mfma_f32_16x16x32_bf16 v[132:135], a[164:167], a[144:147], v[132:135]
 buffer_load_dwordx4 v3, s[16:19], s72 offen offset:2048 lds
 v_mfma_f32_16x16x32_bf16 v[164:167], a[164:167], a[148:151], v[164:167]
 v_mfma_f32_16x16x32_bf16 v[196:199], a[164:167], a[152:155], v[196:199]
 ds_read_b64_tr_b16 a[232:233], v8 offset:8192
 v_mfma_f32_16x16x32_bf16 v[228:231], a[164:167], a[156:159], v[228:231]
 ds_read_b64_tr_b16 a[234:235], v8 offset:9216
 v_mfma_f32_16x16x32_bf16 a[104:107], a[168:171], a[128:131], a[104:107]
 v_mfma_f32_16x16x32_bf16 v[40:43], a[168:171], a[132:135], v[40:43]
 buffer_load_dwordx4 v3, s[16:19], s73 offen offset:3072 lds
 s_add_u32 m0, s82, 147456
 v_mfma_f32_16x16x32_bf16 v[72:75], a[168:171], a[136:139], v[72:75]
 ds_read_b128 a[200:203], v5 offset:8192
 v_mfma_f32_16x16x32_bf16 v[104:107], a[168:171], a[140:143], v[104:107]
 ds_read_b64_tr_b16 a[236:237], v9 offset:8192
 v_mfma_f32_16x16x32_bf16 v[136:139], a[168:171], a[144:147], v[136:139]
 v_mfma_f32_16x16x32_bf16 v[168:171], a[168:171], a[148:151], v[168:171]
 ds_read_b64_tr_b16 a[238:239], v9 offset:9216
 v_mfma_f32_16x16x32_bf16 v[200:203], a[168:171], a[152:155], v[200:203]
 buffer_load_dwordx4 v2, s[20:23], 0 offen offset:0 lds
 v_mfma_f32_16x16x32_bf16 v[232:235], a[168:171], a[156:159], v[232:235]
 ds_read_b128 a[204:207], v5 offset:10240
 v_mfma_f32_16x16x32_bf16 a[108:111], a[172:175], a[128:131], a[108:111]
 v_mfma_f32_16x16x32_bf16 v[44:47], a[172:175], a[132:135], v[44:47]
 ds_read_b64_tr_b16 a[240:241], v10 offset:8192
 v_mfma_f32_16x16x32_bf16 v[76:79], a[172:175], a[136:139], v[76:79]
 v_mfma_f32_16x16x32_bf16 v[108:111], a[172:175], a[140:143], v[108:111]
 buffer_load_dwordx4 v2, s[20:23], s71 offen offset:1024 lds
 s_waitcnt vmcnt(15)
 v_mfma_f32_16x16x32_bf16 v[140:143], a[172:175], a[144:147], v[140:143]
 ds_read_b128 a[0:3], v20 offset:0
 v_mfma_f32_16x16x32_bf16 v[172:175], a[172:175], a[148:151], v[172:175]
 ds_read_b128 a[4:7], v20 offset:2048
 v_mfma_f32_16x16x32_bf16 v[204:207], a[172:175], a[152:155], v[204:207]
 ds_read_b64_tr_b16 a[242:243], v10 offset:9216
 v_mfma_f32_16x16x32_bf16 v[236:239], a[172:175], a[156:159], v[236:239]
 ds_read_b128 a[8:11], v20 offset:4096
 v_mfma_f32_16x16x32_bf16 a[112:115], a[176:179], a[128:131], a[112:115]
 buffer_load_dwordx4 v3, s[20:23], s72 offen offset:2048 lds
 v_mfma_f32_16x16x32_bf16 v[48:51], a[176:179], a[132:135], v[48:51]
 ds_read_b128 a[12:15], v20 offset:6144
 v_mfma_f32_16x16x32_bf16 v[80:83], a[176:179], a[136:139], v[80:83]
 ds_read_b128 a[208:211], v5 offset:16384
 v_mfma_f32_16x16x32_bf16 v[112:115], a[176:179], a[140:143], v[112:115]
 ds_read_b128 a[16:19], v21 offset:0
 v_mfma_f32_16x16x32_bf16 v[144:147], a[176:179], a[144:147], v[144:147]
 ds_read_b128 a[20:23], v21 offset:2048
 v_mfma_f32_16x16x32_bf16 v[176:179], a[176:179], a[148:151], v[176:179]
 buffer_load_dwordx4 v3, s[20:23], s73 offen offset:3072 lds
 v_mfma_f32_16x16x32_bf16 v[208:211], a[176:179], a[152:155], v[208:211]
 v_mfma_f32_16x16x32_bf16 v[240:243], a[176:179], a[156:159], v[240:243]
 ds_read_b128 a[24:27], v21 offset:4096
 v_mfma_f32_16x16x32_bf16 a[116:119], a[180:183], a[128:131], a[116:119]
 ds_read_b128 a[28:31], v21 offset:6144
 v_mfma_f32_16x16x32_bf16 v[52:55], a[180:183], a[132:135], v[52:55]
 ds_read_b64_tr_b16 a[244:245], v11 offset:8192
 v_mfma_f32_16x16x32_bf16 v[84:87], a[180:183], a[136:139], v[84:87]
 ds_read_b64_tr_b16 a[246:247], v11 offset:9216
 v_add_u32 v0, 0x80, v0
 v_add_u32 v1, 0x80, v1
 v_mfma_f32_16x16x32_bf16 v[116:119], a[180:183], a[140:143], v[116:119]
 v_add_u32 v2, 0x80000, v2
 v_add_u32 v3, 0x80000, v3
 v_mfma_f32_16x16x32_bf16 v[148:151], a[180:183], a[144:147], v[148:151]
 ds_read_b128 a[212:215], v5 offset:18432
 v_mfma_f32_16x16x32_bf16 v[180:183], a[180:183], a[148:151], v[180:183]
 ds_read_b64_tr_b16 a[248:249], v12 offset:8192
 v_mfma_f32_16x16x32_bf16 v[212:215], a[180:183], a[152:155], v[212:215]
 v_mfma_f32_16x16x32_bf16 v[244:247], a[180:183], a[156:159], v[244:247]
 s_waitcnt lgkmcnt(0)
 ds_read_b64_tr_b16 a[250:251], v12 offset:9216
 v_mfma_f32_16x16x32_bf16 v[32:35], a[184:187], a[128:131], v[32:35]
 s_add_u32 m0, s81, 0
 ds_read_b128 a[216:219], v5 offset:24576
 v_mfma_f32_16x16x32_bf16 v[56:59], a[184:187], a[132:135], v[56:59]
 buffer_load_dwordx4 v17, s[8:11], 0 offen offset:0 lds
 v_mfma_f32_16x16x32_bf16 v[88:91], a[184:187], a[136:139], v[88:91]
 v_mfma_f32_16x16x32_bf16 v[120:123], a[184:187], a[140:143], v[120:123]
 ds_read_b64_tr_b16 a[252:253], v13 offset:8192
 v_mfma_f32_16x16x32_bf16 v[152:155], a[184:187], a[144:147], v[152:155]
 ds_read_b64_tr_b16 a[254:255], v13 offset:9216
 v_mfma_f32_16x16x32_bf16 v[184:187], a[184:187], a[148:151], v[184:187]
 buffer_load_dwordx4 v18, s[8:11], s74 offen offset:1024 lds
 v_mfma_f32_16x16x32_bf16 v[216:219], a[184:187], a[152:155], v[216:219]
 v_mfma_f32_16x16x32_bf16 v[248:251], a[184:187], a[156:159], v[248:251]
 ds_read_b128 a[220:223], v5 offset:26624
 v_mfma_f32_16x16x32_bf16 v[36:39], a[188:191], a[128:131], v[36:39]
 v_mfma_f32_16x16x32_bf16 v[60:63], a[188:191], a[132:135], v[60:63]
 buffer_load_dwordx4 v17, s[8:11], s75 offen offset:2048 lds
 v_mfma_f32_16x16x32_bf16 v[92:95], a[188:191], a[136:139], v[92:95]
 v_mfma_f32_16x16x32_bf16 v[124:127], a[188:191], a[140:143], v[124:127]
 v_mfma_f32_16x16x32_bf16 v[156:159], a[188:191], a[144:147], v[156:159]
 v_mfma_f32_16x16x32_bf16 v[188:191], a[188:191], a[148:151], v[188:191]
 buffer_load_dwordx4 v18, s[8:11], s76 offen offset:3072 lds
 s_add_u32 m0, s81, 4096
 v_mfma_f32_16x16x32_bf16 v[220:223], a[188:191], a[152:155], v[220:223]
 v_mfma_f32_16x16x32_bf16 v[252:255], a[188:191], a[156:159], v[252:255]
 v_mfma_f32_16x16x32_bf16 v[24:27], a[224:227], a[192:195], v[24:27]
 v_mfma_f32_16x16x32_bf16 a[120:123], a[224:227], a[196:199], a[120:123]
 buffer_load_dwordx4 v17, s[8:11], s77 offen offset:0 lds
 v_mfma_f32_16x16x32_bf16 v[64:67], a[224:227], a[200:203], v[64:67]
 v_mfma_f32_16x16x32_bf16 v[96:99], a[224:227], a[204:207], v[96:99]
 v_mfma_f32_16x16x32_bf16 v[128:131], a[224:227], a[208:211], v[128:131]
 v_mfma_f32_16x16x32_bf16 v[160:163], a[224:227], a[212:215], v[160:163]
 s_waitcnt lgkmcnt(3)
 buffer_load_dwordx4 v18, s[8:11], s78 offen offset:1024 lds
 v_mfma_f32_16x16x32_bf16 v[192:195], a[224:227], a[216:219], v[192:195]
 s_waitcnt lgkmcnt(0)
 v_mfma_f32_16x16x32_bf16 v[224:227], a[224:227], a[220:223], v[224:227]
 v_mfma_f32_16x16x32_bf16 v[28:31], a[228:231], a[192:195], v[28:31]
 v_mfma_f32_16x16x32_bf16 a[124:127], a[228:231], a[196:199], a[124:127]
 buffer_load_dwordx4 v17, s[8:11], s79 offen offset:2048 lds
 v_mfma_f32_16x16x32_bf16 v[68:71], a[228:231], a[200:203], v[68:71]
 v_mfma_f32_16x16x32_bf16 v[100:103], a[228:231], a[204:207], v[100:103]
 v_mfma_f32_16x16x32_bf16 v[132:135], a[228:231], a[208:211], v[132:135]
 v_mfma_f32_16x16x32_bf16 v[164:167], a[228:231], a[212:215], v[164:167]
 buffer_load_dwordx4 v18, s[8:11], s80 offen offset:3072 lds
 v_mfma_f32_16x16x32_bf16 v[196:199], a[228:231], a[216:219], v[196:199]
 v_mfma_f32_16x16x32_bf16 v[228:231], a[228:231], a[220:223], v[228:231]
 v_mfma_f32_16x16x32_bf16 a[104:107], a[232:235], a[192:195], a[104:107]
 v_mfma_f32_16x16x32_bf16 v[40:43], a[232:235], a[196:199], v[40:43]
 buffer_load_dword a100, v16, s[40:43], s88 offen
 s_add_u32 s88, s88, s89
 v_add_u32 v17, 0x80, v17
 v_add_u32 v18, 0x80, v18
 v_mfma_f32_16x16x32_bf16 v[72:75], a[232:235], a[200:203], v[72:75]
 v_mfma_f32_16x16x32_bf16 v[104:107], a[232:235], a[204:207], v[104:107]
 s_lshr_b32 s94, s63, 1
 s_xor_b32 s94, s94, 0
 s_or_b32 s94, s94, s60
 s_cselect_b32 s94, 0x100000, s2
 v_lshl_add_u32 v15, v14, 4, s94
 v_mfma_f32_16x16x32_bf16 v[136:139], a[232:235], a[208:211], v[136:139]
 buffer_store_byte v19, v15, s[36:39], 0 offen sc1
 v_mfma_f32_16x16x32_bf16 v[168:171], a[232:235], a[212:215], v[168:171]
 v_mfma_f32_16x16x32_bf16 v[200:203], a[232:235], a[216:219], v[200:203]
 v_mfma_f32_16x16x32_bf16 v[232:235], a[232:235], a[220:223], v[232:235]
 v_mfma_f32_16x16x32_bf16 a[108:111], a[236:239], a[192:195], a[108:111]
 s_waitcnt vmcnt(10) lgkmcnt(0)
 s_barrier
 v_mfma_f32_16x16x32_bf16 v[44:47], a[236:239], a[196:199], v[44:47]
 s_add_u32 m0, s81, 32768
 ds_read_b64_tr_b16 a[160:161], v6 offset:32768
 v_mfma_f32_16x16x32_bf16 v[76:79], a[236:239], a[200:203], v[76:79]
 buffer_load_dwordx4 v0, s[12:15], 0 offen offset:0 lds
 v_mfma_f32_16x16x32_bf16 v[108:111], a[236:239], a[204:207], v[108:111]
 ds_read_b64_tr_b16 a[162:163], v6 offset:33792
 v_mfma_f32_16x16x32_bf16 v[140:143], a[236:239], a[208:211], v[140:143]
 ds_read_b128 a[128:131], v4 offset:32768
 v_mfma_f32_16x16x32_bf16 v[172:175], a[236:239], a[212:215], v[172:175]
 ds_read_b64_tr_b16 a[164:165], v7 offset:32768
 v_mfma_f32_16x16x32_bf16 v[204:207], a[236:239], a[216:219], v[204:207]
 ds_read_b64_tr_b16 a[166:167], v7 offset:33792
 v_mfma_f32_16x16x32_bf16 v[236:239], a[236:239], a[220:223], v[236:239]
 buffer_load_dwordx4 v1, s[12:15], s64 offen offset:1024 lds
 v_mfma_f32_16x16x32_bf16 a[112:115], a[240:243], a[192:195], a[112:115]
 ds_read_b128 a[132:135], v4 offset:34816
 v_mfma_f32_16x16x32_bf16 v[48:51], a[240:243], a[196:199], v[48:51]
 ds_read_b64_tr_b16 a[168:169], v8 offset:32768
 v_mfma_f32_16x16x32_bf16 v[80:83], a[240:243], a[200:203], v[80:83]
 ds_read_b64_tr_b16 a[170:171], v8 offset:33792
 v_mfma_f32_16x16x32_bf16 v[112:115], a[240:243], a[204:207], v[112:115]
 ds_read_b128 a[136:139], v4 offset:40960
 v_mfma_f32_16x16x32_bf16 v[144:147], a[240:243], a[208:211], v[144:147]
 buffer_load_dwordx4 v0, s[12:15], s65 offen offset:2048 lds
 v_mfma_f32_16x16x32_bf16 v[176:179], a[240:243], a[212:215], v[176:179]
 ds_read_b64_tr_b16 a[172:173], v9 offset:32768
 v_mfma_f32_16x16x32_bf16 v[208:211], a[240:243], a[216:219], v[208:211]
 ds_read_b64_tr_b16 a[174:175], v9 offset:33792
 v_mfma_f32_16x16x32_bf16 v[240:243], a[240:243], a[220:223], v[240:243]
 ds_read_b128 a[140:143], v4 offset:43008
 v_mfma_f32_16x16x32_bf16 a[116:119], a[244:247], a[192:195], a[116:119]
 v_mfma_f32_16x16x32_bf16 v[52:55], a[244:247], a[196:199], v[52:55]
 buffer_load_dwordx4 v1, s[12:15], s66 offen offset:3072 lds
 s_add_u32 m0, s81, 36864
 v_mfma_f32_16x16x32_bf16 v[84:87], a[244:247], a[200:203], v[84:87]
 ds_read_b64_tr_b16 a[176:177], v10 offset:32768
 v_mfma_f32_16x16x32_bf16 v[116:119], a[244:247], a[204:207], v[116:119]
 ds_read_b64_tr_b16 a[178:179], v10 offset:33792
 v_mfma_f32_16x16x32_bf16 v[148:151], a[244:247], a[208:211], v[148:151]
 ds_read_b128 a[144:147], v4 offset:49152
 v_mfma_f32_16x16x32_bf16 v[180:183], a[244:247], a[212:215], v[180:183]
 ds_read_b64_tr_b16 a[180:181], v11 offset:32768
 v_mfma_f32_16x16x32_bf16 v[212:215], a[244:247], a[216:219], v[212:215]
 buffer_load_dwordx4 v0, s[12:15], s67 offen offset:0 lds
 v_mfma_f32_16x16x32_bf16 v[244:247], a[244:247], a[220:223], v[244:247]
 ds_read_b64_tr_b16 a[182:183], v11 offset:33792
 v_mfma_f32_16x16x32_bf16 v[32:35], a[248:251], a[192:195], v[32:35]
 ds_read_b128 a[148:151], v4 offset:51200
 v_mfma_f32_16x16x32_bf16 v[56:59], a[248:251], a[196:199], v[56:59]
 ds_read_b64_tr_b16 a[184:185], v12 offset:32768
 v_mfma_f32_16x16x32_bf16 v[88:91], a[248:251], a[200:203], v[88:91]
 ds_read_b64_tr_b16 a[186:187], v12 offset:33792
 v_mfma_f32_16x16x32_bf16 v[120:123], a[248:251], a[204:207], v[120:123]
 buffer_load_dwordx4 v1, s[12:15], s68 offen offset:1024 lds
 v_mfma_f32_16x16x32_bf16 v[152:155], a[248:251], a[208:211], v[152:155]
 ds_read_b128 a[152:155], v4 offset:57344
 v_mfma_f32_16x16x32_bf16 v[184:187], a[248:251], a[212:215], v[184:187]
 ds_read_b64_tr_b16 a[188:189], v13 offset:32768
 v_mfma_f32_16x16x32_bf16 v[216:219], a[248:251], a[216:219], v[216:219]
 ds_read_b64_tr_b16 a[190:191], v13 offset:33792
 v_mfma_f32_16x16x32_bf16 v[248:251], a[248:251], a[220:223], v[248:251]
 ds_read_b128 a[156:159], v4 offset:59392
 v_mfma_f32_16x16x32_bf16 v[36:39], a[252:255], a[192:195], v[36:39]
 buffer_load_dwordx4 v0, s[12:15], s69 offen offset:2048 lds
 v_mfma_f32_16x16x32_bf16 v[60:63], a[252:255], a[196:199], v[60:63]
 v_mfma_f32_16x16x32_bf16 v[92:95], a[252:255], a[200:203], v[92:95]
 v_mfma_f32_16x16x32_bf16 v[124:127], a[252:255], a[204:207], v[124:127]
 v_mfma_f32_16x16x32_bf16 v[156:159], a[252:255], a[208:211], v[156:159]
 v_mfma_f32_16x16x32_bf16 v[188:191], a[252:255], a[212:215], v[188:191]
 buffer_load_dwordx4 v1, s[12:15], s70 offen offset:3072 lds
 s_add_u32 m0, s82, 98304
 v_mfma_f32_16x16x32_bf16 v[220:223], a[252:255], a[216:219], v[220:223]
 v_mfma_f32_16x16x32_bf16 v[252:255], a[252:255], a[220:223], v[252:255]
 s_waitcnt lgkmcnt(15)
 v_mfma_f32_16x16x32_bf16 v[24:27], a[160:163], a[128:131], v[24:27]
 v_mfma_f32_16x16x32_bf16 a[120:123], a[160:163], a[132:135], a[120:123]
 v_mfma_f32_16x16x32_bf16 v[64:67], a[160:163], a[136:139], v[64:67]
 s_waitcnt lgkmcnt(12)
 buffer_load_dwordx4 v2, s[16:19], 0 offen offset:0 lds
 v_mfma_f32_16x16x32_bf16 v[96:99], a[160:163], a[140:143], v[96:99]
 s_waitcnt lgkmcnt(9)
 ds_read_b64_tr_b16 a[224:225], v6 offset:40960
 v_mfma_f32_16x16x32_bf16 v[128:131], a[160:163], a[144:147], v[128:131]
 s_waitcnt lgkmcnt(7)
 ds_read_b64_tr_b16 a[226:227], v6 offset:41984
 v_mfma_f32_16x16x32_bf16 v[160:163], a[160:163], a[148:151], v[160:163]
 s_waitcnt lgkmcnt(5)
 v_mfma_f32_16x16x32_bf16 v[192:195], a[160:163], a[152:155], v[192:195]
 s_waitcnt lgkmcnt(2)
 ds_read_b128 a[192:195], v5 offset:32768
 v_mfma_f32_16x16x32_bf16 v[224:227], a[160:163], a[156:159], v[224:227]
 buffer_load_dwordx4 v2, s[16:19], s71 offen offset:1024 lds
 v_mfma_f32_16x16x32_bf16 v[28:31], a[164:167], a[128:131], v[28:31]
 ds_read_b64_tr_b16 a[228:229], v7 offset:40960
 v_mfma_f32_16x16x32_bf16 a[124:127], a[164:167], a[132:135], a[124:127]
 v_mfma_f32_16x16x32_bf16 v[68:71], a[164:167], a[136:139], v[68:71]
 ds_read_b64_tr_b16 a[230:231], v7 offset:41984
 v_mfma_f32_16x16x32_bf16 v[100:103], a[164:167], a[140:143], v[100:103]
 ds_read_b128 a[196:199], v5 offset:34816
 v_mfma_f32_16x16x32_bf16 v[132:135], a[164:167], a[144:147], v[132:135]
 buffer_load_dwordx4 v3, s[16:19], s72 offen offset:2048 lds
 v_mfma_f32_16x16x32_bf16 v[164:167], a[164:167], a[148:151], v[164:167]
 v_mfma_f32_16x16x32_bf16 v[196:199], a[164:167], a[152:155], v[196:199]
 ds_read_b64_tr_b16 a[232:233], v8 offset:40960
 v_mfma_f32_16x16x32_bf16 v[228:231], a[164:167], a[156:159], v[228:231]
 ds_read_b64_tr_b16 a[234:235], v8 offset:41984
 v_mfma_f32_16x16x32_bf16 a[104:107], a[168:171], a[128:131], a[104:107]
 v_mfma_f32_16x16x32_bf16 v[40:43], a[168:171], a[132:135], v[40:43]
 buffer_load_dwordx4 v3, s[16:19], s73 offen offset:3072 lds
 s_add_u32 m0, s82, 114688
 v_mfma_f32_16x16x32_bf16 v[72:75], a[168:171], a[136:139], v[72:75]
 ds_read_b128 a[200:203], v5 offset:40960
 v_mfma_f32_16x16x32_bf16 v[104:107], a[168:171], a[140:143], v[104:107]
 ds_read_b64_tr_b16 a[236:237], v9 offset:40960
 v_mfma_f32_16x16x32_bf16 v[136:139], a[168:171], a[144:147], v[136:139]
 v_mfma_f32_16x16x32_bf16 v[168:171], a[168:171], a[148:151], v[168:171]
 ds_read_b64_tr_b16 a[238:239], v9 offset:41984
 v_mfma_f32_16x16x32_bf16 v[200:203], a[168:171], a[152:155], v[200:203]
 buffer_load_dwordx4 v2, s[20:23], 0 offen offset:0 lds
 v_mfma_f32_16x16x32_bf16 v[232:235], a[168:171], a[156:159], v[232:235]
 ds_read_b128 a[204:207], v5 offset:43008
 v_mfma_f32_16x16x32_bf16 a[108:111], a[172:175], a[128:131], a[108:111]
 v_mfma_f32_16x16x32_bf16 v[44:47], a[172:175], a[132:135], v[44:47]
 ds_read_b64_tr_b16 a[240:241], v10 offset:40960
 v_mfma_f32_16x16x32_bf16 v[76:79], a[172:175], a[136:139], v[76:79]
 v_mfma_f32_16x16x32_bf16 v[108:111], a[172:175], a[140:143], v[108:111]
 buffer_load_dwordx4 v2, s[20:23], s71 offen offset:1024 lds
 s_waitcnt vmcnt(16)
 v_mfma_f32_16x16x32_bf16 v[140:143], a[172:175], a[144:147], v[140:143]
 ds_read_b128 a[32:35], v20 offset:0
 v_mfma_f32_16x16x32_bf16 v[172:175], a[172:175], a[148:151], v[172:175]
 ds_read_b128 a[36:39], v20 offset:2048
 v_mfma_f32_16x16x32_bf16 v[204:207], a[172:175], a[152:155], v[204:207]
 ds_read_b64_tr_b16 a[242:243], v10 offset:41984
 v_mfma_f32_16x16x32_bf16 v[236:239], a[172:175], a[156:159], v[236:239]
 ds_read_b128 a[40:43], v20 offset:4096
 v_mfma_f32_16x16x32_bf16 a[112:115], a[176:179], a[128:131], a[112:115]
 buffer_load_dwordx4 v3, s[20:23], s72 offen offset:2048 lds
 v_mfma_f32_16x16x32_bf16 v[48:51], a[176:179], a[132:135], v[48:51]
 ds_read_b128 a[44:47], v20 offset:6144
 v_mfma_f32_16x16x32_bf16 v[80:83], a[176:179], a[136:139], v[80:83]
 ds_read_b128 a[208:211], v5 offset:49152
 v_mfma_f32_16x16x32_bf16 v[112:115], a[176:179], a[140:143], v[112:115]
 ds_read_b128 a[48:51], v21 offset:0
 v_mfma_f32_16x16x32_bf16 v[144:147], a[176:179], a[144:147], v[144:147]
 ds_read_b128 a[52:55], v21 offset:2048
 v_mfma_f32_16x16x32_bf16 v[176:179], a[176:179], a[148:151], v[176:179]
 buffer_load_dwordx4 v3, s[20:23], s73 offen offset:3072 lds
 v_mfma_f32_16x16x32_bf16 v[208:211], a[176:179], a[152:155], v[208:211]
 v_mfma_f32_16x16x32_bf16 v[240:243], a[176:179], a[156:159], v[240:243]
 ds_read_b128 a[56:59], v21 offset:4096
 v_mfma_f32_16x16x32_bf16 a[116:119], a[180:183], a[128:131], a[116:119]
 ds_read_b128 a[60:63], v21 offset:6144
 v_mfma_f32_16x16x32_bf16 v[52:55], a[180:183], a[132:135], v[52:55]
 ds_read_b64_tr_b16 a[244:245], v11 offset:40960
 v_mfma_f32_16x16x32_bf16 v[84:87], a[180:183], a[136:139], v[84:87]
 ds_read_b64_tr_b16 a[246:247], v11 offset:41984
 v_add_u32 v0, 0x80, v0
 v_add_u32 v1, 0x80, v1
 v_mfma_f32_16x16x32_bf16 v[116:119], a[180:183], a[140:143], v[116:119]
 v_add_u32 v2, 0x80000, v2
 v_add_u32 v3, 0x80000, v3
 v_mfma_f32_16x16x32_bf16 v[148:151], a[180:183], a[144:147], v[148:151]
 ds_read_b128 a[212:215], v5 offset:51200
 v_mfma_f32_16x16x32_bf16 v[180:183], a[180:183], a[148:151], v[180:183]
 ds_read_b64_tr_b16 a[248:249], v12 offset:40960
 v_mfma_f32_16x16x32_bf16 v[212:215], a[180:183], a[152:155], v[212:215]
 v_mfma_f32_16x16x32_bf16 v[244:247], a[180:183], a[156:159], v[244:247]
 s_waitcnt lgkmcnt(0)
 ds_read_b64_tr_b16 a[250:251], v12 offset:41984
 v_mfma_f32_16x16x32_bf16 v[32:35], a[184:187], a[128:131], v[32:35]
 s_add_u32 m0, s81, 0
 ds_read_b128 a[216:219], v5 offset:57344
 v_mfma_f32_16x16x32_bf16 v[56:59], a[184:187], a[132:135], v[56:59]
 buffer_load_dwordx4 v17, s[8:11], 0 offen offset:0 lds
 v_mfma_f32_16x16x32_bf16 v[88:91], a[184:187], a[136:139], v[88:91]
 v_mfma_f32_16x16x32_bf16 v[120:123], a[184:187], a[140:143], v[120:123]
 ds_read_b64_tr_b16 a[252:253], v13 offset:40960
 v_mfma_f32_16x16x32_bf16 v[152:155], a[184:187], a[144:147], v[152:155]
 ds_read_b64_tr_b16 a[254:255], v13 offset:41984
 v_mfma_f32_16x16x32_bf16 v[184:187], a[184:187], a[148:151], v[184:187]
 buffer_load_dwordx4 v18, s[8:11], s74 offen offset:1024 lds
 v_mfma_f32_16x16x32_bf16 v[216:219], a[184:187], a[152:155], v[216:219]
 v_mfma_f32_16x16x32_bf16 v[248:251], a[184:187], a[156:159], v[248:251]
 ds_read_b128 a[220:223], v5 offset:59392
 v_mfma_f32_16x16x32_bf16 v[36:39], a[188:191], a[128:131], v[36:39]
 v_mfma_f32_16x16x32_bf16 v[60:63], a[188:191], a[132:135], v[60:63]
 buffer_load_dwordx4 v17, s[8:11], s75 offen offset:2048 lds
 v_mfma_f32_16x16x32_bf16 v[92:95], a[188:191], a[136:139], v[92:95]
 v_mfma_f32_16x16x32_bf16 v[124:127], a[188:191], a[140:143], v[124:127]
 v_mfma_f32_16x16x32_bf16 v[156:159], a[188:191], a[144:147], v[156:159]
 v_mfma_f32_16x16x32_bf16 v[188:191], a[188:191], a[148:151], v[188:191]
 buffer_load_dwordx4 v18, s[8:11], s76 offen offset:3072 lds
 s_add_u32 m0, s81, 4096
 v_mfma_f32_16x16x32_bf16 v[220:223], a[188:191], a[152:155], v[220:223]
 v_mfma_f32_16x16x32_bf16 v[252:255], a[188:191], a[156:159], v[252:255]
 v_mfma_f32_16x16x32_bf16 v[24:27], a[224:227], a[192:195], v[24:27]
 v_mfma_f32_16x16x32_bf16 a[120:123], a[224:227], a[196:199], a[120:123]
 buffer_load_dwordx4 v17, s[8:11], s77 offen offset:0 lds
 v_mfma_f32_16x16x32_bf16 v[64:67], a[224:227], a[200:203], v[64:67]
 v_mfma_f32_16x16x32_bf16 v[96:99], a[224:227], a[204:207], v[96:99]
 v_mfma_f32_16x16x32_bf16 v[128:131], a[224:227], a[208:211], v[128:131]
 v_mfma_f32_16x16x32_bf16 v[160:163], a[224:227], a[212:215], v[160:163]
 s_waitcnt lgkmcnt(3)
 buffer_load_dwordx4 v18, s[8:11], s78 offen offset:1024 lds
 v_mfma_f32_16x16x32_bf16 v[192:195], a[224:227], a[216:219], v[192:195]
 s_waitcnt lgkmcnt(0)
 v_mfma_f32_16x16x32_bf16 v[224:227], a[224:227], a[220:223], v[224:227]
 v_mfma_f32_16x16x32_bf16 v[28:31], a[228:231], a[192:195], v[28:31]
 v_mfma_f32_16x16x32_bf16 a[124:127], a[228:231], a[196:199], a[124:127]
 buffer_load_dwordx4 v17, s[8:11], s79 offen offset:2048 lds
 v_mfma_f32_16x16x32_bf16 v[68:71], a[228:231], a[200:203], v[68:71]
 v_mfma_f32_16x16x32_bf16 v[100:103], a[228:231], a[204:207], v[100:103]
 v_mfma_f32_16x16x32_bf16 v[132:135], a[228:231], a[208:211], v[132:135]
 v_mfma_f32_16x16x32_bf16 v[164:167], a[228:231], a[212:215], v[164:167]
 buffer_load_dwordx4 v18, s[8:11], s80 offen offset:3072 lds
 v_mfma_f32_16x16x32_bf16 v[196:199], a[228:231], a[216:219], v[196:199]
 v_mfma_f32_16x16x32_bf16 v[228:231], a[228:231], a[220:223], v[228:231]
 v_mfma_f32_16x16x32_bf16 a[104:107], a[232:235], a[192:195], a[104:107]
 v_mfma_f32_16x16x32_bf16 v[40:43], a[232:235], a[196:199], v[40:43]
 buffer_load_dword a100, v16, s[40:43], s88 offen
 s_add_u32 s88, s88, s89
 v_add_u32 v17, 0x80, v17
 v_add_u32 v18, 0x80, v18
 v_mfma_f32_16x16x32_bf16 v[72:75], a[232:235], a[200:203], v[72:75]
 v_mfma_f32_16x16x32_bf16 v[104:107], a[232:235], a[204:207], v[104:107]
 s_lshr_b32 s94, s63, 1
 s_xor_b32 s94, s94, 1
 s_or_b32 s94, s94, s60
 s_cselect_b32 s94, 0x100000, s2
 v_lshl_add_u32 v15, v14, 4, s94
 v_mfma_f32_16x16x32_bf16 v[136:139], a[232:235], a[208:211], v[136:139]
 buffer_store_byte v19, v15, s[36:39], 0 offen sc1
 v_mfma_f32_16x16x32_bf16 v[168:171], a[232:235], a[212:215], v[168:171]
 v_mfma_f32_16x16x32_bf16 v[200:203], a[232:235], a[216:219], v[200:203]
 v_mfma_f32_16x16x32_bf16 v[232:235], a[232:235], a[220:223], v[232:235]
 v_mfma_f32_16x16x32_bf16 a[108:111], a[236:239], a[192:195], a[108:111]
 s_waitcnt vmcnt(10) lgkmcnt(0)
 s_barrier
 v_mfma_f32_16x16x32_bf16 v[44:47], a[236:239], a[196:199], v[44:47]
 s_add_u32 m0, s81, 65536
 ds_read_b64_tr_b16 a[160:161], v6 offset:0
 v_mfma_f32_16x16x32_bf16 v[76:79], a[236:239], a[200:203], v[76:79]
 buffer_load_dwordx4 v0, s[12:15], 0 offen offset:0 lds
 v_mfma_f32_16x16x32_bf16 v[108:111], a[236:239], a[204:207], v[108:111]
 ds_read_b64_tr_b16 a[162:163], v6 offset:1024
 v_mfma_f32_16x16x32_bf16 v[140:143], a[236:239], a[208:211], v[140:143]
 ds_read_b128 a[128:131], v4 offset:0
 v_mfma_f32_16x16x32_bf16 v[172:175], a[236:239], a[212:215], v[172:175]
 ds_read_b64_tr_b16 a[164:165], v7 offset:0
 v_mfma_f32_16x16x32_bf16 v[204:207], a[236:239], a[216:219], v[204:207]
 ds_read_b64_tr_b16 a[166:167], v7 offset:1024
 v_mfma_f32_16x16x32_bf16 v[236:239], a[236:239], a[220:223], v[236:239]
 buffer_load_dwordx4 v1, s[12:15], s64 offen offset:1024 lds
 v_mfma_f32_16x16x32_bf16 a[112:115], a[240:243], a[192:195], a[112:115]
 ds_read_b128 a[132:135], v4 offset:2048
 v_mfma_f32_16x16x32_bf16 v[48:51], a[240:243], a[196:199], v[48:51]
 ds_read_b64_tr_b16 a[168:169], v8 offset:0
 v_mfma_f32_16x16x32_bf16 v[80:83], a[240:243], a[200:203], v[80:83]
 ds_read_b64_tr_b16 a[170:171], v8 offset:1024
 v_mfma_f32_16x16x32_bf16 v[112:115], a[240:243], a[204:207], v[112:115]
 ds_read_b128 a[136:139], v4 offset:8192
 v_mfma_f32_16x16x32_bf16 v[144:147], a[240:243], a[208:211], v[144:147]
 buffer_load_dwordx4 v0, s[12:15], s65 offen offset:2048 lds
 v_mfma_f32_16x16x32_bf16 v[176:179], a[240:243], a[212:215], v[176:179]
 ds_read_b64_tr_b16 a[172:173], v9 offset:0
 v_mfma_f32_16x16x32_bf16 v[208:211], a[240:243], a[216:219], v[208:211]
 ds_read_b64_tr_b16 a[174:175], v9 offset:1024
 v_mfma_f32_16x16x32_bf16 v[240:243], a[240:243], a[220:223], v[240:243]
 ds_read_b128 a[140:143], v4 offset:10240
 v_mfma_f32_16x16x32_bf16 a[116:119], a[244:247], a[192:195], a[116:119]
 v_mfma_f32_16x16x32_bf16 v[52:55], a[244:247], a[196:199], v[52:55]
 buffer_load_dwordx4 v1, s[12:15], s66 offen offset:3072 lds
 s_add_u32 m0, s81, 69632
 v_mfma_f32_16x16x32_bf16 v[84:87], a[244:247], a[200:203], v[84:87]
 ds_read_b64_tr_b16 a[176:177], v10 offset:0
 v_mfma_f32_16x16x32_bf16 v[116:119], a[244:247], a[204:207], v[116:119]
 ds_read_b64_tr_b16 a[178:179], v10 offset:1024
 v_mfma_f32_16x16x32_bf16 v[148:151], a[244:247], a[208:211], v[148:151]
 ds_read_b128 a[144:147], v4 offset:16384
 v_mfma_f32_16x16x32_bf16 v[180:183], a[244:247], a[212:215], v[180:183]
 ds_read_b64_tr_b16 a[180:181], v11 offset:0
 v_mfma_f32_16x16x32_bf16 v[212:215], a[244:247], a[216:219], v[212:215]
 buffer_load_dwordx4 v0, s[12:15], s67 offen offset:0 lds
 v_mfma_f32_16x16x32_bf16 v[244:247], a[244:247], a[220:223], v[244:247]
 ds_read_b64_tr_b16 a[182:183], v11 offset:1024
 v_mfma_f32_16x16x32_bf16 v[32:35], a[248:251], a[192:195], v[32:35]
 ds_read_b128 a[148:151], v4 offset:18432
 v_mfma_f32_16x16x32_bf16 v[56:59], a[248:251], a[196:199], v[56:59]
 ds_read_b64_tr_b16 a[184:185], v12 offset:0
 v_mfma_f32_16x16x32_bf16 v[88:91], a[248:251], a[200:203], v[88:91]
 ds_read_b64_tr_b16 a[186:187], v12 offset:1024
 v_mfma_f32_16x16x32_bf16 v[120:123], a[248:251], a[204:207], v[120:123]
 buffer_load_dwordx4 v1, s[12:15], s68 offen offset:1024 lds
 v_mfma_f32_16x16x32_bf16 v[152:155], a[248:251], a[208:211], v[152:155]
 ds_read_b128 a[152:155], v4 offset:24576
 v_mfma_f32_16x16x32_bf16 v[184:187], a[248:251], a[212:215], v[184:187]
 ds_read_b64_tr_b16 a[188:189], v13 offset:0
 v_mfma_f32_16x16x32_bf16 v[216:219], a[248:251], a[216:219], v[216:219]
 ds_read_b64_tr_b16 a[190:191], v13 offset:1024
 v_mfma_f32_16x16x32_bf16 v[248:251], a[248:251], a[220:223], v[248:251]
 ds_read_b128 a[156:159], v4 offset:26624
 v_mfma_f32_16x16x32_bf16 v[36:39], a[252:255], a[192:195], v[36:39]
 buffer_load_dwordx4 v0, s[12:15], s69 offen offset:2048 lds
 v_mfma_f32_16x16x32_bf16 v[60:63], a[252:255], a[196:199], v[60:63]
 v_mfma_f32_16x16x32_bf16 v[92:95], a[252:255], a[200:203], v[92:95]
 v_mfma_f32_16x16x32_bf16 v[124:127], a[252:255], a[204:207], v[124:127]
 v_mfma_f32_16x16x32_bf16 v[156:159], a[252:255], a[208:211], v[156:159]
 v_mfma_f32_16x16x32_bf16 v[188:191], a[252:255], a[212:215], v[188:191]
 buffer_load_dwordx4 v1, s[12:15], s70 offen offset:3072 lds
 s_add_u32 m0, s82, 131072
 v_mfma_f32_16x16x32_bf16 v[220:223], a[252:255], a[216:219], v[220:223]
 v_mfma_f32_16x16x32_bf16 v[252:255], a[252:255], a[220:223], v[252:255]
 s_waitcnt lgkmcnt(15)
 v_mfma_f32_16x16x32_bf16 v[24:27], a[160:163], a[128:131], v[24:27]
 v_mfma_f32_16x16x32_bf16 a[120:123], a[160:163], a[132:135], a[120:123]
 v_mfma_f32_16x16x32_bf16 v[64:67], a[160:163], a[136:139], v[64:67]
 s_waitcnt lgkmcnt(12)
 buffer_load_dwordx4 v2, s[16:19], 0 offen offset:0 lds
 v_mfma_f32_16x16x32_bf16 v[96:99], a[160:163], a[140:143], v[96:99]
 s_waitcnt lgkmcnt(9)
 ds_read_b64_tr_b16 a[224:225], v6 offset:8192
 v_mfma_f32_16x16x32_bf16 v[128:131], a[160:163], a[144:147], v[128:131]
 s_waitcnt lgkmcnt(7)
 ds_read_b64_tr_b16 a[226:227], v6 offset:9216
 v_mfma_f32_16x16x32_bf16 v[160:163], a[160:163], a[148:151], v[160:163]
 s_waitcnt lgkmcnt(5)
 v_mfma_f32_16x16x32_bf16 v[192:195], a[160:163], a[152:155], v[192:195]
 s_waitcnt lgkmcnt(2)
 ds_read_b128 a[192:195], v5 offset:0
 v_mfma_f32_16x16x32_bf16 v[224:227], a[160:163], a[156:159], v[224:227]
 buffer_load_dwordx4 v2, s[16:19], s71 offen offset:1024 lds
 v_mfma_f32_16x16x32_bf16 v[28:31], a[164:167], a[128:131], v[28:31]
 ds_read_b64_tr_b16 a[228:229], v7 offset:8192
 v_mfma_f32_16x16x32_bf16 a[124:127], a[164:167], a[132:135], a[124:127]
 v_mfma_f32_16x16x32_bf16 v[68:71], a[164:167], a[136:139], v[68:71]
 ds_read_b64_tr_b16 a[230:231], v7 offset:9216
 v_mfma_f32_16x16x32_bf16 v[100:103], a[164:167], a[140:143], v[100:103]
 ds_read_b128 a[196:199], v5 offset:2048
 v_mfma_f32_16x16x32_bf16 v[132:135], a[164:167], a[144:147], v[132:135]
 buffer_load_dwordx4 v3, s[16:19], s72 offen offset:2048 lds
 v_mfma_f32_16x16x32_bf16 v[164:167], a[164:167], a[148:151], v[164:167]
 v_mfma_f32_16x16x32_bf16 v[196:199], a[164:167], a[152:155], v[196:199]
 ds_read_b64_tr_b16 a[232:233], v8 offset:8192
 v_mfma_f32_16x16x32_bf16 v[228:231], a[164:167], a[156:159], v[228:231]
 ds_read_b64_tr_b16 a[234:235], v8 offset:9216
 v_mfma_f32_16x16x32_bf16 a[104:107], a[168:171], a[128:131], a[104:107]
 v_mfma_f32_16x16x32_bf16 v[40:43], a[168:171], a[132:135], v[40:43]
 buffer_load_dwordx4 v3, s[16:19], s73 offen offset:3072 lds
 s_add_u32 m0, s82, 147456
 v_mfma_f32_16x16x32_bf16 v[72:75], a[168:171], a[136:139], v[72:75]
 ds_read_b128 a[200:203], v5 offset:8192
 v_mfma_f32_16x16x32_bf16 v[104:107], a[168:171], a[140:143], v[104:107]
 ds_read_b64_tr_b16 a[236:237], v9 offset:8192
 v_mfma_f32_16x16x32_bf16 v[136:139], a[168:171], a[144:147], v[136:139]
 v_mfma_f32_16x16x32_bf16 v[168:171], a[168:171], a[148:151], v[168:171]
 ds_read_b64_tr_b16 a[238:239], v9 offset:9216
 v_mfma_f32_16x16x32_bf16 v[200:203], a[168:171], a[152:155], v[200:203]
 buffer_load_dwordx4 v2, s[20:23], 0 offen offset:0 lds
 v_mfma_f32_16x16x32_bf16 v[232:235], a[168:171], a[156:159], v[232:235]
 ds_read_b128 a[204:207], v5 offset:10240
 v_mfma_f32_16x16x32_bf16 a[108:111], a[172:175], a[128:131], a[108:111]
 v_mfma_f32_16x16x32_bf16 v[44:47], a[172:175], a[132:135], v[44:47]
 ds_read_b64_tr_b16 a[240:241], v10 offset:8192
 v_mfma_f32_16x16x32_bf16 v[76:79], a[172:175], a[136:139], v[76:79]
 v_mfma_f32_16x16x32_bf16 v[108:111], a[172:175], a[140:143], v[108:111]
 buffer_load_dwordx4 v2, s[20:23], s71 offen offset:1024 lds
 s_waitcnt vmcnt(16)
 v_mfma_f32_16x16x32_bf16 v[140:143], a[172:175], a[144:147], v[140:143]
 ds_read_b128 a[64:67], v20 offset:0
 v_mfma_f32_16x16x32_bf16 v[172:175], a[172:175], a[148:151], v[172:175]
 ds_read_b128 a[68:71], v20 offset:2048
 v_mfma_f32_16x16x32_bf16 v[204:207], a[172:175], a[152:155], v[204:207]
 ds_read_b64_tr_b16 a[242:243], v10 offset:9216
 v_mfma_f32_16x16x32_bf16 v[236:239], a[172:175], a[156:159], v[236:239]
 ds_read_b128 a[72:75], v20 offset:4096
 v_mfma_f32_16x16x32_bf16 a[112:115], a[176:179], a[128:131], a[112:115]
 buffer_load_dwordx4 v3, s[20:23], s72 offen offset:2048 lds
 v_mfma_f32_16x16x32_bf16 v[48:51], a[176:179], a[132:135], v[48:51]
 ds_read_b128 a[76:79], v20 offset:6144
 v_mfma_f32_16x16x32_bf16 v[80:83], a[176:179], a[136:139], v[80:83]
 ds_read_b128 a[208:211], v5 offset:16384
 v_mfma_f32_16x16x32_bf16 v[112:115], a[176:179], a[140:143], v[112:115]
 ds_read_b128 a[80:83], v21 offset:0
 v_mfma_f32_16x16x32_bf16 v[144:147], a[176:179], a[144:147], v[144:147]
 ds_read_b128 a[84:87], v21 offset:2048
 v_mfma_f32_16x16x32_bf16 v[176:179], a[176:179], a[148:151], v[176:179]
 buffer_load_dwordx4 v3, s[20:23], s73 offen offset:3072 lds
 v_mfma_f32_16x16x32_bf16 v[208:211], a[176:179], a[152:155], v[208:211]
 v_mfma_f32_16x16x32_bf16 v[240:243], a[176:179], a[156:159], v[240:243]
 ds_read_b128 a[88:91], v21 offset:4096
 v_mfma_f32_16x16x32_bf16 a[116:119], a[180:183], a[128:131], a[116:119]
 ds_read_b128 a[92:95], v21 offset:6144
 v_mfma_f32_16x16x32_bf16 v[52:55], a[180:183], a[132:135], v[52:55]
 ds_read_b64_tr_b16 a[244:245], v11 offset:8192
 v_mfma_f32_16x16x32_bf16 v[84:87], a[180:183], a[136:139], v[84:87]
 ds_read_b64_tr_b16 a[246:247], v11 offset:9216
 v_add_u32 v0, 0x80, v0
 v_add_u32 v1, 0x80, v1
 v_mfma_f32_16x16x32_bf16 v[116:119], a[180:183], a[140:143], v[116:119]
 v_add_u32 v2, 0x80000, v2
 v_add_u32 v3, 0x80000, v3
 v_mfma_f32_16x16x32_bf16 v[148:151], a[180:183], a[144:147], v[148:151]
 ds_read_b128 a[212:215], v5 offset:18432
 v_mfma_f32_16x16x32_bf16 v[180:183], a[180:183], a[148:151], v[180:183]
 ds_read_b64_tr_b16 a[248:249], v12 offset:8192
 v_mfma_f32_16x16x32_bf16 v[212:215], a[180:183], a[152:155], v[212:215]
 v_mfma_f32_16x16x32_bf16 v[244:247], a[180:183], a[156:159], v[244:247]
 s_waitcnt lgkmcnt(0)
 ds_read_b64_tr_b16 a[250:251], v12 offset:9216
 v_mfma_f32_16x16x32_bf16 v[32:35], a[184:187], a[128:131], v[32:35]
 s_add_u32 m0, s81, 0
 ds_read_b128 a[216:219], v5 offset:24576
 v_mfma_f32_16x16x32_bf16 v[56:59], a[184:187], a[132:135], v[56:59]
 buffer_load_dwordx4 v17, s[8:11], 0 offen offset:0 lds
 v_mfma_f32_16x16x32_bf16 v[88:91], a[184:187], a[136:139], v[88:91]
 v_mfma_f32_16x16x32_bf16 v[120:123], a[184:187], a[140:143], v[120:123]
 ds_read_b64_tr_b16 a[252:253], v13 offset:8192
 v_mfma_f32_16x16x32_bf16 v[152:155], a[184:187], a[144:147], v[152:155]
 ds_read_b64_tr_b16 a[254:255], v13 offset:9216
 v_mfma_f32_16x16x32_bf16 v[184:187], a[184:187], a[148:151], v[184:187]
 buffer_load_dwordx4 v18, s[8:11], s74 offen offset:1024 lds
 v_mfma_f32_16x16x32_bf16 v[216:219], a[184:187], a[152:155], v[216:219]
 v_mfma_f32_16x16x32_bf16 v[248:251], a[184:187], a[156:159], v[248:251]
 ds_read_b128 a[220:223], v5 offset:26624
 v_mfma_f32_16x16x32_bf16 v[36:39], a[188:191], a[128:131], v[36:39]
 v_mfma_f32_16x16x32_bf16 v[60:63], a[188:191], a[132:135], v[60:63]
 buffer_load_dwordx4 v17, s[8:11], s75 offen offset:2048 lds
 v_mfma_f32_16x16x32_bf16 v[92:95], a[188:191], a[136:139], v[92:95]
 v_mfma_f32_16x16x32_bf16 v[124:127], a[188:191], a[140:143], v[124:127]
 v_mfma_f32_16x16x32_bf16 v[156:159], a[188:191], a[144:147], v[156:159]
 v_mfma_f32_16x16x32_bf16 v[188:191], a[188:191], a[148:151], v[188:191]
 buffer_load_dwordx4 v18, s[8:11], s76 offen offset:3072 lds
 s_add_u32 m0, s81, 4096
 v_mfma_f32_16x16x32_bf16 v[220:223], a[188:191], a[152:155], v[220:223]
 v_mfma_f32_16x16x32_bf16 v[252:255], a[188:191], a[156:159], v[252:255]
 v_mfma_f32_16x16x32_bf16 v[24:27], a[224:227], a[192:195], v[24:27]
 v_mfma_f32_16x16x32_bf16 a[120:123], a[224:227], a[196:199], a[120:123]
 buffer_load_dwordx4 v17, s[8:11], s77 offen offset:0 lds
 v_mfma_f32_16x16x32_bf16 v[64:67], a[224:227], a[200:203], v[64:67]
 v_mfma_f32_16x16x32_bf16 v[96:99], a[224:227], a[204:207], v[96:99]
 v_mfma_f32_16x16x32_bf16 v[128:131], a[224:227], a[208:211], v[128:131]
 v_mfma_f32_16x16x32_bf16 v[160:163], a[224:227], a[212:215], v[160:163]
 s_waitcnt lgkmcnt(3)
 buffer_load_dwordx4 v18, s[8:11], s78 offen offset:1024 lds
 v_mfma_f32_16x16x32_bf16 v[192:195], a[224:227], a[216:219], v[192:195]
 s_waitcnt lgkmcnt(0)
 v_mfma_f32_16x16x32_bf16 v[224:227], a[224:227], a[220:223], v[224:227]
 v_mfma_f32_16x16x32_bf16 v[28:31], a[228:231], a[192:195], v[28:31]
 v_mfma_f32_16x16x32_bf16 a[124:127], a[228:231], a[196:199], a[124:127]
 buffer_load_dwordx4 v17, s[8:11], s79 offen offset:2048 lds
 v_mfma_f32_16x16x32_bf16 v[68:71], a[228:231], a[200:203], v[68:71]
 v_mfma_f32_16x16x32_bf16 v[100:103], a[228:231], a[204:207], v[100:103]
 v_mfma_f32_16x16x32_bf16 v[132:135], a[228:231], a[208:211], v[132:135]
 v_mfma_f32_16x16x32_bf16 v[164:167], a[228:231], a[212:215], v[164:167]
 buffer_load_dwordx4 v18, s[8:11], s80 offen offset:3072 lds
 v_mfma_f32_16x16x32_bf16 v[196:199], a[228:231], a[216:219], v[196:199]
 v_mfma_f32_16x16x32_bf16 v[228:231], a[228:231], a[220:223], v[228:231]
 v_mfma_f32_16x16x32_bf16 a[104:107], a[232:235], a[192:195], a[104:107]
 v_mfma_f32_16x16x32_bf16 v[40:43], a[232:235], a[196:199], v[40:43]
 buffer_load_dword a100, v16, s[40:43], s88 offen
 s_add_u32 s88, s88, s89
 v_add_u32 v17, 0x80, v17
 v_add_u32 v18, 0x80, v18
 v_mfma_f32_16x16x32_bf16 v[72:75], a[232:235], a[200:203], v[72:75]
 v_mfma_f32_16x16x32_bf16 v[104:107], a[232:235], a[204:207], v[104:107]
 s_lshr_b32 s94, s63, 1
 s_xor_b32 s94, s94, 2
 s_or_b32 s94, s94, s60
 s_cselect_b32 s94, 0x100000, s2
 v_lshl_add_u32 v15, v14, 4, s94
 v_mfma_f32_16x16x32_bf16 v[136:139], a[232:235], a[208:211], v[136:139]
 buffer_store_byte v19, v15, s[36:39], 0 offen sc1
 v_mfma_f32_16x16x32_bf16 v[168:171], a[232:235], a[212:215], v[168:171]
 v_mfma_f32_16x16x32_bf16 v[200:203], a[232:235], a[216:219], v[200:203]
 v_mfma_f32_16x16x32_bf16 v[232:235], a[232:235], a[220:223], v[232:235]
 v_mfma_f32_16x16x32_bf16 a[108:111], a[236:239], a[192:195], a[108:111]
 s_waitcnt vmcnt(10) lgkmcnt(0)
 s_barrier
 v_mfma_f32_16x16x32_bf16 v[44:47], a[236:239], a[196:199], v[44:47]
 s_add_u32 m0, s81, 32768
 ds_read_b64_tr_b16 a[160:161], v6 offset:32768
 v_mfma_f32_16x16x32_bf16 v[76:79], a[236:239], a[200:203], v[76:79]
 buffer_load_dwordx4 v0, s[12:15], 0 offen offset:0 lds
 v_mfma_f32_16x16x32_bf16 v[108:111], a[236:239], a[204:207], v[108:111]
 ds_read_b64_tr_b16 a[162:163], v6 offset:33792
 v_mfma_f32_16x16x32_bf16 v[140:143], a[236:239], a[208:211], v[140:143]
 ds_read_b128 a[128:131], v4 offset:32768
 v_mfma_f32_16x16x32_bf16 v[172:175], a[236:239], a[212:215], v[172:175]
 ds_read_b64_tr_b16 a[164:165], v7 offset:32768
 v_mfma_f32_16x16x32_bf16 v[204:207], a[236:239], a[216:219], v[204:207]
 ds_read_b64_tr_b16 a[166:167], v7 offset:33792
 v_mfma_f32_16x16x32_bf16 v[236:239], a[236:239], a[220:223], v[236:239]
 buffer_load_dwordx4 v1, s[12:15], s64 offen offset:1024 lds
 v_mfma_f32_16x16x32_bf16 a[112:115], a[240:243], a[192:195], a[112:115]
 ds_read_b128 a[132:135], v4 offset:34816
 v_mfma_f32_16x16x32_bf16 v[48:51], a[240:243], a[196:199], v[48:51]
 ds_read_b64_tr_b16 a[168:169], v8 offset:32768
 v_mfma_f32_16x16x32_bf16 v[80:83], a[240:243], a[200:203], v[80:83]
 ds_read_b64_tr_b16 a[170:171], v8 offset:33792
 v_mfma_f32_16x16x32_bf16 v[112:115], a[240:243], a[204:207], v[112:115]
 ds_read_b128 a[136:139], v4 offset:40960
 v_mfma_f32_16x16x32_bf16 v[144:147], a[240:243], a[208:211], v[144:147]
 buffer_load_dwordx4 v0, s[12:15], s65 offen offset:2048 lds
 v_mfma_f32_16x16x32_bf16 v[176:179], a[240:243], a[212:215], v[176:179]
 ds_read_b64_tr_b16 a[172:173], v9 offset:32768
 v_mfma_f32_16x16x32_bf16 v[208:211], a[240:243], a[216:219], v[208:211]
 ds_read_b64_tr_b16 a[174:175], v9 offset:33792
 v_mfma_f32_16x16x32_bf16 v[240:243], a[240:243], a[220:223], v[240:243]
 ds_read_b128 a[140:143], v4 offset:43008
 v_mfma_f32_16x16x32_bf16 a[116:119], a[244:247], a[192:195], a[116:119]
 v_mfma_f32_16x16x32_bf16 v[52:55], a[244:247], a[196:199], v[52:55]
 buffer_load_dwordx4 v1, s[12:15], s66 offen offset:3072 lds
 s_add_u32 m0, s81, 36864
 v_mfma_f32_16x16x32_bf16 v[84:87], a[244:247], a[200:203], v[84:87]
 ds_read_b64_tr_b16 a[176:177], v10 offset:32768
 v_mfma_f32_16x16x32_bf16 v[116:119], a[244:247], a[204:207], v[116:119]
 ds_read_b64_tr_b16 a[178:179], v10 offset:33792
 v_mfma_f32_16x16x32_bf16 v[148:151], a[244:247], a[208:211], v[148:151]
 ds_read_b128 a[144:147], v4 offset:49152
 v_mfma_f32_16x16x32_bf16 v[180:183], a[244:247], a[212:215], v[180:183]
 ds_read_b64_tr_b16 a[180:181], v11 offset:32768
 v_mfma_f32_16x16x32_bf16 v[212:215], a[244:247], a[216:219], v[212:215]
 buffer_load_dwordx4 v0, s[12:15], s67 offen offset:0 lds
 v_mfma_f32_16x16x32_bf16 v[244:247], a[244:247], a[220:223], v[244:247]
 ds_read_b64_tr_b16 a[182:183], v11 offset:33792
 v_mfma_f32_16x16x32_bf16 v[32:35], a[248:251], a[192:195], v[32:35]
 ds_read_b128 a[148:151], v4 offset:51200
 v_mfma_f32_16x16x32_bf16 v[56:59], a[248:251], a[196:199], v[56:59]
 ds_read_b64_tr_b16 a[184:185], v12 offset:32768
 v_mfma_f32_16x16x32_bf16 v[88:91], a[248:251], a[200:203], v[88:91]
 ds_read_b64_tr_b16 a[186:187], v12 offset:33792
 v_mfma_f32_16x16x32_bf16 v[120:123], a[248:251], a[204:207], v[120:123]
 buffer_load_dwordx4 v1, s[12:15], s68 offen offset:1024 lds
 v_mfma_f32_16x16x32_bf16 v[152:155], a[248:251], a[208:211], v[152:155]
 ds_read_b128 a[152:155], v4 offset:57344
 v_mfma_f32_16x16x32_bf16 v[184:187], a[248:251], a[212:215], v[184:187]
 ds_read_b64_tr_b16 a[188:189], v13 offset:32768
 v_mfma_f32_16x16x32_bf16 v[216:219], a[248:251], a[216:219], v[216:219]
 ds_read_b64_tr_b16 a[190:191], v13 offset:33792
 v_mfma_f32_16x16x32_bf16 v[248:251], a[248:251], a[220:223], v[248:251]
 ds_read_b128 a[156:159], v4 offset:59392
 v_mfma_f32_16x16x32_bf16 v[36:39], a[252:255], a[192:195], v[36:39]
 buffer_load_dwordx4 v0, s[12:15], s69 offen offset:2048 lds
 v_mfma_f32_16x16x32_bf16 v[60:63], a[252:255], a[196:199], v[60:63]
 v_mfma_f32_16x16x32_bf16 v[92:95], a[252:255], a[200:203], v[92:95]
 v_mfma_f32_16x16x32_bf16 v[124:127], a[252:255], a[204:207], v[124:127]
 v_mfma_f32_16x16x32_bf16 v[156:159], a[252:255], a[208:211], v[156:159]
 v_mfma_f32_16x16x32_bf16 v[188:191], a[252:255], a[212:215], v[188:191]
 buffer_load_dwordx4 v1, s[12:15], s70 offen offset:3072 lds
 s_add_u32 m0, s82, 98304
 v_mfma_f32_16x16x32_bf16 v[220:223], a[252:255], a[216:219], v[220:223]
 v_mfma_f32_16x16x32_bf16 v[252:255], a[252:255], a[220:223], v[252:255]
 s_waitcnt lgkmcnt(15)
 v_mfma_f32_16x16x32_bf16 v[24:27], a[160:163], a[128:131], v[24:27]
 v_mfma_f32_16x16x32_bf16 a[120:123], a[160:163], a[132:135], a[120:123]
 v_mfma_f32_16x16x32_bf16 v[64:67], a[160:163], a[136:139], v[64:67]
 s_waitcnt lgkmcnt(12)
 buffer_load_dwordx4 v2, s[16:19], 0 offen offset:0 lds
 v_mfma_f32_16x16x32_bf16 v[96:99], a[160:163], a[140:143], v[96:99]
 s_waitcnt lgkmcnt(9)
 ds_read_b64_tr_b16 a[224:225], v6 offset:40960
 v_mfma_f32_16x16x32_bf16 v[128:131], a[160:163], a[144:147], v[128:131]
 s_waitcnt lgkmcnt(7)
 ds_read_b64_tr_b16 a[226:227], v6 offset:41984
 v_mfma_f32_16x16x32_bf16 v[160:163], a[160:163], a[148:151], v[160:163]
 s_waitcnt lgkmcnt(5)
 v_mfma_f32_16x16x32_bf16 v[192:195], a[160:163], a[152:155], v[192:195]
 s_waitcnt lgkmcnt(2)
 ds_read_b128 a[192:195], v5 offset:32768
 v_mfma_f32_16x16x32_bf16 v[224:227], a[160:163], a[156:159], v[224:227]
 buffer_load_dwordx4 v2, s[16:19], s71 offen offset:1024 lds
 v_mfma_f32_16x16x32_bf16 v[28:31], a[164:167], a[128:131], v[28:31]
 v_mfma_f32_16x16x32_bf16 a[124:127], a[164:167], a[132:135], a[124:127]
 ds_read_b64_tr_b16 a[228:229], v7 offset:40960
 v_mfma_f32_16x16x32_bf16 v[68:71], a[164:167], a[136:139], v[68:71]
 v_mfma_f32_16x16x32_bf16 v[100:103], a[164:167], a[140:143], v[100:103]
 ds_read_b64_tr_b16 a[230:231], v7 offset:41984
 v_mfma_f32_16x16x32_bf16 v[132:135], a[164:167], a[144:147], v[132:135]
 buffer_load_dwordx4 v3, s[16:19], s72 offen offset:2048 lds
 v_mfma_f32_16x16x32_bf16 v[164:167], a[164:167], a[148:151], v[164:167]
 v_mfma_f32_16x16x32_bf16 v[196:199], a[164:167], a[152:155], v[196:199]
 ds_read_b128 a[196:199], v5 offset:34816
 v_mfma_f32_16x16x32_bf16 v[228:231], a[164:167], a[156:159], v[228:231]
 v_mfma_f32_16x16x32_bf16 a[104:107], a[168:171], a[128:131], a[104:107]
 ds_read_b64_tr_b16 a[232:233], v8 offset:40960
 v_mfma_f32_16x16x32_bf16 v[40:43], a[168:171], a[132:135], v[40:43]
 buffer_load_dwordx4 v3, s[16:19], s73 offen offset:3072 lds
 s_add_u32 m0, s82, 114688
 v_mfma_f32_16x16x32_bf16 v[72:75], a[168:171], a[136:139], v[72:75]
 v_mfma_f32_16x16x32_bf16 v[104:107], a[168:171], a[140:143], v[104:107]
 ds_read_b64_tr_b16 a[234:235], v8 offset:41984
 v_mfma_f32_16x16x32_bf16 v[136:139], a[168:171], a[144:147], v[136:139]
 v_mfma_f32_16x16x32_bf16 v[168:171], a[168:171], a[148:151], v[168:171]
 ds_read_b128 a[200:203], v5 offset:40960
 v_mfma_f32_16x16x32_bf16 v[200:203], a[168:171], a[152:155], v[200:203]
 buffer_load_dwordx4 v2, s[20:23], 0 offen offset:0 lds
 v_mfma_f32_16x16x32_bf16 v[232:235], a[168:171], a[156:159], v[232:235]
 v_mfma_f32_16x16x32_bf16 a[108:111], a[172:175], a[128:131], a[108:111]
 ds_read_b64_tr_b16 a[236:237], v9 offset:40960
 v_mfma_f32_16x16x32_bf16 v[44:47], a[172:175], a[132:135], v[44:47]
 v_mfma_f32_16x16x32_bf16 v[76:79], a[172:175], a[136:139], v[76:79]
 ds_read_b64_tr_b16 a[238:239], v9 offset:41984
 v_mfma_f32_16x16x32_bf16 v[108:111], a[172:175], a[140:143], v[108:111]
 buffer_load_dwordx4 v2, s[20:23], s71 offen offset:1024 lds
 v_mfma_f32_16x16x32_bf16 v[140:143], a[172:175], a[144:147], v[140:143]
 v_mfma_f32_16x16x32_bf16 v[172:175], a[172:175], a[148:151], v[172:175]
 ds_read_b128 a[204:207], v5 offset:43008
 v_mfma_f32_16x16x32_bf16 v[204:207], a[172:175], a[152:155], v[204:207]
 v_mfma_f32_16x16x32_bf16 v[236:239], a[172:175], a[156:159], v[236:239]
 ds_read_b64_tr_b16 a[240:241], v10 offset:40960
 v_mfma_f32_16x16x32_bf16 a[112:115], a[176:179], a[128:131], a[112:115]
 buffer_load_dwordx4 v3, s[20:23], s72 offen offset:2048 lds
 v_mfma_f32_16x16x32_bf16 v[48:51], a[176:179], a[132:135], v[48:51]
 ds_read_b64_tr_b16 a[242:243], v10 offset:41984
 v_mfma_f32_16x16x32_bf16 v[80:83], a[176:179], a[136:139], v[80:83]
 v_mfma_f32_16x16x32_bf16 v[112:115], a[176:179], a[140:143], v[112:115]
 ds_read_b128 a[208:211], v5 offset:49152
 v_mfma_f32_16x16x32_bf16 v[144:147], a[176:179], a[144:147], v[144:147]
 v_mfma_f32_16x16x32_bf16 v[176:179], a[176:179], a[148:151], v[176:179]
 buffer_load_dwordx4 v3, s[20:23], s73 offen offset:3072 lds
 v_mfma_f32_16x16x32_bf16 v[208:211], a[176:179], a[152:155], v[208:211]
 ds_read_b64_tr_b16 a[244:245], v11 offset:40960
 v_mfma_f32_16x16x32_bf16 v[240:243], a[176:179], a[156:159], v[240:243]
 v_mfma_f32_16x16x32_bf16 a[116:119], a[180:183], a[128:131], a[116:119]
 ds_read_b64_tr_b16 a[246:247], v11 offset:41984
 v_mfma_f32_16x16x32_bf16 v[52:55], a[180:183], a[132:135], v[52:55]
 s_lshr_b32 s94, s63, 1
 s_xor_b32 s94, s94, 3
 s_or_b32 s94, s94, s60
 s_cselect_b32 s94, 0x100000, s2
 v_lshl_add_u32 v15, v14, 4, s94
 v_mfma_f32_16x16x32_bf16 v[84:87], a[180:183], a[136:139], v[84:87]
 buffer_store_byte v19, v15, s[36:39], 0 offen sc1
 v_add_u32 v0, 0x80, v0
 v_add_u32 v1, 0x80, v1
 v_mfma_f32_16x16x32_bf16 v[116:119], a[180:183], a[140:143], v[116:119]
 ds_read_b128 a[212:215], v5 offset:51200
 v_add_u32 v2, 0x80000, v2
 v_add_u32 v3, 0x80000, v3
 v_mfma_f32_16x16x32_bf16 v[148:151], a[180:183], a[144:147], v[148:151]
 v_mfma_f32_16x16x32_bf16 v[180:183], a[180:183], a[148:151], v[180:183]
 ds_read_b64_tr_b16 a[248:249], v12 offset:40960
 v_mfma_f32_16x16x32_bf16 v[212:215], a[180:183], a[152:155], v[212:215]
 v_mfma_f32_16x16x32_bf16 v[244:247], a[180:183], a[156:159], v[244:247]
 s_lshl_b32 s94, s63, 1
 s_sub_u32 s94, 15, s94
 s_lshl_b32 s94, s94, 7
 s_sub_u32 s94, s94, 32
 v_lshrrev_b32 v22, 9, v14
 v_mul_u32_u24 v22, s94, v22
 ds_read_b64_tr_b16 a[250:251], v12 offset:41984
 v_mfma_f32_16x16x32_bf16 v[32:35], a[184:187], a[128:131], v[32:35]
 s_lshl_b32 s94, s63, 7
 s_lshl_b32 s95, s62, 5
 s_add_u32 s94, s94, s95
 v_lshl_add_u32 v22, v22, 4, v14
 v_lshrrev_b32 v22, 4, v22
 v_add_u32 v22, s94, v22
 v_mul_u32_u24 v22, 0x480, v22
 v_mfma_f32_16x16x32_bf16 v[56:59], a[184:187], a[132:135], v[56:59]
 s_lshl_b32 s95, s60, 7
 buffer_load_dword a101, v22, s[8:11], s95 offen offset:512
 v_mfma_f32_16x16x32_bf16 v[88:91], a[184:187], a[136:139], v[88:91]
 ds_read_b128 a[216:219], v5 offset:57344
 v_mfma_f32_16x16x32_bf16 v[120:123], a[184:187], a[140:143], v[120:123]
 v_mfma_f32_16x16x32_bf16 v[152:155], a[184:187], a[144:147], v[152:155]
 ds_read_b64_tr_b16 a[252:253], v13 offset:40960
 v_mfma_f32_16x16x32_bf16 v[184:187], a[184:187], a[148:151], v[184:187]
 v_mfma_f32_16x16x32_bf16 v[216:219], a[184:187], a[152:155], v[216:219]
 ds_read_b64_tr_b16 a[254:255], v13 offset:41984
 v_mfma_f32_16x16x32_bf16 v[248:251], a[184:187], a[156:159], v[248:251]
 v_mfma_f32_16x16x32_bf16 v[36:39], a[188:191], a[128:131], v[36:39]
 ds_read_b128 a[220:223], v5 offset:59392
 v_mfma_f32_16x16x32_bf16 v[60:63], a[188:191], a[132:135], v[60:63]
 v_mfma_f32_16x16x32_bf16 v[92:95], a[188:191], a[136:139], v[92:95]
 v_mfma_f32_16x16x32_bf16 v[124:127], a[188:191], a[140:143], v[124:127]
 v_mfma_f32_16x16x32_bf16 v[156:159], a[188:191], a[144:147], v[156:159]
 v_mfma_f32_16x16x32_bf16 v[188:191], a[188:191], a[148:151], v[188:191]
 s_cmp_eq_u32 s60, 0
 s_cselect_b32 s95, 0, 2147483632
 buffer_load_dword a101, v22, s[8:11], s95 offen offset:1024
 v_mfma_f32_16x16x32_bf16 v[220:223], a[188:191], a[152:155], v[220:223]
 v_mfma_f32_16x16x32_bf16 v[252:255], a[188:191], a[156:159], v[252:255]
 s_waitcnt lgkmcnt(15)
 v_mfma_f32_16x16x32_bf16 v[24:27], a[224:227], a[192:195], v[24:27]
 v_mfma_f32_16x16x32_bf16 a[120:123], a[224:227], a[196:199], a[120:123]
 v_mfma_f32_16x16x32_bf16 v[64:67], a[224:227], a[200:203], v[64:67]
 s_waitcnt lgkmcnt(12)
 v_mfma_f32_16x16x32_bf16 v[96:99], a[224:227], a[204:207], v[96:99]
 s_waitcnt lgkmcnt(9)
 v_mfma_f32_16x16x32_bf16 v[128:131], a[224:227], a[208:211], v[128:131]
 s_waitcnt lgkmcnt(6)
 v_mfma_f32_16x16x32_bf16 v[160:163], a[224:227], a[212:215], v[160:163]
 s_waitcnt lgkmcnt(3)
 v_mfma_f32_16x16x32_bf16 v[192:195], a[224:227], a[216:219], v[192:195]
 s_waitcnt lgkmcnt(0)
 v_mfma_f32_16x16x32_bf16 v[224:227], a[224:227], a[220:223], v[224:227]
 v_mfma_f32_16x16x32_bf16 v[28:31], a[228:231], a[192:195], v[28:31]
 v_mfma_f32_16x16x32_bf16 a[124:127], a[228:231], a[196:199], a[124:127]
 v_mfma_f32_16x16x32_bf16 v[68:71], a[228:231], a[200:203], v[68:71]
 v_mfma_f32_16x16x32_bf16 v[100:103], a[228:231], a[204:207], v[100:103]
 v_mfma_f32_16x16x32_bf16 v[132:135], a[228:231], a[208:211], v[132:135]
 v_mfma_f32_16x16x32_bf16 v[164:167], a[228:231], a[212:215], v[164:167]
 v_mfma_f32_16x16x32_bf16 v[196:199], a[228:231], a[216:219], v[196:199]
 v_mfma_f32_16x16x32_bf16 v[228:231], a[228:231], a[220:223], v[228:231]
 v_mfma_f32_16x16x32_bf16 a[104:107], a[232:235], a[192:195], a[104:107]
 v_mfma_f32_16x16x32_bf16 v[40:43], a[232:235], a[196:199], v[40:43]
 v_mfma_f32_16x16x32_bf16 v[72:75], a[232:235], a[200:203], v[72:75]
 v_mfma_f32_16x16x32_bf16 v[104:107], a[232:235], a[204:207], v[104:107]
 v_mfma_f32_16x16x32_bf16 v[136:139], a[232:235], a[208:211], v[136:139]
 v_mfma_f32_16x16x32_bf16 v[168:171], a[232:235], a[212:215], v[168:171]
 v_mfma_f32_16x16x32_bf16 v[200:203], a[232:235], a[216:219], v[200:203]
 v_mfma_f32_16x16x32_bf16 v[232:235], a[232:235], a[220:223], v[232:235]
 v_mfma_f32_16x16x32_bf16 a[108:111], a[236:239], a[192:195], a[108:111]
 s_waitcnt vmcnt(3) lgkmcnt(0)
 s_barrier
 v_mfma_f32_16x16x32_bf16 v[44:47], a[236:239], a[196:199], v[44:47]
 s_add_u32 m0, s81, 65536
 ds_read_b64_tr_b16 a[160:161], v6 offset:0
 v_mfma_f32_16x16x32_bf16 v[76:79], a[236:239], a[200:203], v[76:79]
 buffer_load_dwordx4 v0, s[12:15], 0 offen offset:0 lds
 v_mfma_f32_16x16x32_bf16 v[108:111], a[236:239], a[204:207], v[108:111]
 ds_read_b64_tr_b16 a[162:163], v6 offset:1024
 v_mfma_f32_16x16x32_bf16 v[140:143], a[236:239], a[208:211], v[140:143]
 ds_read_b128 a[128:131], v4 offset:0
 v_mfma_f32_16x16x32_bf16 v[172:175], a[236:239], a[212:215], v[172:175]
 ds_read_b64_tr_b16 a[164:165], v7 offset:0
 v_mfma_f32_16x16x32_bf16 v[204:207], a[236:239], a[216:219], v[204:207]
 ds_read_b64_tr_b16 a[166:167], v7 offset:1024
 v_mfma_f32_16x16x32_bf16 v[236:239], a[236:239], a[220:223], v[236:239]
 buffer_load_dwordx4 v1, s[12:15], s64 offen offset:1024 lds
 v_mfma_f32_16x16x32_bf16 a[112:115], a[240:243], a[192:195], a[112:115]
 ds_read_b128 a[132:135], v4 offset:2048
 v_mfma_f32_16x16x32_bf16 v[48:51], a[240:243], a[196:199], v[48:51]
 ds_read_b64_tr_b16 a[168:169], v8 offset:0
 v_mfma_f32_16x16x32_bf16 v[80:83], a[240:243], a[200:203], v[80:83]
 ds_read_b64_tr_b16 a[170:171], v8 offset:1024
 v_mfma_f32_16x16x32_bf16 v[112:115], a[240:243], a[204:207], v[112:115]
 ds_read_b128 a[136:139], v4 offset:8192
 v_mfma_f32_16x16x32_bf16 v[144:147], a[240:243], a[208:211], v[144:147]
 buffer_load_dwordx4 v0, s[12:15], s65 offen offset:2048 lds
 v_mfma_f32_16x16x32_bf16 v[176:179], a[240:243], a[212:215], v[176:179]
 ds_read_b64_tr_b16 a[172:173], v9 offset:0
 v_mfma_f32_16x16x32_bf16 v[208:211], a[240:243], a[216:219], v[208:211]
 ds_read_b64_tr_b16 a[174:175], v9 offset:1024
 v_mfma_f32_16x16x32_bf16 v[240:243], a[240:243], a[220:223], v[240:243]
 ds_read_b128 a[140:143], v4 offset:10240
 v_mfma_f32_16x16x32_bf16 a[116:119], a[244:247], a[192:195], a[116:119]
 v_mfma_f32_16x16x32_bf16 v[52:55], a[244:247], a[196:199], v[52:55]
 buffer_load_dwordx4 v1, s[12:15], s66 offen offset:3072 lds
 s_add_u32 m0, s81, 69632
 v_mfma_f32_16x16x32_bf16 v[84:87], a[244:247], a[200:203], v[84:87]
 ds_read_b64_tr_b16 a[176:177], v10 offset:0
 v_mfma_f32_16x16x32_bf16 v[116:119], a[244:247], a[204:207], v[116:119]
 ds_read_b64_tr_b16 a[178:179], v10 offset:1024
 v_mfma_f32_16x16x32_bf16 v[148:151], a[244:247], a[208:211], v[148:151]
 ds_read_b128 a[144:147], v4 offset:16384
 v_mfma_f32_16x16x32_bf16 v[180:183], a[244:247], a[212:215], v[180:183]
 ds_read_b64_tr_b16 a[180:181], v11 offset:0
 v_mfma_f32_16x16x32_bf16 v[212:215], a[244:247], a[216:219], v[212:215]
 buffer_load_dwordx4 v0, s[12:15], s67 offen offset:0 lds
 v_mfma_f32_16x16x32_bf16 v[244:247], a[244:247], a[220:223], v[244:247]
 ds_read_b64_tr_b16 a[182:183], v11 offset:1024
 v_mfma_f32_16x16x32_bf16 v[32:35], a[248:251], a[192:195], v[32:35]
 ds_read_b128 a[148:151], v4 offset:18432
 v_mfma_f32_16x16x32_bf16 v[56:59], a[248:251], a[196:199], v[56:59]
 ds_read_b64_tr_b16 a[184:185], v12 offset:0
 v_mfma_f32_16x16x32_bf16 v[88:91], a[248:251], a[200:203], v[88:91]
 ds_read_b64_tr_b16 a[186:187], v12 offset:1024
 v_mfma_f32_16x16x32_bf16 v[120:123], a[248:251], a[204:207], v[120:123]
 buffer_load_dwordx4 v1, s[12:15], s68 offen offset:1024 lds
 v_mfma_f32_16x16x32_bf16 v[152:155], a[248:251], a[208:211], v[152:155]
 ds_read_b128 a[152:155], v4 offset:24576
 v_mfma_f32_16x16x32_bf16 v[184:187], a[248:251], a[212:215], v[184:187]
 ds_read_b64_tr_b16 a[188:189], v13 offset:0
 v_mfma_f32_16x16x32_bf16 v[216:219], a[248:251], a[216:219], v[216:219]
 ds_read_b64_tr_b16 a[190:191], v13 offset:1024
 v_mfma_f32_16x16x32_bf16 v[248:251], a[248:251], a[220:223], v[248:251]
 ds_read_b128 a[156:159], v4 offset:26624
 v_mfma_f32_16x16x32_bf16 v[36:39], a[252:255], a[192:195], v[36:39]
 buffer_load_dwordx4 v0, s[12:15], s69 offen offset:2048 lds
 v_mfma_f32_16x16x32_bf16 v[60:63], a[252:255], a[196:199], v[60:63]
 v_mfma_f32_16x16x32_bf16 v[92:95], a[252:255], a[200:203], v[92:95]
 v_mfma_f32_16x16x32_bf16 v[124:127], a[252:255], a[204:207], v[124:127]
 v_mfma_f32_16x16x32_bf16 v[156:159], a[252:255], a[208:211], v[156:159]
 v_mfma_f32_16x16x32_bf16 v[188:191], a[252:255], a[212:215], v[188:191]
 buffer_load_dwordx4 v1, s[12:15], s70 offen offset:3072 lds
 s_add_u32 m0, s82, 131072
 v_mfma_f32_16x16x32_bf16 v[220:223], a[252:255], a[216:219], v[220:223]
 v_mfma_f32_16x16x32_bf16 v[252:255], a[252:255], a[220:223], v[252:255]
 s_waitcnt lgkmcnt(15)
 v_mfma_f32_16x16x32_bf16 v[24:27], a[160:163], a[128:131], v[24:27]
 v_mfma_f32_16x16x32_bf16 a[120:123], a[160:163], a[132:135], a[120:123]
 v_mfma_f32_16x16x32_bf16 v[64:67], a[160:163], a[136:139], v[64:67]
 s_waitcnt lgkmcnt(12)
 buffer_load_dwordx4 v2, s[16:19], 0 offen offset:0 lds
 v_mfma_f32_16x16x32_bf16 v[96:99], a[160:163], a[140:143], v[96:99]
 s_waitcnt lgkmcnt(9)
 ds_read_b64_tr_b16 a[224:225], v6 offset:8192
 v_mfma_f32_16x16x32_bf16 v[128:131], a[160:163], a[144:147], v[128:131]
 s_waitcnt lgkmcnt(7)
 ds_read_b64_tr_b16 a[226:227], v6 offset:9216
 v_mfma_f32_16x16x32_bf16 v[160:163], a[160:163], a[148:151], v[160:163]
 s_waitcnt lgkmcnt(5)
 v_mfma_f32_16x16x32_bf16 v[192:195], a[160:163], a[152:155], v[192:195]
 s_waitcnt lgkmcnt(2)
 ds_read_b128 a[192:195], v5 offset:0
 v_mfma_f32_16x16x32_bf16 v[224:227], a[160:163], a[156:159], v[224:227]
 buffer_load_dwordx4 v2, s[16:19], s71 offen offset:1024 lds
 v_mfma_f32_16x16x32_bf16 v[28:31], a[164:167], a[128:131], v[28:31]
 v_mfma_f32_16x16x32_bf16 a[124:127], a[164:167], a[132:135], a[124:127]
 ds_read_b64_tr_b16 a[228:229], v7 offset:8192
 v_mfma_f32_16x16x32_bf16 v[68:71], a[164:167], a[136:139], v[68:71]
 v_mfma_f32_16x16x32_bf16 v[100:103], a[164:167], a[140:143], v[100:103]
 ds_read_b64_tr_b16 a[230:231], v7 offset:9216
 v_mfma_f32_16x16x32_bf16 v[132:135], a[164:167], a[144:147], v[132:135]
 buffer_load_dwordx4 v3, s[16:19], s72 offen offset:2048 lds
 v_mfma_f32_16x16x32_bf16 v[164:167], a[164:167], a[148:151], v[164:167]
 v_mfma_f32_16x16x32_bf16 v[196:199], a[164:167], a[152:155], v[196:199]
 ds_read_b128 a[196:199], v5 offset:2048
 v_mfma_f32_16x16x32_bf16 v[228:231], a[164:167], a[156:159], v[228:231]
 v_mfma_f32_16x16x32_bf16 a[104:107], a[168:171], a[128:131], a[104:107]
 ds_read_b64_tr_b16 a[232:233], v8 offset:8192
 v_mfma_f32_16x16x32_bf16 v[40:43], a[168:171], a[132:135], v[40:43]
 buffer_load_dwordx4 v3, s[16:19], s73 offen offset:3072 lds
 s_add_u32 m0, s82, 147456
 v_mfma_f32_16x16x32_bf16 v[72:75], a[168:171], a[136:139], v[72:75]
 v_mfma_f32_16x16x32_bf16 v[104:107], a[168:171], a[140:143], v[104:107]
 ds_read_b64_tr_b16 a[234:235], v8 offset:9216
 v_mfma_f32_16x16x32_bf16 v[136:139], a[168:171], a[144:147], v[136:139]
 v_mfma_f32_16x16x32_bf16 v[168:171], a[168:171], a[148:151], v[168:171]
 ds_read_b128 a[200:203], v5 offset:8192
 v_mfma_f32_16x16x32_bf16 v[200:203], a[168:171], a[152:155], v[200:203]
 buffer_load_dwordx4 v2, s[20:23], 0 offen offset:0 lds
 v_mfma_f32_16x16x32_bf16 v[232:235], a[168:171], a[156:159], v[232:235]
 v_mfma_f32_16x16x32_bf16 a[108:111], a[172:175], a[128:131], a[108:111]
 ds_read_b64_tr_b16 a[236:237], v9 offset:8192
 v_mfma_f32_16x16x32_bf16 v[44:47], a[172:175], a[132:135], v[44:47]
 v_mfma_f32_16x16x32_bf16 v[76:79], a[172:175], a[136:139], v[76:79]
 ds_read_b64_tr_b16 a[238:239], v9 offset:9216
 v_mfma_f32_16x16x32_bf16 v[108:111], a[172:175], a[140:143], v[108:111]
 buffer_load_dwordx4 v2, s[20:23], s71 offen offset:1024 lds
 v_mfma_f32_16x16x32_bf16 v[140:143], a[172:175], a[144:147], v[140:143]
 v_mfma_f32_16x16x32_bf16 v[172:175], a[172:175], a[148:151], v[172:175]
 ds_read_b128 a[204:207], v5 offset:10240
 v_mfma_f32_16x16x32_bf16 v[204:207], a[172:175], a[152:155], v[204:207]
 v_mfma_f32_16x16x32_bf16 v[236:239], a[172:175], a[156:159], v[236:239]
 ds_read_b64_tr_b16 a[240:241], v10 offset:8192
 v_mfma_f32_16x16x32_bf16 a[112:115], a[176:179], a[128:131], a[112:115]
 buffer_load_dwordx4 v3, s[20:23], s72 offen offset:2048 lds
 v_mfma_f32_16x16x32_bf16 v[48:51], a[176:179], a[132:135], v[48:51]
 v_mfma_f32_16x16x32_bf16 v[80:83], a[176:179], a[136:139], v[80:83]
 ds_read_b64_tr_b16 a[242:243], v10 offset:9216
 v_mfma_f32_16x16x32_bf16 v[112:115], a[176:179], a[140:143], v[112:115]
 v_mfma_f32_16x16x32_bf16 v[144:147], a[176:179], a[144:147], v[144:147]
 ds_read_b128 a[208:211], v5 offset:16384
 v_mfma_f32_16x16x32_bf16 v[176:179], a[176:179], a[148:151], v[176:179]
 buffer_load_dwordx4 v3, s[20:23], s73 offen offset:3072 lds
 v_mfma_f32_16x16x32_bf16 v[208:211], a[176:179], a[152:155], v[208:211]
 v_mfma_f32_16x16x32_bf16 v[240:243], a[176:179], a[156:159], v[240:243]
 ds_read_b64_tr_b16 a[244:245], v11 offset:8192
 v_mfma_f32_16x16x32_bf16 a[116:119], a[180:183], a[128:131], a[116:119]
 v_mfma_f32_16x16x32_bf16 v[52:55], a[180:183], a[132:135], v[52:55]
 ds_read_b64_tr_b16 a[246:247], v11 offset:9216
 v_mfma_f32_16x16x32_bf16 v[84:87], a[180:183], a[136:139], v[84:87]
 v_add_u32 v0, 0x80, v0
 v_add_u32 v1, 0x80, v1
 v_mfma_f32_16x16x32_bf16 v[116:119], a[180:183], a[140:143], v[116:119]
 ds_read_b128 a[212:215], v5 offset:18432
 v_add_u32 v2, 0x80000, v2
 v_add_u32 v3, 0x80000, v3
 v_mfma_f32_16x16x32_bf16 v[148:151], a[180:183], a[144:147], v[148:151]
 s_mul_i32 s94, s63, 72
 s_mul_i32 s95, s60, 18
 s_add_u32 s94, s94, s95
 s_lshl_b32 s94, s94, 13
 s_lshl_b32 s95, s3, 8
 s_add_u32 s84, s94, s95
 v_lshrrev_b32 v22, 5, v14
 v_min_u32 v22, 17, v22
 v_mfma_f32_16x16x32_bf16 v[180:183], a[180:183], a[148:151], v[180:183]
 ds_read_b64_tr_b16 a[248:249], v12 offset:8192
 v_lshlrev_b32 v22, 13, v22
 v_bfe_u32 v15, v14, 4, 1
 v_lshl_add_u32 v22, v15, 7, v22
 v_mfma_f32_16x16x32_bf16 v[212:215], a[180:183], a[152:155], v[212:215]
 buffer_load_dword a101, v22, s[24:27], s84 offen
 v_mfma_f32_16x16x32_bf16 v[244:247], a[180:183], a[156:159], v[244:247]
 v_mov_b32 v0, v17
 v_mov_b32 v1, v18
 v_mfma_f32_16x16x32_bf16 v[32:35], a[184:187], a[128:131], v[32:35]
 ds_read_b64_tr_b16 a[250:251], v12 offset:9216
 v_subrev_u32 v2, 0x400000, v2
 v_subrev_u32 v3, 0x400000, v3
 v_mfma_f32_16x16x32_bf16 v[56:59], a[184:187], a[132:135], v[56:59]
 v_mfma_f32_16x16x32_bf16 v[88:91], a[184:187], a[136:139], v[88:91]
 ds_read_b128 a[216:219], v5 offset:24576
 v_mfma_f32_16x16x32_bf16 v[120:123], a[184:187], a[140:143], v[120:123]
 v_mfma_f32_16x16x32_bf16 v[152:155], a[184:187], a[144:147], v[152:155]
 ds_read_b64_tr_b16 a[252:253], v13 offset:8192
 v_mfma_f32_16x16x32_bf16 v[184:187], a[184:187], a[148:151], v[184:187]
 v_mfma_f32_16x16x32_bf16 v[216:219], a[184:187], a[152:155], v[216:219]
 ds_read_b64_tr_b16 a[254:255], v13 offset:9216
 v_mfma_f32_16x16x32_bf16 v[248:251], a[184:187], a[156:159], v[248:251]
 v_mfma_f32_16x16x32_bf16 v[36:39], a[188:191], a[128:131], v[36:39]
 ds_read_b128 a[220:223], v5 offset:26624
 v_mfma_f32_16x16x32_bf16 v[60:63], a[188:191], a[132:135], v[60:63]
 v_mfma_f32_16x16x32_bf16 v[92:95], a[188:191], a[136:139], v[92:95]
 v_mfma_f32_16x16x32_bf16 v[124:127], a[188:191], a[140:143], v[124:127]
 v_mfma_f32_16x16x32_bf16 v[156:159], a[188:191], a[144:147], v[156:159]
 v_mfma_f32_16x16x32_bf16 v[188:191], a[188:191], a[148:151], v[188:191]
 v_mfma_f32_16x16x32_bf16 v[220:223], a[188:191], a[152:155], v[220:223]
 v_mfma_f32_16x16x32_bf16 v[252:255], a[188:191], a[156:159], v[252:255]
 s_waitcnt lgkmcnt(15)
 v_mfma_f32_16x16x32_bf16 v[24:27], a[224:227], a[192:195], v[24:27]
 v_mfma_f32_16x16x32_bf16 a[120:123], a[224:227], a[196:199], a[120:123]
 v_mfma_f32_16x16x32_bf16 v[64:67], a[224:227], a[200:203], v[64:67]
 s_waitcnt lgkmcnt(12)
 v_mfma_f32_16x16x32_bf16 v[96:99], a[224:227], a[204:207], v[96:99]
 s_waitcnt lgkmcnt(9)
 v_mfma_f32_16x16x32_bf16 v[128:131], a[224:227], a[208:211], v[128:131]
 s_waitcnt lgkmcnt(6)
 v_mfma_f32_16x16x32_bf16 v[160:163], a[224:227], a[212:215], v[160:163]
 s_waitcnt lgkmcnt(3)
 v_mfma_f32_16x16x32_bf16 v[192:195], a[224:227], a[216:219], v[192:195]
 s_waitcnt lgkmcnt(0)
 v_mfma_f32_16x16x32_bf16 v[224:227], a[224:227], a[220:223], v[224:227]
 v_mfma_f32_16x16x32_bf16 v[28:31], a[228:231], a[192:195], v[28:31]
 v_mfma_f32_16x16x32_bf16 a[124:127], a[228:231], a[196:199], a[124:127]
 v_mfma_f32_16x16x32_bf16 v[68:71], a[228:231], a[200:203], v[68:71]
 v_mfma_f32_16x16x32_bf16 v[100:103], a[228:231], a[204:207], v[100:103]
 v_mfma_f32_16x16x32_bf16 v[132:135], a[228:231], a[208:211], v[132:135]
 v_mfma_f32_16x16x32_bf16 v[164:167], a[228:231], a[212:215], v[164:167]
 v_mfma_f32_16x16x32_bf16 v[196:199], a[228:231], a[216:219], v[196:199]
 v_mfma_f32_16x16x32_bf16 v[228:231], a[228:231], a[220:223], v[228:231]
 v_mfma_f32_16x16x32_bf16 a[104:107], a[232:235], a[192:195], a[104:107]
 v_mfma_f32_16x16x32_bf16 v[40:43], a[232:235], a[196:199], v[40:43]
 v_mfma_f32_16x16x32_bf16 v[72:75], a[232:235], a[200:203], v[72:75]
 v_mfma_f32_16x16x32_bf16 v[104:107], a[232:235], a[204:207], v[104:107]
 v_mfma_f32_16x16x32_bf16 v[136:139], a[232:235], a[208:211], v[136:139]
 v_mfma_f32_16x16x32_bf16 v[168:171], a[232:235], a[212:215], v[168:171]
 v_mfma_f32_16x16x32_bf16 v[200:203], a[232:235], a[216:219], v[200:203]
 v_mfma_f32_16x16x32_bf16 v[232:235], a[232:235], a[220:223], v[232:235]
 v_mfma_f32_16x16x32_bf16 a[108:111], a[236:239], a[192:195], a[108:111]
 s_waitcnt vmcnt(1) lgkmcnt(0)
 s_barrier
 v_mfma_f32_16x16x32_bf16 v[44:47], a[236:239], a[196:199], v[44:47]
 s_add_u32 m0, s82, 98304
 ds_read_b64_tr_b16 a[160:161], v6 offset:32768
 v_mfma_f32_16x16x32_bf16 v[76:79], a[236:239], a[200:203], v[76:79]
 buffer_load_dwordx4 v2, s[24:27], 0 offen offset:0 lds
 v_mfma_f32_16x16x32_bf16 v[108:111], a[236:239], a[204:207], v[108:111]
 ds_read_b64_tr_b16 a[162:163], v6 offset:33792
 v_mfma_f32_16x16x32_bf16 v[140:143], a[236:239], a[208:211], v[140:143]
 ds_read_b128 a[128:131], v4 offset:32768
 v_mfma_f32_16x16x32_bf16 v[172:175], a[236:239], a[212:215], v[172:175]
 ds_read_b64_tr_b16 a[164:165], v7 offset:32768
 v_mfma_f32_16x16x32_bf16 v[204:207], a[236:239], a[216:219], v[204:207]
 ds_read_b64_tr_b16 a[166:167], v7 offset:33792
 v_mfma_f32_16x16x32_bf16 v[236:239], a[236:239], a[220:223], v[236:239]
 buffer_load_dwordx4 v2, s[24:27], s71 offen offset:1024 lds
 v_mfma_f32_16x16x32_bf16 a[112:115], a[240:243], a[192:195], a[112:115]
 ds_read_b128 a[132:135], v4 offset:34816
 v_mfma_f32_16x16x32_bf16 v[48:51], a[240:243], a[196:199], v[48:51]
 ds_read_b64_tr_b16 a[168:169], v8 offset:32768
 v_mfma_f32_16x16x32_bf16 v[80:83], a[240:243], a[200:203], v[80:83]
 ds_read_b64_tr_b16 a[170:171], v8 offset:33792
 v_mfma_f32_16x16x32_bf16 v[112:115], a[240:243], a[204:207], v[112:115]
 v_mfma_f32_16x16x32_bf16 v[144:147], a[240:243], a[208:211], v[144:147]
 buffer_load_dwordx4 v3, s[24:27], s72 offen offset:2048 lds
 v_mfma_f32_16x16x32_bf16 v[176:179], a[240:243], a[212:215], v[176:179]
 ds_read_b128 a[136:139], v4 offset:40960
 v_mfma_f32_16x16x32_bf16 v[208:211], a[240:243], a[216:219], v[208:211]
 ds_read_b64_tr_b16 a[172:173], v9 offset:32768
 v_mfma_f32_16x16x32_bf16 v[240:243], a[240:243], a[220:223], v[240:243]
 ds_read_b64_tr_b16 a[174:175], v9 offset:33792
 v_mfma_f32_16x16x32_bf16 a[116:119], a[244:247], a[192:195], a[116:119]
 ds_read_b128 a[140:143], v4 offset:43008
 v_mfma_f32_16x16x32_bf16 v[52:55], a[244:247], a[196:199], v[52:55]
 buffer_load_dwordx4 v3, s[24:27], s73 offen offset:3072 lds
 v_mfma_f32_16x16x32_bf16 v[84:87], a[244:247], a[200:203], v[84:87]
 ds_read_b64_tr_b16 a[176:177], v10 offset:32768
 v_mfma_f32_16x16x32_bf16 v[116:119], a[244:247], a[204:207], v[116:119]
 ds_read_b64_tr_b16 a[178:179], v10 offset:33792
 v_mfma_f32_16x16x32_bf16 v[148:151], a[244:247], a[208:211], v[148:151]
 ds_read_b128 a[144:147], v4 offset:49152
 v_mfma_f32_16x16x32_bf16 v[180:183], a[244:247], a[212:215], v[180:183]
 ds_read_b64_tr_b16 a[180:181], v11 offset:32768
 v_mfma_f32_16x16x32_bf16 v[212:215], a[244:247], a[216:219], v[212:215]
 v_add_u32 v2, 0x80000, v2
 v_add_u32 v3, 0x80000, v3
 v_mfma_f32_16x16x32_bf16 v[244:247], a[244:247], a[220:223], v[244:247]
 s_add_u32 m0, s82, 114688
 ds_read_b64_tr_b16 a[182:183], v11 offset:33792
 v_mfma_f32_16x16x32_bf16 v[32:35], a[248:251], a[192:195], v[32:35]
 buffer_load_dwordx4 v2, s[24:27], 0 offen offset:0 lds
 v_mfma_f32_16x16x32_bf16 v[56:59], a[248:251], a[196:199], v[56:59]
 ds_read_b128 a[148:151], v4 offset:51200
 v_mfma_f32_16x16x32_bf16 v[88:91], a[248:251], a[200:203], v[88:91]
 ds_read_b64_tr_b16 a[184:185], v12 offset:32768
 v_mfma_f32_16x16x32_bf16 v[120:123], a[248:251], a[204:207], v[120:123]
 ds_read_b64_tr_b16 a[186:187], v12 offset:33792
 v_mfma_f32_16x16x32_bf16 v[152:155], a[248:251], a[208:211], v[152:155]
 ds_read_b128 a[152:155], v4 offset:57344
 v_mfma_f32_16x16x32_bf16 v[184:187], a[248:251], a[212:215], v[184:187]
 buffer_load_dwordx4 v2, s[24:27], s71 offen offset:1024 lds
 v_mfma_f32_16x16x32_bf16 v[216:219], a[248:251], a[216:219], v[216:219]
 ds_read_b64_tr_b16 a[188:189], v13 offset:32768
 v_mfma_f32_16x16x32_bf16 v[248:251], a[248:251], a[220:223], v[248:251]
 ds_read_b64_tr_b16 a[190:191], v13 offset:33792
 v_mfma_f32_16x16x32_bf16 v[36:39], a[252:255], a[192:195], v[36:39]
 ds_read_b128 a[156:159], v4 offset:59392
 v_mfma_f32_16x16x32_bf16 v[60:63], a[252:255], a[196:199], v[60:63]
 v_mfma_f32_16x16x32_bf16 v[92:95], a[252:255], a[200:203], v[92:95]
 buffer_load_dwordx4 v3, s[24:27], s72 offen offset:2048 lds
 v_mfma_f32_16x16x32_bf16 v[124:127], a[252:255], a[204:207], v[124:127]
 v_mfma_f32_16x16x32_bf16 v[156:159], a[252:255], a[208:211], v[156:159]
 v_mfma_f32_16x16x32_bf16 v[188:191], a[252:255], a[212:215], v[188:191]
 v_mfma_f32_16x16x32_bf16 v[220:223], a[252:255], a[216:219], v[220:223]
 v_mfma_f32_16x16x32_bf16 v[252:255], a[252:255], a[220:223], v[252:255]
 s_waitcnt lgkmcnt(15)
 buffer_load_dwordx4 v3, s[24:27], s73 offen offset:3072 lds
 v_mfma_f32_16x16x32_bf16 v[24:27], a[160:163], a[128:131], v[24:27]
 v_mfma_f32_16x16x32_bf16 a[120:123], a[160:163], a[132:135], a[120:123]
 v_mfma_f32_16x16x32_bf16 v[64:67], a[160:163], a[136:139], v[64:67]
 s_waitcnt lgkmcnt(12)
 ds_read_b64_tr_b16 a[224:225], v6 offset:40960
 v_mfma_f32_16x16x32_bf16 v[96:99], a[160:163], a[140:143], v[96:99]
 s_waitcnt lgkmcnt(10)
 ds_read_b64_tr_b16 a[226:227], v6 offset:41984
 v_mfma_f32_16x16x32_bf16 v[128:131], a[160:163], a[144:147], v[128:131]
 s_waitcnt lgkmcnt(8)
 v_add_u32 v2, 0x80000, v2
 v_add_u32 v3, 0x80000, v3
 v_mfma_f32_16x16x32_bf16 v[160:163], a[160:163], a[148:151], v[160:163]
 s_waitcnt lgkmcnt(5)
 s_add_u32 m0, s81, 32768
 ds_read_b128 a[192:195], v5 offset:32768
 v_mfma_f32_16x16x32_bf16 v[192:195], a[160:163], a[152:155], v[192:195]
 s_waitcnt lgkmcnt(3)
 buffer_load_dwordx4 v0, s[8:11], 0 offen offset:0 lds
 v_mfma_f32_16x16x32_bf16 v[224:227], a[160:163], a[156:159], v[224:227]
 v_mfma_f32_16x16x32_bf16 v[28:31], a[164:167], a[128:131], v[28:31]
 ds_read_b64_tr_b16 a[228:229], v7 offset:40960
 v_mfma_f32_16x16x32_bf16 a[124:127], a[164:167], a[132:135], a[124:127]
 v_mfma_f32_16x16x32_bf16 v[68:71], a[164:167], a[136:139], v[68:71]
 ds_read_b64_tr_b16 a[230:231], v7 offset:41984
 v_mfma_f32_16x16x32_bf16 v[100:103], a[164:167], a[140:143], v[100:103]
 buffer_load_dwordx4 v1, s[8:11], s74 offen offset:1024 lds
 v_mfma_f32_16x16x32_bf16 v[132:135], a[164:167], a[144:147], v[132:135]
 v_mfma_f32_16x16x32_bf16 v[164:167], a[164:167], a[148:151], v[164:167]
 ds_read_b128 a[196:199], v5 offset:34816
 v_mfma_f32_16x16x32_bf16 v[196:199], a[164:167], a[152:155], v[196:199]
 v_mfma_f32_16x16x32_bf16 v[228:231], a[164:167], a[156:159], v[228:231]
 ds_read_b64_tr_b16 a[232:233], v8 offset:40960
 v_mfma_f32_16x16x32_bf16 a[104:107], a[168:171], a[128:131], a[104:107]
 buffer_load_dwordx4 v0, s[8:11], s75 offen offset:2048 lds
 v_mfma_f32_16x16x32_bf16 v[40:43], a[168:171], a[132:135], v[40:43]
 v_mfma_f32_16x16x32_bf16 v[72:75], a[168:171], a[136:139], v[72:75]
 ds_read_b64_tr_b16 a[234:235], v8 offset:41984
 v_mfma_f32_16x16x32_bf16 v[104:107], a[168:171], a[140:143], v[104:107]
 v_mfma_f32_16x16x32_bf16 v[136:139], a[168:171], a[144:147], v[136:139]
 ds_read_b128 a[200:203], v5 offset:40960
 v_mfma_f32_16x16x32_bf16 v[168:171], a[168:171], a[148:151], v[168:171]
 buffer_load_dwordx4 v1, s[8:11], s76 offen offset:3072 lds
 s_add_u32 m0, s81, 36864
 v_mfma_f32_16x16x32_bf16 v[200:203], a[168:171], a[152:155], v[200:203]
 v_mfma_f32_16x16x32_bf16 v[232:235], a[168:171], a[156:159], v[232:235]
 ds_read_b64_tr_b16 a[236:237], v9 offset:40960
 v_mfma_f32_16x16x32_bf16 a[108:111], a[172:175], a[128:131], a[108:111]
 v_mfma_f32_16x16x32_bf16 v[44:47], a[172:175], a[132:135], v[44:47]
 ds_read_b64_tr_b16 a[238:239], v9 offset:41984
 v_mfma_f32_16x16x32_bf16 v[76:79], a[172:175], a[136:139], v[76:79]
 buffer_load_dwordx4 v0, s[8:11], s77 offen offset:0 lds
 v_mfma_f32_16x16x32_bf16 v[108:111], a[172:175], a[140:143], v[108:111]
 v_mfma_f32_16x16x32_bf16 v[140:143], a[172:175], a[144:147], v[140:143]
 ds_read_b128 a[204:207], v5 offset:43008
 v_mfma_f32_16x16x32_bf16 v[172:175], a[172:175], a[148:151], v[172:175]
 v_mfma_f32_16x16x32_bf16 v[204:207], a[172:175], a[152:155], v[204:207]
 ds_read_b64_tr_b16 a[240:241], v10 offset:40960
 v_mfma_f32_16x16x32_bf16 v[236:239], a[172:175], a[156:159], v[236:239]
 buffer_load_dwordx4 v1, s[8:11], s78 offen offset:1024 lds
 v_mfma_f32_16x16x32_bf16 a[112:115], a[176:179], a[128:131], a[112:115]
 v_mfma_f32_16x16x32_bf16 v[48:51], a[176:179], a[132:135], v[48:51]
 ds_read_b64_tr_b16 a[242:243], v10 offset:41984
 v_mfma_f32_16x16x32_bf16 v[80:83], a[176:179], a[136:139], v[80:83]
 v_mfma_f32_16x16x32_bf16 v[112:115], a[176:179], a[140:143], v[112:115]
 ds_read_b128 a[208:211], v5 offset:49152
 v_mfma_f32_16x16x32_bf16 v[144:147], a[176:179], a[144:147], v[144:147]
 buffer_load_dwordx4 v0, s[8:11], s79 offen offset:2048 lds
 v_mfma_f32_16x16x32_bf16 v[176:179], a[176:179], a[148:151], v[176:179]
 v_mfma_f32_16x16x32_bf16 v[208:211], a[176:179], a[152:155], v[208:211]
 ds_read_b64_tr_b16 a[244:245], v11 offset:40960
 v_mfma_f32_16x16x32_bf16 v[240:243], a[176:179], a[156:159], v[240:243]
 v_mfma_f32_16x16x32_bf16 a[116:119], a[180:183], a[128:131], a[116:119]
 ds_read_b64_tr_b16 a[246:247], v11 offset:41984
 v_mfma_f32_16x16x32_bf16 v[52:55], a[180:183], a[132:135], v[52:55]
 buffer_load_dwordx4 v1, s[8:11], s80 offen offset:3072 lds
 v_mfma_f32_16x16x32_bf16 v[84:87], a[180:183], a[136:139], v[84:87]
 v_mfma_f32_16x16x32_bf16 v[116:119], a[180:183], a[140:143], v[116:119]
 ds_read_b128 a[212:215], v5 offset:51200
 v_mfma_f32_16x16x32_bf16 v[148:151], a[180:183], a[144:147], v[148:151]
 v_lshrrev_b32 v15, 2, v14
 v_mfma_f32_16x16x32_bf16 v[180:183], a[180:183], a[148:151], v[180:183]
 buffer_load_dword v15, v15, s[36:39], 0 offen sc1
 v_mfma_f32_16x16x32_bf16 v[212:215], a[180:183], a[152:155], v[212:215]
 ds_read_b64_tr_b16 a[248:249], v12 offset:40960
 v_add_u32 v0, 0x80, v0
 v_add_u32 v1, 0x80, v1
 v_mfma_f32_16x16x32_bf16 v[244:247], a[180:183], a[156:159], v[244:247]
 v_mfma_f32_16x16x32_bf16 v[32:35], a[184:187], a[128:131], v[32:35]
 ds_read_b64_tr_b16 a[250:251], v12 offset:41984
 v_mfma_f32_16x16x32_bf16 v[56:59], a[184:187], a[132:135], v[56:59]
 v_mfma_f32_16x16x32_bf16 v[88:91], a[184:187], a[136:139], v[88:91]
 ds_read_b128 a[216:219], v5 offset:57344
 v_mfma_f32_16x16x32_bf16 v[120:123], a[184:187], a[140:143], v[120:123]
 v_mfma_f32_16x16x32_bf16 v[152:155], a[184:187], a[144:147], v[152:155]
 ds_read_b64_tr_b16 a[252:253], v13 offset:40960
 v_mfma_f32_16x16x32_bf16 v[184:187], a[184:187], a[148:151], v[184:187]
 v_mfma_f32_16x16x32_bf16 v[216:219], a[184:187], a[152:155], v[216:219]
 ds_read_b64_tr_b16 a[254:255], v13 offset:41984
 v_mfma_f32_16x16x32_bf16 v[248:251], a[184:187], a[156:159], v[248:251]
 v_mfma_f32_16x16x32_bf16 v[36:39], a[188:191], a[128:131], v[36:39]
 ds_read_b128 a[220:223], v5 offset:59392
 v_mfma_f32_16x16x32_bf16 v[60:63], a[188:191], a[132:135], v[60:63]
 v_mfma_f32_16x16x32_bf16 v[92:95], a[188:191], a[136:139], v[92:95]
 v_mfma_f32_16x16x32_bf16 v[124:127], a[188:191], a[140:143], v[124:127]
 v_mfma_f32_16x16x32_bf16 v[156:159], a[188:191], a[144:147], v[156:159]
 v_mfma_f32_16x16x32_bf16 v[188:191], a[188:191], a[148:151], v[188:191]
 v_mfma_f32_16x16x32_bf16 v[220:223], a[188:191], a[152:155], v[220:223]
 v_mfma_f32_16x16x32_bf16 v[252:255], a[188:191], a[156:159], v[252:255]
 s_waitcnt lgkmcnt(15)
 v_mfma_f32_16x16x32_bf16 v[24:27], a[224:227], a[192:195], v[24:27]
 s_waitcnt vmcnt(13) lgkmcnt(0)
 s_barrier
 v_mfma_f32_16x16x32_bf16 v[28:31], a[228:231], a[192:195], v[28:31]
 s_lshl_b32 s87, s3, 19
 v_mov_b32 v4, v20
 v_mov_b32 v5, v21
 v_mfma_f32_16x16x32_bf16 a[104:107], a[232:235], a[192:195], a[104:107]
 s_lshl_b32 s94, s63, 13
 s_add_u32 s87, s87, s94
 s_add_u32 m0, s82, 131072
 v_mfma_f32_16x16x32_bf16 a[108:111], a[236:239], a[192:195], a[108:111]
 s_and_b32 s94, s60, 1
 s_lshl_b32 s94, s94, 16
 s_add_u32 s87, s87, s94
 buffer_load_dwordx4 v2, s[24:27], 0 offen offset:0 lds
 v_mfma_f32_16x16x32_bf16 a[112:115], a[240:243], a[192:195], a[112:115]
 v_mfma_f32_16x16x32_bf16 a[116:119], a[244:247], a[192:195], a[116:119]
 v_mfma_f32_16x16x32_bf16 v[32:35], a[248:251], a[192:195], v[32:35]
 v_cvt_pk_bf16_f32 v24, v24, v25
 v_cvt_pk_bf16_f32 v25, v26, v27
 v_mfma_f32_16x16x32_bf16 v[36:39], a[252:255], a[192:195], v[36:39]
 v_cvt_pk_bf16_f32 v26, v28, v29
 v_cvt_pk_bf16_f32 v27, v30, v31
 v_mfma_f32_16x16x32_bf16 a[120:123], a[224:227], a[196:199], a[120:123]
 v_accvgpr_read_b32 v16, a104
 v_accvgpr_read_b32 v17, a105
 v_mfma_f32_16x16x32_bf16 a[124:127], a[228:231], a[196:199], a[124:127]
 buffer_load_dwordx4 v2, s[24:27], s71 offen offset:1024 lds
 v_mfma_f32_16x16x32_bf16 v[40:43], a[232:235], a[196:199], v[40:43]
 v_accvgpr_read_b32 v18, a106
 v_accvgpr_read_b32 v19, a107
 v_mfma_f32_16x16x32_bf16 v[44:47], a[236:239], a[196:199], v[44:47]
 s_add_u32 s83, s87, 0
 buffer_store_dwordx4 v[24:27], v14, s[4:7], s83 offen offset:0
 v_mfma_f32_16x16x32_bf16 v[48:51], a[240:243], a[196:199], v[48:51]
 v_accvgpr_read_b32 v20, a108
 v_accvgpr_read_b32 v21, a109
 v_mfma_f32_16x16x32_bf16 v[52:55], a[244:247], a[196:199], v[52:55]
 v_accvgpr_read_b32 v22, a110
 v_accvgpr_read_b32 v23, a111
 v_mfma_f32_16x16x32_bf16 v[56:59], a[248:251], a[196:199], v[56:59]
 v_cvt_pk_bf16_f32 v16, v16, v17
 v_cvt_pk_bf16_f32 v17, v18, v19
 v_mfma_f32_16x16x32_bf16 v[60:63], a[252:255], a[196:199], v[60:63]
 buffer_load_dwordx4 v3, s[24:27], s72 offen offset:2048 lds
 v_mfma_f32_16x16x32_bf16 v[64:67], a[224:227], a[200:203], v[64:67]
 v_cvt_pk_bf16_f32 v18, v20, v21
 v_cvt_pk_bf16_f32 v19, v22, v23
 v_mfma_f32_16x16x32_bf16 v[68:71], a[228:231], a[200:203], v[68:71]
 s_add_u32 s83, s87, 0
 buffer_store_dwordx4 v[16:19], v14, s[4:7], s83 offen offset:1024
 v_mfma_f32_16x16x32_bf16 v[72:75], a[232:235], a[200:203], v[72:75]
 v_accvgpr_read_b32 v20, a112
 v_accvgpr_read_b32 v21, a113
 v_mfma_f32_16x16x32_bf16 v[76:79], a[236:239], a[200:203], v[76:79]
 v_accvgpr_read_b32 v22, a114
 v_accvgpr_read_b32 v23, a115
 v_mfma_f32_16x16x32_bf16 v[80:83], a[240:243], a[200:203], v[80:83]
 v_accvgpr_read_b32 v28, a116
 v_accvgpr_read_b32 v29, a117
 v_mfma_f32_16x16x32_bf16 v[84:87], a[244:247], a[200:203], v[84:87]
 buffer_load_dwordx4 v3, s[24:27], s73 offen offset:3072 lds
 v_mfma_f32_16x16x32_bf16 v[88:91], a[248:251], a[200:203], v[88:91]
 v_accvgpr_read_b32 v30, a118
 v_accvgpr_read_b32 v31, a119
 v_mfma_f32_16x16x32_bf16 v[92:95], a[252:255], a[200:203], v[92:95]
 v_cvt_pk_bf16_f32 v20, v20, v21
 v_cvt_pk_bf16_f32 v21, v22, v23
 v_mfma_f32_16x16x32_bf16 v[96:99], a[224:227], a[204:207], v[96:99]
 v_cvt_pk_bf16_f32 v22, v28, v29
 v_cvt_pk_bf16_f32 v23, v30, v31
 v_mfma_f32_16x16x32_bf16 v[100:103], a[228:231], a[204:207], v[100:103]
 s_add_u32 s83, s87, 0
 buffer_store_dwordx4 v[20:23], v14, s[4:7], s83 offen offset:2048
 v_mfma_f32_16x16x32_bf16 v[104:107], a[232:235], a[204:207], v[104:107]
 v_cvt_pk_bf16_f32 v32, v32, v33
 v_cvt_pk_bf16_f32 v33, v34, v35
 v_mfma_f32_16x16x32_bf16 v[108:111], a[236:239], a[204:207], v[108:111]
 v_add_u32 v2, 0x80000, v2
 v_add_u32 v3, 0x80000, v3
 v_mfma_f32_16x16x32_bf16 v[112:115], a[240:243], a[204:207], v[112:115]
 v_cvt_pk_bf16_f32 v34, v36, v37
 v_cvt_pk_bf16_f32 v35, v38, v39
 v_mfma_f32_16x16x32_bf16 v[116:119], a[244:247], a[204:207], v[116:119]
 v_accvgpr_read_b32 v28, a120
 v_accvgpr_read_b32 v29, a121
 v_mfma_f32_16x16x32_bf16 v[120:123], a[248:251], a[204:207], v[120:123]
 ds_read_b64_tr_b16 a[144:145], v6 offset:0
 v_accvgpr_read_b32 v30, a122
 v_mfma_f32_16x16x32_bf16 v[124:127], a[252:255], a[204:207], v[124:127]
 ds_read_b64_tr_b16 a[146:147], v6 offset:1024
 s_add_u32 s83, s87, 0
 buffer_store_dwordx4 v[32:35], v14, s[4:7], s83 offen offset:3072
 v_mfma_f32_16x16x32_bf16 v[128:131], a[224:227], a[208:211], v[128:131]
 v_accvgpr_read_b32 v31, a123
 v_accvgpr_read_b32 v36, a124
 v_mfma_f32_16x16x32_bf16 v[132:135], a[228:231], a[208:211], v[132:135]
 ds_read_b64_tr_b16 a[148:149], v7 offset:0
 v_accvgpr_read_b32 v37, a125
 v_mfma_f32_16x16x32_bf16 v[136:139], a[232:235], a[208:211], v[136:139]
 v_accvgpr_read_b32 v38, a126
 v_accvgpr_read_b32 v39, a127
 v_mfma_f32_16x16x32_bf16 v[140:143], a[236:239], a[208:211], v[140:143]
 ds_read_b64_tr_b16 a[150:151], v7 offset:1024
 v_cvt_pk_bf16_f32 v28, v28, v29
 v_mfma_f32_16x16x32_bf16 v[144:147], a[240:243], a[208:211], v[144:147]
 v_cvt_pk_bf16_f32 v29, v30, v31
 v_cvt_pk_bf16_f32 v30, v36, v37
 v_mfma_f32_16x16x32_bf16 v[148:151], a[244:247], a[208:211], v[148:151]
 ds_read_b64_tr_b16 a[152:153], v8 offset:0
 v_cvt_pk_bf16_f32 v31, v38, v39
 v_mfma_f32_16x16x32_bf16 v[152:155], a[248:251], a[208:211], v[152:155]
 s_add_u32 s83, s87, 4096
 buffer_store_dwordx4 v[28:31], v14, s[4:7], s83 offen offset:0
 v_mfma_f32_16x16x32_bf16 v[156:159], a[252:255], a[208:211], v[156:159]
 ds_read_b64_tr_b16 a[154:155], v8 offset:1024
 v_cvt_pk_bf16_f32 v40, v40, v41
 v_mfma_f32_16x16x32_bf16 v[160:163], a[224:227], a[212:215], v[160:163]
 ds_read_b64_tr_b16 a[156:157], v9 offset:0
 v_cvt_pk_bf16_f32 v41, v42, v43
 v_mfma_f32_16x16x32_bf16 v[164:167], a[228:231], a[212:215], v[164:167]
 v_cvt_pk_bf16_f32 v42, v44, v45
 v_cvt_pk_bf16_f32 v43, v46, v47
 v_mfma_f32_16x16x32_bf16 v[168:171], a[232:235], a[212:215], v[168:171]
 ds_read_b64_tr_b16 a[158:159], v9 offset:1024
 v_cvt_pk_bf16_f32 v48, v48, v49
 v_mfma_f32_16x16x32_bf16 v[172:175], a[236:239], a[212:215], v[172:175]
 v_cvt_pk_bf16_f32 v49, v50, v51
 v_cvt_pk_bf16_f32 v50, v52, v53
 v_mfma_f32_16x16x32_bf16 v[176:179], a[240:243], a[212:215], v[176:179]
 ds_read_b64_tr_b16 a[160:161], v10 offset:0
 s_add_u32 s83, s87, 4096
 buffer_store_dwordx4 v[40:43], v14, s[4:7], s83 offen offset:1024
 v_mfma_f32_16x16x32_bf16 v[180:183], a[244:247], a[212:215], v[180:183]
 v_cvt_pk_bf16_f32 v51, v54, v55
 v_cvt_pk_bf16_f32 v56, v56, v57
 v_mfma_f32_16x16x32_bf16 v[184:187], a[248:251], a[212:215], v[184:187]
 ds_read_b64_tr_b16 a[162:163], v10 offset:1024
 v_cvt_pk_bf16_f32 v57, v58, v59
 v_mfma_f32_16x16x32_bf16 v[188:191], a[252:255], a[212:215], v[188:191]
 v_cvt_pk_bf16_f32 v58, v60, v61
 v_cvt_pk_bf16_f32 v59, v62, v63
 v_mfma_f32_16x16x32_bf16 v[192:195], a[224:227], a[216:219], v[192:195]
 ds_read_b64_tr_b16 a[164:165], v11 offset:0
 v_cvt_pk_bf16_f32 v64, v64, v65
 v_mfma_f32_16x16x32_bf16 v[196:199], a[228:231], a[216:219], v[196:199]
 ds_read_b64_tr_b16 a[166:167], v11 offset:1024
 v_cvt_pk_bf16_f32 v65, v66, v67
 v_mfma_f32_16x16x32_bf16 v[200:203], a[232:235], a[216:219], v[200:203]
 s_add_u32 s83, s87, 4096
 buffer_store_dwordx4 v[48:51], v14, s[4:7], s83 offen offset:2048
 v_mfma_f32_16x16x32_bf16 v[204:207], a[236:239], a[216:219], v[204:207]
 ds_read_b64_tr_b16 a[168:169], v12 offset:0
 v_cvt_pk_bf16_f32 v66, v68, v69
 v_mfma_f32_16x16x32_bf16 v[208:211], a[240:243], a[216:219], v[208:211]
 v_cvt_pk_bf16_f32 v67, v70, v71
 v_cvt_pk_bf16_f32 v72, v72, v73
 v_mfma_f32_16x16x32_bf16 v[212:215], a[244:247], a[216:219], v[212:215]
 ds_read_b64_tr_b16 a[170:171], v12 offset:1024
 v_cvt_pk_bf16_f32 v73, v74, v75
 v_mfma_f32_16x16x32_bf16 v[216:219], a[248:251], a[216:219], v[216:219]
 v_cvt_pk_bf16_f32 v74, v76, v77
 v_cvt_pk_bf16_f32 v75, v78, v79
 v_mfma_f32_16x16x32_bf16 v[220:223], a[252:255], a[216:219], v[220:223]
 ds_read_b64_tr_b16 a[172:173], v13 offset:0
 v_cvt_pk_bf16_f32 v80, v80, v81
 v_mfma_f32_16x16x32_bf16 v[224:227], a[224:227], a[220:223], v[224:227]
 s_add_u32 s83, s87, 4096
 buffer_store_dwordx4 v[56:59], v14, s[4:7], s83 offen offset:3072
 v_mfma_f32_16x16x32_bf16 v[228:231], a[228:231], a[220:223], v[228:231]
 ds_read_b64_tr_b16 a[174:175], v13 offset:1024
 v_cvt_pk_bf16_f32 v81, v82, v83
 v_mfma_f32_16x16x32_bf16 v[232:235], a[232:235], a[220:223], v[232:235]
 v_cvt_pk_bf16_f32 v82, v84, v85
 v_cvt_pk_bf16_f32 v83, v86, v87
 v_mfma_f32_16x16x32_bf16 v[236:239], a[236:239], a[220:223], v[236:239]
 v_cvt_pk_bf16_f32 v88, v88, v89
 v_cvt_pk_bf16_f32 v89, v90, v91
 v_mfma_f32_16x16x32_bf16 v[240:243], a[240:243], a[220:223], v[240:243]
 v_cvt_pk_bf16_f32 v90, v92, v93
 v_cvt_pk_bf16_f32 v91, v94, v95
 v_mfma_f32_16x16x32_bf16 v[244:247], a[244:247], a[220:223], v[244:247]
 v_cvt_pk_bf16_f32 v96, v96, v97
 v_cvt_pk_bf16_f32 v97, v98, v99
 v_mfma_f32_16x16x32_bf16 v[248:251], a[248:251], a[220:223], v[248:251]
 v_cvt_pk_bf16_f32 v98, v100, v101
 v_cvt_pk_bf16_f32 v99, v102, v103
 v_mfma_f32_16x16x32_bf16 v[252:255], a[252:255], a[220:223], v[252:255]
 v_cvt_pk_bf16_f32 v104, v104, v105
 v_cvt_pk_bf16_f32 v105, v106, v107
 v_cvt_pk_bf16_f32 v106, v108, v109
 v_cvt_pk_bf16_f32 v107, v110, v111
 v_cvt_pk_bf16_f32 v112, v112, v113
 v_cvt_pk_bf16_f32 v113, v114, v115
 v_cvt_pk_bf16_f32 v114, v116, v117
 v_cvt_pk_bf16_f32 v115, v118, v119
 v_cvt_pk_bf16_f32 v120, v120, v121
 v_cvt_pk_bf16_f32 v121, v122, v123
 v_cvt_pk_bf16_f32 v122, v124, v125
 v_cvt_pk_bf16_f32 v123, v126, v127
 v_cvt_pk_bf16_f32 v128, v128, v129
 v_cvt_pk_bf16_f32 v129, v130, v131
 v_cvt_pk_bf16_f32 v130, v132, v133
 v_cvt_pk_bf16_f32 v131, v134, v135
 v_cvt_pk_bf16_f32 v136, v136, v137
 v_cvt_pk_bf16_f32 v137, v138, v139
 v_cvt_pk_bf16_f32 v138, v140, v141
 v_cvt_pk_bf16_f32 v139, v142, v143
 v_cvt_pk_bf16_f32 v144, v144, v145
 v_cvt_pk_bf16_f32 v145, v146, v147
 v_cvt_pk_bf16_f32 v146, v148, v149
 v_cvt_pk_bf16_f32 v147, v150, v151
 v_cvt_pk_bf16_f32 v152, v152, v153
 v_cvt_pk_bf16_f32 v153, v154, v155
 v_cvt_pk_bf16_f32 v154, v156, v157
 v_cvt_pk_bf16_f32 v155, v158, v159
 s_branch L_q
L_kv1:
 s_waitcnt lgkmcnt(15)
 v_mfma_f32_16x16x32_bf16 v[24:27], a[128:131], a[160:163], 0
 buffer_load_dwordx4 v2, s[16:19], 0 offen offset:0 lds
 v_mfma_f32_16x16x32_bf16 a[104:107], a[128:131], a[164:167], 0
 v_mfma_f32_16x16x32_bf16 a[112:115], a[128:131], a[168:171], 0
 s_waitcnt lgkmcnt(13)
 ds_read_b64_tr_b16 a[224:225], v6 offset:8192
 v_mfma_f32_16x16x32_bf16 v[32:35], a[128:131], a[172:175], 0
 s_waitcnt lgkmcnt(11)
 v_mfma_f32_16x16x32_bf16 a[120:123], a[128:131], a[176:179], 0
 s_waitcnt lgkmcnt(8)
 buffer_load_dwordx4 v2, s[16:19], s71 offen offset:1024 lds
 v_mfma_f32_16x16x32_bf16 v[40:43], a[128:131], a[180:183], 0
 s_waitcnt lgkmcnt(5)
 ds_read_b64_tr_b16 a[226:227], v6 offset:9216
 v_mfma_f32_16x16x32_bf16 v[48:51], a[128:131], a[184:187], 0
 s_waitcnt lgkmcnt(3)
 v_mfma_f32_16x16x32_bf16 v[56:59], a[128:131], a[188:191], 0
 ds_read_b128 a[192:195], v5 offset:0
 v_mfma_f32_16x16x32_bf16 v[28:31], a[132:135], a[160:163], 0
 buffer_load_dwordx4 v3, s[16:19], s72 offen offset:2048 lds
 v_mfma_f32_16x16x32_bf16 a[108:111], a[132:135], a[164:167], 0
 v_mfma_f32_16x16x32_bf16 a[116:119], a[132:135], a[168:171], 0
 ds_read_b64_tr_b16 a[228:229], v7 offset:8192
 v_mfma_f32_16x16x32_bf16 v[36:39], a[132:135], a[172:175], 0
 v_mfma_f32_16x16x32_bf16 a[124:127], a[132:135], a[176:179], 0
 buffer_load_dwordx4 v3, s[16:19], s73 offen offset:3072 lds
 s_add_u32 m0, s82, 147456
 v_mfma_f32_16x16x32_bf16 v[44:47], a[132:135], a[180:183], 0
 ds_read_b64_tr_b16 a[230:231], v7 offset:9216
 v_mfma_f32_16x16x32_bf16 v[52:55], a[132:135], a[184:187], 0
 v_mfma_f32_16x16x32_bf16 v[60:63], a[132:135], a[188:191], 0
 ds_read_b128 a[196:199], v5 offset:2048
 v_mfma_f32_16x16x32_bf16 v[64:67], a[136:139], a[160:163], 0
 buffer_load_dwordx4 v2, s[20:23], 0 offen offset:0 lds
 v_mfma_f32_16x16x32_bf16 v[72:75], a[136:139], a[164:167], 0
 v_mfma_f32_16x16x32_bf16 v[80:83], a[136:139], a[168:171], 0
 ds_read_b64_tr_b16 a[232:233], v8 offset:8192
 v_mfma_f32_16x16x32_bf16 v[88:91], a[136:139], a[172:175], 0
 v_mfma_f32_16x16x32_bf16 v[96:99], a[136:139], a[176:179], 0
 buffer_load_dwordx4 v2, s[20:23], s71 offen offset:1024 lds
 v_mfma_f32_16x16x32_bf16 v[104:107], a[136:139], a[180:183], 0
 ds_read_b64_tr_b16 a[234:235], v8 offset:9216
 v_mfma_f32_16x16x32_bf16 v[112:115], a[136:139], a[184:187], 0
 v_mfma_f32_16x16x32_bf16 v[120:123], a[136:139], a[188:191], 0
 ds_read_b128 a[200:203], v5 offset:8192
 v_mfma_f32_16x16x32_bf16 v[68:71], a[140:143], a[160:163], 0
 buffer_load_dwordx4 v3, s[20:23], s72 offen offset:2048 lds
 v_mfma_f32_16x16x32_bf16 v[76:79], a[140:143], a[164:167], 0
 v_mfma_f32_16x16x32_bf16 v[84:87], a[140:143], a[168:171], 0
 ds_read_b64_tr_b16 a[236:237], v9 offset:8192
 v_mfma_f32_16x16x32_bf16 v[92:95], a[140:143], a[172:175], 0
 v_mfma_f32_16x16x32_bf16 v[100:103], a[140:143], a[176:179], 0
 buffer_load_dwordx4 v3, s[20:23], s73 offen offset:3072 lds
 v_mfma_f32_16x16x32_bf16 v[108:111], a[140:143], a[180:183], 0
 ds_read_b64_tr_b16 a[238:239], v9 offset:9216
 v_mfma_f32_16x16x32_bf16 v[116:119], a[140:143], a[184:187], 0
 v_mfma_f32_16x16x32_bf16 v[124:127], a[140:143], a[188:191], 0
 ds_read_b128 a[204:207], v5 offset:10240
 v_mfma_f32_16x16x32_bf16 v[128:131], a[144:147], a[160:163], 0
 buffer_load_dword a100, v16, s[40:43], s88 offen
 s_add_u32 s88, s88, s89
 v_add_u32 v0, 0x80, v0
 v_add_u32 v1, 0x80, v1
 v_mfma_f32_16x16x32_bf16 v[136:139], a[144:147], a[164:167], 0
 v_add_u32 v2, 0x80000, v2
 v_add_u32 v3, 0x80000, v3
 v_mfma_f32_16x16x32_bf16 v[144:147], a[144:147], a[168:171], 0
 ds_read_b64_tr_b16 a[240:241], v10 offset:8192
 v_mfma_f32_16x16x32_bf16 v[152:155], a[144:147], a[172:175], 0
 v_mfma_f32_16x16x32_bf16 v[160:163], a[144:147], a[176:179], 0
 ds_read_b64_tr_b16 a[242:243], v10 offset:9216
 v_mfma_f32_16x16x32_bf16 v[168:171], a[144:147], a[180:183], 0
 v_mfma_f32_16x16x32_bf16 v[176:179], a[144:147], a[184:187], 0
 ds_read_b128 a[208:211], v5 offset:16384
 v_mfma_f32_16x16x32_bf16 v[184:187], a[144:147], a[188:191], 0
 v_mfma_f32_16x16x32_bf16 v[132:135], a[148:151], a[160:163], 0
 ds_read_b64_tr_b16 a[244:245], v11 offset:8192
 v_mfma_f32_16x16x32_bf16 v[140:143], a[148:151], a[164:167], 0
 v_mfma_f32_16x16x32_bf16 v[148:151], a[148:151], a[168:171], 0
 ds_read_b64_tr_b16 a[246:247], v11 offset:9216
 v_mfma_f32_16x16x32_bf16 v[156:159], a[148:151], a[172:175], 0
 v_mfma_f32_16x16x32_bf16 v[164:167], a[148:151], a[176:179], 0
 ds_read_b128 a[212:215], v5 offset:18432
 v_mfma_f32_16x16x32_bf16 v[172:175], a[148:151], a[180:183], 0
 v_mfma_f32_16x16x32_bf16 v[180:183], a[148:151], a[184:187], 0
 ds_read_b64_tr_b16 a[248:249], v12 offset:8192
 v_mfma_f32_16x16x32_bf16 v[188:191], a[148:151], a[188:191], 0
 v_mfma_f32_16x16x32_bf16 v[192:195], a[152:155], a[160:163], 0
 ds_read_b64_tr_b16 a[250:251], v12 offset:9216
 v_mfma_f32_16x16x32_bf16 v[200:203], a[152:155], a[164:167], 0
 v_mfma_f32_16x16x32_bf16 v[208:211], a[152:155], a[168:171], 0
 ds_read_b128 a[216:219], v5 offset:24576
 v_mfma_f32_16x16x32_bf16 v[216:219], a[152:155], a[172:175], 0
 v_mfma_f32_16x16x32_bf16 v[224:227], a[152:155], a[176:179], 0
 ds_read_b64_tr_b16 a[252:253], v13 offset:8192
 v_mfma_f32_16x16x32_bf16 v[232:235], a[152:155], a[180:183], 0
 v_mfma_f32_16x16x32_bf16 v[240:243], a[152:155], a[184:187], 0
 ds_read_b64_tr_b16 a[254:255], v13 offset:9216
 v_mfma_f32_16x16x32_bf16 v[248:251], a[152:155], a[188:191], 0
 s_waitcnt lgkmcnt(15)
 v_mfma_f32_16x16x32_bf16 v[196:199], a[156:159], a[160:163], 0
 ds_read_b128 a[220:223], v5 offset:26624
 v_mfma_f32_16x16x32_bf16 v[204:207], a[156:159], a[164:167], 0
 v_mfma_f32_16x16x32_bf16 v[212:215], a[156:159], a[168:171], 0
 v_mfma_f32_16x16x32_bf16 v[220:223], a[156:159], a[172:175], 0
 v_mfma_f32_16x16x32_bf16 v[228:231], a[156:159], a[176:179], 0
 v_mfma_f32_16x16x32_bf16 v[236:239], a[156:159], a[180:183], 0
 v_mfma_f32_16x16x32_bf16 v[244:247], a[156:159], a[184:187], 0
 v_mfma_f32_16x16x32_bf16 v[252:255], a[156:159], a[188:191], 0
 v_mfma_f32_16x16x32_bf16 v[24:27], a[192:195], a[224:227], v[24:27]
 v_mfma_f32_16x16x32_bf16 a[104:107], a[192:195], a[228:231], a[104:107]
 v_mfma_f32_16x16x32_bf16 a[112:115], a[192:195], a[232:235], a[112:115]
 s_waitcnt lgkmcnt(13)
 v_mfma_f32_16x16x32_bf16 v[32:35], a[192:195], a[236:239], v[32:35]
 s_waitcnt lgkmcnt(10)
 v_mfma_f32_16x16x32_bf16 a[120:123], a[192:195], a[240:243], a[120:123]
 s_waitcnt lgkmcnt(7)
 v_mfma_f32_16x16x32_bf16 v[40:43], a[192:195], a[244:247], v[40:43]
 s_waitcnt lgkmcnt(4)
 v_mfma_f32_16x16x32_bf16 v[48:51], a[192:195], a[248:251], v[48:51]
 s_waitcnt lgkmcnt(1)
 v_mfma_f32_16x16x32_bf16 v[56:59], a[192:195], a[252:255], v[56:59]
 v_mfma_f32_16x16x32_bf16 v[28:31], a[196:199], a[224:227], v[28:31]
 v_mfma_f32_16x16x32_bf16 a[108:111], a[196:199], a[228:231], a[108:111]
 v_mfma_f32_16x16x32_bf16 a[116:119], a[196:199], a[232:235], a[116:119]
 v_mfma_f32_16x16x32_bf16 v[36:39], a[196:199], a[236:239], v[36:39]
 v_mfma_f32_16x16x32_bf16 a[124:127], a[196:199], a[240:243], a[124:127]
 v_mfma_f32_16x16x32_bf16 v[44:47], a[196:199], a[244:247], v[44:47]
 v_mfma_f32_16x16x32_bf16 v[52:55], a[196:199], a[248:251], v[52:55]
 v_mfma_f32_16x16x32_bf16 v[60:63], a[196:199], a[252:255], v[60:63]
 v_mfma_f32_16x16x32_bf16 v[64:67], a[200:203], a[224:227], v[64:67]
 v_mfma_f32_16x16x32_bf16 v[72:75], a[200:203], a[228:231], v[72:75]
 v_mfma_f32_16x16x32_bf16 v[80:83], a[200:203], a[232:235], v[80:83]
 v_mfma_f32_16x16x32_bf16 v[88:91], a[200:203], a[236:239], v[88:91]
 v_mfma_f32_16x16x32_bf16 v[96:99], a[200:203], a[240:243], v[96:99]
 v_mfma_f32_16x16x32_bf16 v[104:107], a[200:203], a[244:247], v[104:107]
 v_mfma_f32_16x16x32_bf16 v[112:115], a[200:203], a[248:251], v[112:115]
 v_mfma_f32_16x16x32_bf16 v[120:123], a[200:203], a[252:255], v[120:123]
 v_mfma_f32_16x16x32_bf16 v[68:71], a[204:207], a[224:227], v[68:71]
 s_waitcnt vmcnt(1) lgkmcnt(0)
 s_barrier
 v_mfma_f32_16x16x32_bf16 v[76:79], a[204:207], a[228:231], v[76:79]
 s_add_u32 m0, s81, 32768
 ds_read_b64_tr_b16 a[160:161], v6 offset:32768
 v_mfma_f32_16x16x32_bf16 v[84:87], a[204:207], a[232:235], v[84:87]
 buffer_load_dwordx4 v0, s[12:15], 0 offen offset:0 lds
 v_mfma_f32_16x16x32_bf16 v[92:95], a[204:207], a[236:239], v[92:95]
 ds_read_b64_tr_b16 a[162:163], v6 offset:33792
 v_mfma_f32_16x16x32_bf16 v[100:103], a[204:207], a[240:243], v[100:103]
 ds_read_b128 a[128:131], v4 offset:32768
 v_mfma_f32_16x16x32_bf16 v[108:111], a[204:207], a[244:247], v[108:111]
 ds_read_b64_tr_b16 a[164:165], v7 offset:32768
 v_mfma_f32_16x16x32_bf16 v[116:119], a[204:207], a[248:251], v[116:119]
 ds_read_b64_tr_b16 a[166:167], v7 offset:33792
 v_mfma_f32_16x16x32_bf16 v[124:127], a[204:207], a[252:255], v[124:127]
 buffer_load_dwordx4 v1, s[12:15], s64 offen offset:1024 lds
 v_mfma_f32_16x16x32_bf16 v[128:131], a[208:211], a[224:227], v[128:131]
 ds_read_b128 a[132:135], v4 offset:34816
 v_mfma_f32_16x16x32_bf16 v[136:139], a[208:211], a[228:231], v[136:139]
 ds_read_b64_tr_b16 a[168:169], v8 offset:32768
 v_mfma_f32_16x16x32_bf16 v[144:147], a[208:211], a[232:235], v[144:147]
 ds_read_b64_tr_b16 a[170:171], v8 offset:33792
 v_mfma_f32_16x16x32_bf16 v[152:155], a[208:211], a[236:239], v[152:155]
 ds_read_b128 a[136:139], v4 offset:40960
 v_mfma_f32_16x16x32_bf16 v[160:163], a[208:211], a[240:243], v[160:163]
 buffer_load_dwordx4 v0, s[12:15], s65 offen offset:2048 lds
 v_mfma_f32_16x16x32_bf16 v[168:171], a[208:211], a[244:247], v[168:171]
 ds_read_b64_tr_b16 a[172:173], v9 offset:32768
 v_mfma_f32_16x16x32_bf16 v[176:179], a[208:211], a[248:251], v[176:179]
 ds_read_b64_tr_b16 a[174:175], v9 offset:33792
 v_mfma_f32_16x16x32_bf16 v[184:187], a[208:211], a[252:255], v[184:187]
 ds_read_b128 a[140:143], v4 offset:43008
 v_mfma_f32_16x16x32_bf16 v[132:135], a[212:215], a[224:227], v[132:135]
 v_mfma_f32_16x16x32_bf16 v[140:143], a[212:215], a[228:231], v[140:143]
 buffer_load_dwordx4 v1, s[12:15], s66 offen offset:3072 lds
 s_add_u32 m0, s81, 36864
 v_mfma_f32_16x16x32_bf16 v[148:151], a[212:215], a[232:235], v[148:151]
 ds_read_b64_tr_b16 a[176:177], v10 offset:32768
 v_mfma_f32_16x16x32_bf16 v[156:159], a[212:215], a[236:239], v[156:159]
 ds_read_b64_tr_b16 a[178:179], v10 offset:33792
 v_mfma_f32_16x16x32_bf16 v[164:167], a[212:215], a[240:243], v[164:167]
 ds_read_b128 a[144:147], v4 offset:49152
 v_mfma_f32_16x16x32_bf16 v[172:175], a[212:215], a[244:247], v[172:175]
 ds_read_b64_tr_b16 a[180:181], v11 offset:32768
 v_mfma_f32_16x16x32_bf16 v[180:183], a[212:215], a[248:251], v[180:183]
 buffer_load_dwordx4 v0, s[12:15], s67 offen offset:0 lds
 v_mfma_f32_16x16x32_bf16 v[188:191], a[212:215], a[252:255], v[188:191]
 ds_read_b64_tr_b16 a[182:183], v11 offset:33792
 v_mfma_f32_16x16x32_bf16 v[192:195], a[216:219], a[224:227], v[192:195]
 ds_read_b128 a[148:151], v4 offset:51200
 v_mfma_f32_16x16x32_bf16 v[200:203], a[216:219], a[228:231], v[200:203]
 ds_read_b64_tr_b16 a[184:185], v12 offset:32768
 v_mfma_f32_16x16x32_bf16 v[208:211], a[216:219], a[232:235], v[208:211]
 ds_read_b64_tr_b16 a[186:187], v12 offset:33792
 v_mfma_f32_16x16x32_bf16 v[216:219], a[216:219], a[236:239], v[216:219]
 buffer_load_dwordx4 v1, s[12:15], s68 offen offset:1024 lds
 v_mfma_f32_16x16x32_bf16 v[224:227], a[216:219], a[240:243], v[224:227]
 ds_read_b128 a[152:155], v4 offset:57344
 v_mfma_f32_16x16x32_bf16 v[232:235], a[216:219], a[244:247], v[232:235]
 ds_read_b64_tr_b16 a[188:189], v13 offset:32768
 v_mfma_f32_16x16x32_bf16 v[240:243], a[216:219], a[248:251], v[240:243]
 ds_read_b64_tr_b16 a[190:191], v13 offset:33792
 v_mfma_f32_16x16x32_bf16 v[248:251], a[216:219], a[252:255], v[248:251]
 ds_read_b128 a[156:159], v4 offset:59392
 v_mfma_f32_16x16x32_bf16 v[196:199], a[220:223], a[224:227], v[196:199]
 buffer_load_dwordx4 v0, s[12:15], s69 offen offset:2048 lds
 v_mfma_f32_16x16x32_bf16 v[204:207], a[220:223], a[228:231], v[204:207]
 v_mfma_f32_16x16x32_bf16 v[212:215], a[220:223], a[232:235], v[212:215]
 v_mfma_f32_16x16x32_bf16 v[220:223], a[220:223], a[236:239], v[220:223]
 v_mfma_f32_16x16x32_bf16 v[228:231], a[220:223], a[240:243], v[228:231]
 v_mfma_f32_16x16x32_bf16 v[236:239], a[220:223], a[244:247], v[236:239]
 buffer_load_dwordx4 v1, s[12:15], s70 offen offset:3072 lds
 s_add_u32 m0, s82, 98304
 v_mfma_f32_16x16x32_bf16 v[244:247], a[220:223], a[248:251], v[244:247]
 v_mfma_f32_16x16x32_bf16 v[252:255], a[220:223], a[252:255], v[252:255]
 s_waitcnt lgkmcnt(15)
 v_mfma_f32_16x16x32_bf16 v[24:27], a[128:131], a[160:163], v[24:27]
 v_mfma_f32_16x16x32_bf16 a[104:107], a[128:131], a[164:167], a[104:107]
 v_mfma_f32_16x16x32_bf16 a[112:115], a[128:131], a[168:171], a[112:115]
 s_waitcnt lgkmcnt(13)
 buffer_load_dwordx4 v2, s[16:19], 0 offen offset:0 lds
 v_mfma_f32_16x16x32_bf16 v[32:35], a[128:131], a[172:175], v[32:35]
 s_waitcnt lgkmcnt(10)
 ds_read_b64_tr_b16 a[224:225], v6 offset:40960
 v_mfma_f32_16x16x32_bf16 a[120:123], a[128:131], a[176:179], a[120:123]
 s_waitcnt lgkmcnt(8)
 ds_read_b64_tr_b16 a[226:227], v6 offset:41984
 v_mfma_f32_16x16x32_bf16 v[40:43], a[128:131], a[180:183], v[40:43]
 s_waitcnt lgkmcnt(6)
 v_mfma_f32_16x16x32_bf16 v[48:51], a[128:131], a[184:187], v[48:51]
 s_waitcnt lgkmcnt(3)
 ds_read_b128 a[192:195], v5 offset:32768
 v_mfma_f32_16x16x32_bf16 v[56:59], a[128:131], a[188:191], v[56:59]
 buffer_load_dwordx4 v2, s[16:19], s71 offen offset:1024 lds
 v_mfma_f32_16x16x32_bf16 v[28:31], a[132:135], a[160:163], v[28:31]
 v_mfma_f32_16x16x32_bf16 a[108:111], a[132:135], a[164:167], a[108:111]
 ds_read_b64_tr_b16 a[228:229], v7 offset:40960
 v_mfma_f32_16x16x32_bf16 a[116:119], a[132:135], a[168:171], a[116:119]
 v_mfma_f32_16x16x32_bf16 v[36:39], a[132:135], a[172:175], v[36:39]
 ds_read_b64_tr_b16 a[230:231], v7 offset:41984
 v_mfma_f32_16x16x32_bf16 a[124:127], a[132:135], a[176:179], a[124:127]
 buffer_load_dwordx4 v3, s[16:19], s72 offen offset:2048 lds
 v_mfma_f32_16x16x32_bf16 v[44:47], a[132:135], a[180:183], v[44:47]
 v_mfma_f32_16x16x32_bf16 v[52:55], a[132:135], a[184:187], v[52:55]
 ds_read_b128 a[196:199], v5 offset:34816
 v_mfma_f32_16x16x32_bf16 v[60:63], a[132:135], a[188:191], v[60:63]
 v_mfma_f32_16x16x32_bf16 v[64:67], a[136:139], a[160:163], v[64:67]
 ds_read_b64_tr_b16 a[232:233], v8 offset:40960
 v_mfma_f32_16x16x32_bf16 v[72:75], a[136:139], a[164:167], v[72:75]
 buffer_load_dwordx4 v3, s[16:19], s73 offen offset:3072 lds
 s_add_u32 m0, s82, 114688
 v_mfma_f32_16x16x32_bf16 v[80:83], a[136:139], a[168:171], v[80:83]
 v_mfma_f32_16x16x32_bf16 v[88:91], a[136:139], a[172:175], v[88:91]
 ds_read_b64_tr_b16 a[234:235], v8 offset:41984
 v_mfma_f32_16x16x32_bf16 v[96:99], a[136:139], a[176:179], v[96:99]
 v_mfma_f32_16x16x32_bf16 v[104:107], a[136:139], a[180:183], v[104:107]
 ds_read_b128 a[200:203], v5 offset:40960
 v_mfma_f32_16x16x32_bf16 v[112:115], a[136:139], a[184:187], v[112:115]
 buffer_load_dwordx4 v2, s[20:23], 0 offen offset:0 lds
 v_mfma_f32_16x16x32_bf16 v[120:123], a[136:139], a[188:191], v[120:123]
 ds_read_b64_tr_b16 a[236:237], v9 offset:40960
 v_mfma_f32_16x16x32_bf16 v[68:71], a[140:143], a[160:163], v[68:71]
 v_mfma_f32_16x16x32_bf16 v[76:79], a[140:143], a[164:167], v[76:79]
 ds_read_b64_tr_b16 a[238:239], v9 offset:41984
 v_mfma_f32_16x16x32_bf16 v[84:87], a[140:143], a[168:171], v[84:87]
 v_mfma_f32_16x16x32_bf16 v[92:95], a[140:143], a[172:175], v[92:95]
 buffer_load_dwordx4 v2, s[20:23], s71 offen offset:1024 lds
 v_mfma_f32_16x16x32_bf16 v[100:103], a[140:143], a[176:179], v[100:103]
 ds_read_b128 a[204:207], v5 offset:43008
 v_mfma_f32_16x16x32_bf16 v[108:111], a[140:143], a[180:183], v[108:111]
 v_mfma_f32_16x16x32_bf16 v[116:119], a[140:143], a[184:187], v[116:119]
 ds_read_b64_tr_b16 a[240:241], v10 offset:40960
 v_mfma_f32_16x16x32_bf16 v[124:127], a[140:143], a[188:191], v[124:127]
 v_mfma_f32_16x16x32_bf16 v[128:131], a[144:147], a[160:163], v[128:131]
 buffer_load_dwordx4 v3, s[20:23], s72 offen offset:2048 lds
 v_mfma_f32_16x16x32_bf16 v[136:139], a[144:147], a[164:167], v[136:139]
 ds_read_b64_tr_b16 a[242:243], v10 offset:41984
 v_mfma_f32_16x16x32_bf16 v[144:147], a[144:147], a[168:171], v[144:147]
 v_mfma_f32_16x16x32_bf16 v[152:155], a[144:147], a[172:175], v[152:155]
 ds_read_b128 a[208:211], v5 offset:49152
 v_mfma_f32_16x16x32_bf16 v[160:163], a[144:147], a[176:179], v[160:163]
 v_mfma_f32_16x16x32_bf16 v[168:171], a[144:147], a[180:183], v[168:171]
 buffer_load_dwordx4 v3, s[20:23], s73 offen offset:3072 lds
 v_mfma_f32_16x16x32_bf16 v[176:179], a[144:147], a[184:187], v[176:179]
 ds_read_b64_tr_b16 a[244:245], v11 offset:40960
 v_mfma_f32_16x16x32_bf16 v[184:187], a[144:147], a[188:191], v[184:187]
 v_mfma_f32_16x16x32_bf16 v[132:135], a[148:151], a[160:163], v[132:135]
 ds_read_b64_tr_b16 a[246:247], v11 offset:41984
 v_mfma_f32_16x16x32_bf16 v[140:143], a[148:151], a[164:167], v[140:143]
 ds_read_b128 a[212:215], v5 offset:51200
 v_mfma_f32_16x16x32_bf16 v[148:151], a[148:151], a[168:171], v[148:151]
 v_add_u32 v0, 0x80, v0
 v_add_u32 v1, 0x80, v1
 v_mfma_f32_16x16x32_bf16 v[156:159], a[148:151], a[172:175], v[156:159]
 ds_read_b64_tr_b16 a[248:249], v12 offset:40960
 v_add_u32 v2, 0x80000, v2
 v_add_u32 v3, 0x80000, v3
 v_mfma_f32_16x16x32_bf16 v[164:167], a[148:151], a[176:179], v[164:167]
 v_mfma_f32_16x16x32_bf16 v[172:175], a[148:151], a[180:183], v[172:175]
 ds_read_b64_tr_b16 a[250:251], v12 offset:41984
 v_mfma_f32_16x16x32_bf16 v[180:183], a[148:151], a[184:187], v[180:183]
 v_mfma_f32_16x16x32_bf16 v[188:191], a[148:151], a[188:191], v[188:191]
 ds_read_b128 a[216:219], v5 offset:57344
 v_mfma_f32_16x16x32_bf16 v[192:195], a[152:155], a[160:163], v[192:195]
 s_add_u32 m0, s81, 0
 v_mfma_f32_16x16x32_bf16 v[200:203], a[152:155], a[164:167], v[200:203]
 buffer_load_dwordx4 v17, s[8:11], 0 offen offset:0 lds
 v_mfma_f32_16x16x32_bf16 v[208:211], a[152:155], a[168:171], v[208:211]
 ds_read_b64_tr_b16 a[252:253], v13 offset:40960
 v_mfma_f32_16x16x32_bf16 v[216:219], a[152:155], a[172:175], v[216:219]
 v_mfma_f32_16x16x32_bf16 v[224:227], a[152:155], a[176:179], v[224:227]
 ds_read_b64_tr_b16 a[254:255], v13 offset:41984
 v_mfma_f32_16x16x32_bf16 v[232:235], a[152:155], a[180:183], v[232:235]
 buffer_load_dwordx4 v18, s[8:11], s74 offen offset:1024 lds
 v_mfma_f32_16x16x32_bf16 v[240:243], a[152:155], a[184:187], v[240:243]
 v_mfma_f32_16x16x32_bf16 v[248:251], a[152:155], a[188:191], v[248:251]
 s_waitcnt lgkmcnt(15)
 ds_read_b128 a[220:223], v5 offset:59392
 v_mfma_f32_16x16x32_bf16 v[196:199], a[156:159], a[160:163], v[196:199]
 v_mfma_f32_16x16x32_bf16 v[204:207], a[156:159], a[164:167], v[204:207]
 buffer_load_dwordx4 v17, s[8:11], s75 offen offset:2048 lds
 v_mfma_f32_16x16x32_bf16 v[212:215], a[156:159], a[168:171], v[212:215]
 v_mfma_f32_16x16x32_bf16 v[220:223], a[156:159], a[172:175], v[220:223]
 v_mfma_f32_16x16x32_bf16 v[228:231], a[156:159], a[176:179], v[228:231]
 v_mfma_f32_16x16x32_bf16 v[236:239], a[156:159], a[180:183], v[236:239]
 buffer_load_dwordx4 v18, s[8:11], s76 offen offset:3072 lds
 s_add_u32 m0, s81, 4096
 v_mfma_f32_16x16x32_bf16 v[244:247], a[156:159], a[184:187], v[244:247]
 v_mfma_f32_16x16x32_bf16 v[252:255], a[156:159], a[188:191], v[252:255]
 v_mfma_f32_16x16x32_bf16 v[24:27], a[192:195], a[224:227], v[24:27]
 v_mfma_f32_16x16x32_bf16 a[104:107], a[192:195], a[228:231], a[104:107]
 buffer_load_dwordx4 v17, s[8:11], s77 offen offset:0 lds
 v_mfma_f32_16x16x32_bf16 a[112:115], a[192:195], a[232:235], a[112:115]
 s_waitcnt lgkmcnt(13)
 v_mfma_f32_16x16x32_bf16 v[32:35], a[192:195], a[236:239], v[32:35]
 s_waitcnt lgkmcnt(10)
 v_mfma_f32_16x16x32_bf16 a[120:123], a[192:195], a[240:243], a[120:123]
 s_waitcnt lgkmcnt(7)
 v_mfma_f32_16x16x32_bf16 v[40:43], a[192:195], a[244:247], v[40:43]
 s_waitcnt lgkmcnt(4)
 buffer_load_dwordx4 v18, s[8:11], s78 offen offset:1024 lds
 v_mfma_f32_16x16x32_bf16 v[48:51], a[192:195], a[248:251], v[48:51]
 s_waitcnt lgkmcnt(1)
 v_mfma_f32_16x16x32_bf16 v[56:59], a[192:195], a[252:255], v[56:59]
 v_mfma_f32_16x16x32_bf16 v[28:31], a[196:199], a[224:227], v[28:31]
 v_mfma_f32_16x16x32_bf16 a[108:111], a[196:199], a[228:231], a[108:111]
 buffer_load_dwordx4 v17, s[8:11], s79 offen offset:2048 lds
 v_mfma_f32_16x16x32_bf16 a[116:119], a[196:199], a[232:235], a[116:119]
 v_mfma_f32_16x16x32_bf16 v[36:39], a[196:199], a[236:239], v[36:39]
 v_mfma_f32_16x16x32_bf16 a[124:127], a[196:199], a[240:243], a[124:127]
 v_mfma_f32_16x16x32_bf16 v[44:47], a[196:199], a[244:247], v[44:47]
 buffer_load_dwordx4 v18, s[8:11], s80 offen offset:3072 lds
 v_mfma_f32_16x16x32_bf16 v[52:55], a[196:199], a[248:251], v[52:55]
 v_mfma_f32_16x16x32_bf16 v[60:63], a[196:199], a[252:255], v[60:63]
 v_mfma_f32_16x16x32_bf16 v[64:67], a[200:203], a[224:227], v[64:67]
 v_mfma_f32_16x16x32_bf16 v[72:75], a[200:203], a[228:231], v[72:75]
 buffer_load_dword a100, v16, s[40:43], s88 offen
 s_add_u32 s88, s88, s89
 v_add_u32 v17, 0x80, v17
 v_add_u32 v18, 0x80, v18
 v_mfma_f32_16x16x32_bf16 v[80:83], a[200:203], a[232:235], v[80:83]
 v_mfma_f32_16x16x32_bf16 v[88:91], a[200:203], a[236:239], v[88:91]
 v_mfma_f32_16x16x32_bf16 v[96:99], a[200:203], a[240:243], v[96:99]
 v_mfma_f32_16x16x32_bf16 v[104:107], a[200:203], a[244:247], v[104:107]
 v_mfma_f32_16x16x32_bf16 v[112:115], a[200:203], a[248:251], v[112:115]
 v_mfma_f32_16x16x32_bf16 v[120:123], a[200:203], a[252:255], v[120:123]
 v_mfma_f32_16x16x32_bf16 v[68:71], a[204:207], a[224:227], v[68:71]
 s_waitcnt vmcnt(9) lgkmcnt(0)
 s_barrier
 v_mfma_f32_16x16x32_bf16 v[76:79], a[204:207], a[228:231], v[76:79]
 s_add_u32 m0, s81, 65536
 ds_read_b64_tr_b16 a[160:161], v6 offset:0
 v_mfma_f32_16x16x32_bf16 v[84:87], a[204:207], a[232:235], v[84:87]
 buffer_load_dwordx4 v0, s[12:15], 0 offen offset:0 lds
 v_mfma_f32_16x16x32_bf16 v[92:95], a[204:207], a[236:239], v[92:95]
 ds_read_b64_tr_b16 a[162:163], v6 offset:1024
 v_mfma_f32_16x16x32_bf16 v[100:103], a[204:207], a[240:243], v[100:103]
 ds_read_b128 a[128:131], v4 offset:0
 v_mfma_f32_16x16x32_bf16 v[108:111], a[204:207], a[244:247], v[108:111]
 ds_read_b64_tr_b16 a[164:165], v7 offset:0
 v_mfma_f32_16x16x32_bf16 v[116:119], a[204:207], a[248:251], v[116:119]
 ds_read_b64_tr_b16 a[166:167], v7 offset:1024
 v_mfma_f32_16x16x32_bf16 v[124:127], a[204:207], a[252:255], v[124:127]
 buffer_load_dwordx4 v1, s[12:15], s64 offen offset:1024 lds
 v_mfma_f32_16x16x32_bf16 v[128:131], a[208:211], a[224:227], v[128:131]
 ds_read_b128 a[132:135], v4 offset:2048
 v_mfma_f32_16x16x32_bf16 v[136:139], a[208:211], a[228:231], v[136:139]
 ds_read_b64_tr_b16 a[168:169], v8 offset:0
 v_mfma_f32_16x16x32_bf16 v[144:147], a[208:211], a[232:235], v[144:147]
 ds_read_b64_tr_b16 a[170:171], v8 offset:1024
 v_mfma_f32_16x16x32_bf16 v[152:155], a[208:211], a[236:239], v[152:155]
 ds_read_b128 a[136:139], v4 offset:8192
 v_mfma_f32_16x16x32_bf16 v[160:163], a[208:211], a[240:243], v[160:163]
 buffer_load_dwordx4 v0, s[12:15], s65 offen offset:2048 lds
 v_mfma_f32_16x16x32_bf16 v[168:171], a[208:211], a[244:247], v[168:171]
 ds_read_b64_tr_b16 a[172:173], v9 offset:0
 v_mfma_f32_16x16x32_bf16 v[176:179], a[208:211], a[248:251], v[176:179]
 ds_read_b64_tr_b16 a[174:175], v9 offset:1024
 v_mfma_f32_16x16x32_bf16 v[184:187], a[208:211], a[252:255], v[184:187]
 ds_read_b128 a[140:143], v4 offset:10240
 v_mfma_f32_16x16x32_bf16 v[132:135], a[212:215], a[224:227], v[132:135]
 v_mfma_f32_16x16x32_bf16 v[140:143], a[212:215], a[228:231], v[140:143]
 buffer_load_dwordx4 v1, s[12:15], s66 offen offset:3072 lds
 s_add_u32 m0, s81, 69632
 v_mfma_f32_16x16x32_bf16 v[148:151], a[212:215], a[232:235], v[148:151]
 ds_read_b64_tr_b16 a[176:177], v10 offset:0
 v_mfma_f32_16x16x32_bf16 v[156:159], a[212:215], a[236:239], v[156:159]
 ds_read_b64_tr_b16 a[178:179], v10 offset:1024
 v_mfma_f32_16x16x32_bf16 v[164:167], a[212:215], a[240:243], v[164:167]
 ds_read_b128 a[144:147], v4 offset:16384
 v_mfma_f32_16x16x32_bf16 v[172:175], a[212:215], a[244:247], v[172:175]
 ds_read_b64_tr_b16 a[180:181], v11 offset:0
 v_mfma_f32_16x16x32_bf16 v[180:183], a[212:215], a[248:251], v[180:183]
 buffer_load_dwordx4 v0, s[12:15], s67 offen offset:0 lds
 v_mfma_f32_16x16x32_bf16 v[188:191], a[212:215], a[252:255], v[188:191]
 ds_read_b64_tr_b16 a[182:183], v11 offset:1024
 v_mfma_f32_16x16x32_bf16 v[192:195], a[216:219], a[224:227], v[192:195]
 ds_read_b128 a[148:151], v4 offset:18432
 v_mfma_f32_16x16x32_bf16 v[200:203], a[216:219], a[228:231], v[200:203]
 ds_read_b64_tr_b16 a[184:185], v12 offset:0
 v_mfma_f32_16x16x32_bf16 v[208:211], a[216:219], a[232:235], v[208:211]
 ds_read_b64_tr_b16 a[186:187], v12 offset:1024
 v_mfma_f32_16x16x32_bf16 v[216:219], a[216:219], a[236:239], v[216:219]
 buffer_load_dwordx4 v1, s[12:15], s68 offen offset:1024 lds
 v_mfma_f32_16x16x32_bf16 v[224:227], a[216:219], a[240:243], v[224:227]
 ds_read_b128 a[152:155], v4 offset:24576
 v_mfma_f32_16x16x32_bf16 v[232:235], a[216:219], a[244:247], v[232:235]
 ds_read_b64_tr_b16 a[188:189], v13 offset:0
 v_mfma_f32_16x16x32_bf16 v[240:243], a[216:219], a[248:251], v[240:243]
 ds_read_b64_tr_b16 a[190:191], v13 offset:1024
 v_mfma_f32_16x16x32_bf16 v[248:251], a[216:219], a[252:255], v[248:251]
 ds_read_b128 a[156:159], v4 offset:26624
 v_mfma_f32_16x16x32_bf16 v[196:199], a[220:223], a[224:227], v[196:199]
 buffer_load_dwordx4 v0, s[12:15], s69 offen offset:2048 lds
 v_mfma_f32_16x16x32_bf16 v[204:207], a[220:223], a[228:231], v[204:207]
 v_mfma_f32_16x16x32_bf16 v[212:215], a[220:223], a[232:235], v[212:215]
 v_mfma_f32_16x16x32_bf16 v[220:223], a[220:223], a[236:239], v[220:223]
 v_mfma_f32_16x16x32_bf16 v[228:231], a[220:223], a[240:243], v[228:231]
 v_mfma_f32_16x16x32_bf16 v[236:239], a[220:223], a[244:247], v[236:239]
 buffer_load_dwordx4 v1, s[12:15], s70 offen offset:3072 lds
 s_add_u32 m0, s82, 131072
 v_mfma_f32_16x16x32_bf16 v[244:247], a[220:223], a[248:251], v[244:247]
 v_mfma_f32_16x16x32_bf16 v[252:255], a[220:223], a[252:255], v[252:255]
 s_waitcnt lgkmcnt(15)
 v_mfma_f32_16x16x32_bf16 v[24:27], a[128:131], a[160:163], v[24:27]
 v_mfma_f32_16x16x32_bf16 a[104:107], a[128:131], a[164:167], a[104:107]
 v_mfma_f32_16x16x32_bf16 a[112:115], a[128:131], a[168:171], a[112:115]
 s_waitcnt lgkmcnt(13)
 buffer_load_dwordx4 v2, s[16:19], 0 offen offset:0 lds
 v_mfma_f32_16x16x32_bf16 v[32:35], a[128:131], a[172:175], v[32:35]
 s_waitcnt lgkmcnt(10)
 ds_read_b64_tr_b16 a[224:225], v6 offset:8192
 v_mfma_f32_16x16x32_bf16 a[120:123], a[128:131], a[176:179], a[120:123]
 s_waitcnt lgkmcnt(8)
 ds_read_b64_tr_b16 a[226:227], v6 offset:9216
 v_mfma_f32_16x16x32_bf16 v[40:43], a[128:131], a[180:183], v[40:43]
 s_waitcnt lgkmcnt(6)
 v_mfma_f32_16x16x32_bf16 v[48:51], a[128:131], a[184:187], v[48:51]
 s_waitcnt lgkmcnt(3)
 ds_read_b128 a[192:195], v5 offset:0
 v_mfma_f32_16x16x32_bf16 v[56:59], a[128:131], a[188:191], v[56:59]
 buffer_load_dwordx4 v2, s[16:19], s71 offen offset:1024 lds
 v_mfma_f32_16x16x32_bf16 v[28:31], a[132:135], a[160:163], v[28:31]
 ds_read_b64_tr_b16 a[228:229], v7 offset:8192
 v_mfma_f32_16x16x32_bf16 a[108:111], a[132:135], a[164:167], a[108:111]
 v_mfma_f32_16x16x32_bf16 a[116:119], a[132:135], a[168:171], a[116:119]
 ds_read_b64_tr_b16 a[230:231], v7 offset:9216
 v_mfma_f32_16x16x32_bf16 v[36:39], a[132:135], a[172:175], v[36:39]
 ds_read_b128 a[196:199], v5 offset:2048
 v_mfma_f32_16x16x32_bf16 a[124:127], a[132:135], a[176:179], a[124:127]
 buffer_load_dwordx4 v3, s[16:19], s72 offen offset:2048 lds
 v_mfma_f32_16x16x32_bf16 v[44:47], a[132:135], a[180:183], v[44:47]
 v_mfma_f32_16x16x32_bf16 v[52:55], a[132:135], a[184:187], v[52:55]
 ds_read_b64_tr_b16 a[232:233], v8 offset:8192
 v_mfma_f32_16x16x32_bf16 v[60:63], a[132:135], a[188:191], v[60:63]
 ds_read_b64_tr_b16 a[234:235], v8 offset:9216
 v_mfma_f32_16x16x32_bf16 v[64:67], a[136:139], a[160:163], v[64:67]
 v_mfma_f32_16x16x32_bf16 v[72:75], a[136:139], a[164:167], v[72:75]
 buffer_load_dwordx4 v3, s[16:19], s73 offen offset:3072 lds
 s_add_u32 m0, s82, 147456
 v_mfma_f32_16x16x32_bf16 v[80:83], a[136:139], a[168:171], v[80:83]
 ds_read_b128 a[200:203], v5 offset:8192
 v_mfma_f32_16x16x32_bf16 v[88:91], a[136:139], a[172:175], v[88:91]
 ds_read_b64_tr_b16 a[236:237], v9 offset:8192
 v_mfma_f32_16x16x32_bf16 v[96:99], a[136:139], a[176:179], v[96:99]
 v_mfma_f32_16x16x32_bf16 v[104:107], a[136:139], a[180:183], v[104:107]
 ds_read_b64_tr_b16 a[238:239], v9 offset:9216
 v_mfma_f32_16x16x32_bf16 v[112:115], a[136:139], a[184:187], v[112:115]
 buffer_load_dwordx4 v2, s[20:23], 0 offen offset:0 lds
 v_mfma_f32_16x16x32_bf16 v[120:123], a[136:139], a[188:191], v[120:123]
 ds_read_b128 a[204:207], v5 offset:10240
 v_mfma_f32_16x16x32_bf16 v[68:71], a[140:143], a[160:163], v[68:71]
 v_mfma_f32_16x16x32_bf16 v[76:79], a[140:143], a[164:167], v[76:79]
 ds_read_b64_tr_b16 a[240:241], v10 offset:8192
 v_mfma_f32_16x16x32_bf16 v[84:87], a[140:143], a[168:171], v[84:87]
 v_mfma_f32_16x16x32_bf16 v[92:95], a[140:143], a[172:175], v[92:95]
 buffer_load_dwordx4 v2, s[20:23], s71 offen offset:1024 lds
 s_waitcnt vmcnt(15)
 v_mfma_f32_16x16x32_bf16 v[100:103], a[140:143], a[176:179], v[100:103]
 ds_read_b128 a[0:3], v20 offset:0
 v_mfma_f32_16x16x32_bf16 v[108:111], a[140:143], a[180:183], v[108:111]
 ds_read_b128 a[4:7], v20 offset:2048
 v_mfma_f32_16x16x32_bf16 v[116:119], a[140:143], a[184:187], v[116:119]
 ds_read_b64_tr_b16 a[242:243], v10 offset:9216
 v_mfma_f32_16x16x32_bf16 v[124:127], a[140:143], a[188:191], v[124:127]
 ds_read_b128 a[8:11], v20 offset:4096
 v_mfma_f32_16x16x32_bf16 v[128:131], a[144:147], a[160:163], v[128:131]
 buffer_load_dwordx4 v3, s[20:23], s72 offen offset:2048 lds
 v_mfma_f32_16x16x32_bf16 v[136:139], a[144:147], a[164:167], v[136:139]
 ds_read_b128 a[12:15], v20 offset:6144
 v_mfma_f32_16x16x32_bf16 v[144:147], a[144:147], a[168:171], v[144:147]
 ds_read_b128 a[208:211], v5 offset:16384
 v_mfma_f32_16x16x32_bf16 v[152:155], a[144:147], a[172:175], v[152:155]
 ds_read_b128 a[16:19], v21 offset:0
 v_mfma_f32_16x16x32_bf16 v[160:163], a[144:147], a[176:179], v[160:163]
 ds_read_b128 a[20:23], v21 offset:2048
 v_mfma_f32_16x16x32_bf16 v[168:171], a[144:147], a[180:183], v[168:171]
 buffer_load_dwordx4 v3, s[20:23], s73 offen offset:3072 lds
 v_mfma_f32_16x16x32_bf16 v[176:179], a[144:147], a[184:187], v[176:179]
 v_mfma_f32_16x16x32_bf16 v[184:187], a[144:147], a[188:191], v[184:187]
 ds_read_b128 a[24:27], v21 offset:4096
 v_mfma_f32_16x16x32_bf16 v[132:135], a[148:151], a[160:163], v[132:135]
 ds_read_b128 a[28:31], v21 offset:6144
 v_mfma_f32_16x16x32_bf16 v[140:143], a[148:151], a[164:167], v[140:143]
 ds_read_b64_tr_b16 a[244:245], v11 offset:8192
 v_mfma_f32_16x16x32_bf16 v[148:151], a[148:151], a[168:171], v[148:151]
 ds_read_b64_tr_b16 a[246:247], v11 offset:9216
 v_add_u32 v0, 0x80, v0
 v_add_u32 v1, 0x80, v1
 v_mfma_f32_16x16x32_bf16 v[156:159], a[148:151], a[172:175], v[156:159]
 v_add_u32 v2, 0x80000, v2
 v_add_u32 v3, 0x80000, v3
 v_mfma_f32_16x16x32_bf16 v[164:167], a[148:151], a[176:179], v[164:167]
 ds_read_b128 a[212:215], v5 offset:18432
 v_mfma_f32_16x16x32_bf16 v[172:175], a[148:151], a[180:183], v[172:175]
 ds_read_b64_tr_b16 a[248:249], v12 offset:8192
 v_mfma_f32_16x16x32_bf16 v[180:183], a[148:151], a[184:187], v[180:183]
 v_mfma_f32_16x16x32_bf16 v[188:191], a[148:151], a[188:191], v[188:191]
 s_waitcnt lgkmcnt(0)
 ds_read_b64_tr_b16 a[250:251], v12 offset:9216
 v_mfma_f32_16x16x32_bf16 v[192:195], a[152:155], a[160:163], v[192:195]
 s_add_u32 m0, s81, 0
 ds_read_b128 a[216:219], v5 offset:24576
 v_mfma_f32_16x16x32_bf16 v[200:203], a[152:155], a[164:167], v[200:203]
 buffer_load_dwordx4 v17, s[8:11], 0 offen offset:0 lds
 v_mfma_f32_16x16x32_bf16 v[208:211], a[152:155], a[168:171], v[208:211]
 v_mfma_f32_16x16x32_bf16 v[216:219], a[152:155], a[172:175], v[216:219]
 ds_read_b64_tr_b16 a[252:253], v13 offset:8192
 v_mfma_f32_16x16x32_bf16 v[224:227], a[152:155], a[176:179], v[224:227]
 ds_read_b64_tr_b16 a[254:255], v13 offset:9216
 v_mfma_f32_16x16x32_bf16 v[232:235], a[152:155], a[180:183], v[232:235]
 buffer_load_dwordx4 v18, s[8:11], s74 offen offset:1024 lds
 v_mfma_f32_16x16x32_bf16 v[240:243], a[152:155], a[184:187], v[240:243]
 v_mfma_f32_16x16x32_bf16 v[248:251], a[152:155], a[188:191], v[248:251]
 ds_read_b128 a[220:223], v5 offset:26624
 v_mfma_f32_16x16x32_bf16 v[196:199], a[156:159], a[160:163], v[196:199]
 v_mfma_f32_16x16x32_bf16 v[204:207], a[156:159], a[164:167], v[204:207]
 buffer_load_dwordx4 v17, s[8:11], s75 offen offset:2048 lds
 v_mfma_f32_16x16x32_bf16 v[212:215], a[156:159], a[168:171], v[212:215]
 v_mfma_f32_16x16x32_bf16 v[220:223], a[156:159], a[172:175], v[220:223]
 v_mfma_f32_16x16x32_bf16 v[228:231], a[156:159], a[176:179], v[228:231]
 v_mfma_f32_16x16x32_bf16 v[236:239], a[156:159], a[180:183], v[236:239]
 buffer_load_dwordx4 v18, s[8:11], s76 offen offset:3072 lds
 s_add_u32 m0, s81, 4096
 v_mfma_f32_16x16x32_bf16 v[244:247], a[156:159], a[184:187], v[244:247]
 v_mfma_f32_16x16x32_bf16 v[252:255], a[156:159], a[188:191], v[252:255]
 v_mfma_f32_16x16x32_bf16 v[24:27], a[192:195], a[224:227], v[24:27]
 v_mfma_f32_16x16x32_bf16 a[104:107], a[192:195], a[228:231], a[104:107]
 buffer_load_dwordx4 v17, s[8:11], s77 offen offset:0 lds
 v_mfma_f32_16x16x32_bf16 a[112:115], a[192:195], a[232:235], a[112:115]
 v_mfma_f32_16x16x32_bf16 v[32:35], a[192:195], a[236:239], v[32:35]
 v_mfma_f32_16x16x32_bf16 a[120:123], a[192:195], a[240:243], a[120:123]
 v_mfma_f32_16x16x32_bf16 v[40:43], a[192:195], a[244:247], v[40:43]
 s_waitcnt lgkmcnt(4)
 buffer_load_dwordx4 v18, s[8:11], s78 offen offset:1024 lds
 v_mfma_f32_16x16x32_bf16 v[48:51], a[192:195], a[248:251], v[48:51]
 s_waitcnt lgkmcnt(1)
 v_mfma_f32_16x16x32_bf16 v[56:59], a[192:195], a[252:255], v[56:59]
 v_mfma_f32_16x16x32_bf16 v[28:31], a[196:199], a[224:227], v[28:31]
 v_mfma_f32_16x16x32_bf16 a[108:111], a[196:199], a[228:231], a[108:111]
 buffer_load_dwordx4 v17, s[8:11], s79 offen offset:2048 lds
 v_mfma_f32_16x16x32_bf16 a[116:119], a[196:199], a[232:235], a[116:119]
 v_mfma_f32_16x16x32_bf16 v[36:39], a[196:199], a[236:239], v[36:39]
 v_mfma_f32_16x16x32_bf16 a[124:127], a[196:199], a[240:243], a[124:127]
 v_mfma_f32_16x16x32_bf16 v[44:47], a[196:199], a[244:247], v[44:47]
 buffer_load_dwordx4 v18, s[8:11], s80 offen offset:3072 lds
 v_mfma_f32_16x16x32_bf16 v[52:55], a[196:199], a[248:251], v[52:55]
 v_mfma_f32_16x16x32_bf16 v[60:63], a[196:199], a[252:255], v[60:63]
 v_mfma_f32_16x16x32_bf16 v[64:67], a[200:203], a[224:227], v[64:67]
 v_mfma_f32_16x16x32_bf16 v[72:75], a[200:203], a[228:231], v[72:75]
 buffer_load_dword a100, v16, s[40:43], s88 offen
 s_add_u32 s88, s88, s89
 v_add_u32 v17, 0x80, v17
 v_add_u32 v18, 0x80, v18
 v_mfma_f32_16x16x32_bf16 v[80:83], a[200:203], a[232:235], v[80:83]
 v_mfma_f32_16x16x32_bf16 v[88:91], a[200:203], a[236:239], v[88:91]
 s_lshr_b32 s94, s63, 1
 s_xor_b32 s94, s94, 0
 s_or_b32 s94, s94, s60
 s_cselect_b32 s94, 0x100000, s2
 v_lshl_add_u32 v15, v14, 4, s94
 v_mfma_f32_16x16x32_bf16 v[96:99], a[200:203], a[240:243], v[96:99]
 buffer_store_byte v19, v15, s[36:39], 0 offen sc1
 v_mfma_f32_16x16x32_bf16 v[104:107], a[200:203], a[244:247], v[104:107]
 v_mfma_f32_16x16x32_bf16 v[112:115], a[200:203], a[248:251], v[112:115]
 v_mfma_f32_16x16x32_bf16 v[120:123], a[200:203], a[252:255], v[120:123]
 v_mfma_f32_16x16x32_bf16 v[68:71], a[204:207], a[224:227], v[68:71]
 s_waitcnt vmcnt(10) lgkmcnt(0)
 s_barrier
 v_mfma_f32_16x16x32_bf16 v[76:79], a[204:207], a[228:231], v[76:79]
 s_add_u32 m0, s81, 32768
 ds_read_b64_tr_b16 a[160:161], v6 offset:32768
 v_mfma_f32_16x16x32_bf16 v[84:87], a[204:207], a[232:235], v[84:87]
 buffer_load_dwordx4 v0, s[12:15], 0 offen offset:0 lds
 v_mfma_f32_16x16x32_bf16 v[92:95], a[204:207], a[236:239], v[92:95]
 ds_read_b64_tr_b16 a[162:163], v6 offset:33792
 v_mfma_f32_16x16x32_bf16 v[100:103], a[204:207], a[240:243], v[100:103]
 ds_read_b128 a[128:131], v4 offset:32768
 v_mfma_f32_16x16x32_bf16 v[108:111], a[204:207], a[244:247], v[108:111]
 ds_read_b64_tr_b16 a[164:165], v7 offset:32768
 v_mfma_f32_16x16x32_bf16 v[116:119], a[204:207], a[248:251], v[116:119]
 ds_read_b64_tr_b16 a[166:167], v7 offset:33792
 v_mfma_f32_16x16x32_bf16 v[124:127], a[204:207], a[252:255], v[124:127]
 buffer_load_dwordx4 v1, s[12:15], s64 offen offset:1024 lds
 v_mfma_f32_16x16x32_bf16 v[128:131], a[208:211], a[224:227], v[128:131]
 ds_read_b128 a[132:135], v4 offset:34816
 v_mfma_f32_16x16x32_bf16 v[136:139], a[208:211], a[228:231], v[136:139]
 ds_read_b64_tr_b16 a[168:169], v8 offset:32768
 v_mfma_f32_16x16x32_bf16 v[144:147], a[208:211], a[232:235], v[144:147]
 ds_read_b64_tr_b16 a[170:171], v8 offset:33792
 v_mfma_f32_16x16x32_bf16 v[152:155], a[208:211], a[236:239], v[152:155]
 ds_read_b128 a[136:139], v4 offset:40960
 v_mfma_f32_16x16x32_bf16 v[160:163], a[208:211], a[240:243], v[160:163]
 buffer_load_dwordx4 v0, s[12:15], s65 offen offset:2048 lds
 v_mfma_f32_16x16x32_bf16 v[168:171], a[208:211], a[244:247], v[168:171]
 ds_read_b64_tr_b16 a[172:173], v9 offset:32768
 v_mfma_f32_16x16x32_bf16 v[176:179], a[208:211], a[248:251], v[176:179]
 ds_read_b64_tr_b16 a[174:175], v9 offset:33792
 v_mfma_f32_16x16x32_bf16 v[184:187], a[208:211], a[252:255], v[184:187]
 ds_read_b128 a[140:143], v4 offset:43008
 v_mfma_f32_16x16x32_bf16 v[132:135], a[212:215], a[224:227], v[132:135]
 v_mfma_f32_16x16x32_bf16 v[140:143], a[212:215], a[228:231], v[140:143]
 buffer_load_dwordx4 v1, s[12:15], s66 offen offset:3072 lds
 s_add_u32 m0, s81, 36864
 v_mfma_f32_16x16x32_bf16 v[148:151], a[212:215], a[232:235], v[148:151]
 ds_read_b64_tr_b16 a[176:177], v10 offset:32768
 v_mfma_f32_16x16x32_bf16 v[156:159], a[212:215], a[236:239], v[156:159]
 ds_read_b64_tr_b16 a[178:179], v10 offset:33792
 v_mfma_f32_16x16x32_bf16 v[164:167], a[212:215], a[240:243], v[164:167]
 ds_read_b128 a[144:147], v4 offset:49152
 v_mfma_f32_16x16x32_bf16 v[172:175], a[212:215], a[244:247], v[172:175]
 ds_read_b64_tr_b16 a[180:181], v11 offset:32768
 v_mfma_f32_16x16x32_bf16 v[180:183], a[212:215], a[248:251], v[180:183]
 buffer_load_dwordx4 v0, s[12:15], s67 offen offset:0 lds
 v_mfma_f32_16x16x32_bf16 v[188:191], a[212:215], a[252:255], v[188:191]
 ds_read_b64_tr_b16 a[182:183], v11 offset:33792
 v_mfma_f32_16x16x32_bf16 v[192:195], a[216:219], a[224:227], v[192:195]
 ds_read_b128 a[148:151], v4 offset:51200
 v_mfma_f32_16x16x32_bf16 v[200:203], a[216:219], a[228:231], v[200:203]
 ds_read_b64_tr_b16 a[184:185], v12 offset:32768
 v_mfma_f32_16x16x32_bf16 v[208:211], a[216:219], a[232:235], v[208:211]
 ds_read_b64_tr_b16 a[186:187], v12 offset:33792
 v_mfma_f32_16x16x32_bf16 v[216:219], a[216:219], a[236:239], v[216:219]
 buffer_load_dwordx4 v1, s[12:15], s68 offen offset:1024 lds
 v_mfma_f32_16x16x32_bf16 v[224:227], a[216:219], a[240:243], v[224:227]
 ds_read_b128 a[152:155], v4 offset:57344
 v_mfma_f32_16x16x32_bf16 v[232:235], a[216:219], a[244:247], v[232:235]
 ds_read_b64_tr_b16 a[188:189], v13 offset:32768
 v_mfma_f32_16x16x32_bf16 v[240:243], a[216:219], a[248:251], v[240:243]
 ds_read_b64_tr_b16 a[190:191], v13 offset:33792
 v_mfma_f32_16x16x32_bf16 v[248:251], a[216:219], a[252:255], v[248:251]
 ds_read_b128 a[156:159], v4 offset:59392
 v_mfma_f32_16x16x32_bf16 v[196:199], a[220:223], a[224:227], v[196:199]
 buffer_load_dwordx4 v0, s[12:15], s69 offen offset:2048 lds
 v_mfma_f32_16x16x32_bf16 v[204:207], a[220:223], a[228:231], v[204:207]
 v_mfma_f32_16x16x32_bf16 v[212:215], a[220:223], a[232:235], v[212:215]
 v_mfma_f32_16x16x32_bf16 v[220:223], a[220:223], a[236:239], v[220:223]
 v_mfma_f32_16x16x32_bf16 v[228:231], a[220:223], a[240:243], v[228:231]
 v_mfma_f32_16x16x32_bf16 v[236:239], a[220:223], a[244:247], v[236:239]
 buffer_load_dwordx4 v1, s[12:15], s70 offen offset:3072 lds
 s_add_u32 m0, s82, 98304
 v_mfma_f32_16x16x32_bf16 v[244:247], a[220:223], a[248:251], v[244:247]
 v_mfma_f32_16x16x32_bf16 v[252:255], a[220:223], a[252:255], v[252:255]
 s_waitcnt lgkmcnt(15)
 v_mfma_f32_16x16x32_bf16 v[24:27], a[128:131], a[160:163], v[24:27]
 v_mfma_f32_16x16x32_bf16 a[104:107], a[128:131], a[164:167], a[104:107]
 v_mfma_f32_16x16x32_bf16 a[112:115], a[128:131], a[168:171], a[112:115]
 s_waitcnt lgkmcnt(13)
 buffer_load_dwordx4 v2, s[16:19], 0 offen offset:0 lds
 v_mfma_f32_16x16x32_bf16 v[32:35], a[128:131], a[172:175], v[32:35]
 s_waitcnt lgkmcnt(10)
 ds_read_b64_tr_b16 a[224:225], v6 offset:40960
 v_mfma_f32_16x16x32_bf16 a[120:123], a[128:131], a[176:179], a[120:123]
 s_waitcnt lgkmcnt(8)
 ds_read_b64_tr_b16 a[226:227], v6 offset:41984
 v_mfma_f32_16x16x32_bf16 v[40:43], a[128:131], a[180:183], v[40:43]
 s_waitcnt lgkmcnt(6)
 v_mfma_f32_16x16x32_bf16 v[48:51], a[128:131], a[184:187], v[48:51]
 s_waitcnt lgkmcnt(3)
 ds_read_b128 a[192:195], v5 offset:32768
 v_mfma_f32_16x16x32_bf16 v[56:59], a[128:131], a[188:191], v[56:59]
 buffer_load_dwordx4 v2, s[16:19], s71 offen offset:1024 lds
 v_mfma_f32_16x16x32_bf16 v[28:31], a[132:135], a[160:163], v[28:31]
 ds_read_b64_tr_b16 a[228:229], v7 offset:40960
 v_mfma_f32_16x16x32_bf16 a[108:111], a[132:135], a[164:167], a[108:111]
 v_mfma_f32_16x16x32_bf16 a[116:119], a[132:135], a[168:171], a[116:119]
 ds_read_b64_tr_b16 a[230:231], v7 offset:41984
 v_mfma_f32_16x16x32_bf16 v[36:39], a[132:135], a[172:175], v[36:39]
 ds_read_b128 a[196:199], v5 offset:34816
 v_mfma_f32_16x16x32_bf16 a[124:127], a[132:135], a[176:179], a[124:127]
 buffer_load_dwordx4 v3, s[16:19], s72 offen offset:2048 lds
 v_mfma_f32_16x16x32_bf16 v[44:47], a[132:135], a[180:183], v[44:47]
 v_mfma_f32_16x16x32_bf16 v[52:55], a[132:135], a[184:187], v[52:55]
 ds_read_b64_tr_b16 a[232:233], v8 offset:40960
 v_mfma_f32_16x16x32_bf16 v[60:63], a[132:135], a[188:191], v[60:63]
 ds_read_b64_tr_b16 a[234:235], v8 offset:41984
 v_mfma_f32_16x16x32_bf16 v[64:67], a[136:139], a[160:163], v[64:67]
 v_mfma_f32_16x16x32_bf16 v[72:75], a[136:139], a[164:167], v[72:75]
 buffer_load_dwordx4 v3, s[16:19], s73 offen offset:3072 lds
 s_add_u32 m0, s82, 114688
 v_mfma_f32_16x16x32_bf16 v[80:83], a[136:139], a[168:171], v[80:83]
 ds_read_b128 a[200:203], v5 offset:40960
 v_mfma_f32_16x16x32_bf16 v[88:91], a[136:139], a[172:175], v[88:91]
 ds_read_b64_tr_b16 a[236:237], v9 offset:40960
 v_mfma_f32_16x16x32_bf16 v[96:99], a[136:139], a[176:179], v[96:99]
 v_mfma_f32_16x16x32_bf16 v[104:107], a[136:139], a[180:183], v[104:107]
 ds_read_b64_tr_b16 a[238:239], v9 offset:41984
 v_mfma_f32_16x16x32_bf16 v[112:115], a[136:139], a[184:187], v[112:115]
 buffer_load_dwordx4 v2, s[20:23], 0 offen offset:0 lds
 v_mfma_f32_16x16x32_bf16 v[120:123], a[136:139], a[188:191], v[120:123]
 ds_read_b128 a[204:207], v5 offset:43008
 v_mfma_f32_16x16x32_bf16 v[68:71], a[140:143], a[160:163], v[68:71]
 v_mfma_f32_16x16x32_bf16 v[76:79], a[140:143], a[164:167], v[76:79]
 ds_read_b64_tr_b16 a[240:241], v10 offset:40960
 v_mfma_f32_16x16x32_bf16 v[84:87], a[140:143], a[168:171], v[84:87]
 v_mfma_f32_16x16x32_bf16 v[92:95], a[140:143], a[172:175], v[92:95]
 buffer_load_dwordx4 v2, s[20:23], s71 offen offset:1024 lds
 s_waitcnt vmcnt(16)
 v_mfma_f32_16x16x32_bf16 v[100:103], a[140:143], a[176:179], v[100:103]
 ds_read_b128 a[32:35], v20 offset:0
 v_mfma_f32_16x16x32_bf16 v[108:111], a[140:143], a[180:183], v[108:111]
 ds_read_b128 a[36:39], v20 offset:2048
 v_mfma_f32_16x16x32_bf16 v[116:119], a[140:143], a[184:187], v[116:119]
 ds_read_b64_tr_b16 a[242:243], v10 offset:41984
 v_mfma_f32_16x16x32_bf16 v[124:127], a[140:143], a[188:191], v[124:127]
 ds_read_b128 a[40:43], v20 offset:4096
 v_mfma_f32_16x16x32_bf16 v[128:131], a[144:147], a[160:163], v[128:131]
 buffer_load_dwordx4 v3, s[20:23], s72 offen offset:2048 lds
 v_mfma_f32_16x16x32_bf16 v[136:139], a[144:147], a[164:167], v[136:139]
 ds_read_b128 a[44:47], v20 offset:6144
 v_mfma_f32_16x16x32_bf16 v[144:147], a[144:147], a[168:171], v[144:147]
 ds_read_b128 a[208:211], v5 offset:49152
 v_mfma_f32_16x16x32_bf16 v[152:155], a[144:147], a[172:175], v[152:155]
 ds_read_b128 a[48:51], v21 offset:0
 v_mfma_f32_16x16x32_bf16 v[160:163], a[144:147], a[176:179], v[160:163]
 ds_read_b128 a[52:55], v21 offset:2048
 v_mfma_f32_16x16x32_bf16 v[168:171], a[144:147], a[180:183], v[168:171]
 buffer_load_dwordx4 v3, s[20:23], s73 offen offset:3072 lds
 v_mfma_f32_16x16x32_bf16 v[176:179], a[144:147], a[184:187], v[176:179]
 v_mfma_f32_16x16x32_bf16 v[184:187], a[144:147], a[188:191], v[184:187]
 ds_read_b128 a[56:59], v21 offset:4096
 v_mfma_f32_16x16x32_bf16 v[132:135], a[148:151], a[160:163], v[132:135]
 ds_read_b128 a[60:63], v21 offset:6144
 v_mfma_f32_16x16x32_bf16 v[140:143], a[148:151], a[164:167], v[140:143]
 ds_read_b64_tr_b16 a[244:245], v11 offset:40960
 v_mfma_f32_16x16x32_bf16 v[148:151], a[148:151], a[168:171], v[148:151]
 ds_read_b64_tr_b16 a[246:247], v11 offset:41984
 v_add_u32 v0, 0x80, v0
 v_add_u32 v1, 0x80, v1
 v_mfma_f32_16x16x32_bf16 v[156:159], a[148:151], a[172:175], v[156:159]
 v_add_u32 v2, 0x80000, v2
 v_add_u32 v3, 0x80000, v3
 v_mfma_f32_16x16x32_bf16 v[164:167], a[148:151], a[176:179], v[164:167]
 ds_read_b128 a[212:215], v5 offset:51200
 v_mfma_f32_16x16x32_bf16 v[172:175], a[148:151], a[180:183], v[172:175]
 ds_read_b64_tr_b16 a[248:249], v12 offset:40960
 v_mfma_f32_16x16x32_bf16 v[180:183], a[148:151], a[184:187], v[180:183]
 v_mfma_f32_16x16x32_bf16 v[188:191], a[148:151], a[188:191], v[188:191]
 s_waitcnt lgkmcnt(0)
 ds_read_b64_tr_b16 a[250:251], v12 offset:41984
 v_mfma_f32_16x16x32_bf16 v[192:195], a[152:155], a[160:163], v[192:195]
 s_add_u32 m0, s81, 0
 ds_read_b128 a[216:219], v5 offset:57344
 v_mfma_f32_16x16x32_bf16 v[200:203], a[152:155], a[164:167], v[200:203]
 buffer_load_dwordx4 v17, s[8:11], 0 offen offset:0 lds
 v_mfma_f32_16x16x32_bf16 v[208:211], a[152:155], a[168:171], v[208:211]
 v_mfma_f32_16x16x32_bf16 v[216:219], a[152:155], a[172:175], v[216:219]
 ds_read_b64_tr_b16 a[252:253], v13 offset:40960
 v_mfma_f32_16x16x32_bf16 v[224:227], a[152:155], a[176:179], v[224:227]
 ds_read_b64_tr_b16 a[254:255], v13 offset:41984
 v_mfma_f32_16x16x32_bf16 v[232:235], a[152:155], a[180:183], v[232:235]
 buffer_load_dwordx4 v18, s[8:11], s74 offen offset:1024 lds
 v_mfma_f32_16x16x32_bf16 v[240:243], a[152:155], a[184:187], v[240:243]
 v_mfma_f32_16x16x32_bf16 v[248:251], a[152:155], a[188:191], v[248:251]
 ds_read_b128 a[220:223], v5 offset:59392
 v_mfma_f32_16x16x32_bf16 v[196:199], a[156:159], a[160:163], v[196:199]
 v_mfma_f32_16x16x32_bf16 v[204:207], a[156:159], a[164:167], v[204:207]
 buffer_load_dwordx4 v17, s[8:11], s75 offen offset:2048 lds
 v_mfma_f32_16x16x32_bf16 v[212:215], a[156:159], a[168:171], v[212:215]
 v_mfma_f32_16x16x32_bf16 v[220:223], a[156:159], a[172:175], v[220:223]
 v_mfma_f32_16x16x32_bf16 v[228:231], a[156:159], a[176:179], v[228:231]
 v_mfma_f32_16x16x32_bf16 v[236:239], a[156:159], a[180:183], v[236:239]
 buffer_load_dwordx4 v18, s[8:11], s76 offen offset:3072 lds
 s_add_u32 m0, s81, 4096
 v_mfma_f32_16x16x32_bf16 v[244:247], a[156:159], a[184:187], v[244:247]
 v_mfma_f32_16x16x32_bf16 v[252:255], a[156:159], a[188:191], v[252:255]
 v_mfma_f32_16x16x32_bf16 v[24:27], a[192:195], a[224:227], v[24:27]
 v_mfma_f32_16x16x32_bf16 a[104:107], a[192:195], a[228:231], a[104:107]
 buffer_load_dwordx4 v17, s[8:11], s77 offen offset:0 lds
 v_mfma_f32_16x16x32_bf16 a[112:115], a[192:195], a[232:235], a[112:115]
 v_mfma_f32_16x16x32_bf16 v[32:35], a[192:195], a[236:239], v[32:35]
 v_mfma_f32_16x16x32_bf16 a[120:123], a[192:195], a[240:243], a[120:123]
 v_mfma_f32_16x16x32_bf16 v[40:43], a[192:195], a[244:247], v[40:43]
 s_waitcnt lgkmcnt(4)
 buffer_load_dwordx4 v18, s[8:11], s78 offen offset:1024 lds
 v_mfma_f32_16x16x32_bf16 v[48:51], a[192:195], a[248:251], v[48:51]
 s_waitcnt lgkmcnt(1)
 v_mfma_f32_16x16x32_bf16 v[56:59], a[192:195], a[252:255], v[56:59]
 v_mfma_f32_16x16x32_bf16 v[28:31], a[196:199], a[224:227], v[28:31]
 v_mfma_f32_16x16x32_bf16 a[108:111], a[196:199], a[228:231], a[108:111]
 buffer_load_dwordx4 v17, s[8:11], s79 offen offset:2048 lds
 v_mfma_f32_16x16x32_bf16 a[116:119], a[196:199], a[232:235], a[116:119]
 v_mfma_f32_16x16x32_bf16 v[36:39], a[196:199], a[236:239], v[36:39]
 v_mfma_f32_16x16x32_bf16 a[124:127], a[196:199], a[240:243], a[124:127]
 v_mfma_f32_16x16x32_bf16 v[44:47], a[196:199], a[244:247], v[44:47]
 buffer_load_dwordx4 v18, s[8:11], s80 offen offset:3072 lds
 v_mfma_f32_16x16x32_bf16 v[52:55], a[196:199], a[248:251], v[52:55]
 v_mfma_f32_16x16x32_bf16 v[60:63], a[196:199], a[252:255], v[60:63]
 v_mfma_f32_16x16x32_bf16 v[64:67], a[200:203], a[224:227], v[64:67]
 v_mfma_f32_16x16x32_bf16 v[72:75], a[200:203], a[228:231], v[72:75]
 buffer_load_dword a100, v16, s[40:43], s88 offen
 s_add_u32 s88, s88, s89
 v_add_u32 v17, 0x80, v17
 v_add_u32 v18, 0x80, v18
 v_mfma_f32_16x16x32_bf16 v[80:83], a[200:203], a[232:235], v[80:83]
 v_mfma_f32_16x16x32_bf16 v[88:91], a[200:203], a[236:239], v[88:91]
 s_lshr_b32 s94, s63, 1
 s_xor_b32 s94, s94, 1
 s_or_b32 s94, s94, s60
 s_cselect_b32 s94, 0x100000, s2
 v_lshl_add_u32 v15, v14, 4, s94
 v_mfma_f32_16x16x32_bf16 v[96:99], a[200:203], a[240:243], v[96:99]
 buffer_store_byte v19, v15, s[36:39], 0 offen sc1
 v_mfma_f32_16x16x32_bf16 v[104:107], a[200:203], a[244:247], v[104:107]
 v_mfma_f32_16x16x32_bf16 v[112:115], a[200:203], a[248:251], v[112:115]
 v_mfma_f32_16x16x32_bf16 v[120:123], a[200:203], a[252:255], v[120:123]
 v_mfma_f32_16x16x32_bf16 v[68:71], a[204:207], a[224:227], v[68:71]
 s_waitcnt vmcnt(10) lgkmcnt(0)
 s_barrier
 v_mfma_f32_16x16x32_bf16 v[76:79], a[204:207], a[228:231], v[76:79]
 s_add_u32 m0, s81, 65536
 ds_read_b64_tr_b16 a[160:161], v6 offset:0
 v_mfma_f32_16x16x32_bf16 v[84:87], a[204:207], a[232:235], v[84:87]
 buffer_load_dwordx4 v0, s[12:15], 0 offen offset:0 lds
 v_mfma_f32_16x16x32_bf16 v[92:95], a[204:207], a[236:239], v[92:95]
 ds_read_b64_tr_b16 a[162:163], v6 offset:1024
 v_mfma_f32_16x16x32_bf16 v[100:103], a[204:207], a[240:243], v[100:103]
 ds_read_b128 a[128:131], v4 offset:0
 v_mfma_f32_16x16x32_bf16 v[108:111], a[204:207], a[244:247], v[108:111]
 ds_read_b64_tr_b16 a[164:165], v7 offset:0
 v_mfma_f32_16x16x32_bf16 v[116:119], a[204:207], a[248:251], v[116:119]
 ds_read_b64_tr_b16 a[166:167], v7 offset:1024
 v_mfma_f32_16x16x32_bf16 v[124:127], a[204:207], a[252:255], v[124:127]
 buffer_load_dwordx4 v1, s[12:15], s64 offen offset:1024 lds
 v_mfma_f32_16x16x32_bf16 v[128:131], a[208:211], a[224:227], v[128:131]
 ds_read_b128 a[132:135], v4 offset:2048
 v_mfma_f32_16x16x32_bf16 v[136:139], a[208:211], a[228:231], v[136:139]
 ds_read_b64_tr_b16 a[168:169], v8 offset:0
 v_mfma_f32_16x16x32_bf16 v[144:147], a[208:211], a[232:235], v[144:147]
 ds_read_b64_tr_b16 a[170:171], v8 offset:1024
 v_mfma_f32_16x16x32_bf16 v[152:155], a[208:211], a[236:239], v[152:155]
 ds_read_b128 a[136:139], v4 offset:8192
 v_mfma_f32_16x16x32_bf16 v[160:163], a[208:211], a[240:243], v[160:163]
 buffer_load_dwordx4 v0, s[12:15], s65 offen offset:2048 lds
 v_mfma_f32_16x16x32_bf16 v[168:171], a[208:211], a[244:247], v[168:171]
 ds_read_b64_tr_b16 a[172:173], v9 offset:0
 v_mfma_f32_16x16x32_bf16 v[176:179], a[208:211], a[248:251], v[176:179]
 ds_read_b64_tr_b16 a[174:175], v9 offset:1024
 v_mfma_f32_16x16x32_bf16 v[184:187], a[208:211], a[252:255], v[184:187]
 ds_read_b128 a[140:143], v4 offset:10240
 v_mfma_f32_16x16x32_bf16 v[132:135], a[212:215], a[224:227], v[132:135]
 v_mfma_f32_16x16x32_bf16 v[140:143], a[212:215], a[228:231], v[140:143]
 buffer_load_dwordx4 v1, s[12:15], s66 offen offset:3072 lds
 s_add_u32 m0, s81, 69632
 v_mfma_f32_16x16x32_bf16 v[148:151], a[212:215], a[232:235], v[148:151]
 ds_read_b64_tr_b16 a[176:177], v10 offset:0
 v_mfma_f32_16x16x32_bf16 v[156:159], a[212:215], a[236:239], v[156:159]
 ds_read_b64_tr_b16 a[178:179], v10 offset:1024
 v_mfma_f32_16x16x32_bf16 v[164:167], a[212:215], a[240:243], v[164:167]
 ds_read_b128 a[144:147], v4 offset:16384
 v_mfma_f32_16x16x32_bf16 v[172:175], a[212:215], a[244:247], v[172:175]
 ds_read_b64_tr_b16 a[180:181], v11 offset:0
 v_mfma_f32_16x16x32_bf16 v[180:183], a[212:215], a[248:251], v[180:183]
 buffer_load_dwordx4 v0, s[12:15], s67 offen offset:0 lds
 v_mfma_f32_16x16x32_bf16 v[188:191], a[212:215], a[252:255], v[188:191]
 ds_read_b64_tr_b16 a[182:183], v11 offset:1024
 v_mfma_f32_16x16x32_bf16 v[192:195], a[216:219], a[224:227], v[192:195]
 ds_read_b128 a[148:151], v4 offset:18432
 v_mfma_f32_16x16x32_bf16 v[200:203], a[216:219], a[228:231], v[200:203]
 ds_read_b64_tr_b16 a[184:185], v12 offset:0
 v_mfma_f32_16x16x32_bf16 v[208:211], a[216:219], a[232:235], v[208:211]
 ds_read_b64_tr_b16 a[186:187], v12 offset:1024
 v_mfma_f32_16x16x32_bf16 v[216:219], a[216:219], a[236:239], v[216:219]
 buffer_load_dwordx4 v1, s[12:15], s68 offen offset:1024 lds
 v_mfma_f32_16x16x32_bf16 v[224:227], a[216:219], a[240:243], v[224:227]
 ds_read_b128 a[152:155], v4 offset:24576
 v_mfma_f32_16x16x32_bf16 v[232:235], a[216:219], a[244:247], v[232:235]
 ds_read_b64_tr_b16 a[188:189], v13 offset:0
 v_mfma_f32_16x16x32_bf16 v[240:243], a[216:219], a[248:251], v[240:243]
 ds_read_b64_tr_b16 a[190:191], v13 offset:1024
 v_mfma_f32_16x16x32_bf16 v[248:251], a[216:219], a[252:255], v[248:251]
 ds_read_b128 a[156:159], v4 offset:26624
 v_mfma_f32_16x16x32_bf16 v[196:199], a[220:223], a[224:227], v[196:199]
 buffer_load_dwordx4 v0, s[12:15], s69 offen offset:2048 lds
 v_mfma_f32_16x16x32_bf16 v[204:207], a[220:223], a[228:231], v[204:207]
 v_mfma_f32_16x16x32_bf16 v[212:215], a[220:223], a[232:235], v[212:215]
 v_mfma_f32_16x16x32_bf16 v[220:223], a[220:223], a[236:239], v[220:223]
 v_mfma_f32_16x16x32_bf16 v[228:231], a[220:223], a[240:243], v[228:231]
 v_mfma_f32_16x16x32_bf16 v[236:239], a[220:223], a[244:247], v[236:239]
 buffer_load_dwordx4 v1, s[12:15], s70 offen offset:3072 lds
 s_add_u32 m0, s82, 131072
 v_mfma_f32_16x16x32_bf16 v[244:247], a[220:223], a[248:251], v[244:247]
 v_mfma_f32_16x16x32_bf16 v[252:255], a[220:223], a[252:255], v[252:255]
 s_waitcnt lgkmcnt(15)
 v_mfma_f32_16x16x32_bf16 v[24:27], a[128:131], a[160:163], v[24:27]
 v_mfma_f32_16x16x32_bf16 a[104:107], a[128:131], a[164:167], a[104:107]
 v_mfma_f32_16x16x32_bf16 a[112:115], a[128:131], a[168:171], a[112:115]
 s_waitcnt lgkmcnt(13)
 buffer_load_dwordx4 v2, s[16:19], 0 offen offset:0 lds
 v_mfma_f32_16x16x32_bf16 v[32:35], a[128:131], a[172:175], v[32:35]
 s_waitcnt lgkmcnt(10)
 ds_read_b64_tr_b16 a[224:225], v6 offset:8192
 v_mfma_f32_16x16x32_bf16 a[120:123], a[128:131], a[176:179], a[120:123]
 s_waitcnt lgkmcnt(8)
 ds_read_b64_tr_b16 a[226:227], v6 offset:9216
 v_mfma_f32_16x16x32_bf16 v[40:43], a[128:131], a[180:183], v[40:43]
 s_waitcnt lgkmcnt(6)
 v_mfma_f32_16x16x32_bf16 v[48:51], a[128:131], a[184:187], v[48:51]
 s_waitcnt lgkmcnt(3)
 ds_read_b128 a[192:195], v5 offset:0
 v_mfma_f32_16x16x32_bf16 v[56:59], a[128:131], a[188:191], v[56:59]
 buffer_load_dwordx4 v2, s[16:19], s71 offen offset:1024 lds
 v_mfma_f32_16x16x32_bf16 v[28:31], a[132:135], a[160:163], v[28:31]
 ds_read_b64_tr_b16 a[228:229], v7 offset:8192
 v_mfma_f32_16x16x32_bf16 a[108:111], a[132:135], a[164:167], a[108:111]
 v_mfma_f32_16x16x32_bf16 a[116:119], a[132:135], a[168:171], a[116:119]
 ds_read_b64_tr_b16 a[230:231], v7 offset:9216
 v_mfma_f32_16x16x32_bf16 v[36:39], a[132:135], a[172:175], v[36:39]
 ds_read_b128 a[196:199], v5 offset:2048
 v_mfma_f32_16x16x32_bf16 a[124:127], a[132:135], a[176:179], a[124:127]
 buffer_load_dwordx4 v3, s[16:19], s72 offen offset:2048 lds
 v_mfma_f32_16x16x32_bf16 v[44:47], a[132:135], a[180:183], v[44:47]
 v_mfma_f32_16x16x32_bf16 v[52:55], a[132:135], a[184:187], v[52:55]
 ds_read_b64_tr_b16 a[232:233], v8 offset:8192
 v_mfma_f32_16x16x32_bf16 v[60:63], a[132:135], a[188:191], v[60:63]
 ds_read_b64_tr_b16 a[234:235], v8 offset:9216
 v_mfma_f32_16x16x32_bf16 v[64:67], a[136:139], a[160:163], v[64:67]
 v_mfma_f32_16x16x32_bf16 v[72:75], a[136:139], a[164:167], v[72:75]
 buffer_load_dwordx4 v3, s[16:19], s73 offen offset:3072 lds
 s_add_u32 m0, s82, 147456
 v_mfma_f32_16x16x32_bf16 v[80:83], a[136:139], a[168:171], v[80:83]
 ds_read_b128 a[200:203], v5 offset:8192
 v_mfma_f32_16x16x32_bf16 v[88:91], a[136:139], a[172:175], v[88:91]
 ds_read_b64_tr_b16 a[236:237], v9 offset:8192
 v_mfma_f32_16x16x32_bf16 v[96:99], a[136:139], a[176:179], v[96:99]
 v_mfma_f32_16x16x32_bf16 v[104:107], a[136:139], a[180:183], v[104:107]
 ds_read_b64_tr_b16 a[238:239], v9 offset:9216
 v_mfma_f32_16x16x32_bf16 v[112:115], a[136:139], a[184:187], v[112:115]
 buffer_load_dwordx4 v2, s[20:23], 0 offen offset:0 lds
 v_mfma_f32_16x16x32_bf16 v[120:123], a[136:139], a[188:191], v[120:123]
 ds_read_b128 a[204:207], v5 offset:10240
 v_mfma_f32_16x16x32_bf16 v[68:71], a[140:143], a[160:163], v[68:71]
 v_mfma_f32_16x16x32_bf16 v[76:79], a[140:143], a[164:167], v[76:79]
 ds_read_b64_tr_b16 a[240:241], v10 offset:8192
 v_mfma_f32_16x16x32_bf16 v[84:87], a[140:143], a[168:171], v[84:87]
 v_mfma_f32_16x16x32_bf16 v[92:95], a[140:143], a[172:175], v[92:95]
 buffer_load_dwordx4 v2, s[20:23], s71 offen offset:1024 lds
 s_waitcnt vmcnt(16)
 v_mfma_f32_16x16x32_bf16 v[100:103], a[140:143], a[176:179], v[100:103]
 ds_read_b128 a[64:67], v20 offset:0
 v_mfma_f32_16x16x32_bf16 v[108:111], a[140:143], a[180:183], v[108:111]
 ds_read_b128 a[68:71], v20 offset:2048
 v_mfma_f32_16x16x32_bf16 v[116:119], a[140:143], a[184:187], v[116:119]
 ds_read_b64_tr_b16 a[242:243], v10 offset:9216
 v_mfma_f32_16x16x32_bf16 v[124:127], a[140:143], a[188:191], v[124:127]
 ds_read_b128 a[72:75], v20 offset:4096
 v_mfma_f32_16x16x32_bf16 v[128:131], a[144:147], a[160:163], v[128:131]
 buffer_load_dwordx4 v3, s[20:23], s72 offen offset:2048 lds
 v_mfma_f32_16x16x32_bf16 v[136:139], a[144:147], a[164:167], v[136:139]
 ds_read_b128 a[76:79], v20 offset:6144
 v_mfma_f32_16x16x32_bf16 v[144:147], a[144:147], a[168:171], v[144:147]
 ds_read_b128 a[208:211], v5 offset:16384
 v_mfma_f32_16x16x32_bf16 v[152:155], a[144:147], a[172:175], v[152:155]
 ds_read_b128 a[80:83], v21 offset:0
 v_mfma_f32_16x16x32_bf16 v[160:163], a[144:147], a[176:179], v[160:163]
 ds_read_b128 a[84:87], v21 offset:2048
 v_mfma_f32_16x16x32_bf16 v[168:171], a[144:147], a[180:183], v[168:171]
 buffer_load_dwordx4 v3, s[20:23], s73 offen offset:3072 lds
 v_mfma_f32_16x16x32_bf16 v[176:179], a[144:147], a[184:187], v[176:179]
 v_mfma_f32_16x16x32_bf16 v[184:187], a[144:147], a[188:191], v[184:187]
 ds_read_b128 a[88:91], v21 offset:4096
 v_mfma_f32_16x16x32_bf16 v[132:135], a[148:151], a[160:163], v[132:135]
 ds_read_b128 a[92:95], v21 offset:6144
 v_mfma_f32_16x16x32_bf16 v[140:143], a[148:151], a[164:167], v[140:143]
 ds_read_b64_tr_b16 a[244:245], v11 offset:8192
 v_mfma_f32_16x16x32_bf16 v[148:151], a[148:151], a[168:171], v[148:151]
 ds_read_b64_tr_b16 a[246:247], v11 offset:9216
 v_add_u32 v0, 0x80, v0
 v_add_u32 v1, 0x80, v1
 v_mfma_f32_16x16x32_bf16 v[156:159], a[148:151], a[172:175], v[156:159]
 v_add_u32 v2, 0x80000, v2
 v_add_u32 v3, 0x80000, v3
 v_mfma_f32_16x16x32_bf16 v[164:167], a[148:151], a[176:179], v[164:167]
 ds_read_b128 a[212:215], v5 offset:18432
 v_mfma_f32_16x16x32_bf16 v[172:175], a[148:151], a[180:183], v[172:175]
 ds_read_b64_tr_b16 a[248:249], v12 offset:8192
 v_mfma_f32_16x16x32_bf16 v[180:183], a[148:151], a[184:187], v[180:183]
 v_mfma_f32_16x16x32_bf16 v[188:191], a[148:151], a[188:191], v[188:191]
 s_waitcnt lgkmcnt(0)
 ds_read_b64_tr_b16 a[250:251], v12 offset:9216
 v_mfma_f32_16x16x32_bf16 v[192:195], a[152:155], a[160:163], v[192:195]
 s_add_u32 m0, s81, 0
 ds_read_b128 a[216:219], v5 offset:24576
 v_mfma_f32_16x16x32_bf16 v[200:203], a[152:155], a[164:167], v[200:203]
 buffer_load_dwordx4 v17, s[8:11], 0 offen offset:0 lds
 v_mfma_f32_16x16x32_bf16 v[208:211], a[152:155], a[168:171], v[208:211]
 v_mfma_f32_16x16x32_bf16 v[216:219], a[152:155], a[172:175], v[216:219]
 ds_read_b64_tr_b16 a[252:253], v13 offset:8192
 v_mfma_f32_16x16x32_bf16 v[224:227], a[152:155], a[176:179], v[224:227]
 ds_read_b64_tr_b16 a[254:255], v13 offset:9216
 v_mfma_f32_16x16x32_bf16 v[232:235], a[152:155], a[180:183], v[232:235]
 buffer_load_dwordx4 v18, s[8:11], s74 offen offset:1024 lds
 v_mfma_f32_16x16x32_bf16 v[240:243], a[152:155], a[184:187], v[240:243]
 v_mfma_f32_16x16x32_bf16 v[248:251], a[152:155], a[188:191], v[248:251]
 ds_read_b128 a[220:223], v5 offset:26624
 v_mfma_f32_16x16x32_bf16 v[196:199], a[156:159], a[160:163], v[196:199]
 v_mfma_f32_16x16x32_bf16 v[204:207], a[156:159], a[164:167], v[204:207]
 buffer_load_dwordx4 v17, s[8:11], s75 offen offset:2048 lds
 v_mfma_f32_16x16x32_bf16 v[212:215], a[156:159], a[168:171], v[212:215]
 v_mfma_f32_16x16x32_bf16 v[220:223], a[156:159], a[172:175], v[220:223]
 v_mfma_f32_16x16x32_bf16 v[228:231], a[156:159], a[176:179], v[228:231]
 v_mfma_f32_16x16x32_bf16 v[236:239], a[156:159], a[180:183], v[236:239]
 buffer_load_dwordx4 v18, s[8:11], s76 offen offset:3072 lds
 s_add_u32 m0, s81, 4096
 v_mfma_f32_16x16x32_bf16 v[244:247], a[156:159], a[184:187], v[244:247]
 v_mfma_f32_16x16x32_bf16 v[252:255], a[156:159], a[188:191], v[252:255]
 v_mfma_f32_16x16x32_bf16 v[24:27], a[192:195], a[224:227], v[24:27]
 v_mfma_f32_16x16x32_bf16 a[104:107], a[192:195], a[228:231], a[104:107]
 buffer_load_dwordx4 v17, s[8:11], s77 offen offset:0 lds
 v_mfma_f32_16x16x32_bf16 a[112:115], a[192:195], a[232:235], a[112:115]
 v_mfma_f32_16x16x32_bf16 v[32:35], a[192:195], a[236:239], v[32:35]
 v_mfma_f32_16x16x32_bf16 a[120:123], a[192:195], a[240:243], a[120:123]
 v_mfma_f32_16x16x32_bf16 v[40:43], a[192:195], a[244:247], v[40:43]
 s_waitcnt lgkmcnt(4)
 buffer_load_dwordx4 v18, s[8:11], s78 offen offset:1024 lds
 v_mfma_f32_16x16x32_bf16 v[48:51], a[192:195], a[248:251], v[48:51]
 s_waitcnt lgkmcnt(1)
 v_mfma_f32_16x16x32_bf16 v[56:59], a[192:195], a[252:255], v[56:59]
 v_mfma_f32_16x16x32_bf16 v[28:31], a[196:199], a[224:227], v[28:31]
 v_mfma_f32_16x16x32_bf16 a[108:111], a[196:199], a[228:231], a[108:111]
 buffer_load_dwordx4 v17, s[8:11], s79 offen offset:2048 lds
 v_mfma_f32_16x16x32_bf16 a[116:119], a[196:199], a[232:235], a[116:119]
 v_mfma_f32_16x16x32_bf16 v[36:39], a[196:199], a[236:239], v[36:39]
 v_mfma_f32_16x16x32_bf16 a[124:127], a[196:199], a[240:243], a[124:127]
 v_mfma_f32_16x16x32_bf16 v[44:47], a[196:199], a[244:247], v[44:47]
 buffer_load_dwordx4 v18, s[8:11], s80 offen offset:3072 lds
 v_mfma_f32_16x16x32_bf16 v[52:55], a[196:199], a[248:251], v[52:55]
 v_mfma_f32_16x16x32_bf16 v[60:63], a[196:199], a[252:255], v[60:63]
 v_mfma_f32_16x16x32_bf16 v[64:67], a[200:203], a[224:227], v[64:67]
 v_mfma_f32_16x16x32_bf16 v[72:75], a[200:203], a[228:231], v[72:75]
 buffer_load_dword a100, v16, s[40:43], s88 offen
 s_add_u32 s88, s88, s89
 v_add_u32 v17, 0x80, v17
 v_add_u32 v18, 0x80, v18
 v_mfma_f32_16x16x32_bf16 v[80:83], a[200:203], a[232:235], v[80:83]
 v_mfma_f32_16x16x32_bf16 v[88:91], a[200:203], a[236:239], v[88:91]
 s_lshr_b32 s94, s63, 1
 s_xor_b32 s94, s94, 2
 s_or_b32 s94, s94, s60
 s_cselect_b32 s94, 0x100000, s2
 v_lshl_add_u32 v15, v14, 4, s94
 v_mfma_f32_16x16x32_bf16 v[96:99], a[200:203], a[240:243], v[96:99]
 buffer_store_byte v19, v15, s[36:39], 0 offen sc1
 v_mfma_f32_16x16x32_bf16 v[104:107], a[200:203], a[244:247], v[104:107]
 v_mfma_f32_16x16x32_bf16 v[112:115], a[200:203], a[248:251], v[112:115]
 v_mfma_f32_16x16x32_bf16 v[120:123], a[200:203], a[252:255], v[120:123]
 v_mfma_f32_16x16x32_bf16 v[68:71], a[204:207], a[224:227], v[68:71]
 s_waitcnt vmcnt(10) lgkmcnt(0)
 s_barrier
 v_mfma_f32_16x16x32_bf16 v[76:79], a[204:207], a[228:231], v[76:79]
 s_add_u32 m0, s81, 32768
 ds_read_b64_tr_b16 a[160:161], v6 offset:32768
 v_mfma_f32_16x16x32_bf16 v[84:87], a[204:207], a[232:235], v[84:87]
 buffer_load_dwordx4 v0, s[12:15], 0 offen offset:0 lds
 v_mfma_f32_16x16x32_bf16 v[92:95], a[204:207], a[236:239], v[92:95]
 ds_read_b64_tr_b16 a[162:163], v6 offset:33792
 v_mfma_f32_16x16x32_bf16 v[100:103], a[204:207], a[240:243], v[100:103]
 ds_read_b128 a[128:131], v4 offset:32768
 v_mfma_f32_16x16x32_bf16 v[108:111], a[204:207], a[244:247], v[108:111]
 ds_read_b64_tr_b16 a[164:165], v7 offset:32768
 v_mfma_f32_16x16x32_bf16 v[116:119], a[204:207], a[248:251], v[116:119]
 ds_read_b64_tr_b16 a[166:167], v7 offset:33792
 v_mfma_f32_16x16x32_bf16 v[124:127], a[204:207], a[252:255], v[124:127]
 buffer_load_dwordx4 v1, s[12:15], s64 offen offset:1024 lds
 v_mfma_f32_16x16x32_bf16 v[128:131], a[208:211], a[224:227], v[128:131]
 ds_read_b128 a[132:135], v4 offset:34816
 v_mfma_f32_16x16x32_bf16 v[136:139], a[208:211], a[228:231], v[136:139]
 ds_read_b64_tr_b16 a[168:169], v8 offset:32768
 v_mfma_f32_16x16x32_bf16 v[144:147], a[208:211], a[232:235], v[144:147]
 ds_read_b64_tr_b16 a[170:171], v8 offset:33792
 v_mfma_f32_16x16x32_bf16 v[152:155], a[208:211], a[236:239], v[152:155]
 ds_read_b128 a[136:139], v4 offset:40960
 v_mfma_f32_16x16x32_bf16 v[160:163], a[208:211], a[240:243], v[160:163]
 buffer_load_dwordx4 v0, s[12:15], s65 offen offset:2048 lds
 v_mfma_f32_16x16x32_bf16 v[168:171], a[208:211], a[244:247], v[168:171]
 ds_read_b64_tr_b16 a[172:173], v9 offset:32768
 v_mfma_f32_16x16x32_bf16 v[176:179], a[208:211], a[248:251], v[176:179]
 ds_read_b64_tr_b16 a[174:175], v9 offset:33792
 v_mfma_f32_16x16x32_bf16 v[184:187], a[208:211], a[252:255], v[184:187]
 ds_read_b128 a[140:143], v4 offset:43008
 v_mfma_f32_16x16x32_bf16 v[132:135], a[212:215], a[224:227], v[132:135]
 v_mfma_f32_16x16x32_bf16 v[140:143], a[212:215], a[228:231], v[140:143]
 buffer_load_dwordx4 v1, s[12:15], s66 offen offset:3072 lds
 s_add_u32 m0, s81, 36864
 v_mfma_f32_16x16x32_bf16 v[148:151], a[212:215], a[232:235], v[148:151]
 ds_read_b64_tr_b16 a[176:177], v10 offset:32768
 v_mfma_f32_16x16x32_bf16 v[156:159], a[212:215], a[236:239], v[156:159]
 ds_read_b64_tr_b16 a[178:179], v10 offset:33792
 v_mfma_f32_16x16x32_bf16 v[164:167], a[212:215], a[240:243], v[164:167]
 ds_read_b128 a[144:147], v4 offset:49152
 v_mfma_f32_16x16x32_bf16 v[172:175], a[212:215], a[244:247], v[172:175]
 ds_read_b64_tr_b16 a[180:181], v11 offset:32768
 v_mfma_f32_16x16x32_bf16 v[180:183], a[212:215], a[248:251], v[180:183]
 buffer_load_dwordx4 v0, s[12:15], s67 offen offset:0 lds
 v_mfma_f32_16x16x32_bf16 v[188:191], a[212:215], a[252:255], v[188:191]
 ds_read_b64_tr_b16 a[182:183], v11 offset:33792
 v_mfma_f32_16x16x32_bf16 v[192:195], a[216:219], a[224:227], v[192:195]
 ds_read_b128 a[148:151], v4 offset:51200
 v_mfma_f32_16x16x32_bf16 v[200:203], a[216:219], a[228:231], v[200:203]
 ds_read_b64_tr_b16 a[184:185], v12 offset:32768
 v_mfma_f32_16x16x32_bf16 v[208:211], a[216:219], a[232:235], v[208:211]
 ds_read_b64_tr_b16 a[186:187], v12 offset:33792
 v_mfma_f32_16x16x32_bf16 v[216:219], a[216:219], a[236:239], v[216:219]
 buffer_load_dwordx4 v1, s[12:15], s68 offen offset:1024 lds
 v_mfma_f32_16x16x32_bf16 v[224:227], a[216:219], a[240:243], v[224:227]
 ds_read_b128 a[152:155], v4 offset:57344
 v_mfma_f32_16x16x32_bf16 v[232:235], a[216:219], a[244:247], v[232:235]
 ds_read_b64_tr_b16 a[188:189], v13 offset:32768
 v_mfma_f32_16x16x32_bf16 v[240:243], a[216:219], a[248:251], v[240:243]
 ds_read_b64_tr_b16 a[190:191], v13 offset:33792
 v_mfma_f32_16x16x32_bf16 v[248:251], a[216:219], a[252:255], v[248:251]
 ds_read_b128 a[156:159], v4 offset:59392
 v_mfma_f32_16x16x32_bf16 v[196:199], a[220:223], a[224:227], v[196:199]
 buffer_load_dwordx4 v0, s[12:15], s69 offen offset:2048 lds
 v_mfma_f32_16x16x32_bf16 v[204:207], a[220:223], a[228:231], v[204:207]
 v_mfma_f32_16x16x32_bf16 v[212:215], a[220:223], a[232:235], v[212:215]
 v_mfma_f32_16x16x32_bf16 v[220:223], a[220:223], a[236:239], v[220:223]
 v_mfma_f32_16x16x32_bf16 v[228:231], a[220:223], a[240:243], v[228:231]
 v_mfma_f32_16x16x32_bf16 v[236:239], a[220:223], a[244:247], v[236:239]
 buffer_load_dwordx4 v1, s[12:15], s70 offen offset:3072 lds
 s_add_u32 m0, s82, 98304
 v_mfma_f32_16x16x32_bf16 v[244:247], a[220:223], a[248:251], v[244:247]
 v_mfma_f32_16x16x32_bf16 v[252:255], a[220:223], a[252:255], v[252:255]
 s_waitcnt lgkmcnt(15)
 v_mfma_f32_16x16x32_bf16 v[24:27], a[128:131], a[160:163], v[24:27]
 v_mfma_f32_16x16x32_bf16 a[104:107], a[128:131], a[164:167], a[104:107]
 v_mfma_f32_16x16x32_bf16 a[112:115], a[128:131], a[168:171], a[112:115]
 s_waitcnt lgkmcnt(13)
 buffer_load_dwordx4 v2, s[16:19], 0 offen offset:0 lds
 v_mfma_f32_16x16x32_bf16 v[32:35], a[128:131], a[172:175], v[32:35]
 s_waitcnt lgkmcnt(10)
 ds_read_b64_tr_b16 a[224:225], v6 offset:40960
 v_mfma_f32_16x16x32_bf16 a[120:123], a[128:131], a[176:179], a[120:123]
 s_waitcnt lgkmcnt(8)
 ds_read_b64_tr_b16 a[226:227], v6 offset:41984
 v_mfma_f32_16x16x32_bf16 v[40:43], a[128:131], a[180:183], v[40:43]
 s_waitcnt lgkmcnt(6)
 v_mfma_f32_16x16x32_bf16 v[48:51], a[128:131], a[184:187], v[48:51]
 s_waitcnt lgkmcnt(3)
 ds_read_b128 a[192:195], v5 offset:32768
 v_mfma_f32_16x16x32_bf16 v[56:59], a[128:131], a[188:191], v[56:59]
 buffer_load_dwordx4 v2, s[16:19], s71 offen offset:1024 lds
 v_mfma_f32_16x16x32_bf16 v[28:31], a[132:135], a[160:163], v[28:31]
 v_mfma_f32_16x16x32_bf16 a[108:111], a[132:135], a[164:167], a[108:111]
 ds_read_b64_tr_b16 a[228:229], v7 offset:40960
 v_mfma_f32_16x16x32_bf16 a[116:119], a[132:135], a[168:171], a[116:119]
 v_mfma_f32_16x16x32_bf16 v[36:39], a[132:135], a[172:175], v[36:39]
 ds_read_b64_tr_b16 a[230:231], v7 offset:41984
 v_mfma_f32_16x16x32_bf16 a[124:127], a[132:135], a[176:179], a[124:127]
 buffer_load_dwordx4 v3, s[16:19], s72 offen offset:2048 lds
 v_mfma_f32_16x16x32_bf16 v[44:47], a[132:135], a[180:183], v[44:47]
 v_mfma_f32_16x16x32_bf16 v[52:55], a[132:135], a[184:187], v[52:55]
 ds_read_b128 a[196:199], v5 offset:34816
 v_mfma_f32_16x16x32_bf16 v[60:63], a[132:135], a[188:191], v[60:63]
 v_mfma_f32_16x16x32_bf16 v[64:67], a[136:139], a[160:163], v[64:67]
 ds_read_b64_tr_b16 a[232:233], v8 offset:40960
 v_mfma_f32_16x16x32_bf16 v[72:75], a[136:139], a[164:167], v[72:75]
 buffer_load_dwordx4 v3, s[16:19], s73 offen offset:3072 lds
 s_add_u32 m0, s82, 114688
 v_mfma_f32_16x16x32_bf16 v[80:83], a[136:139], a[168:171], v[80:83]
 v_mfma_f32_16x16x32_bf16 v[88:91], a[136:139], a[172:175], v[88:91]
 ds_read_b64_tr_b16 a[234:235], v8 offset:41984
 v_mfma_f32_16x16x32_bf16 v[96:99], a[136:139], a[176:179], v[96:99]
 v_mfma_f32_16x16x32_bf16 v[104:107], a[136:139], a[180:183], v[104:107]
 ds_read_b128 a[200:203], v5 offset:40960
 v_mfma_f32_16x16x32_bf16 v[112:115], a[136:139], a[184:187], v[112:115]
 buffer_load_dwordx4 v2, s[20:23], 0 offen offset:0 lds
 v_mfma_f32_16x16x32_bf16 v[120:123], a[136:139], a[188:191], v[120:123]
 v_mfma_f32_16x16x32_bf16 v[68:71], a[140:143], a[160:163], v[68:71]
 ds_read_b64_tr_b16 a[236:237], v9 offset:40960
 v_mfma_f32_16x16x32_bf16 v[76:79], a[140:143], a[164:167], v[76:79]
 v_mfma_f32_16x16x32_bf16 v[84:87], a[140:143], a[168:171], v[84:87]
 ds_read_b64_tr_b16 a[238:239], v9 offset:41984
 v_mfma_f32_16x16x32_bf16 v[92:95], a[140:143], a[172:175], v[92:95]
 buffer_load_dwordx4 v2, s[20:23], s71 offen offset:1024 lds
 v_mfma_f32_16x16x32_bf16 v[100:103], a[140:143], a[176:179], v[100:103]
 v_mfma_f32_16x16x32_bf16 v[108:111], a[140:143], a[180:183], v[108:111]
 ds_read_b128 a[204:207], v5 offset:43008
 v_mfma_f32_16x16x32_bf16 v[116:119], a[140:143], a[184:187], v[116:119]
 v_mfma_f32_16x16x32_bf16 v[124:127], a[140:143], a[188:191], v[124:127]
 ds_read_b64_tr_b16 a[240:241], v10 offset:40960
 v_mfma_f32_16x16x32_bf16 v[128:131], a[144:147], a[160:163], v[128:131]
 buffer_load_dwordx4 v3, s[20:23], s72 offen offset:2048 lds
 v_mfma_f32_16x16x32_bf16 v[136:139], a[144:147], a[164:167], v[136:139]
 ds_read_b64_tr_b16 a[242:243], v10 offset:41984
 v_mfma_f32_16x16x32_bf16 v[144:147], a[144:147], a[168:171], v[144:147]
 v_mfma_f32_16x16x32_bf16 v[152:155], a[144:147], a[172:175], v[152:155]
 ds_read_b128 a[208:211], v5 offset:49152
 v_mfma_f32_16x16x32_bf16 v[160:163], a[144:147], a[176:179], v[160:163]
 v_mfma_f32_16x16x32_bf16 v[168:171], a[144:147], a[180:183], v[168:171]
 buffer_load_dwordx4 v3, s[20:23], s73 offen offset:3072 lds
 v_mfma_f32_16x16x32_bf16 v[176:179], a[144:147], a[184:187], v[176:179]
 ds_read_b64_tr_b16 a[244:245], v11 offset:40960
 v_mfma_f32_16x16x32_bf16 v[184:187], a[144:147], a[188:191], v[184:187]
 v_mfma_f32_16x16x32_bf16 v[132:135], a[148:151], a[160:163], v[132:135]
 ds_read_b64_tr_b16 a[246:247], v11 offset:41984
 v_mfma_f32_16x16x32_bf16 v[140:143], a[148:151], a[164:167], v[140:143]
 s_lshr_b32 s94, s63, 1
 s_xor_b32 s94, s94, 3
 s_or_b32 s94, s94, s60
 s_cselect_b32 s94, 0x100000, s2
 v_lshl_add_u32 v15, v14, 4, s94
 v_mfma_f32_16x16x32_bf16 v[148:151], a[148:151], a[168:171], v[148:151]
 buffer_store_byte v19, v15, s[36:39], 0 offen sc1
 v_add_u32 v0, 0x80, v0
 v_add_u32 v1, 0x80, v1
 v_mfma_f32_16x16x32_bf16 v[156:159], a[148:151], a[172:175], v[156:159]
 ds_read_b128 a[212:215], v5 offset:51200
 v_add_u32 v2, 0x80000, v2
 v_add_u32 v3, 0x80000, v3
 v_mfma_f32_16x16x32_bf16 v[164:167], a[148:151], a[176:179], v[164:167]
 v_mfma_f32_16x16x32_bf16 v[172:175], a[148:151], a[180:183], v[172:175]
 ds_read_b64_tr_b16 a[248:249], v12 offset:40960
 v_mfma_f32_16x16x32_bf16 v[180:183], a[148:151], a[184:187], v[180:183]
 v_mfma_f32_16x16x32_bf16 v[188:191], a[148:151], a[188:191], v[188:191]
 s_lshl_b32 s94, s63, 1
 s_sub_u32 s94, 15, s94
 s_lshl_b32 s94, s94, 7
 s_sub_u32 s94, s94, 32
 v_lshrrev_b32 v22, 9, v14
 v_mul_u32_u24 v22, s94, v22
 ds_read_b64_tr_b16 a[250:251], v12 offset:41984
 v_mfma_f32_16x16x32_bf16 v[192:195], a[152:155], a[160:163], v[192:195]
 s_lshl_b32 s94, s63, 7
 s_lshl_b32 s95, s62, 5
 s_add_u32 s94, s94, s95
 v_lshl_add_u32 v22, v22, 4, v14
 v_lshrrev_b32 v22, 4, v22
 v_add_u32 v22, s94, v22
 v_mul_u32_u24 v22, 0x480, v22
 v_mfma_f32_16x16x32_bf16 v[200:203], a[152:155], a[164:167], v[200:203]
 s_lshl_b32 s95, s60, 7
 buffer_load_dword a101, v22, s[8:11], s95 offen offset:512
 v_mfma_f32_16x16x32_bf16 v[208:211], a[152:155], a[168:171], v[208:211]
 ds_read_b128 a[216:219], v5 offset:57344
 v_mfma_f32_16x16x32_bf16 v[216:219], a[152:155], a[172:175], v[216:219]
 v_mfma_f32_16x16x32_bf16 v[224:227], a[152:155], a[176:179], v[224:227]
 ds_read_b64_tr_b16 a[252:253], v13 offset:40960
 v_mfma_f32_16x16x32_bf16 v[232:235], a[152:155], a[180:183], v[232:235]
 v_mfma_f32_16x16x32_bf16 v[240:243], a[152:155], a[184:187], v[240:243]
 ds_read_b64_tr_b16 a[254:255], v13 offset:41984
 v_mfma_f32_16x16x32_bf16 v[248:251], a[152:155], a[188:191], v[248:251]
 s_waitcnt lgkmcnt(15)
 v_mfma_f32_16x16x32_bf16 v[196:199], a[156:159], a[160:163], v[196:199]
 ds_read_b128 a[220:223], v5 offset:59392
 v_mfma_f32_16x16x32_bf16 v[204:207], a[156:159], a[164:167], v[204:207]
 v_mfma_f32_16x16x32_bf16 v[212:215], a[156:159], a[168:171], v[212:215]
 v_mfma_f32_16x16x32_bf16 v[220:223], a[156:159], a[172:175], v[220:223]
 v_mfma_f32_16x16x32_bf16 v[228:231], a[156:159], a[176:179], v[228:231]
 v_mfma_f32_16x16x32_bf16 v[236:239], a[156:159], a[180:183], v[236:239]
 s_cmp_eq_u32 s60, 0
 s_cselect_b32 s95, 0, 2147483632
 buffer_load_dword a101, v22, s[8:11], s95 offen offset:1024
 v_mfma_f32_16x16x32_bf16 v[244:247], a[156:159], a[184:187], v[244:247]
 v_mfma_f32_16x16x32_bf16 v[252:255], a[156:159], a[188:191], v[252:255]
 v_mfma_f32_16x16x32_bf16 v[24:27], a[192:195], a[224:227], v[24:27]
 v_mfma_f32_16x16x32_bf16 a[104:107], a[192:195], a[228:231], a[104:107]
 v_mfma_f32_16x16x32_bf16 a[112:115], a[192:195], a[232:235], a[112:115]
 s_waitcnt lgkmcnt(13)
 v_mfma_f32_16x16x32_bf16 v[32:35], a[192:195], a[236:239], v[32:35]
 s_waitcnt lgkmcnt(10)
 v_mfma_f32_16x16x32_bf16 a[120:123], a[192:195], a[240:243], a[120:123]
 s_waitcnt lgkmcnt(7)
 v_mfma_f32_16x16x32_bf16 v[40:43], a[192:195], a[244:247], v[40:43]
 s_waitcnt lgkmcnt(4)
 v_mfma_f32_16x16x32_bf16 v[48:51], a[192:195], a[248:251], v[48:51]
 s_waitcnt lgkmcnt(1)
 v_mfma_f32_16x16x32_bf16 v[56:59], a[192:195], a[252:255], v[56:59]
 v_mfma_f32_16x16x32_bf16 v[28:31], a[196:199], a[224:227], v[28:31]
 v_mfma_f32_16x16x32_bf16 a[108:111], a[196:199], a[228:231], a[108:111]
 v_mfma_f32_16x16x32_bf16 a[116:119], a[196:199], a[232:235], a[116:119]
 v_mfma_f32_16x16x32_bf16 v[36:39], a[196:199], a[236:239], v[36:39]
 v_mfma_f32_16x16x32_bf16 a[124:127], a[196:199], a[240:243], a[124:127]
 v_mfma_f32_16x16x32_bf16 v[44:47], a[196:199], a[244:247], v[44:47]
 v_mfma_f32_16x16x32_bf16 v[52:55], a[196:199], a[248:251], v[52:55]
 v_mfma_f32_16x16x32_bf16 v[60:63], a[196:199], a[252:255], v[60:63]
 v_mfma_f32_16x16x32_bf16 v[64:67], a[200:203], a[224:227], v[64:67]
 v_mfma_f32_16x16x32_bf16 v[72:75], a[200:203], a[228:231], v[72:75]
 v_mfma_f32_16x16x32_bf16 v[80:83], a[200:203], a[232:235], v[80:83]
 v_mfma_f32_16x16x32_bf16 v[88:91], a[200:203], a[236:239], v[88:91]
 v_mfma_f32_16x16x32_bf16 v[96:99], a[200:203], a[240:243], v[96:99]
 v_mfma_f32_16x16x32_bf16 v[104:107], a[200:203], a[244:247], v[104:107]
 v_mfma_f32_16x16x32_bf16 v[112:115], a[200:203], a[248:251], v[112:115]
 v_mfma_f32_16x16x32_bf16 v[120:123], a[200:203], a[252:255], v[120:123]
 v_mfma_f32_16x16x32_bf16 v[68:71], a[204:207], a[224:227], v[68:71]
 s_waitcnt vmcnt(3) lgkmcnt(0)
 s_barrier
 v_mfma_f32_16x16x32_bf16 v[76:79], a[204:207], a[228:231], v[76:79]
 s_add_u32 m0, s81, 65536
 ds_read_b64_tr_b16 a[160:161], v6 offset:0
 v_mfma_f32_16x16x32_bf16 v[84:87], a[204:207], a[232:235], v[84:87]
 buffer_load_dwordx4 v0, s[12:15], 0 offen offset:0 lds
 v_mfma_f32_16x16x32_bf16 v[92:95], a[204:207], a[236:239], v[92:95]
 ds_read_b64_tr_b16 a[162:163], v6 offset:1024
 v_mfma_f32_16x16x32_bf16 v[100:103], a[204:207], a[240:243], v[100:103]
 ds_read_b128 a[128:131], v4 offset:0
 v_mfma_f32_16x16x32_bf16 v[108:111], a[204:207], a[244:247], v[108:111]
 ds_read_b64_tr_b16 a[164:165], v7 offset:0
 v_mfma_f32_16x16x32_bf16 v[116:119], a[204:207], a[248:251], v[116:119]
 ds_read_b64_tr_b16 a[166:167], v7 offset:1024
 v_mfma_f32_16x16x32_bf16 v[124:127], a[204:207], a[252:255], v[124:127]
 buffer_load_dwordx4 v1, s[12:15], s64 offen offset:1024 lds
 v_mfma_f32_16x16x32_bf16 v[128:131], a[208:211], a[224:227], v[128:131]
 ds_read_b128 a[132:135], v4 offset:2048
 v_mfma_f32_16x16x32_bf16 v[136:139], a[208:211], a[228:231], v[136:139]
 ds_read_b64_tr_b16 a[168:169], v8 offset:0
 v_mfma_f32_16x16x32_bf16 v[144:147], a[208:211], a[232:235], v[144:147]
 ds_read_b64_tr_b16 a[170:171], v8 offset:1024
 v_mfma_f32_16x16x32_bf16 v[152:155], a[208:211], a[236:239], v[152:155]
 ds_read_b128 a[136:139], v4 offset:8192
 v_mfma_f32_16x16x32_bf16 v[160:163], a[208:211], a[240:243], v[160:163]
 buffer_load_dwordx4 v0, s[12:15], s65 offen offset:2048 lds
 v_mfma_f32_16x16x32_bf16 v[168:171], a[208:211], a[244:247], v[168:171]
 ds_read_b64_tr_b16 a[172:173], v9 offset:0
 v_mfma_f32_16x16x32_bf16 v[176:179], a[208:211], a[248:251], v[176:179]
 ds_read_b64_tr_b16 a[174:175], v9 offset:1024
 v_mfma_f32_16x16x32_bf16 v[184:187], a[208:211], a[252:255], v[184:187]
 ds_read_b128 a[140:143], v4 offset:10240
 v_mfma_f32_16x16x32_bf16 v[132:135], a[212:215], a[224:227], v[132:135]
 v_mfma_f32_16x16x32_bf16 v[140:143], a[212:215], a[228:231], v[140:143]
 buffer_load_dwordx4 v1, s[12:15], s66 offen offset:3072 lds
 s_add_u32 m0, s81, 69632
 v_mfma_f32_16x16x32_bf16 v[148:151], a[212:215], a[232:235], v[148:151]
 ds_read_b64_tr_b16 a[176:177], v10 offset:0
 v_mfma_f32_16x16x32_bf16 v[156:159], a[212:215], a[236:239], v[156:159]
 ds_read_b64_tr_b16 a[178:179], v10 offset:1024
 v_mfma_f32_16x16x32_bf16 v[164:167], a[212:215], a[240:243], v[164:167]
 ds_read_b128 a[144:147], v4 offset:16384
 v_mfma_f32_16x16x32_bf16 v[172:175], a[212:215], a[244:247], v[172:175]
 ds_read_b64_tr_b16 a[180:181], v11 offset:0
 v_mfma_f32_16x16x32_bf16 v[180:183], a[212:215], a[248:251], v[180:183]
 buffer_load_dwordx4 v0, s[12:15], s67 offen offset:0 lds
 v_mfma_f32_16x16x32_bf16 v[188:191], a[212:215], a[252:255], v[188:191]
 ds_read_b64_tr_b16 a[182:183], v11 offset:1024
 v_mfma_f32_16x16x32_bf16 v[192:195], a[216:219], a[224:227], v[192:195]
 ds_read_b128 a[148:151], v4 offset:18432
 v_mfma_f32_16x16x32_bf16 v[200:203], a[216:219], a[228:231], v[200:203]
 ds_read_b64_tr_b16 a[184:185], v12 offset:0
 v_mfma_f32_16x16x32_bf16 v[208:211], a[216:219], a[232:235], v[208:211]
 ds_read_b64_tr_b16 a[186:187], v12 offset:1024
 v_mfma_f32_16x16x32_bf16 v[216:219], a[216:219], a[236:239], v[216:219]
 buffer_load_dwordx4 v1, s[12:15], s68 offen offset:1024 lds
 v_mfma_f32_16x16x32_bf16 v[224:227], a[216:219], a[240:243], v[224:227]
 ds_read_b128 a[152:155], v4 offset:24576
 v_mfma_f32_16x16x32_bf16 v[232:235], a[216:219], a[244:247], v[232:235]
 ds_read_b64_tr_b16 a[188:189], v13 offset:0
 v_mfma_f32_16x16x32_bf16 v[240:243], a[216:219], a[248:251], v[240:243]
 ds_read_b64_tr_b16 a[190:191], v13 offset:1024
 v_mfma_f32_16x16x32_bf16 v[248:251], a[216:219], a[252:255], v[248:251]
 ds_read_b128 a[156:159], v4 offset:26624
 v_mfma_f32_16x16x32_bf16 v[196:199], a[220:223], a[224:227], v[196:199]
 buffer_load_dwordx4 v0, s[12:15], s69 offen offset:2048 lds
 v_mfma_f32_16x16x32_bf16 v[204:207], a[220:223], a[228:231], v[204:207]
 v_mfma_f32_16x16x32_bf16 v[212:215], a[220:223], a[232:235], v[212:215]
 v_mfma_f32_16x16x32_bf16 v[220:223], a[220:223], a[236:239], v[220:223]
 v_mfma_f32_16x16x32_bf16 v[228:231], a[220:223], a[240:243], v[228:231]
 v_mfma_f32_16x16x32_bf16 v[236:239], a[220:223], a[244:247], v[236:239]
 buffer_load_dwordx4 v1, s[12:15], s70 offen offset:3072 lds
 s_add_u32 m0, s82, 131072
 v_mfma_f32_16x16x32_bf16 v[244:247], a[220:223], a[248:251], v[244:247]
 v_mfma_f32_16x16x32_bf16 v[252:255], a[220:223], a[252:255], v[252:255]
 s_waitcnt lgkmcnt(15)
 v_mfma_f32_16x16x32_bf16 v[24:27], a[128:131], a[160:163], v[24:27]
 v_mfma_f32_16x16x32_bf16 a[104:107], a[128:131], a[164:167], a[104:107]
 v_mfma_f32_16x16x32_bf16 a[112:115], a[128:131], a[168:171], a[112:115]
 s_waitcnt lgkmcnt(13)
 buffer_load_dwordx4 v2, s[16:19], 0 offen offset:0 lds
 v_mfma_f32_16x16x32_bf16 v[32:35], a[128:131], a[172:175], v[32:35]
 s_waitcnt lgkmcnt(10)
 ds_read_b64_tr_b16 a[224:225], v6 offset:8192
 v_mfma_f32_16x16x32_bf16 a[120:123], a[128:131], a[176:179], a[120:123]
 s_waitcnt lgkmcnt(8)
 ds_read_b64_tr_b16 a[226:227], v6 offset:9216
 v_mfma_f32_16x16x32_bf16 v[40:43], a[128:131], a[180:183], v[40:43]
 s_waitcnt lgkmcnt(6)
 v_mfma_f32_16x16x32_bf16 v[48:51], a[128:131], a[184:187], v[48:51]
 s_waitcnt lgkmcnt(3)
 ds_read_b128 a[192:195], v5 offset:0
 v_mfma_f32_16x16x32_bf16 v[56:59], a[128:131], a[188:191], v[56:59]
 buffer_load_dwordx4 v2, s[16:19], s71 offen offset:1024 lds
 v_mfma_f32_16x16x32_bf16 v[28:31], a[132:135], a[160:163], v[28:31]
 v_mfma_f32_16x16x32_bf16 a[108:111], a[132:135], a[164:167], a[108:111]
 ds_read_b64_tr_b16 a[228:229], v7 offset:8192
 v_mfma_f32_16x16x32_bf16 a[116:119], a[132:135], a[168:171], a[116:119]
 v_mfma_f32_16x16x32_bf16 v[36:39], a[132:135], a[172:175], v[36:39]
 ds_read_b64_tr_b16 a[230:231], v7 offset:9216
 v_mfma_f32_16x16x32_bf16 a[124:127], a[132:135], a[176:179], a[124:127]
 buffer_load_dwordx4 v3, s[16:19], s72 offen offset:2048 lds
 v_mfma_f32_16x16x32_bf16 v[44:47], a[132:135], a[180:183], v[44:47]
 v_mfma_f32_16x16x32_bf16 v[52:55], a[132:135], a[184:187], v[52:55]
 ds_read_b128 a[196:199], v5 offset:2048
 v_mfma_f32_16x16x32_bf16 v[60:63], a[132:135], a[188:191], v[60:63]
 v_mfma_f32_16x16x32_bf16 v[64:67], a[136:139], a[160:163], v[64:67]
 ds_read_b64_tr_b16 a[232:233], v8 offset:8192
 v_mfma_f32_16x16x32_bf16 v[72:75], a[136:139], a[164:167], v[72:75]
 buffer_load_dwordx4 v3, s[16:19], s73 offen offset:3072 lds
 s_add_u32 m0, s82, 147456
 v_mfma_f32_16x16x32_bf16 v[80:83], a[136:139], a[168:171], v[80:83]
 v_mfma_f32_16x16x32_bf16 v[88:91], a[136:139], a[172:175], v[88:91]
 ds_read_b64_tr_b16 a[234:235], v8 offset:9216
 v_mfma_f32_16x16x32_bf16 v[96:99], a[136:139], a[176:179], v[96:99]
 v_mfma_f32_16x16x32_bf16 v[104:107], a[136:139], a[180:183], v[104:107]
 ds_read_b128 a[200:203], v5 offset:8192
 v_mfma_f32_16x16x32_bf16 v[112:115], a[136:139], a[184:187], v[112:115]
 buffer_load_dwordx4 v2, s[20:23], 0 offen offset:0 lds
 v_mfma_f32_16x16x32_bf16 v[120:123], a[136:139], a[188:191], v[120:123]
 v_mfma_f32_16x16x32_bf16 v[68:71], a[140:143], a[160:163], v[68:71]
 ds_read_b64_tr_b16 a[236:237], v9 offset:8192
 v_mfma_f32_16x16x32_bf16 v[76:79], a[140:143], a[164:167], v[76:79]
 v_mfma_f32_16x16x32_bf16 v[84:87], a[140:143], a[168:171], v[84:87]
 ds_read_b64_tr_b16 a[238:239], v9 offset:9216
 v_mfma_f32_16x16x32_bf16 v[92:95], a[140:143], a[172:175], v[92:95]
 buffer_load_dwordx4 v2, s[20:23], s71 offen offset:1024 lds
 v_mfma_f32_16x16x32_bf16 v[100:103], a[140:143], a[176:179], v[100:103]
 v_mfma_f32_16x16x32_bf16 v[108:111], a[140:143], a[180:183], v[108:111]
 ds_read_b128 a[204:207], v5 offset:10240
 v_mfma_f32_16x16x32_bf16 v[116:119], a[140:143], a[184:187], v[116:119]
 v_mfma_f32_16x16x32_bf16 v[124:127], a[140:143], a[188:191], v[124:127]
 ds_read_b64_tr_b16 a[240:241], v10 offset:8192
 v_mfma_f32_16x16x32_bf16 v[128:131], a[144:147], a[160:163], v[128:131]
 buffer_load_dwordx4 v3, s[20:23], s72 offen offset:2048 lds
 v_mfma_f32_16x16x32_bf16 v[136:139], a[144:147], a[164:167], v[136:139]
 v_mfma_f32_16x16x32_bf16 v[144:147], a[144:147], a[168:171], v[144:147]
 ds_read_b64_tr_b16 a[242:243], v10 offset:9216
 v_mfma_f32_16x16x32_bf16 v[152:155], a[144:147], a[172:175], v[152:155]
 v_mfma_f32_16x16x32_bf16 v[160:163], a[144:147], a[176:179], v[160:163]
 ds_read_b128 a[208:211], v5 offset:16384
 v_mfma_f32_16x16x32_bf16 v[168:171], a[144:147], a[180:183], v[168:171]
 buffer_load_dwordx4 v3, s[20:23], s73 offen offset:3072 lds
 v_mfma_f32_16x16x32_bf16 v[176:179], a[144:147], a[184:187], v[176:179]
 v_mfma_f32_16x16x32_bf16 v[184:187], a[144:147], a[188:191], v[184:187]
 ds_read_b64_tr_b16 a[244:245], v11 offset:8192
 v_mfma_f32_16x16x32_bf16 v[132:135], a[148:151], a[160:163], v[132:135]
 v_mfma_f32_16x16x32_bf16 v[140:143], a[148:151], a[164:167], v[140:143]
 ds_read_b64_tr_b16 a[246:247], v11 offset:9216
 v_mfma_f32_16x16x32_bf16 v[148:151], a[148:151], a[168:171], v[148:151]
 v_add_u32 v0, 0x80, v0
 v_add_u32 v1, 0x80, v1
 v_mfma_f32_16x16x32_bf16 v[156:159], a[148:151], a[172:175], v[156:159]
 ds_read_b128 a[212:215], v5 offset:18432
 v_add_u32 v2, 0x80000, v2
 v_add_u32 v3, 0x80000, v3
 v_mfma_f32_16x16x32_bf16 v[164:167], a[148:151], a[176:179], v[164:167]
 s_mul_i32 s94, s63, 72
 s_mul_i32 s95, s60, 18
 s_add_u32 s94, s94, s95
 s_lshl_b32 s94, s94, 13
 s_lshl_b32 s95, s3, 8
 s_add_u32 s84, s94, s95
 v_lshrrev_b32 v22, 5, v14
 v_min_u32 v22, 17, v22
 v_mfma_f32_16x16x32_bf16 v[172:175], a[148:151], a[180:183], v[172:175]
 ds_read_b64_tr_b16 a[248:249], v12 offset:8192
 v_lshlrev_b32 v22, 13, v22
 v_bfe_u32 v15, v14, 4, 1
 v_lshl_add_u32 v22, v15, 7, v22
 v_mfma_f32_16x16x32_bf16 v[180:183], a[148:151], a[184:187], v[180:183]
 buffer_load_dword a101, v22, s[24:27], s84 offen
 v_mfma_f32_16x16x32_bf16 v[188:191], a[148:151], a[188:191], v[188:191]
 v_mov_b32 v0, v17
 v_mov_b32 v1, v18
 v_mfma_f32_16x16x32_bf16 v[192:195], a[152:155], a[160:163], v[192:195]
 ds_read_b64_tr_b16 a[250:251], v12 offset:9216
 v_subrev_u32 v2, 0x400000, v2
 v_subrev_u32 v3, 0x400000, v3
 v_mfma_f32_16x16x32_bf16 v[200:203], a[152:155], a[164:167], v[200:203]
 v_mfma_f32_16x16x32_bf16 v[208:211], a[152:155], a[168:171], v[208:211]
 ds_read_b128 a[216:219], v5 offset:24576
 v_mfma_f32_16x16x32_bf16 v[216:219], a[152:155], a[172:175], v[216:219]
 v_mfma_f32_16x16x32_bf16 v[224:227], a[152:155], a[176:179], v[224:227]
 ds_read_b64_tr_b16 a[252:253], v13 offset:8192
 v_mfma_f32_16x16x32_bf16 v[232:235], a[152:155], a[180:183], v[232:235]
 v_mfma_f32_16x16x32_bf16 v[240:243], a[152:155], a[184:187], v[240:243]
 ds_read_b64_tr_b16 a[254:255], v13 offset:9216
 v_mfma_f32_16x16x32_bf16 v[248:251], a[152:155], a[188:191], v[248:251]
 s_waitcnt lgkmcnt(15)
 v_mfma_f32_16x16x32_bf16 v[196:199], a[156:159], a[160:163], v[196:199]
 ds_read_b128 a[220:223], v5 offset:26624
 v_mfma_f32_16x16x32_bf16 v[204:207], a[156:159], a[164:167], v[204:207]
 v_mfma_f32_16x16x32_bf16 v[212:215], a[156:159], a[168:171], v[212:215]
 v_mfma_f32_16x16x32_bf16 v[220:223], a[156:159], a[172:175], v[220:223]
 v_mfma_f32_16x16x32_bf16 v[228:231], a[156:159], a[176:179], v[228:231]
 v_mfma_f32_16x16x32_bf16 v[236:239], a[156:159], a[180:183], v[236:239]
 v_mfma_f32_16x16x32_bf16 v[244:247], a[156:159], a[184:187], v[244:247]
 v_mfma_f32_16x16x32_bf16 v[252:255], a[156:159], a[188:191], v[252:255]
 v_mfma_f32_16x16x32_bf16 v[24:27], a[192:195], a[224:227], v[24:27]
 v_mfma_f32_16x16x32_bf16 a[104:107], a[192:195], a[228:231], a[104:107]
 v_mfma_f32_16x16x32_bf16 a[112:115], a[192:195], a[232:235], a[112:115]
 s_waitcnt lgkmcnt(13)
 v_mfma_f32_16x16x32_bf16 v[32:35], a[192:195], a[236:239], v[32:35]
 s_waitcnt lgkmcnt(10)
 v_mfma_f32_16x16x32_bf16 a[120:123], a[192:195], a[240:243], a[120:123]
 s_waitcnt lgkmcnt(7)
 v_mfma_f32_16x16x32_bf16 v[40:43], a[192:195], a[244:247], v[40:43]
 s_waitcnt lgkmcnt(4)
 v_mfma_f32_16x16x32_bf16 v[48:51], a[192:195], a[248:251], v[48:51]
 s_waitcnt lgkmcnt(1)
 v_mfma_f32_16x16x32_bf16 v[56:59], a[192:195], a[252:255], v[56:59]
 v_mfma_f32_16x16x32_bf16 v[28:31], a[196:199], a[224:227], v[28:31]
 v_mfma_f32_16x16x32_bf16 a[108:111], a[196:199], a[228:231], a[108:111]
 v_mfma_f32_16x16x32_bf16 a[116:119], a[196:199], a[232:235], a[116:119]
 v_mfma_f32_16x16x32_bf16 v[36:39], a[196:199], a[236:239], v[36:39]
 v_mfma_f32_16x16x32_bf16 a[124:127], a[196:199], a[240:243], a[124:127]
 v_mfma_f32_16x16x32_bf16 v[44:47], a[196:199], a[244:247], v[44:47]
 v_mfma_f32_16x16x32_bf16 v[52:55], a[196:199], a[248:251], v[52:55]
 v_mfma_f32_16x16x32_bf16 v[60:63], a[196:199], a[252:255], v[60:63]
 v_mfma_f32_16x16x32_bf16 v[64:67], a[200:203], a[224:227], v[64:67]
 v_mfma_f32_16x16x32_bf16 v[72:75], a[200:203], a[228:231], v[72:75]
 v_mfma_f32_16x16x32_bf16 v[80:83], a[200:203], a[232:235], v[80:83]
 v_mfma_f32_16x16x32_bf16 v[88:91], a[200:203], a[236:239], v[88:91]
 v_mfma_f32_16x16x32_bf16 v[96:99], a[200:203], a[240:243], v[96:99]
 v_mfma_f32_16x16x32_bf16 v[104:107], a[200:203], a[244:247], v[104:107]
 v_mfma_f32_16x16x32_bf16 v[112:115], a[200:203], a[248:251], v[112:115]
 v_mfma_f32_16x16x32_bf16 v[120:123], a[200:203], a[252:255], v[120:123]
 v_mfma_f32_16x16x32_bf16 v[68:71], a[204:207], a[224:227], v[68:71]
 s_waitcnt vmcnt(1) lgkmcnt(0)
 s_barrier
 v_mfma_f32_16x16x32_bf16 v[76:79], a[204:207], a[228:231], v[76:79]
 s_add_u32 m0, s82, 98304
 ds_read_b64_tr_b16 a[160:161], v6 offset:32768
 v_mfma_f32_16x16x32_bf16 v[84:87], a[204:207], a[232:235], v[84:87]
 buffer_load_dwordx4 v2, s[24:27], 0 offen offset:0 lds
 v_mfma_f32_16x16x32_bf16 v[92:95], a[204:207], a[236:239], v[92:95]
 ds_read_b64_tr_b16 a[162:163], v6 offset:33792
 v_mfma_f32_16x16x32_bf16 v[100:103], a[204:207], a[240:243], v[100:103]
 ds_read_b128 a[128:131], v4 offset:32768
 v_mfma_f32_16x16x32_bf16 v[108:111], a[204:207], a[244:247], v[108:111]
 ds_read_b64_tr_b16 a[164:165], v7 offset:32768
 v_mfma_f32_16x16x32_bf16 v[116:119], a[204:207], a[248:251], v[116:119]
 ds_read_b64_tr_b16 a[166:167], v7 offset:33792
 v_mfma_f32_16x16x32_bf16 v[124:127], a[204:207], a[252:255], v[124:127]
 buffer_load_dwordx4 v2, s[24:27], s71 offen offset:1024 lds
 v_mfma_f32_16x16x32_bf16 v[128:131], a[208:211], a[224:227], v[128:131]
 ds_read_b128 a[132:135], v4 offset:34816
 v_mfma_f32_16x16x32_bf16 v[136:139], a[208:211], a[228:231], v[136:139]
 ds_read_b64_tr_b16 a[168:169], v8 offset:32768
 v_mfma_f32_16x16x32_bf16 v[144:147], a[208:211], a[232:235], v[144:147]
 ds_read_b64_tr_b16 a[170:171], v8 offset:33792
 v_mfma_f32_16x16x32_bf16 v[152:155], a[208:211], a[236:239], v[152:155]
 v_mfma_f32_16x16x32_bf16 v[160:163], a[208:211], a[240:243], v[160:163]
 buffer_load_dwordx4 v3, s[24:27], s72 offen offset:2048 lds
 v_mfma_f32_16x16x32_bf16 v[168:171], a[208:211], a[244:247], v[168:171]
 ds_read_b128 a[136:139], v4 offset:40960
 v_mfma_f32_16x16x32_bf16 v[176:179], a[208:211], a[248:251], v[176:179]
 ds_read_b64_tr_b16 a[172:173], v9 offset:32768
 v_mfma_f32_16x16x32_bf16 v[184:187], a[208:211], a[252:255], v[184:187]
 ds_read_b64_tr_b16 a[174:175], v9 offset:33792
 v_mfma_f32_16x16x32_bf16 v[132:135], a[212:215], a[224:227], v[132:135]
 ds_read_b128 a[140:143], v4 offset:43008
 v_mfma_f32_16x16x32_bf16 v[140:143], a[212:215], a[228:231], v[140:143]
 buffer_load_dwordx4 v3, s[24:27], s73 offen offset:3072 lds
 v_mfma_f32_16x16x32_bf16 v[148:151], a[212:215], a[232:235], v[148:151]
 ds_read_b64_tr_b16 a[176:177], v10 offset:32768
 v_mfma_f32_16x16x32_bf16 v[156:159], a[212:215], a[236:239], v[156:159]
 ds_read_b64_tr_b16 a[178:179], v10 offset:33792
 v_mfma_f32_16x16x32_bf16 v[164:167], a[212:215], a[240:243], v[164:167]
 ds_read_b128 a[144:147], v4 offset:49152
 v_mfma_f32_16x16x32_bf16 v[172:175], a[212:215], a[244:247], v[172:175]
 ds_read_b64_tr_b16 a[180:181], v11 offset:32768
 v_mfma_f32_16x16x32_bf16 v[180:183], a[212:215], a[248:251], v[180:183]
 v_add_u32 v2, 0x80000, v2
 v_add_u32 v3, 0x80000, v3
 v_mfma_f32_16x16x32_bf16 v[188:191], a[212:215], a[252:255], v[188:191]
 s_add_u32 m0, s82, 114688
 ds_read_b64_tr_b16 a[182:183], v11 offset:33792
 v_mfma_f32_16x16x32_bf16 v[192:195], a[216:219], a[224:227], v[192:195]
 buffer_load_dwordx4 v2, s[24:27], 0 offen offset:0 lds
 v_mfma_f32_16x16x32_bf16 v[200:203], a[216:219], a[228:231], v[200:203]
 ds_read_b128 a[148:151], v4 offset:51200
 v_mfma_f32_16x16x32_bf16 v[208:211], a[216:219], a[232:235], v[208:211]
 ds_read_b64_tr_b16 a[184:185], v12 offset:32768
 v_mfma_f32_16x16x32_bf16 v[216:219], a[216:219], a[236:239], v[216:219]
 ds_read_b64_tr_b16 a[186:187], v12 offset:33792
 v_mfma_f32_16x16x32_bf16 v[224:227], a[216:219], a[240:243], v[224:227]
 ds_read_b128 a[152:155], v4 offset:57344
 v_mfma_f32_16x16x32_bf16 v[232:235], a[216:219], a[244:247], v[232:235]
 buffer_load_dwordx4 v2, s[24:27], s71 offen offset:1024 lds
 v_mfma_f32_16x16x32_bf16 v[240:243], a[216:219], a[248:251], v[240:243]
 ds_read_b64_tr_b16 a[188:189], v13 offset:32768
 v_mfma_f32_16x16x32_bf16 v[248:251], a[216:219], a[252:255], v[248:251]
 ds_read_b64_tr_b16 a[190:191], v13 offset:33792
 v_mfma_f32_16x16x32_bf16 v[196:199], a[220:223], a[224:227], v[196:199]
 ds_read_b128 a[156:159], v4 offset:59392
 v_mfma_f32_16x16x32_bf16 v[204:207], a[220:223], a[228:231], v[204:207]
 v_mfma_f32_16x16x32_bf16 v[212:215], a[220:223], a[232:235], v[212:215]
 buffer_load_dwordx4 v3, s[24:27], s72 offen offset:2048 lds
 v_mfma_f32_16x16x32_bf16 v[220:223], a[220:223], a[236:239], v[220:223]
 v_mfma_f32_16x16x32_bf16 v[228:231], a[220:223], a[240:243], v[228:231]
 v_mfma_f32_16x16x32_bf16 v[236:239], a[220:223], a[244:247], v[236:239]
 v_mfma_f32_16x16x32_bf16 v[244:247], a[220:223], a[248:251], v[244:247]
 v_mfma_f32_16x16x32_bf16 v[252:255], a[220:223], a[252:255], v[252:255]
 s_waitcnt lgkmcnt(15)
 buffer_load_dwordx4 v3, s[24:27], s73 offen offset:3072 lds
 v_mfma_f32_16x16x32_bf16 v[24:27], a[128:131], a[160:163], v[24:27]
 v_mfma_f32_16x16x32_bf16 a[104:107], a[128:131], a[164:167], a[104:107]
 v_mfma_f32_16x16x32_bf16 a[112:115], a[128:131], a[168:171], a[112:115]
 s_waitcnt lgkmcnt(13)
 ds_read_b64_tr_b16 a[224:225], v6 offset:40960
 v_mfma_f32_16x16x32_bf16 v[32:35], a[128:131], a[172:175], v[32:35]
 s_waitcnt lgkmcnt(11)
 ds_read_b64_tr_b16 a[226:227], v6 offset:41984
 v_mfma_f32_16x16x32_bf16 a[120:123], a[128:131], a[176:179], a[120:123]
 s_waitcnt lgkmcnt(9)
 v_add_u32 v2, 0x80000, v2
 v_add_u32 v3, 0x80000, v3
 v_mfma_f32_16x16x32_bf16 v[40:43], a[128:131], a[180:183], v[40:43]
 s_waitcnt lgkmcnt(6)
 s_add_u32 m0, s81, 32768
 ds_read_b128 a[192:195], v5 offset:32768
 v_mfma_f32_16x16x32_bf16 v[48:51], a[128:131], a[184:187], v[48:51]
 s_waitcnt lgkmcnt(4)
 buffer_load_dwordx4 v0, s[8:11], 0 offen offset:0 lds
 v_mfma_f32_16x16x32_bf16 v[56:59], a[128:131], a[188:191], v[56:59]
 v_mfma_f32_16x16x32_bf16 v[28:31], a[132:135], a[160:163], v[28:31]
 ds_read_b64_tr_b16 a[228:229], v7 offset:40960
 v_mfma_f32_16x16x32_bf16 a[108:111], a[132:135], a[164:167], a[108:111]
 v_mfma_f32_16x16x32_bf16 a[116:119], a[132:135], a[168:171], a[116:119]
 ds_read_b64_tr_b16 a[230:231], v7 offset:41984
 v_mfma_f32_16x16x32_bf16 v[36:39], a[132:135], a[172:175], v[36:39]
 buffer_load_dwordx4 v1, s[8:11], s74 offen offset:1024 lds
 v_mfma_f32_16x16x32_bf16 a[124:127], a[132:135], a[176:179], a[124:127]
 v_mfma_f32_16x16x32_bf16 v[44:47], a[132:135], a[180:183], v[44:47]
 ds_read_b128 a[196:199], v5 offset:34816
 v_mfma_f32_16x16x32_bf16 v[52:55], a[132:135], a[184:187], v[52:55]
 v_mfma_f32_16x16x32_bf16 v[60:63], a[132:135], a[188:191], v[60:63]
 ds_read_b64_tr_b16 a[232:233], v8 offset:40960
 v_mfma_f32_16x16x32_bf16 v[64:67], a[136:139], a[160:163], v[64:67]
 buffer_load_dwordx4 v0, s[8:11], s75 offen offset:2048 lds
 v_mfma_f32_16x16x32_bf16 v[72:75], a[136:139], a[164:167], v[72:75]
 v_mfma_f32_16x16x32_bf16 v[80:83], a[136:139], a[168:171], v[80:83]
 ds_read_b64_tr_b16 a[234:235], v8 offset:41984
 v_mfma_f32_16x16x32_bf16 v[88:91], a[136:139], a[172:175], v[88:91]
 v_mfma_f32_16x16x32_bf16 v[96:99], a[136:139], a[176:179], v[96:99]
 ds_read_b128 a[200:203], v5 offset:40960
 v_mfma_f32_16x16x32_bf16 v[104:107], a[136:139], a[180:183], v[104:107]
 buffer_load_dwordx4 v1, s[8:11], s76 offen offset:3072 lds
 s_add_u32 m0, s81, 36864
 v_mfma_f32_16x16x32_bf16 v[112:115], a[136:139], a[184:187], v[112:115]
 v_mfma_f32_16x16x32_bf16 v[120:123], a[136:139], a[188:191], v[120:123]
 ds_read_b64_tr_b16 a[236:237], v9 offset:40960
 v_mfma_f32_16x16x32_bf16 v[68:71], a[140:143], a[160:163], v[68:71]
 v_mfma_f32_16x16x32_bf16 v[76:79], a[140:143], a[164:167], v[76:79]
 ds_read_b64_tr_b16 a[238:239], v9 offset:41984
 v_mfma_f32_16x16x32_bf16 v[84:87], a[140:143], a[168:171], v[84:87]
 buffer_load_dwordx4 v0, s[8:11], s77 offen offset:0 lds
 v_mfma_f32_16x16x32_bf16 v[92:95], a[140:143], a[172:175], v[92:95]
 v_mfma_f32_16x16x32_bf16 v[100:103], a[140:143], a[176:179], v[100:103]
 ds_read_b128 a[204:207], v5 offset:43008
 v_mfma_f32_16x16x32_bf16 v[108:111], a[140:143], a[180:183], v[108:111]
 v_mfma_f32_16x16x32_bf16 v[116:119], a[140:143], a[184:187], v[116:119]
 ds_read_b64_tr_b16 a[240:241], v10 offset:40960
 v_mfma_f32_16x16x32_bf16 v[124:127], a[140:143], a[188:191], v[124:127]
 buffer_load_dwordx4 v1, s[8:11], s78 offen offset:1024 lds
 v_mfma_f32_16x16x32_bf16 v[128:131], a[144:147], a[160:163], v[128:131]
 v_mfma_f32_16x16x32_bf16 v[136:139], a[144:147], a[164:167], v[136:139]
 ds_read_b64_tr_b16 a[242:243], v10 offset:41984
 v_mfma_f32_16x16x32_bf16 v[144:147], a[144:147], a[168:171], v[144:147]
 v_mfma_f32_16x16x32_bf16 v[152:155], a[144:147], a[172:175], v[152:155]
 ds_read_b128 a[208:211], v5 offset:49152
 v_mfma_f32_16x16x32_bf16 v[160:163], a[144:147], a[176:179], v[160:163]
 buffer_load_dwordx4 v0, s[8:11], s79 offen offset:2048 lds
 v_mfma_f32_16x16x32_bf16 v[168:171], a[144:147], a[180:183], v[168:171]
 v_mfma_f32_16x16x32_bf16 v[176:179], a[144:147], a[184:187], v[176:179]
 ds_read_b64_tr_b16 a[244:245], v11 offset:40960
 v_mfma_f32_16x16x32_bf16 v[184:187], a[144:147], a[188:191], v[184:187]
 v_mfma_f32_16x16x32_bf16 v[132:135], a[148:151], a[160:163], v[132:135]
 ds_read_b64_tr_b16 a[246:247], v11 offset:41984
 v_mfma_f32_16x16x32_bf16 v[140:143], a[148:151], a[164:167], v[140:143]
 buffer_load_dwordx4 v1, s[8:11], s80 offen offset:3072 lds
 v_mfma_f32_16x16x32_bf16 v[148:151], a[148:151], a[168:171], v[148:151]
 v_mfma_f32_16x16x32_bf16 v[156:159], a[148:151], a[172:175], v[156:159]
 ds_read_b128 a[212:215], v5 offset:51200
 v_mfma_f32_16x16x32_bf16 v[164:167], a[148:151], a[176:179], v[164:167]
 v_lshrrev_b32 v15, 2, v14
 v_mfma_f32_16x16x32_bf16 v[172:175], a[148:151], a[180:183], v[172:175]
 buffer_load_dword v15, v15, s[36:39], 0 offen sc1
 v_mfma_f32_16x16x32_bf16 v[180:183], a[148:151], a[184:187], v[180:183]
 ds_read_b64_tr_b16 a[248:249], v12 offset:40960
 v_add_u32 v0, 0x80, v0
 v_add_u32 v1, 0x80, v1
 v_mfma_f32_16x16x32_bf16 v[188:191], a[148:151], a[188:191], v[188:191]
 v_mfma_f32_16x16x32_bf16 v[192:195], a[152:155], a[160:163], v[192:195]
 ds_read_b64_tr_b16 a[250:251], v12 offset:41984
 v_mfma_f32_16x16x32_bf16 v[200:203], a[152:155], a[164:167], v[200:203]
 v_mfma_f32_16x16x32_bf16 v[208:211], a[152:155], a[168:171], v[208:211]
 ds_read_b128 a[216:219], v5 offset:57344
 v_mfma_f32_16x16x32_bf16 v[216:219], a[152:155], a[172:175], v[216:219]
 v_mfma_f32_16x16x32_bf16 v[224:227], a[152:155], a[176:179], v[224:227]
 ds_read_b64_tr_b16 a[252:253], v13 offset:40960
 v_mfma_f32_16x16x32_bf16 v[232:235], a[152:155], a[180:183], v[232:235]
 v_mfma_f32_16x16x32_bf16 v[240:243], a[152:155], a[184:187], v[240:243]
 ds_read_b64_tr_b16 a[254:255], v13 offset:41984
 v_mfma_f32_16x16x32_bf16 v[248:251], a[152:155], a[188:191], v[248:251]
 s_waitcnt lgkmcnt(15)
 v_mfma_f32_16x16x32_bf16 v[196:199], a[156:159], a[160:163], v[196:199]
 ds_read_b128 a[220:223], v5 offset:59392
 v_mfma_f32_16x16x32_bf16 v[204:207], a[156:159], a[164:167], v[204:207]
 v_mfma_f32_16x16x32_bf16 v[212:215], a[156:159], a[168:171], v[212:215]
 v_mfma_f32_16x16x32_bf16 v[220:223], a[156:159], a[172:175], v[220:223]
 v_mfma_f32_16x16x32_bf16 v[228:231], a[156:159], a[176:179], v[228:231]
 v_mfma_f32_16x16x32_bf16 v[236:239], a[156:159], a[180:183], v[236:239]
 v_mfma_f32_16x16x32_bf16 v[244:247], a[156:159], a[184:187], v[244:247]
 v_mfma_f32_16x16x32_bf16 v[252:255], a[156:159], a[188:191], v[252:255]
 v_mfma_f32_16x16x32_bf16 v[24:27], a[192:195], a[224:227], v[24:27]
 s_waitcnt vmcnt(13) lgkmcnt(0)
 s_barrier
 v_mfma_f32_16x16x32_bf16 v[28:31], a[196:199], a[224:227], v[28:31]
 s_lshl_b32 s87, s3, 19
 v_mov_b32 v4, v20
 v_mov_b32 v5, v21
 v_mfma_f32_16x16x32_bf16 a[104:107], a[192:195], a[228:231], a[104:107]
 s_lshl_b32 s94, s63, 13
 s_add_u32 s87, s87, s94
 s_add_u32 m0, s82, 131072
 v_subrev_u32 v6, 0x4000, v6
 v_subrev_u32 v7, 0x4000, v7
 v_mfma_f32_16x16x32_bf16 a[108:111], a[196:199], a[228:231], a[108:111]
 s_and_b32 s94, s60, 1
 s_lshl_b32 s94, s94, 16
 s_add_u32 s87, s87, s94
 buffer_load_dwordx4 v2, s[24:27], 0 offen offset:0 lds
 v_subrev_u32 v8, 0x4000, v8
 v_subrev_u32 v9, 0x4000, v9
 v_mfma_f32_16x16x32_bf16 a[112:115], a[192:195], a[232:235], a[112:115]
 s_add_u32 s87, s87, 16777216
 v_subrev_u32 v10, 0x4000, v10
 v_subrev_u32 v11, 0x4000, v11
 v_mfma_f32_16x16x32_bf16 a[116:119], a[196:199], a[232:235], a[116:119]
 v_subrev_u32 v12, 0x4000, v12
 v_subrev_u32 v13, 0x4000, v13
 v_mfma_f32_16x16x32_bf16 v[32:35], a[192:195], a[236:239], v[32:35]
 v_cvt_pk_bf16_f32 v24, v24, v25
 v_cvt_pk_bf16_f32 v25, v26, v27
 v_mfma_f32_16x16x32_bf16 v[36:39], a[196:199], a[236:239], v[36:39]
 v_cvt_pk_bf16_f32 v26, v28, v29
 v_cvt_pk_bf16_f32 v27, v30, v31
 v_mfma_f32_16x16x32_bf16 a[120:123], a[192:195], a[240:243], a[120:123]
 v_accvgpr_read_b32 v16, a104
 v_accvgpr_read_b32 v17, a105
 v_mfma_f32_16x16x32_bf16 a[124:127], a[196:199], a[240:243], a[124:127]
 buffer_load_dwordx4 v2, s[24:27], s71 offen offset:1024 lds
 v_mfma_f32_16x16x32_bf16 v[40:43], a[192:195], a[244:247], v[40:43]
 v_accvgpr_read_b32 v18, a106
 v_accvgpr_read_b32 v19, a107
 v_mfma_f32_16x16x32_bf16 v[44:47], a[196:199], a[244:247], v[44:47]
 s_add_u32 s83, s87, 0
 buffer_store_dwordx4 v[24:27], v14, s[4:7], s83 offen offset:0
 v_mfma_f32_16x16x32_bf16 v[48:51], a[192:195], a[248:251], v[48:51]
 v_accvgpr_read_b32 v20, a108
 v_accvgpr_read_b32 v21, a109
 v_mfma_f32_16x16x32_bf16 v[52:55], a[196:199], a[248:251], v[52:55]
 v_accvgpr_read_b32 v22, a110
 v_accvgpr_read_b32 v23, a111
 v_mfma_f32_16x16x32_bf16 v[56:59], a[192:195], a[252:255], v[56:59]
 v_cvt_pk_bf16_f32 v16, v16, v17
 v_cvt_pk_bf16_f32 v17, v18, v19
 v_mfma_f32_16x16x32_bf16 v[60:63], a[196:199], a[252:255], v[60:63]
 buffer_load_dwordx4 v3, s[24:27], s72 offen offset:2048 lds
 v_mfma_f32_16x16x32_bf16 v[64:67], a[200:203], a[224:227], v[64:67]
 v_cvt_pk_bf16_f32 v18, v20, v21
 v_cvt_pk_bf16_f32 v19, v22, v23
 v_mfma_f32_16x16x32_bf16 v[68:71], a[204:207], a[224:227], v[68:71]
 s_add_u32 s83, s87, 0
 buffer_store_dwordx4 v[16:19], v14, s[4:7], s83 offen offset:1024
 v_mfma_f32_16x16x32_bf16 v[72:75], a[200:203], a[228:231], v[72:75]
 v_accvgpr_read_b32 v20, a112
 v_accvgpr_read_b32 v21, a113
 v_mfma_f32_16x16x32_bf16 v[76:79], a[204:207], a[228:231], v[76:79]
 v_accvgpr_read_b32 v22, a114
 v_accvgpr_read_b32 v23, a115
 v_mfma_f32_16x16x32_bf16 v[80:83], a[200:203], a[232:235], v[80:83]
 v_accvgpr_read_b32 v28, a116
 v_accvgpr_read_b32 v29, a117
 v_mfma_f32_16x16x32_bf16 v[84:87], a[204:207], a[232:235], v[84:87]
 buffer_load_dwordx4 v3, s[24:27], s73 offen offset:3072 lds
 v_mfma_f32_16x16x32_bf16 v[88:91], a[200:203], a[236:239], v[88:91]
 v_accvgpr_read_b32 v30, a118
 v_accvgpr_read_b32 v31, a119
 v_mfma_f32_16x16x32_bf16 v[92:95], a[204:207], a[236:239], v[92:95]
 v_cvt_pk_bf16_f32 v20, v20, v21
 v_cvt_pk_bf16_f32 v21, v22, v23
 v_mfma_f32_16x16x32_bf16 v[96:99], a[200:203], a[240:243], v[96:99]
 v_cvt_pk_bf16_f32 v22, v28, v29
 v_cvt_pk_bf16_f32 v23, v30, v31
 v_mfma_f32_16x16x32_bf16 v[100:103], a[204:207], a[240:243], v[100:103]
 s_add_u32 s83, s87, 0
 buffer_store_dwordx4 v[20:23], v14, s[4:7], s83 offen offset:2048
 v_mfma_f32_16x16x32_bf16 v[104:107], a[200:203], a[244:247], v[104:107]
 v_cvt_pk_bf16_f32 v32, v32, v33
 v_cvt_pk_bf16_f32 v33, v34, v35
 v_mfma_f32_16x16x32_bf16 v[108:111], a[204:207], a[244:247], v[108:111]
 v_add_u32 v2, 0x80000, v2
 v_add_u32 v3, 0x80000, v3
 v_mfma_f32_16x16x32_bf16 v[112:115], a[200:203], a[248:251], v[112:115]
 v_cvt_pk_bf16_f32 v34, v36, v37
 v_cvt_pk_bf16_f32 v35, v38, v39
 v_mfma_f32_16x16x32_bf16 v[116:119], a[204:207], a[248:251], v[116:119]
 v_accvgpr_read_b32 v28, a120
 v_accvgpr_read_b32 v29, a121
 v_mfma_f32_16x16x32_bf16 v[120:123], a[200:203], a[252:255], v[120:123]
 ds_read_b64_tr_b16 a[144:145], v6 offset:0
 v_accvgpr_read_b32 v30, a122
 v_mfma_f32_16x16x32_bf16 v[124:127], a[204:207], a[252:255], v[124:127]
 ds_read_b64_tr_b16 a[146:147], v6 offset:1024
 s_add_u32 s83, s87, 0
 buffer_store_dwordx4 v[32:35], v14, s[4:7], s83 offen offset:3072
 v_mfma_f32_16x16x32_bf16 v[128:131], a[208:211], a[224:227], v[128:131]
 v_accvgpr_read_b32 v31, a123
 v_accvgpr_read_b32 v36, a124
 v_mfma_f32_16x16x32_bf16 v[132:135], a[212:215], a[224:227], v[132:135]
 ds_read_b64_tr_b16 a[148:149], v7 offset:0
 v_accvgpr_read_b32 v37, a125
 v_mfma_f32_16x16x32_bf16 v[136:139], a[208:211], a[228:231], v[136:139]
 v_accvgpr_read_b32 v38, a126
 v_accvgpr_read_b32 v39, a127
 v_mfma_f32_16x16x32_bf16 v[140:143], a[212:215], a[228:231], v[140:143]
 ds_read_b64_tr_b16 a[150:151], v7 offset:1024
 v_cvt_pk_bf16_f32 v28, v28, v29
 v_mfma_f32_16x16x32_bf16 v[144:147], a[208:211], a[232:235], v[144:147]
 v_cvt_pk_bf16_f32 v29, v30, v31
 v_cvt_pk_bf16_f32 v30, v36, v37
 v_mfma_f32_16x16x32_bf16 v[148:151], a[212:215], a[232:235], v[148:151]
 ds_read_b64_tr_b16 a[152:153], v8 offset:0
 v_cvt_pk_bf16_f32 v31, v38, v39
 v_mfma_f32_16x16x32_bf16 v[152:155], a[208:211], a[236:239], v[152:155]
 s_add_u32 s83, s87, 4096
 buffer_store_dwordx4 v[28:31], v14, s[4:7], s83 offen offset:0
 v_mfma_f32_16x16x32_bf16 v[156:159], a[212:215], a[236:239], v[156:159]
 ds_read_b64_tr_b16 a[154:155], v8 offset:1024
 v_cvt_pk_bf16_f32 v40, v40, v41
 v_mfma_f32_16x16x32_bf16 v[160:163], a[208:211], a[240:243], v[160:163]
 ds_read_b64_tr_b16 a[156:157], v9 offset:0
 v_cvt_pk_bf16_f32 v41, v42, v43
 v_mfma_f32_16x16x32_bf16 v[164:167], a[212:215], a[240:243], v[164:167]
 v_cvt_pk_bf16_f32 v42, v44, v45
 v_cvt_pk_bf16_f32 v43, v46, v47
 v_mfma_f32_16x16x32_bf16 v[168:171], a[208:211], a[244:247], v[168:171]
 ds_read_b64_tr_b16 a[158:159], v9 offset:1024
 v_cvt_pk_bf16_f32 v48, v48, v49
 v_mfma_f32_16x16x32_bf16 v[172:175], a[212:215], a[244:247], v[172:175]
 v_cvt_pk_bf16_f32 v49, v50, v51
 v_cvt_pk_bf16_f32 v50, v52, v53
 v_mfma_f32_16x16x32_bf16 v[176:179], a[208:211], a[248:251], v[176:179]
 ds_read_b64_tr_b16 a[160:161], v10 offset:0
 s_add_u32 s83, s87, 4096
 buffer_store_dwordx4 v[40:43], v14, s[4:7], s83 offen offset:1024
 v_mfma_f32_16x16x32_bf16 v[180:183], a[212:215], a[248:251], v[180:183]
 v_cvt_pk_bf16_f32 v51, v54, v55
 v_cvt_pk_bf16_f32 v56, v56, v57
 v_mfma_f32_16x16x32_bf16 v[184:187], a[208:211], a[252:255], v[184:187]
 ds_read_b64_tr_b16 a[162:163], v10 offset:1024
 v_cvt_pk_bf16_f32 v57, v58, v59
 v_mfma_f32_16x16x32_bf16 v[188:191], a[212:215], a[252:255], v[188:191]
 v_cvt_pk_bf16_f32 v58, v60, v61
 v_cvt_pk_bf16_f32 v59, v62, v63
 v_mfma_f32_16x16x32_bf16 v[192:195], a[216:219], a[224:227], v[192:195]
 ds_read_b64_tr_b16 a[164:165], v11 offset:0
 v_cvt_pk_bf16_f32 v64, v64, v65
 v_mfma_f32_16x16x32_bf16 v[196:199], a[220:223], a[224:227], v[196:199]
 ds_read_b64_tr_b16 a[166:167], v11 offset:1024
 v_cvt_pk_bf16_f32 v65, v66, v67
 v_mfma_f32_16x16x32_bf16 v[200:203], a[216:219], a[228:231], v[200:203]
 s_add_u32 s83, s87, 4096
 buffer_store_dwordx4 v[48:51], v14, s[4:7], s83 offen offset:2048
 v_mfma_f32_16x16x32_bf16 v[204:207], a[220:223], a[228:231], v[204:207]
 ds_read_b64_tr_b16 a[168:169], v12 offset:0
 v_cvt_pk_bf16_f32 v66, v68, v69
 v_mfma_f32_16x16x32_bf16 v[208:211], a[216:219], a[232:235], v[208:211]
 v_cvt_pk_bf16_f32 v67, v70, v71
 v_cvt_pk_bf16_f32 v72, v72, v73
 v_mfma_f32_16x16x32_bf16 v[212:215], a[220:223], a[232:235], v[212:215]
 ds_read_b64_tr_b16 a[170:171], v12 offset:1024
 v_cvt_pk_bf16_f32 v73, v74, v75
 v_mfma_f32_16x16x32_bf16 v[216:219], a[216:219], a[236:239], v[216:219]
 v_cvt_pk_bf16_f32 v74, v76, v77
 v_cvt_pk_bf16_f32 v75, v78, v79
 v_mfma_f32_16x16x32_bf16 v[220:223], a[220:223], a[236:239], v[220:223]
 ds_read_b64_tr_b16 a[172:173], v13 offset:0
 v_cvt_pk_bf16_f32 v80, v80, v81
 v_mfma_f32_16x16x32_bf16 v[224:227], a[216:219], a[240:243], v[224:227]
 s_add_u32 s83, s87, 4096
 buffer_store_dwordx4 v[56:59], v14, s[4:7], s83 offen offset:3072
 v_mfma_f32_16x16x32_bf16 v[228:231], a[220:223], a[240:243], v[228:231]
 ds_read_b64_tr_b16 a[174:175], v13 offset:1024
 v_cvt_pk_bf16_f32 v81, v82, v83
 v_mfma_f32_16x16x32_bf16 v[232:235], a[216:219], a[244:247], v[232:235]
 v_cvt_pk_bf16_f32 v82, v84, v85
 v_cvt_pk_bf16_f32 v83, v86, v87
 v_mfma_f32_16x16x32_bf16 v[236:239], a[220:223], a[244:247], v[236:239]
 v_cvt_pk_bf16_f32 v88, v88, v89
 v_cvt_pk_bf16_f32 v89, v90, v91
 v_mfma_f32_16x16x32_bf16 v[240:243], a[216:219], a[248:251], v[240:243]
 v_cvt_pk_bf16_f32 v90, v92, v93
 v_cvt_pk_bf16_f32 v91, v94, v95
 v_mfma_f32_16x16x32_bf16 v[244:247], a[220:223], a[248:251], v[244:247]
 v_cvt_pk_bf16_f32 v96, v96, v97
 v_cvt_pk_bf16_f32 v97, v98, v99
 v_mfma_f32_16x16x32_bf16 v[248:251], a[216:219], a[252:255], v[248:251]
 v_cvt_pk_bf16_f32 v98, v100, v101
 v_cvt_pk_bf16_f32 v99, v102, v103
 v_mfma_f32_16x16x32_bf16 v[252:255], a[220:223], a[252:255], v[252:255]
 v_cvt_pk_bf16_f32 v104, v104, v105
 v_cvt_pk_bf16_f32 v105, v106, v107
 v_cvt_pk_bf16_f32 v106, v108, v109
 v_cvt_pk_bf16_f32 v107, v110, v111
 v_cvt_pk_bf16_f32 v112, v112, v113
 v_cvt_pk_bf16_f32 v113, v114, v115
 v_cvt_pk_bf16_f32 v114, v116, v117
 v_cvt_pk_bf16_f32 v115, v118, v119
 v_cvt_pk_bf16_f32 v120, v120, v121
 v_cvt_pk_bf16_f32 v121, v122, v123
 v_cvt_pk_bf16_f32 v122, v124, v125
 v_cvt_pk_bf16_f32 v123, v126, v127
 v_cvt_pk_bf16_f32 v128, v128, v129
 v_cvt_pk_bf16_f32 v129, v130, v131
 v_cvt_pk_bf16_f32 v130, v132, v133
 v_cvt_pk_bf16_f32 v131, v134, v135
 v_cvt_pk_bf16_f32 v136, v136, v137
 v_cvt_pk_bf16_f32 v137, v138, v139
 v_cvt_pk_bf16_f32 v138, v140, v141
 v_cvt_pk_bf16_f32 v139, v142, v143
 v_cvt_pk_bf16_f32 v144, v144, v145
 v_cvt_pk_bf16_f32 v145, v146, v147
 v_cvt_pk_bf16_f32 v146, v148, v149
 v_cvt_pk_bf16_f32 v147, v150, v151
 v_cvt_pk_bf16_f32 v152, v152, v153
 v_cvt_pk_bf16_f32 v153, v154, v155
 v_cvt_pk_bf16_f32 v154, v156, v157
 v_cvt_pk_bf16_f32 v155, v158, v159
L_q:
 s_waitcnt lgkmcnt(14)
 v_mfma_f32_16x16x32_bf16 v[32:35], a[144:147], a[0:3], 0
 ds_read_b64_tr_b16 a[192:193], v6 offset:8192
 v_cvt_pk_bf16_f32 v160, v160, v161
 v_cvt_pk_bf16_f32 v161, v162, v163
 v_mfma_f32_16x16x32_bf16 v[40:43], a[144:147], a[4:7], 0
 ds_read_b64_tr_b16 a[194:195], v6 offset:9216
 v_cvt_pk_bf16_f32 v162, v164, v165
 v_cvt_pk_bf16_f32 v163, v166, v167
 v_mfma_f32_16x16x32_bf16 v[48:51], a[144:147], a[8:11], 0
 s_add_u32 m0, s81, 65536
 ds_read_b64_tr_b16 a[196:197], v7 offset:8192
 v_cvt_pk_bf16_f32 v168, v168, v169
 v_cvt_pk_bf16_f32 v169, v170, v171
 v_mfma_f32_16x16x32_bf16 v[56:59], a[144:147], a[12:15], 0
 s_waitcnt lgkmcnt(15)
 buffer_load_dwordx4 v0, s[8:11], 0 offen offset:0 lds
 v_mfma_f32_16x16x32_bf16 v[36:39], a[148:151], a[0:3], 0
 ds_read_b64_tr_b16 a[198:199], v7 offset:9216
 v_cvt_pk_bf16_f32 v170, v172, v173
 v_cvt_pk_bf16_f32 v171, v174, v175
 v_mfma_f32_16x16x32_bf16 v[44:47], a[148:151], a[4:7], 0
 v_cvt_pk_bf16_f32 v176, v176, v177
 v_cvt_pk_bf16_f32 v177, v178, v179
 v_mfma_f32_16x16x32_bf16 v[52:55], a[148:151], a[8:11], 0
 ds_read_b64_tr_b16 a[200:201], v8 offset:8192
 v_cvt_pk_bf16_f32 v178, v180, v181
 v_cvt_pk_bf16_f32 v179, v182, v183
 v_mfma_f32_16x16x32_bf16 v[60:63], a[148:151], a[12:15], 0
 s_waitcnt lgkmcnt(15)
 buffer_load_dwordx4 v1, s[8:11], s74 offen offset:1024 lds
 v_mfma_f32_16x16x32_bf16 v[68:71], a[152:155], a[0:3], 0
 ds_read_b64_tr_b16 a[202:203], v8 offset:9216
 v_cvt_pk_bf16_f32 v184, v184, v185
 v_cvt_pk_bf16_f32 v185, v186, v187
 v_mfma_f32_16x16x32_bf16 v[76:79], a[152:155], a[4:7], 0
 ds_read_b64_tr_b16 a[204:205], v9 offset:8192
 v_cvt_pk_bf16_f32 v186, v188, v189
 v_cvt_pk_bf16_f32 v187, v190, v191
 v_mfma_f32_16x16x32_bf16 v[84:87], a[152:155], a[8:11], 0
 v_cvt_pk_bf16_f32 v192, v192, v193
 v_cvt_pk_bf16_f32 v193, v194, v195
 v_mfma_f32_16x16x32_bf16 v[92:95], a[152:155], a[12:15], 0
 s_waitcnt lgkmcnt(15)
 buffer_load_dwordx4 v0, s[8:11], s75 offen offset:2048 lds
 v_mfma_f32_16x16x32_bf16 v[100:103], a[156:159], a[0:3], 0
 ds_read_b64_tr_b16 a[206:207], v9 offset:9216
 v_cvt_pk_bf16_f32 v194, v196, v197
 v_cvt_pk_bf16_f32 v195, v198, v199
 v_mfma_f32_16x16x32_bf16 v[108:111], a[156:159], a[4:7], 0
 ds_read_b64_tr_b16 a[208:209], v10 offset:8192
 v_cvt_pk_bf16_f32 v200, v200, v201
 v_cvt_pk_bf16_f32 v201, v202, v203
 v_mfma_f32_16x16x32_bf16 v[116:119], a[156:159], a[8:11], 0
 ds_read_b64_tr_b16 a[210:211], v10 offset:9216
 v_cvt_pk_bf16_f32 v202, v204, v205
 v_cvt_pk_bf16_f32 v203, v206, v207
 v_mfma_f32_16x16x32_bf16 v[124:127], a[156:159], a[12:15], 0
 s_waitcnt lgkmcnt(15)
 buffer_load_dwordx4 v1, s[8:11], s76 offen offset:3072 lds
 s_add_u32 m0, s81, 69632
 v_mfma_f32_16x16x32_bf16 v[132:135], a[160:163], a[0:3], 0
 v_cvt_pk_bf16_f32 v208, v208, v209
 v_cvt_pk_bf16_f32 v209, v210, v211
 v_mfma_f32_16x16x32_bf16 v[140:143], a[160:163], a[4:7], 0
 ds_read_b64_tr_b16 a[212:213], v11 offset:8192
 v_cvt_pk_bf16_f32 v210, v212, v213
 v_cvt_pk_bf16_f32 v211, v214, v215
 v_mfma_f32_16x16x32_bf16 v[148:151], a[160:163], a[8:11], 0
 ds_read_b64_tr_b16 a[214:215], v11 offset:9216
 v_cvt_pk_bf16_f32 v216, v216, v217
 v_cvt_pk_bf16_f32 v217, v218, v219
 v_mfma_f32_16x16x32_bf16 v[156:159], a[160:163], a[12:15], 0
 s_waitcnt lgkmcnt(15)
 buffer_load_dwordx4 v0, s[8:11], s77 offen offset:0 lds
 v_mfma_f32_16x16x32_bf16 v[164:167], a[164:167], a[0:3], 0
 ds_read_b64_tr_b16 a[216:217], v12 offset:8192
 v_cvt_pk_bf16_f32 v218, v220, v221
 v_cvt_pk_bf16_f32 v219, v222, v223
 v_mfma_f32_16x16x32_bf16 v[172:175], a[164:167], a[4:7], 0
 v_cvt_pk_bf16_f32 v224, v224, v225
 v_cvt_pk_bf16_f32 v225, v226, v227
 v_mfma_f32_16x16x32_bf16 v[180:183], a[164:167], a[8:11], 0
 ds_read_b64_tr_b16 a[218:219], v12 offset:9216
 v_cvt_pk_bf16_f32 v226, v228, v229
 v_cvt_pk_bf16_f32 v227, v230, v231
 v_mfma_f32_16x16x32_bf16 v[188:191], a[164:167], a[12:15], 0
 s_waitcnt lgkmcnt(15)
 buffer_load_dwordx4 v1, s[8:11], s78 offen offset:1024 lds
 v_mfma_f32_16x16x32_bf16 v[196:199], a[168:171], a[0:3], 0
 ds_read_b64_tr_b16 a[220:221], v13 offset:8192
 v_cvt_pk_bf16_f32 v232, v232, v233
 v_cvt_pk_bf16_f32 v233, v234, v235
 v_mfma_f32_16x16x32_bf16 v[204:207], a[168:171], a[4:7], 0
 ds_read_b64_tr_b16 a[222:223], v13 offset:9216
 v_cvt_pk_bf16_f32 v234, v236, v237
 v_cvt_pk_bf16_f32 v235, v238, v239
 v_mfma_f32_16x16x32_bf16 v[212:215], a[168:171], a[8:11], 0
 v_cvt_pk_bf16_f32 v240, v240, v241
 v_cvt_pk_bf16_f32 v241, v242, v243
 v_mfma_f32_16x16x32_bf16 v[220:223], a[168:171], a[12:15], 0
 s_waitcnt lgkmcnt(15)
 buffer_load_dwordx4 v0, s[8:11], s79 offen offset:2048 lds
 v_mfma_f32_16x16x32_bf16 v[228:231], a[172:175], a[0:3], 0
 v_cvt_pk_bf16_f32 v242, v244, v245
 v_cvt_pk_bf16_f32 v243, v246, v247
 v_mfma_f32_16x16x32_bf16 v[236:239], a[172:175], a[4:7], 0
 v_cvt_pk_bf16_f32 v248, v248, v249
 v_cvt_pk_bf16_f32 v249, v250, v251
 v_mfma_f32_16x16x32_bf16 v[244:247], a[172:175], a[8:11], 0
 v_cvt_pk_bf16_f32 v250, v252, v253
 v_cvt_pk_bf16_f32 v251, v254, v255
 v_mfma_f32_16x16x32_bf16 v[252:255], a[172:175], a[12:15], 0
 s_waitcnt lgkmcnt(14)
 buffer_load_dwordx4 v1, s[8:11], s80 offen offset:3072 lds
 v_mfma_f32_16x16x32_bf16 v[32:35], a[192:195], a[16:19], v[32:35]
 s_waitcnt vmcnt(29) lgkmcnt(0)
 s_barrier
 v_mfma_f32_16x16x32_bf16 v[40:43], a[192:195], a[20:23], v[40:43]
 ds_read_b64_tr_b16 a[144:145], v6 offset:16384
 v_mfma_f32_16x16x32_bf16 v[48:51], a[192:195], a[24:27], v[48:51]
 s_add_u32 s83, s87, 131072
 buffer_store_dwordx4 v[64:67], v14, s[4:7], s83 offen offset:0
 v_mfma_f32_16x16x32_bf16 v[56:59], a[192:195], a[28:31], v[56:59]
 ds_read_b64_tr_b16 a[146:147], v6 offset:17408
 v_add_u32 v0, 0x80, v0
 v_add_u32 v1, 0x80, v1
 v_mfma_f32_16x16x32_bf16 v[36:39], a[196:199], a[16:19], v[36:39]
 ds_read_b64_tr_b16 a[148:149], v7 offset:16384
 v_add_u32 v16, 0x10000, v4
 v_mfma_f32_16x16x32_bf16 v[44:47], a[196:199], a[20:23], v[44:47]
 v_add_u32 v17, 0x10000, v5
 v_mfma_f32_16x16x32_bf16 v[52:55], a[196:199], a[24:27], v[52:55]
 ds_read_b64_tr_b16 a[150:151], v7 offset:17408
 v_mfma_f32_16x16x32_bf16 v[60:63], a[196:199], a[28:31], v[60:63]
 ds_read_b64_tr_b16 a[152:153], v8 offset:16384
 v_mfma_f32_16x16x32_bf16 v[68:71], a[200:203], a[16:19], v[68:71]
 s_add_u32 m0, s82, 98304
 ds_read_b64_tr_b16 a[154:155], v8 offset:17408
 v_mfma_f32_16x16x32_bf16 v[76:79], a[200:203], a[20:23], v[76:79]
 buffer_load_dwordx4 v2, s[24:27], 0 offen offset:0 lds
 v_mfma_f32_16x16x32_bf16 v[84:87], a[200:203], a[24:27], v[84:87]
 s_waitcnt vmcnt(22)
 v_and_b32 v22, 0x80808080, v15
 v_cmp_ne_u32 vcc, 0x80808080, v22
 s_cmp_eq_u64 vcc, 0
 s_cbranch_scc0 L_spin_106
L_back_105:
 v_mfma_f32_16x16x32_bf16 v[92:95], a[200:203], a[28:31], v[92:95]
 ds_read_b64_tr_b16 a[156:157], v9 offset:16384
 s_and_b32 s94, s61, 3
 s_lshl_b32 s94, s94, 3
 v_bfe_u32 v22, v15, s94, 8
 v_mfma_f32_16x16x32_bf16 v[100:103], a[204:207], a[16:19], v[100:103]
 ds_read_b64_tr_b16 a[158:159], v9 offset:17408
 v_cmp_ne_u32 vcc, s0, v22
 s_lshr_b32 s94, s61, 2
 s_lshl_b32 s94, 0x55555555, s94
 s_or_b32 s95, vcc_lo, vcc_hi
 s_and_b32 s95, s95, s94
 s_cselect_b32 s1, 0, 1
 v_mfma_f32_16x16x32_bf16 v[108:111], a[204:207], a[20:23], v[108:111]
 v_mul_u32_u24 v19, 128, v14
 s_and_b32 s94, s2, 0x1f
 s_lshl_b32 s94, s94, 6
 s_add_u32 s94, s94, 71368704
 v_add_u32 v19, s94, v19
 v_mfma_f32_16x16x32_bf16 v[116:119], a[204:207], a[24:27], v[116:119]
 ds_read_b64_tr_b16 a[160:161], v10 offset:16384
 v_mov_b32 v23, 2147483632
 v_mfma_f32_16x16x32_bf16 v[124:127], a[204:207], a[28:31], v[124:127]
 ds_read_b64_tr_b16 a[162:163], v10 offset:17408
 v_mfma_f32_16x16x32_bf16 v[132:135], a[208:211], a[16:19], v[132:135]
 ds_read_b64_tr_b16 a[164:165], v11 offset:16384
 v_mfma_f32_16x16x32_bf16 v[140:143], a[208:211], a[20:23], v[140:143]
 buffer_load_dwordx4 v2, s[24:27], s71 offen offset:1024 lds
 v_mfma_f32_16x16x32_bf16 v[148:151], a[208:211], a[24:27], v[148:151]
 v_cmp_gt_u32 vcc, 128, v14
 s_nop 1
 v_cndmask_b32 v19, v23, v19, vcc
 v_mfma_f32_16x16x32_bf16 v[156:159], a[208:211], a[28:31], v[156:159]
 ds_read_b64_tr_b16 a[166:167], v11 offset:17408
 v_mfma_f32_16x16x32_bf16 v[164:167], a[212:215], a[16:19], v[164:167]
 ds_read_b64_tr_b16 a[168:169], v12 offset:16384
 v_mfma_f32_16x16x32_bf16 v[172:175], a[212:215], a[20:23], v[172:175]
 ds_read_b64_tr_b16 a[170:171], v12 offset:17408
 v_mfma_f32_16x16x32_bf16 v[180:183], a[212:215], a[24:27], v[180:183]
 v_mfma_f32_16x16x32_bf16 v[188:191], a[212:215], a[28:31], v[188:191]
 ds_read_b64_tr_b16 a[172:173], v13 offset:16384
 v_mfma_f32_16x16x32_bf16 v[196:199], a[216:219], a[16:19], v[196:199]
 ds_read_b64_tr_b16 a[174:175], v13 offset:17408
 v_mfma_f32_16x16x32_bf16 v[204:207], a[216:219], a[20:23], v[204:207]
 buffer_load_dwordx4 v3, s[24:27], s72 offen offset:2048 lds
 v_mfma_f32_16x16x32_bf16 v[212:215], a[216:219], a[24:27], v[212:215]
 v_mfma_f32_16x16x32_bf16 v[220:223], a[216:219], a[28:31], v[220:223]
 s_add_u32 s83, s87, 131072
 buffer_store_dwordx4 v[72:75], v14, s[4:7], s83 offen offset:1024
 v_mfma_f32_16x16x32_bf16 v[228:231], a[220:223], a[16:19], v[228:231]
 v_mfma_f32_16x16x32_bf16 v[236:239], a[220:223], a[20:23], v[236:239]
 v_mfma_f32_16x16x32_bf16 v[244:247], a[220:223], a[24:27], v[244:247]
 v_mfma_f32_16x16x32_bf16 v[252:255], a[220:223], a[28:31], v[252:255]
 s_waitcnt lgkmcnt(14)
 v_mfma_f32_16x16x32_bf16 v[32:35], a[144:147], a[32:35], v[32:35]
 ds_read_b64_tr_b16 a[192:193], v6 offset:24576
 v_mfma_f32_16x16x32_bf16 v[40:43], a[144:147], a[36:39], v[40:43]
 buffer_load_dwordx4 v3, s[24:27], s73 offen offset:3072 lds
 v_mfma_f32_16x16x32_bf16 v[48:51], a[144:147], a[40:43], v[48:51]
 ds_read_b64_tr_b16 a[194:195], v6 offset:25600
 v_mfma_f32_16x16x32_bf16 v[56:59], a[144:147], a[44:47], v[56:59]
 s_waitcnt lgkmcnt(14)
 v_mfma_f32_16x16x32_bf16 v[36:39], a[148:151], a[32:35], v[36:39]
 ds_read_b64_tr_b16 a[196:197], v7 offset:24576
 v_mfma_f32_16x16x32_bf16 v[44:47], a[148:151], a[36:39], v[44:47]
 ds_read_b64_tr_b16 a[198:199], v7 offset:25600
 v_mfma_f32_16x16x32_bf16 v[52:55], a[148:151], a[40:43], v[52:55]
 v_mfma_f32_16x16x32_bf16 v[60:63], a[148:151], a[44:47], v[60:63]
 s_waitcnt lgkmcnt(14)
 ds_read_b64_tr_b16 a[200:201], v8 offset:24576
 v_mfma_f32_16x16x32_bf16 v[68:71], a[152:155], a[32:35], v[68:71]
 v_mfma_f32_16x16x32_bf16 v[76:79], a[152:155], a[36:39], v[76:79]
 ds_read_b64_tr_b16 a[202:203], v8 offset:25600
 v_add_u32 v2, 0x80000, v2
 v_add_u32 v3, 0x80000, v3
 v_mfma_f32_16x16x32_bf16 v[84:87], a[152:155], a[40:43], v[84:87]
 ds_read_b64_tr_b16 a[204:205], v9 offset:24576
 v_mfma_f32_16x16x32_bf16 v[92:95], a[152:155], a[44:47], v[92:95]
 s_waitcnt lgkmcnt(15)
 v_mfma_f32_16x16x32_bf16 v[100:103], a[156:159], a[32:35], v[100:103]
 ds_read_b64_tr_b16 a[206:207], v9 offset:25600
 v_mfma_f32_16x16x32_bf16 v[108:111], a[156:159], a[36:39], v[108:111]
 v_mfma_f32_16x16x32_bf16 v[116:119], a[156:159], a[40:43], v[116:119]
 ds_read_b64_tr_b16 a[208:209], v10 offset:24576
 v_mfma_f32_16x16x32_bf16 v[124:127], a[156:159], a[44:47], v[124:127]
 s_waitcnt lgkmcnt(15)
 s_add_u32 s83, s87, 131072
 buffer_store_dwordx4 v[80:83], v14, s[4:7], s83 offen offset:2048
 v_mfma_f32_16x16x32_bf16 v[132:135], a[160:163], a[32:35], v[132:135]
 ds_read_b64_tr_b16 a[210:211], v10 offset:25600
 v_mfma_f32_16x16x32_bf16 v[140:143], a[160:163], a[36:39], v[140:143]
 v_mfma_f32_16x16x32_bf16 v[148:151], a[160:163], a[40:43], v[148:151]
 ds_read_b64_tr_b16 a[212:213], v11 offset:24576
 v_mfma_f32_16x16x32_bf16 v[156:159], a[160:163], a[44:47], v[156:159]
 s_waitcnt lgkmcnt(15)
 ds_read_b64_tr_b16 a[214:215], v11 offset:25600
 v_mfma_f32_16x16x32_bf16 v[164:167], a[164:167], a[32:35], v[164:167]
 v_mfma_f32_16x16x32_bf16 v[172:175], a[164:167], a[36:39], v[172:175]
 ds_read_b64_tr_b16 a[216:217], v12 offset:24576
 v_mfma_f32_16x16x32_bf16 v[180:183], a[164:167], a[40:43], v[180:183]
 v_mfma_f32_16x16x32_bf16 v[188:191], a[164:167], a[44:47], v[188:191]
 s_waitcnt lgkmcnt(15)
 ds_read_b64_tr_b16 a[218:219], v12 offset:25600
 v_mfma_f32_16x16x32_bf16 v[196:199], a[168:171], a[32:35], v[196:199]
 ds_read_b64_tr_b16 a[220:221], v13 offset:24576
 v_mfma_f32_16x16x32_bf16 v[204:207], a[168:171], a[36:39], v[204:207]
 v_mfma_f32_16x16x32_bf16 v[212:215], a[168:171], a[40:43], v[212:215]
 ds_read_b64_tr_b16 a[222:223], v13 offset:25600
 v_mfma_f32_16x16x32_bf16 v[220:223], a[168:171], a[44:47], v[220:223]
 s_waitcnt lgkmcnt(15)
 v_mfma_f32_16x16x32_bf16 v[228:231], a[172:175], a[32:35], v[228:231]
 v_mfma_f32_16x16x32_bf16 v[236:239], a[172:175], a[36:39], v[236:239]
 v_mfma_f32_16x16x32_bf16 v[244:247], a[172:175], a[40:43], v[244:247]
 v_mfma_f32_16x16x32_bf16 v[252:255], a[172:175], a[44:47], v[252:255]
 s_waitcnt lgkmcnt(14)
 v_mfma_f32_16x16x32_bf16 v[32:35], a[192:195], a[48:51], v[32:35]
 s_waitcnt vmcnt(15) lgkmcnt(0)
 s_barrier
 v_mfma_f32_16x16x32_bf16 v[40:43], a[192:195], a[52:55], v[40:43]
 ds_read_b64_tr_b16 a[144:145], v6 offset:32768
 s_cmp_eq_u32 s1, 0
 s_cbranch_scc1 L_fence_86
L_back_87:
 s_lshl_b32 s94, s2, 6
 s_add_u32 s94, s94, 71368704
 s_cmp_eq_u32 s60, 0
 s_cselect_b32 s94, s94, 0x8000000
 v_lshl_add_u32 v22, v14, 21, s94
 v_mov_b32 v23, 1
 v_mfma_f32_16x16x32_bf16 v[48:51], a[192:195], a[56:59], v[48:51]
 buffer_store_dword v23, v22, s[4:7], 0 offen sc1
 v_mfma_f32_16x16x32_bf16 v[56:59], a[192:195], a[60:63], v[56:59]
 ds_read_b64_tr_b16 a[146:147], v6 offset:33792
 v_mfma_f32_16x16x32_bf16 v[36:39], a[196:199], a[48:51], v[36:39]
 ds_read_b64_tr_b16 a[148:149], v7 offset:32768
 v_mfma_f32_16x16x32_bf16 v[44:47], a[196:199], a[52:55], v[44:47]
 s_add_u32 m0, s82, 114688
 v_mfma_f32_16x16x32_bf16 v[52:55], a[196:199], a[56:59], v[52:55]
 buffer_load_dwordx4 v2, s[24:27], 0 offen offset:0 lds
 v_mfma_f32_16x16x32_bf16 v[60:63], a[196:199], a[60:63], v[60:63]
 ds_read_b64_tr_b16 a[150:151], v7 offset:33792
 v_mfma_f32_16x16x32_bf16 v[68:71], a[200:203], a[48:51], v[68:71]
 s_add_u32 s83, s87, 131072
 buffer_store_dwordx4 v[88:91], v14, s[4:7], s83 offen offset:3072
 v_mfma_f32_16x16x32_bf16 v[76:79], a[200:203], a[52:55], v[76:79]
 ds_read_b64_tr_b16 a[152:153], v8 offset:32768
 v_mfma_f32_16x16x32_bf16 v[84:87], a[200:203], a[56:59], v[84:87]
 ds_read_b64_tr_b16 a[154:155], v8 offset:33792
 v_mov_b32 v28, 0x3f803f80
 v_mfma_f32_16x16x32_bf16 v[92:95], a[200:203], a[60:63], v[92:95]
 v_mov_b32 v29, 0x3f803f80
 v_mov_b32 v30, 0x3f803f80
 v_mfma_f32_16x16x32_bf16 v[100:103], a[204:207], a[48:51], v[100:103]
 s_add_u32 s20, s62, 0
 ds_read_b64_tr_b16 a[156:157], v9 offset:32768
 v_mov_b32 v31, 0x3f803f80
 v_mfma_f32_16x16x32_bf16 v[108:111], a[204:207], a[52:55], v[108:111]
 s_and_b32 s20, s20, 3
 ds_read_b64_tr_b16 a[158:159], v9 offset:33792
 v_bfe_u32 v64, v14, 4, 4
 v_mfma_f32_16x16x32_bf16 v[116:119], a[204:207], a[56:59], v[116:119]
 s_lshl_b32 s21, s61, 2
 buffer_load_dwordx4 v2, s[24:27], s71 offen offset:1024 lds
 v_mfma_f32_16x16x32_bf16 v[124:127], a[204:207], a[60:63], v[124:127]
 s_add_u32 s20, s20, s21
 v_lshrrev_b32 v65, 8, v14
 v_lshlrev_b32 v65, 2, v65
 v_mfma_f32_16x16x32_bf16 v[132:135], a[208:211], a[48:51], v[132:135]
 s_lshl_b32 s20, s20, 2
 ds_read_b64_tr_b16 a[160:161], v10 offset:32768
 v_sub_u32 v64, v64, v65
 v_mfma_f32_16x16x32_bf16 v[140:143], a[208:211], a[52:55], v[140:143]
 s_add_u32 s20, s20, s60
 ds_read_b64_tr_b16 a[162:163], v10 offset:33792
 v_mov_b32 v65, 0xf1800000
 v_mfma_f32_16x16x32_bf16 v[148:151], a[208:211], a[56:59], v[148:151]
 s_mul_i32 s20, s20, 36864
 ds_read_b64_tr_b16 a[164:165], v11 offset:32768
 v_mfma_f32_16x16x32_bf16 v[156:159], a[208:211], a[60:63], v[156:159]
 s_mul_i32 s21, s62, 288
 v_cmp_gt_i32 vcc, 0, v64
 s_nop 1
 v_cndmask_b32 v24, 0, v65, vcc
 v_mfma_f32_16x16x32_bf16 v[164:167], a[212:215], a[48:51], v[164:167]
 s_add_u32 s12, s20, s21
 ds_read_b64_tr_b16 a[166:167], v11 offset:33792
 v_mfma_f32_16x16x32_bf16 v[172:175], a[212:215], a[52:55], v[172:175]
 s_add_u32 s20, s62, 1
 ds_read_b64_tr_b16 a[168:169], v12 offset:32768
 v_mfma_f32_16x16x32_bf16 v[180:183], a[212:215], a[56:59], v[180:183]
 s_and_b32 s20, s20, 3
 buffer_load_dwordx4 v3, s[24:27], s72 offen offset:2048 lds
 v_mfma_f32_16x16x32_bf16 v[188:191], a[212:215], a[60:63], v[188:191]
 s_lshl_b32 s21, s61, 2
 ds_read_b64_tr_b16 a[170:171], v12 offset:33792
 v_mfma_f32_16x16x32_bf16 v[196:199], a[216:219], a[48:51], v[196:199]
 s_add_u32 s20, s20, s21
 v_cmp_gt_i32 vcc, 1, v64
 s_nop 1
 v_cndmask_b32 v25, 0, v65, vcc
 v_mfma_f32_16x16x32_bf16 v[204:207], a[216:219], a[52:55], v[204:207]
 s_lshl_b32 s21, s20, 4
 ds_read_b64_tr_b16 a[172:173], v13 offset:32768
 v_mfma_f32_16x16x32_bf16 v[212:215], a[216:219], a[56:59], v[212:215]
 s_add_u32 s21, s21, s63
 ds_read_b64_tr_b16 a[174:175], v13 offset:33792
 v_mfma_f32_16x16x32_bf16 v[220:223], a[216:219], a[60:63], v[220:223]
 s_lshl_b32 s21, s21, 15
 v_cmp_gt_i32 vcc, 2, v64
 s_nop 1
 v_cndmask_b32 v26, 0, v65, vcc
 v_mfma_f32_16x16x32_bf16 v[228:231], a[220:223], a[48:51], v[228:231]
 s_add_u32 s83, s87, 135168
 buffer_store_dwordx4 v[96:99], v14, s[4:7], s83 offen offset:0
 s_add_u32 s21, s21, s81
 v_mfma_f32_16x16x32_bf16 v[236:239], a[220:223], a[52:55], v[236:239]
 s_add_u32 s16, s21, 33554432
 v_cmp_gt_i32 vcc, 3, v64
 s_nop 1
 v_cndmask_b32 v27, 0, v65, vcc
 v_mfma_f32_16x16x32_bf16 v[244:247], a[220:223], a[56:59], v[244:247]
 s_lshl_b32 s20, s20, 2
 buffer_load_dwordx4 v3, s[24:27], s73 offen offset:3072 lds
 v_mfma_f32_16x16x32_bf16 v[252:255], a[220:223], a[60:63], v[252:255]
 s_waitcnt lgkmcnt(14)
 s_add_u32 s20, s20, s60
 v_mfma_f32_16x16x32_bf16 v[32:35], a[144:147], a[64:67], v[32:35]
 s_mul_i32 s20, s20, 36864
 ds_read_b64_tr_b16 a[192:193], v6 offset:40960
 v_mfma_f32_16x16x32_bf16 v[40:43], a[144:147], a[68:71], v[40:43]
 s_mul_i32 s21, s62, 288
 ds_read_b64_tr_b16 a[194:195], v6 offset:41984
 v_mfma_f32_16x16x32_bf16 v[48:51], a[144:147], a[72:75], v[48:51]
 s_add_u32 s13, s20, s21
 v_mfma_f32_16x16x32_bf16 v[56:59], a[144:147], a[76:79], v[56:59]
 s_waitcnt lgkmcnt(14)
 s_add_u32 s20, s62, 2
 ds_read_b64_tr_b16 a[196:197], v7 offset:40960
 v_mfma_f32_16x16x32_bf16 v[36:39], a[148:151], a[64:67], v[36:39]
 s_and_b32 s20, s20, 3
 v_mfma_f32_16x16x32_bf16 v[44:47], a[148:151], a[68:71], v[44:47]
 s_lshl_b32 s21, s61, 2
 ds_read_b64_tr_b16 a[198:199], v7 offset:41984
 v_mfma_f32_16x16x32_bf16 v[52:55], a[148:151], a[72:75], v[52:55]
 s_add_u32 s20, s20, s21
 ds_read_b64_tr_b16 a[200:201], v8 offset:40960
 v_add_u32 v2, 0x80000, v2
 v_add_u32 v3, 0x80000, v3
 v_mfma_f32_16x16x32_bf16 v[60:63], a[148:151], a[76:79], v[60:63]
 s_waitcnt lgkmcnt(15)
 s_lshl_b32 s21, s20, 4
 v_mfma_f32_16x16x32_bf16 v[68:71], a[152:155], a[64:67], v[68:71]
 s_add_u32 s21, s21, s63
 ds_read_b64_tr_b16 a[202:203], v8 offset:41984
 v_mfma_f32_16x16x32_bf16 v[76:79], a[152:155], a[68:71], v[76:79]
 s_lshl_b32 s21, s21, 15
 v_mfma_f32_16x16x32_bf16 v[84:87], a[152:155], a[72:75], v[84:87]
 s_add_u32 s21, s21, s81
 ds_read_b64_tr_b16 a[204:205], v9 offset:40960
 v_mfma_f32_16x16x32_bf16 v[92:95], a[152:155], a[76:79], v[92:95]
 s_waitcnt lgkmcnt(15)
 s_add_u32 s17, s21, 33554432
 ds_read_b64_tr_b16 a[206:207], v9 offset:41984
 v_mfma_f32_16x16x32_bf16 v[100:103], a[156:159], a[64:67], v[100:103]
 s_lshl_b32 s20, s20, 2
 v_mfma_f32_16x16x32_bf16 v[108:111], a[156:159], a[68:71], v[108:111]
 s_add_u32 s20, s20, s60
 ds_read_b64_tr_b16 a[208:209], v10 offset:40960
 v_mfma_f32_16x16x32_bf16 v[116:119], a[156:159], a[72:75], v[116:119]
 s_mul_i32 s20, s20, 36864
 v_mfma_f32_16x16x32_bf16 v[124:127], a[156:159], a[76:79], v[124:127]
 s_waitcnt lgkmcnt(15)
 s_mul_i32 s21, s62, 288
 ds_read_b64_tr_b16 a[210:211], v10 offset:41984
 v_mfma_f32_16x16x32_bf16 v[132:135], a[160:163], a[64:67], v[132:135]
 s_add_u32 s14, s20, s21
 ds_read_b64_tr_b16 a[212:213], v11 offset:40960
 v_mfma_f32_16x16x32_bf16 v[140:143], a[160:163], a[68:71], v[140:143]
 s_add_u32 s20, s62, 3
 v_mfma_f32_16x16x32_bf16 v[148:151], a[160:163], a[72:75], v[148:151]
 s_and_b32 s20, s20, 3
 ds_read_b64_tr_b16 a[214:215], v11 offset:41984
 v_mfma_f32_16x16x32_bf16 v[156:159], a[160:163], a[76:79], v[156:159]
 s_waitcnt lgkmcnt(15)
 s_add_u32 s83, s87, 135168
 buffer_store_dwordx4 v[104:107], v14, s[4:7], s83 offen offset:1024
 s_lshl_b32 s21, s61, 2
 v_mfma_f32_16x16x32_bf16 v[164:167], a[164:167], a[64:67], v[164:167]
 s_add_u32 s20, s20, s21
 v_mfma_f32_16x16x32_bf16 v[172:175], a[164:167], a[68:71], v[172:175]
 s_lshl_b32 s21, s20, 4
 ds_read_b64_tr_b16 a[216:217], v12 offset:40960
 v_mfma_f32_16x16x32_bf16 v[180:183], a[164:167], a[72:75], v[180:183]
 s_add_u32 s21, s21, s63
 ds_read_b64_tr_b16 a[218:219], v12 offset:41984
 v_mfma_f32_16x16x32_bf16 v[188:191], a[164:167], a[76:79], v[188:191]
 s_waitcnt lgkmcnt(15)
 s_lshl_b32 s21, s21, 15
 v_mfma_f32_16x16x32_bf16 v[196:199], a[168:171], a[64:67], v[196:199]
 s_add_u32 s21, s21, s81
 ds_read_b64_tr_b16 a[220:221], v13 offset:40960
 v_mfma_f32_16x16x32_bf16 v[204:207], a[168:171], a[68:71], v[204:207]
 s_add_u32 s18, s21, 33554432
 v_mfma_f32_16x16x32_bf16 v[212:215], a[168:171], a[72:75], v[212:215]
 s_lshl_b32 s20, s20, 2
 ds_read_b64_tr_b16 a[222:223], v13 offset:41984
 v_mfma_f32_16x16x32_bf16 v[220:223], a[168:171], a[76:79], v[220:223]
 s_waitcnt lgkmcnt(15)
 s_add_u32 s20, s20, s60
 v_mfma_f32_16x16x32_bf16 v[228:231], a[172:175], a[64:67], v[228:231]
 s_mul_i32 s20, s20, 36864
 v_mfma_f32_16x16x32_bf16 v[236:239], a[172:175], a[68:71], v[236:239]
 s_mul_i32 s21, s62, 288
 v_mfma_f32_16x16x32_bf16 v[244:247], a[172:175], a[72:75], v[244:247]
 s_add_u32 s15, s20, s21
 v_mfma_f32_16x16x32_bf16 v[252:255], a[172:175], a[76:79], v[252:255]
 s_waitcnt lgkmcnt(14)
 s_mul_i32 s85, s60, 9216
 v_mfma_f32_16x16x32_bf16 v[32:35], a[192:195], a[80:83], v[32:35]
 s_waitcnt vmcnt(9) lgkmcnt(0)
 s_barrier
 s_cmp_eq_u32 s60, 3
 s_cselect_b32 s86, 2147483632, s13
 v_mfma_f32_16x16x32_bf16 v[40:43], a[192:195], a[84:87], v[40:43]
 s_add_u32 m0, s82, 131072
 ds_read_b64_tr_b16 a[144:145], v6 offset:0
 s_cmp_eq_u32 s60, 3
 s_cselect_b32 s22, 28672, s85
 v_mfma_f32_16x16x32_bf16 v[48:51], a[192:195], a[88:91], v[48:51]
 s_sub_u32 s20, s2, 112
 buffer_load_dwordx4 v2, s[24:27], 0 offen offset:0 lds
 v_mfma_f32_16x16x32_bf16 v[56:59], a[192:195], a[92:95], v[56:59]
 s_lshr_b32 s20, s20, 3
 ds_read_b64_tr_b16 a[146:147], v6 offset:1024
 v_mfma_f32_16x16x32_bf16 v[36:39], a[196:199], a[80:83], v[36:39]
 s_mul_i32 s21, s61, 18
 ds_read_b128 a[128:131], v4 offset:0
 v_mfma_f32_16x16x32_bf16 v[44:47], a[196:199], a[84:87], v[44:47]
 s_add_u32 s20, s20, s21
 ds_read_b64_tr_b16 a[148:149], v7 offset:0
 v_mfma_f32_16x16x32_bf16 v[52:55], a[196:199], a[88:91], v[52:55]
 s_lshl_b32 s20, s20, 6
 ds_read_b64_tr_b16 a[150:151], v7 offset:1024
 v_mfma_f32_16x16x32_bf16 v[60:63], a[196:199], a[92:95], v[60:63]
 s_cmp_ge_u32 s2, 112
 s_cselect_b32 s70, s20, 0x400000
 ds_read_b128 a[132:135], v4 offset:2048
 v_mfma_f32_16x16x32_bf16 v[68:71], a[200:203], a[80:83], v[68:71]
 s_cmp_lt_u32 s60, 2
 s_cselect_b64 s[40:41], s[48:49], s[52:53]
 ds_read_b64_tr_b16 a[152:153], v8 offset:0
 v_mfma_f32_16x16x32_bf16 v[76:79], a[200:203], a[84:87], v[76:79]
 s_mov_b32 s42, 5308416
 ds_read_b64_tr_b16 a[154:155], v8 offset:1024
 v_mfma_f32_16x16x32_bf16 v[84:87], a[200:203], a[88:91], v[84:87]
 buffer_load_dwordx4 v2, s[24:27], s71 offen offset:1024 lds
 v_mfma_f32_16x16x32_bf16 v[92:95], a[200:203], a[92:95], v[92:95]
 ds_read_b128 a[136:139], v4 offset:4096
 v_mfma_f32_16x16x32_bf16 v[100:103], a[204:207], a[80:83], v[100:103]
 s_add_u32 s83, s87, 135168
 buffer_store_dwordx4 v[112:115], v14, s[4:7], s83 offen offset:2048
 v_mfma_f32_16x16x32_bf16 v[108:111], a[204:207], a[84:87], v[108:111]
 ds_read_b64_tr_b16 a[156:157], v9 offset:0
 v_mfma_f32_16x16x32_bf16 v[116:119], a[204:207], a[88:91], v[116:119]
 v_lshrrev_b32 v64, 4, v14
 v_add_u32 v65, 0, v64
 v_mfma_f32_16x16x32_bf16 v[124:127], a[204:207], a[92:95], v[124:127]
 ds_read_b64_tr_b16 a[158:159], v9 offset:1024
 v_mul_u32_u24 v66, 0xe39, v65
 v_mfma_f32_16x16x32_bf16 v[132:135], a[208:211], a[80:83], v[132:135]
 ds_read_b128 a[140:143], v4 offset:6144
 v_lshrrev_b32 v66, 16, v66
 v_mfma_f32_16x16x32_bf16 v[140:143], a[208:211], a[84:87], v[140:143]
 ds_read_b64_tr_b16 a[160:161], v10 offset:0
 v_mul_u32_u24 v66, 0x360, v66
 v_mfma_f32_16x16x32_bf16 v[148:151], a[208:211], a[88:91], v[148:151]
 buffer_load_dwordx4 v3, s[24:27], s72 offen offset:2048 lds
 v_mfma_f32_16x16x32_bf16 v[156:159], a[208:211], a[92:95], v[156:159]
 ds_read_b64_tr_b16 a[162:163], v10 offset:1024
 v_lshl_add_u32 v96, v65, 4, v66
 v_mfma_f32_16x16x32_bf16 v[164:167], a[212:215], a[80:83], v[164:167]
 ds_read_b64_tr_b16 a[164:165], v11 offset:0
 v_add_u32 v65, 64, v64
 v_mfma_f32_16x16x32_bf16 v[172:175], a[212:215], a[84:87], v[172:175]
 ds_read_b64_tr_b16 a[166:167], v11 offset:1024
 v_mul_u32_u24 v66, 0xe39, v65
 v_mfma_f32_16x16x32_bf16 v[180:183], a[212:215], a[88:91], v[180:183]
 ds_read_b64_tr_b16 a[168:169], v12 offset:0
 v_lshrrev_b32 v66, 16, v66
 v_mfma_f32_16x16x32_bf16 v[188:191], a[212:215], a[92:95], v[188:191]
 ds_read_b64_tr_b16 a[170:171], v12 offset:1024
 v_mul_u32_u24 v66, 0x360, v66
 v_mfma_f32_16x16x32_bf16 v[196:199], a[216:219], a[80:83], v[196:199]
 ds_read_b64_tr_b16 a[172:173], v13 offset:0
 v_lshl_add_u32 v97, v65, 4, v66
 v_mfma_f32_16x16x32_bf16 v[204:207], a[216:219], a[84:87], v[204:207]
 ds_read_b64_tr_b16 a[174:175], v13 offset:1024
 v_subrev_u32 v97, 1024, v97
 v_mfma_f32_16x16x32_bf16 v[212:215], a[216:219], a[88:91], v[212:215]
 buffer_load_dwordx4 v3, s[24:27], s73 offen offset:3072 lds
 v_mfma_f32_16x16x32_bf16 v[220:223], a[216:219], a[92:95], v[220:223]
 v_add_u32 v65, 128, v64
 v_mul_u32_u24 v66, 0xe39, v65
 v_mfma_f32_16x16x32_bf16 v[228:231], a[220:223], a[80:83], v[228:231]
 v_lshrrev_b32 v66, 16, v66
 v_mul_u32_u24 v66, 0x360, v66
 v_mfma_f32_16x16x32_bf16 v[236:239], a[220:223], a[84:87], v[236:239]
 v_lshl_add_u32 v98, v65, 4, v66
 v_subrev_u32 v98, 2048, v98
 v_mfma_f32_16x16x32_bf16 v[244:247], a[220:223], a[88:91], v[244:247]
 v_add_u32 v65, 192, v64
 v_mul_u32_u24 v66, 0xe39, v65
 v_mfma_f32_16x16x32_bf16 v[252:255], a[220:223], a[92:95], v[252:255]
 s_waitcnt lgkmcnt(15)
 v_lshrrev_b32 v66, 16, v66
 v_mul_u32_u24 v66, 0x360, v66
 v_mfma_f32_16x16x32_bf16 v[32:35], a[144:147], a[128:131], v[32:35]
 s_waitcnt lgkmcnt(14)
 s_add_u32 s83, s87, 135168
 buffer_store_dwordx4 v[120:123], v14, s[4:7], s83 offen offset:3072
 v_mfma_f32_16x16x32_bf16 v[40:43], a[144:147], a[132:135], v[40:43]
 s_waitcnt lgkmcnt(11)
 ds_read_b64_tr_b16 a[192:193], v6 offset:8192
 v_lshl_add_u32 v99, v65, 4, v66
 v_mfma_f32_16x16x32_bf16 v[48:51], a[144:147], a[136:139], v[48:51]
 s_waitcnt lgkmcnt(9)
 ds_read_b64_tr_b16 a[194:195], v6 offset:9216
 v_add_u32 v2, 0x80000, v2
 v_add_u32 v3, 0x80000, v3
 v_mfma_f32_16x16x32_bf16 v[56:59], a[144:147], a[140:143], v[56:59]
 ds_read_b128 a[176:179], v5 offset:0
 v_subrev_u32 v99, 3072, v99
 v_mfma_f32_16x16x32_bf16 v[36:39], a[148:151], a[128:131], v[36:39]
 ds_read_b64_tr_b16 a[196:197], v7 offset:8192
 v_add_u32 v65, 256, v64
 v_mfma_f32_16x16x32_bf16 v[44:47], a[148:151], a[132:135], v[44:47]
 v_mul_u32_u24 v66, 0xe39, v65
 v_lshrrev_b32 v66, 16, v66
 v_mfma_f32_16x16x32_bf16 v[52:55], a[148:151], a[136:139], v[52:55]
 ds_read_b64_tr_b16 a[198:199], v7 offset:9216
 v_mul_u32_u24 v66, 0x360, v66
 v_mfma_f32_16x16x32_bf16 v[60:63], a[148:151], a[140:143], v[60:63]
 ds_read_b128 a[180:183], v5 offset:2048
 v_lshl_add_u32 v104, v65, 4, v66
 v_mfma_f32_16x16x32_bf16 v[68:71], a[152:155], a[128:131], v[68:71]
 ds_read_b64_tr_b16 a[200:201], v8 offset:8192
 v_add_u32 v65, 320, v64
 v_mfma_f32_16x16x32_bf16 v[76:79], a[152:155], a[132:135], v[76:79]
 v_mul_u32_u24 v66, 0xe39, v65
 v_lshrrev_b32 v66, 16, v66
 v_mfma_f32_16x16x32_bf16 v[84:87], a[152:155], a[136:139], v[84:87]
 ds_read_b64_tr_b16 a[202:203], v8 offset:9216
 v_mul_u32_u24 v66, 0x360, v66
 v_mfma_f32_16x16x32_bf16 v[92:95], a[152:155], a[140:143], v[92:95]
 ds_read_b128 a[184:187], v5 offset:4096
 v_lshl_add_u32 v105, v65, 4, v66
 v_mfma_f32_16x16x32_bf16 v[100:103], a[156:159], a[128:131], v[100:103]
 ds_read_b64_tr_b16 a[204:205], v9 offset:8192
 v_subrev_u32 v105, 1024, v105
 v_mfma_f32_16x16x32_bf16 v[108:111], a[156:159], a[132:135], v[108:111]
 v_add_u32 v65, 384, v64
 v_mul_u32_u24 v66, 0xe39, v65
 v_mfma_f32_16x16x32_bf16 v[116:119], a[156:159], a[136:139], v[116:119]
 ds_read_b64_tr_b16 a[206:207], v9 offset:9216
 v_lshrrev_b32 v66, 16, v66
 v_mfma_f32_16x16x32_bf16 v[124:127], a[156:159], a[140:143], v[124:127]
 s_waitcnt lgkmcnt(15)
 ds_read_b128 a[188:191], v5 offset:6144
 v_mul_u32_u24 v66, 0x360, v66
 v_mfma_f32_16x16x32_bf16 v[132:135], a[160:163], a[128:131], v[132:135]
 ds_read_b64_tr_b16 a[208:209], v10 offset:8192
 v_lshl_add_u32 v106, v65, 4, v66
 v_mfma_f32_16x16x32_bf16 v[140:143], a[160:163], a[132:135], v[140:143]
 ds_read_b64_tr_b16 a[210:211], v10 offset:9216
 v_subrev_u32 v106, 2048, v106
 v_mfma_f32_16x16x32_bf16 v[148:151], a[160:163], a[136:139], v[148:151]
 v_add_u32 v65, 448, v64
 v_mul_u32_u24 v66, 0xe39, v65
 v_mfma_f32_16x16x32_bf16 v[156:159], a[160:163], a[140:143], v[156:159]
 ds_read_b64_tr_b16 a[212:213], v11 offset:8192
 v_lshrrev_b32 v66, 16, v66
 v_mfma_f32_16x16x32_bf16 v[164:167], a[164:167], a[128:131], v[164:167]
 ds_read_b64_tr_b16 a[214:215], v11 offset:9216
 v_mul_u32_u24 v66, 0x360, v66
 v_mfma_f32_16x16x32_bf16 v[172:175], a[164:167], a[132:135], v[172:175]
 ds_read_b64_tr_b16 a[216:217], v12 offset:8192
 v_lshl_add_u32 v107, v65, 4, v66
 v_mfma_f32_16x16x32_bf16 v[180:183], a[164:167], a[136:139], v[180:183]
 v_subrev_u32 v107, 3072, v107
 v_add_u32 v65, 512, v64
 v_mfma_f32_16x16x32_bf16 v[188:191], a[164:167], a[140:143], v[188:191]
 s_waitcnt lgkmcnt(15)
 s_add_u32 s83, s87, 262144
 buffer_store_dwordx4 v[128:131], v14, s[4:7], s83 offen offset:0
 v_mfma_f32_16x16x32_bf16 v[196:199], a[168:171], a[128:131], v[196:199]
 ds_read_b64_tr_b16 a[218:219], v12 offset:9216
 v_mul_u32_u24 v66, 0xe39, v65
 v_mfma_f32_16x16x32_bf16 v[204:207], a[168:171], a[132:135], v[204:207]
 ds_read_b64_tr_b16 a[220:221], v13 offset:8192
 v_lshrrev_b32 v66, 16, v66
 v_mfma_f32_16x16x32_bf16 v[212:215], a[168:171], a[136:139], v[212:215]
 ds_read_b64_tr_b16 a[222:223], v13 offset:9216
 v_mul_u32_u24 v66, 0x360, v66
 v_mfma_f32_16x16x32_bf16 v[220:223], a[168:171], a[140:143], v[220:223]
 v_lshl_add_u32 v112, v65, 4, v66
 v_lshrrev_b32 v65, 2, v64
 v_mfma_f32_16x16x32_bf16 v[228:231], a[172:175], a[128:131], v[228:231]
 v_mul_u32_u24 v65, 0x120, v65
 v_and_b32 v66, 3, v64
 v_mfma_f32_16x16x32_bf16 v[236:239], a[172:175], a[132:135], v[236:239]
 v_lshl_add_u32 v114, v66, 3, v65
 v_add_u32 v113, 98304, v114
 v_mfma_f32_16x16x32_bf16 v[244:247], a[172:175], a[136:139], v[244:247]
 v_add_u32 v115, 64512, v114
 v_accvgpr_write_b32 a0, 0
 v_mfma_f32_16x16x32_bf16 v[252:255], a[172:175], a[140:143], v[252:255]
 s_waitcnt lgkmcnt(15)
 v_accvgpr_write_b32 a1, 0
 v_accvgpr_write_b32 a2, 0
 v_mfma_f32_16x16x32_bf16 v[32:35], a[192:195], a[176:179], v[32:35]
 s_waitcnt vmcnt(8) lgkmcnt(0)
 s_barrier
 v_accvgpr_write_b32 a3, 0
 v_mfma_f32_16x16x32_bf16 v[40:43], a[192:195], a[180:183], v[40:43]
 s_add_u32 m0, s82, 98304
 ds_read_b64_tr_b16 a[144:145], v6 offset:16384
 v_accvgpr_write_b32 a4, 0
 v_mfma_f32_16x16x32_bf16 v[48:51], a[192:195], a[184:187], v[48:51]
 buffer_load_dwordx4 v2, s[24:27], 0 offen offset:0 lds
 v_mfma_f32_16x16x32_bf16 v[56:59], a[192:195], a[188:191], v[56:59]
 ds_read_b64_tr_b16 a[146:147], v6 offset:17408
 v_accvgpr_write_b32 a5, 0
 v_mfma_f32_16x16x32_bf16 v[36:39], a[196:199], a[176:179], v[36:39]
 ds_read_b128 a[128:131], v4 offset:32768
 v_accvgpr_write_b32 a6, 0
 v_mfma_f32_16x16x32_bf16 v[44:47], a[196:199], a[180:183], v[44:47]
 ds_read_b64_tr_b16 a[148:149], v7 offset:16384
 v_accvgpr_write_b32 a7, 0
 v_mfma_f32_16x16x32_bf16 v[52:55], a[196:199], a[184:187], v[52:55]
 buffer_load_dwordx4 v2, s[24:27], s71 offen offset:1024 lds
 v_mfma_f32_16x16x32_bf16 v[60:63], a[196:199], a[188:191], v[60:63]
 ds_read_b64_tr_b16 a[150:151], v7 offset:17408
 v_accvgpr_write_b32 a8, 0
 v_mfma_f32_16x16x32_bf16 v[68:71], a[200:203], a[176:179], v[68:71]
 ds_read_b128 a[132:135], v4 offset:34816
 v_accvgpr_write_b32 a9, 0
 v_mfma_f32_16x16x32_bf16 v[76:79], a[200:203], a[180:183], v[76:79]
 ds_read_b64_tr_b16 a[152:153], v8 offset:16384
 v_accvgpr_write_b32 a10, 0
 v_mfma_f32_16x16x32_bf16 v[84:87], a[200:203], a[184:187], v[84:87]
 buffer_load_dwordx4 v3, s[24:27], s72 offen offset:2048 lds
 v_mfma_f32_16x16x32_bf16 v[92:95], a[200:203], a[188:191], v[92:95]
 ds_read_b64_tr_b16 a[154:155], v8 offset:17408
 v_accvgpr_write_b32 a11, 0
 v_mfma_f32_16x16x32_bf16 v[100:103], a[204:207], a[176:179], v[100:103]
 ds_read_b128 a[136:139], v4 offset:36864
 v_accvgpr_write_b32 a12, 0
 v_mfma_f32_16x16x32_bf16 v[108:111], a[204:207], a[180:183], v[108:111]
 ds_read_b64_tr_b16 a[156:157], v9 offset:16384
 v_accvgpr_write_b32 a13, 0
 v_mfma_f32_16x16x32_bf16 v[116:119], a[204:207], a[184:187], v[116:119]
 buffer_load_dwordx4 v3, s[24:27], s73 offen offset:3072 lds
 v_mfma_f32_16x16x32_bf16 v[124:127], a[204:207], a[188:191], v[124:127]
 ds_read_b64_tr_b16 a[158:159], v9 offset:17408
 v_accvgpr_write_b32 a14, 0
 v_mfma_f32_16x16x32_bf16 v[132:135], a[208:211], a[176:179], v[132:135]
 s_add_u32 s83, s87, 262144
 buffer_store_dwordx4 v[136:139], v14, s[4:7], s83 offen offset:1024
 v_mfma_f32_16x16x32_bf16 v[140:143], a[208:211], a[180:183], v[140:143]
 ds_read_b128 a[140:143], v4 offset:38912
 v_accvgpr_write_b32 a15, 0
 v_mfma_f32_16x16x32_bf16 v[148:151], a[208:211], a[184:187], v[148:151]
 ds_read_b64_tr_b16 a[160:161], v10 offset:16384
 v_add_u32 v2, 0x80000, v2
 v_add_u32 v3, 0x80000, v3
 v_mfma_f32_16x16x32_bf16 v[156:159], a[208:211], a[188:191], v[156:159]
 s_add_u32 m0, s81, 0
 ds_read_b64_tr_b16 a[162:163], v10 offset:17408
 v_accvgpr_write_b32 a16, 0
 v_mfma_f32_16x16x32_bf16 v[164:167], a[212:215], a[176:179], v[164:167]
 buffer_load_dwordx4 v0, s[8:11], 0 offen offset:0 lds
 v_mfma_f32_16x16x32_bf16 v[172:175], a[212:215], a[180:183], v[172:175]
 ds_read_b64_tr_b16 a[164:165], v11 offset:16384
 v_accvgpr_write_b32 a17, 0
 v_mfma_f32_16x16x32_bf16 v[180:183], a[212:215], a[184:187], v[180:183]
 ds_read_b64_tr_b16 a[166:167], v11 offset:17408
 v_accvgpr_write_b32 a18, 0
 v_mfma_f32_16x16x32_bf16 v[188:191], a[212:215], a[188:191], v[188:191]
 ds_read_b64_tr_b16 a[168:169], v12 offset:16384
 v_accvgpr_write_b32 a19, 0
 v_mfma_f32_16x16x32_bf16 v[196:199], a[216:219], a[176:179], v[196:199]
 buffer_load_dwordx4 v1, s[8:11], s74 offen offset:1024 lds
 v_mfma_f32_16x16x32_bf16 v[204:207], a[216:219], a[180:183], v[204:207]
 ds_read_b64_tr_b16 a[170:171], v12 offset:17408
 v_accvgpr_write_b32 a20, 0
 v_mfma_f32_16x16x32_bf16 v[212:215], a[216:219], a[184:187], v[212:215]
 ds_read_b64_tr_b16 a[172:173], v13 offset:16384
 v_accvgpr_write_b32 a21, 0
 v_mfma_f32_16x16x32_bf16 v[220:223], a[216:219], a[188:191], v[220:223]
 ds_read_b64_tr_b16 a[174:175], v13 offset:17408
 v_accvgpr_write_b32 a22, 0
 v_mfma_f32_16x16x32_bf16 v[228:231], a[220:223], a[176:179], v[228:231]
 buffer_load_dwordx4 v0, s[8:11], s75 offen offset:2048 lds
 v_mfma_f32_16x16x32_bf16 v[236:239], a[220:223], a[180:183], v[236:239]
 v_accvgpr_write_b32 a23, 0
 v_accvgpr_write_b32 a24, 0
 v_mfma_f32_16x16x32_bf16 v[244:247], a[220:223], a[184:187], v[244:247]
 v_accvgpr_write_b32 a25, 0
 v_accvgpr_write_b32 a26, 0
 v_mfma_f32_16x16x32_bf16 v[252:255], a[220:223], a[188:191], v[252:255]
 s_waitcnt lgkmcnt(15)
 v_accvgpr_write_b32 a27, 0
 v_accvgpr_write_b32 a28, 0
 v_mfma_f32_16x16x32_bf16 v[32:35], a[144:147], a[128:131], v[32:35]
 s_waitcnt lgkmcnt(14)
 buffer_load_dwordx4 v1, s[8:11], s76 offen offset:3072 lds
 s_add_u32 m0, s81, 4096
 v_mfma_f32_16x16x32_bf16 v[40:43], a[144:147], a[132:135], v[40:43]
 s_waitcnt lgkmcnt(11)
 ds_read_b64_tr_b16 a[192:193], v6 offset:24576
 v_accvgpr_write_b32 a29, 0
 v_mfma_f32_16x16x32_bf16 v[48:51], a[144:147], a[136:139], v[48:51]
 s_waitcnt lgkmcnt(9)
 ds_read_b64_tr_b16 a[194:195], v6 offset:25600
 v_accvgpr_write_b32 a30, 0
 v_mfma_f32_16x16x32_bf16 v[56:59], a[144:147], a[140:143], v[56:59]
 ds_read_b128 a[176:179], v5 offset:32768
 v_accvgpr_write_b32 a31, 0
 v_mfma_f32_16x16x32_bf16 v[36:39], a[148:151], a[128:131], v[36:39]
 buffer_load_dwordx4 v0, s[8:11], s77 offen offset:0 lds
 v_mfma_f32_16x16x32_bf16 v[44:47], a[148:151], a[132:135], v[44:47]
 ds_read_b64_tr_b16 a[196:197], v7 offset:24576
 v_mfma_f32_16x16x32_bf16 v[52:55], a[148:151], a[136:139], v[52:55]
 s_add_u32 s83, s87, 262144
 buffer_store_dwordx4 v[144:147], v14, s[4:7], s83 offen offset:2048
 v_mfma_f32_16x16x32_bf16 v[60:63], a[148:151], a[140:143], v[60:63]
 ds_read_b64_tr_b16 a[198:199], v7 offset:25600
 v_mfma_f32_16x16x32_bf16 v[68:71], a[152:155], a[128:131], v[68:71]
 buffer_load_dwordx4 v1, s[8:11], s78 offen offset:1024 lds
 s_mov_b32 s84, 71311360
 v_mfma_f32_16x16x32_bf16 v[76:79], a[152:155], a[132:135], v[76:79]
 ds_read_b128 a[180:183], v5 offset:34816
 v_mfma_f32_16x16x32_bf16 v[84:87], a[152:155], a[136:139], v[84:87]
 ds_read_b64_tr_b16 a[200:201], v8 offset:24576
 buffer_load_dwordx4 v[120:123], v14, s[4:7], s84 offen offset:0 sc1
 v_mfma_f32_16x16x32_bf16 v[92:95], a[152:155], a[140:143], v[92:95]
 ds_read_b64_tr_b16 a[202:203], v8 offset:25600
 v_mfma_f32_16x16x32_bf16 v[100:103], a[156:159], a[128:131], v[100:103]
 buffer_load_dwordx4 v0, s[8:11], s79 offen offset:2048 lds
 v_mfma_f32_16x16x32_bf16 v[108:111], a[156:159], a[132:135], v[108:111]
 ds_read_b128 a[184:187], v5 offset:36864
 v_mfma_f32_16x16x32_bf16 v[116:119], a[156:159], a[136:139], v[116:119]
 ds_read_b64_tr_b16 a[204:205], v9 offset:24576
 buffer_load_dword v15, v19, s[4:7], 0 offen sc1
 v_mfma_f32_16x16x32_bf16 v[124:127], a[156:159], a[140:143], v[124:127]
 s_waitcnt lgkmcnt(15)
 ds_read_b64_tr_b16 a[206:207], v9 offset:25600
 v_mfma_f32_16x16x32_bf16 v[132:135], a[160:163], a[128:131], v[132:135]
 buffer_load_dwordx4 v1, s[8:11], s80 offen offset:3072 lds
 v_mfma_f32_16x16x32_bf16 v[140:143], a[160:163], a[132:135], v[140:143]
 ds_read_b128 a[188:191], v5 offset:38912
 v_mfma_f32_16x16x32_bf16 v[148:151], a[160:163], a[136:139], v[148:151]
 ds_read_b64_tr_b16 a[208:209], v10 offset:24576
 buffer_load_dwordx4 v[128:131], v14, s[4:7], s84 offen offset:1024 sc1
 v_mfma_f32_16x16x32_bf16 v[156:159], a[160:163], a[140:143], v[156:159]
 s_waitcnt lgkmcnt(15)
 ds_read_b64_tr_b16 a[210:211], v10 offset:25600
 v_mfma_f32_16x16x32_bf16 v[164:167], a[164:167], a[128:131], v[164:167]
 ds_read_b64_tr_b16 a[212:213], v11 offset:24576
 v_add_u32 v0, 0x80, v0
 v_add_u32 v1, 0x80, v1
 v_mfma_f32_16x16x32_bf16 v[172:175], a[164:167], a[132:135], v[172:175]
 ds_read_b64_tr_b16 a[214:215], v11 offset:25600
 v_mfma_f32_16x16x32_bf16 v[180:183], a[164:167], a[136:139], v[180:183]
 ds_read_b64_tr_b16 a[216:217], v12 offset:24576
 v_mfma_f32_16x16x32_bf16 v[188:191], a[164:167], a[140:143], v[188:191]
 ds_read_b64_tr_b16 a[218:219], v12 offset:25600
 v_mfma_f32_16x16x32_bf16 v[196:199], a[168:171], a[128:131], v[196:199]
 ds_read_b64_tr_b16 a[220:221], v13 offset:24576
 buffer_load_dwordx4 v[136:139], v14, s[4:7], s84 offen offset:2048 sc1
 v_mfma_f32_16x16x32_bf16 v[204:207], a[168:171], a[132:135], v[204:207]
 ds_read_b64_tr_b16 a[222:223], v13 offset:25600
 v_mfma_f32_16x16x32_bf16 v[212:215], a[168:171], a[136:139], v[212:215]
 v_mfma_f32_16x16x32_bf16 v[220:223], a[168:171], a[140:143], v[220:223]
 s_waitcnt lgkmcnt(15)
 s_add_u32 s83, s87, 262144
 buffer_store_dwordx4 v[152:155], v14, s[4:7], s83 offen offset:3072
 v_mfma_f32_16x16x32_bf16 v[228:231], a[172:175], a[128:131], v[228:231]
 v_mfma_f32_16x16x32_bf16 v[236:239], a[172:175], a[132:135], v[236:239]
 v_mfma_f32_16x16x32_bf16 v[244:247], a[172:175], a[136:139], v[244:247]
 buffer_load_dwordx4 v[144:147], v14, s[4:7], s84 offen offset:3072 sc1
 v_mfma_f32_16x16x32_bf16 v[252:255], a[172:175], a[140:143], v[252:255]
 v_mfma_f32_16x16x32_bf16 v[32:35], a[192:195], a[176:179], v[32:35]
 s_waitcnt vmcnt(22) lgkmcnt(0)
 s_barrier
 v_mfma_f32_16x16x32_bf16 v[40:43], a[192:195], a[180:183], v[40:43]
 s_add_u32 m0, s82, 114688
 ds_read_b64_tr_b16 a[144:145], v6 offset:32768
 v_mfma_f32_16x16x32_bf16 v[48:51], a[192:195], a[184:187], v[48:51]
 buffer_load_dwordx4 v2, s[24:27], 0 offen offset:0 lds
 v_mfma_f32_16x16x32_bf16 v[56:59], a[192:195], a[188:191], v[56:59]
 ds_read_b64_tr_b16 a[146:147], v6 offset:33792
 v_mfma_f32_16x16x32_bf16 v[36:39], a[196:199], a[176:179], v[36:39]
 ds_read_b128 a[128:131], v16 offset:0
 v_mfma_f32_16x16x32_bf16 v[44:47], a[196:199], a[180:183], v[44:47]
 ds_read_b64_tr_b16 a[148:149], v7 offset:32768
 v_mfma_f32_16x16x32_bf16 v[52:55], a[196:199], a[184:187], v[52:55]
 buffer_load_dwordx4 v2, s[24:27], s71 offen offset:1024 lds
 v_mfma_f32_16x16x32_bf16 v[60:63], a[196:199], a[188:191], v[60:63]
 ds_read_b64_tr_b16 a[150:151], v7 offset:33792
 v_mfma_f32_16x16x32_bf16 v[68:71], a[200:203], a[176:179], v[68:71]
 ds_read_b128 a[132:135], v16 offset:2048
 v_mfma_f32_16x16x32_bf16 v[76:79], a[200:203], a[180:183], v[76:79]
 ds_read_b64_tr_b16 a[152:153], v8 offset:32768
 v_mfma_f32_16x16x32_bf16 v[84:87], a[200:203], a[184:187], v[84:87]
 buffer_load_dwordx4 v3, s[24:27], s72 offen offset:2048 lds
 v_mfma_f32_16x16x32_bf16 v[92:95], a[200:203], a[188:191], v[92:95]
 ds_read_b64_tr_b16 a[154:155], v8 offset:33792
 v_mfma_f32_16x16x32_bf16 v[100:103], a[204:207], a[176:179], v[100:103]
 ds_read_b128 a[136:139], v16 offset:4096
 v_mfma_f32_16x16x32_bf16 v[108:111], a[204:207], a[180:183], v[108:111]
 ds_read_b64_tr_b16 a[156:157], v9 offset:32768
 v_mfma_f32_16x16x32_bf16 v[116:119], a[204:207], a[184:187], v[116:119]
 buffer_load_dwordx4 v3, s[24:27], s73 offen offset:3072 lds
 v_mfma_f32_16x16x32_bf16 v[124:127], a[204:207], a[188:191], v[124:127]
 ds_read_b64_tr_b16 a[158:159], v9 offset:33792
 v_mfma_f32_16x16x32_bf16 v[132:135], a[208:211], a[176:179], v[132:135]
 ds_read_b128 a[140:143], v16 offset:6144
 v_mfma_f32_16x16x32_bf16 v[140:143], a[208:211], a[180:183], v[140:143]
 ds_read_b64_tr_b16 a[160:161], v10 offset:32768
 v_mfma_f32_16x16x32_bf16 v[148:151], a[208:211], a[184:187], v[148:151]
 s_add_u32 s83, s87, 266240
 buffer_store_dwordx4 v[160:163], v14, s[4:7], s83 offen offset:0
 v_add_u32 v2, 0x80000, v2
 v_add_u32 v3, 0x80000, v3
 v_mfma_f32_16x16x32_bf16 v[156:159], a[208:211], a[188:191], v[156:159]
 s_add_u32 m0, s81, 32768
 ds_read_b64_tr_b16 a[162:163], v10 offset:33792
 v_mfma_f32_16x16x32_bf16 v[164:167], a[212:215], a[176:179], v[164:167]
 buffer_load_dwordx4 v0, s[8:11], 0 offen offset:0 lds
 v_mfma_f32_16x16x32_bf16 v[172:175], a[212:215], a[180:183], v[172:175]
 ds_read_b64_tr_b16 a[164:165], v11 offset:32768
 v_mfma_f32_16x16x32_bf16 v[180:183], a[212:215], a[184:187], v[180:183]
 ds_read_b64_tr_b16 a[166:167], v11 offset:33792
 v_mfma_f32_16x16x32_bf16 v[188:191], a[212:215], a[188:191], v[188:191]
 ds_read_b64_tr_b16 a[168:169], v12 offset:32768
 v_mfma_f32_16x16x32_bf16 v[196:199], a[216:219], a[176:179], v[196:199]
 buffer_load_dwordx4 v1, s[8:11], s74 offen offset:1024 lds
 v_mfma_f32_16x16x32_bf16 v[204:207], a[216:219], a[180:183], v[204:207]
 ds_read_b64_tr_b16 a[170:171], v12 offset:33792
 v_mfma_f32_16x16x32_bf16 v[212:215], a[216:219], a[184:187], v[212:215]
 ds_read_b64_tr_b16 a[172:173], v13 offset:32768
 v_mfma_f32_16x16x32_bf16 v[220:223], a[216:219], a[188:191], v[220:223]
 ds_read_b64_tr_b16 a[174:175], v13 offset:33792
 v_mfma_f32_16x16x32_bf16 v[228:231], a[220:223], a[176:179], v[228:231]
 buffer_load_dwordx4 v0, s[8:11], s75 offen offset:2048 lds
 v_mfma_f32_16x16x32_bf16 v[236:239], a[220:223], a[180:183], v[236:239]
 v_mfma_f32_16x16x32_bf16 v[244:247], a[220:223], a[184:187], v[244:247]
 v_mfma_f32_16x16x32_bf16 v[252:255], a[220:223], a[188:191], v[252:255]
 s_waitcnt lgkmcnt(15)
 v_mfma_f32_16x16x32_bf16 v[32:35], a[144:147], a[128:131], v[32:35]
 s_waitcnt lgkmcnt(14)
 buffer_load_dwordx4 v1, s[8:11], s76 offen offset:3072 lds
 s_add_u32 m0, s81, 36864
 v_mfma_f32_16x16x32_bf16 v[40:43], a[144:147], a[132:135], v[40:43]
 s_waitcnt lgkmcnt(11)
 ds_read_b64_tr_b16 a[192:193], v6 offset:40960
 v_mfma_f32_16x16x32_bf16 v[48:51], a[144:147], a[136:139], v[48:51]
 s_waitcnt lgkmcnt(9)
 ds_read_b64_tr_b16 a[194:195], v6 offset:41984
 v_mfma_f32_16x16x32_bf16 v[56:59], a[144:147], a[140:143], v[56:59]
 ds_read_b128 a[176:179], v17 offset:0
 v_mfma_f32_16x16x32_bf16 v[36:39], a[148:151], a[128:131], v[36:39]
 buffer_load_dwordx4 v0, s[8:11], s77 offen offset:0 lds
 v_mfma_f32_16x16x32_bf16 v[44:47], a[148:151], a[132:135], v[44:47]
 ds_read_b64_tr_b16 a[196:197], v7 offset:40960
 v_mfma_f32_16x16x32_bf16 v[52:55], a[148:151], a[136:139], v[52:55]
 ds_read_b64_tr_b16 a[198:199], v7 offset:41984
 v_mfma_f32_16x16x32_bf16 v[60:63], a[148:151], a[140:143], v[60:63]
 ds_read_b128 a[180:183], v17 offset:2048
 v_mfma_f32_16x16x32_bf16 v[68:71], a[152:155], a[128:131], v[68:71]
 buffer_load_dwordx4 v1, s[8:11], s78 offen offset:1024 lds
 v_mfma_f32_16x16x32_bf16 v[76:79], a[152:155], a[132:135], v[76:79]
 ds_read_b64_tr_b16 a[200:201], v8 offset:40960
 v_mfma_f32_16x16x32_bf16 v[84:87], a[152:155], a[136:139], v[84:87]
 s_add_u32 s83, s87, 266240
 buffer_store_dwordx4 v[168:171], v14, s[4:7], s83 offen offset:1024
 v_mfma_f32_16x16x32_bf16 v[92:95], a[152:155], a[140:143], v[92:95]
 ds_read_b64_tr_b16 a[202:203], v8 offset:41984
 v_mfma_f32_16x16x32_bf16 v[100:103], a[156:159], a[128:131], v[100:103]
 buffer_load_dwordx4 v0, s[8:11], s79 offen offset:2048 lds
 v_mfma_f32_16x16x32_bf16 v[108:111], a[156:159], a[132:135], v[108:111]
 ds_read_b128 a[184:187], v17 offset:4096
 v_mfma_f32_16x16x32_bf16 v[116:119], a[156:159], a[136:139], v[116:119]
 ds_read_b64_tr_b16 a[204:205], v9 offset:40960
 v_mfma_f32_16x16x32_bf16 v[124:127], a[156:159], a[140:143], v[124:127]
 s_waitcnt lgkmcnt(15)
 v_mfma_f32_16x16x32_bf16 v[132:135], a[160:163], a[128:131], v[132:135]
 buffer_load_dwordx4 v1, s[8:11], s80 offen offset:3072 lds
 v_mfma_f32_16x16x32_bf16 v[140:143], a[160:163], a[132:135], v[140:143]
 s_waitcnt vmcnt(21)
 ds_read_b64_tr_b16 a[206:207], v9 offset:41984
 v_max3_u32 v120, v120, v121, v122
 v_mfma_f32_16x16x32_bf16 v[148:151], a[160:163], a[136:139], v[148:151]
 s_waitcnt vmcnt(17)
 ds_read_b128 a[188:191], v17 offset:6144
 v_max3_u32 v120, v120, v123, v128
 v_mfma_f32_16x16x32_bf16 v[156:159], a[160:163], a[140:143], v[156:159]
 s_waitcnt lgkmcnt(15)
 ds_read_b64_tr_b16 a[208:209], v10 offset:40960
 v_max3_u32 v120, v120, v129, v130
 v_mfma_f32_16x16x32_bf16 v[164:167], a[164:167], a[128:131], v[164:167]
 ds_read_b64_tr_b16 a[210:211], v10 offset:41984
 v_add_u32 v0, 0x80, v0
 v_add_u32 v1, 0x80, v1
 v_mfma_f32_16x16x32_bf16 v[172:175], a[164:167], a[132:135], v[172:175]
 s_waitcnt vmcnt(16)
 ds_read_b64_tr_b16 a[212:213], v11 offset:40960
 v_max3_u32 v120, v120, v131, v136
 v_mfma_f32_16x16x32_bf16 v[180:183], a[164:167], a[136:139], v[180:183]
 ds_read_b64_tr_b16 a[214:215], v11 offset:41984
 v_max3_u32 v120, v120, v137, v138
 v_mfma_f32_16x16x32_bf16 v[188:191], a[164:167], a[140:143], v[188:191]
 s_waitcnt vmcnt(14) lgkmcnt(15)
 ds_read_b64_tr_b16 a[216:217], v12 offset:40960
 v_max3_u32 v120, v120, v139, v144
 v_mfma_f32_16x16x32_bf16 v[196:199], a[168:171], a[128:131], v[196:199]
 ds_read_b64_tr_b16 a[218:219], v12 offset:41984
 v_max3_u32 v120, v120, v145, v146
 v_mfma_f32_16x16x32_bf16 v[204:207], a[168:171], a[132:135], v[204:207]
 ds_read_b64_tr_b16 a[220:221], v13 offset:40960
 v_max_u32 v120, v120, v147
 v_mfma_f32_16x16x32_bf16 v[212:215], a[168:171], a[136:139], v[212:215]
 ds_read_b64_tr_b16 a[222:223], v13 offset:41984
 v_max_u32_dpp v120, v120, v120 quad_perm:[1,0,3,2] row_mask:0xf bank_mask:0xf
 v_mfma_f32_16x16x32_bf16 v[220:223], a[168:171], a[140:143], v[220:223]
 s_nop 0
 v_max_u32_dpp v120, v120, v120 quad_perm:[2,3,0,1] row_mask:0xf bank_mask:0xf
 s_nop 1
 v_max_u32_dpp v120, v120, v120 row_half_mirror row_mask:0xf bank_mask:0xf
 v_mfma_f32_16x16x32_bf16 v[228:231], a[172:175], a[128:131], v[228:231]
 s_nop 0
 v_max_u32_dpp v120, v120, v120 row_mirror row_mask:0xf bank_mask:0xf
 v_mov_b32 v121, v120
 v_mfma_f32_16x16x32_bf16 v[236:239], a[172:175], a[132:135], v[236:239]
 s_nop 0
 v_permlane32_swap_b32 v120, v121
 v_max_u32 v120, v120, v121
 v_mfma_f32_16x16x32_bf16 v[244:247], a[172:175], a[136:139], v[244:247]
 v_mov_b32 v121, v120
 s_nop 1
 v_permlane16_swap_b32 v120, v121
 v_mfma_f32_16x16x32_bf16 v[252:255], a[172:175], a[140:143], v[252:255]
 s_waitcnt lgkmcnt(15)
 s_add_u32 s83, s87, 266240
 buffer_store_dwordx4 v[176:179], v14, s[4:7], s83 offen offset:2048
 v_mfma_f32_16x16x32_bf16 v[32:35], a[192:195], a[176:179], v[32:35]
 s_waitcnt lgkmcnt(0)
 s_barrier
 v_max_u32 v120, v120, v121
 v_mfma_f32_16x16x32_bf16 v[40:43], a[192:195], a[180:183], v[40:43]
 s_add_u32 m0, s82, 131072
 ds_read_b64_tr_b16 a[144:145], v6 offset:0
 v_and_b32 v121, 0x7ff, v120
 v_mfma_f32_16x16x32_bf16 v[48:51], a[192:195], a[184:187], v[48:51]
 buffer_load_dwordx4 v2, s[24:27], 0 offen offset:0 lds
 v_mfma_f32_16x16x32_bf16 v[56:59], a[192:195], a[188:191], v[56:59]
 ds_read_b64_tr_b16 a[146:147], v6 offset:1024
 v_sub_u32 v121, 0x7ff, v121
 v_mfma_f32_16x16x32_bf16 v[36:39], a[196:199], a[176:179], v[36:39]
 ds_read_b128 a[128:131], v4 offset:0
 v_and_b32 v120, 0xfffff800, v120
 v_mfma_f32_16x16x32_bf16 v[44:47], a[196:199], a[180:183], v[44:47]
 ds_read_b64_tr_b16 a[148:149], v7 offset:0
 v_readfirstlane_b32 s93, v121
 v_mfma_f32_16x16x32_bf16 v[52:55], a[196:199], a[184:187], v[52:55]
 buffer_load_dwordx4 v2, s[24:27], s71 offen offset:1024 lds
 v_mfma_f32_16x16x32_bf16 v[60:63], a[196:199], a[188:191], v[60:63]
 ds_read_b64_tr_b16 a[150:151], v7 offset:1024
 v_not_b32 v122, v120
 v_mfma_f32_16x16x32_bf16 v[68:71], a[200:203], a[176:179], v[68:71]
 ds_read_b128 a[132:135], v4 offset:2048
 v_ashrrev_i32 v122, 31, v122
 v_mfma_f32_16x16x32_bf16 v[76:79], a[200:203], a[180:183], v[76:79]
 ds_read_b64_tr_b16 a[152:153], v8 offset:0
 v_or_b32 v122, 0x80000000, v122
 v_mfma_f32_16x16x32_bf16 v[84:87], a[200:203], a[184:187], v[84:87]
 buffer_load_dwordx4 v3, s[24:27], s72 offen offset:2048 lds
 v_mfma_f32_16x16x32_bf16 v[92:95], a[200:203], a[188:191], v[92:95]
 ds_read_b64_tr_b16 a[154:155], v8 offset:1024
 v_xor_b32 v120, v120, v122
 v_mfma_f32_16x16x32_bf16 v[100:103], a[204:207], a[176:179], v[100:103]
 ds_read_b128 a[136:139], v4 offset:4096
 v_mul_f32 v120, 0xbfb8aa3b, v120
 v_mfma_f32_16x16x32_bf16 v[108:111], a[204:207], a[180:183], v[108:111]
 ds_read_b64_tr_b16 a[156:157], v9 offset:0
 v_mfma_f32_16x16x32_bf16 v[116:119], a[204:207], a[184:187], v[116:119]
 buffer_load_dwordx4 v3, s[24:27], s73 offen offset:3072 lds
 v_mfma_f32_16x16x32_bf16 v[124:127], a[204:207], a[188:191], v[124:127]
 ds_read_b64_tr_b16 a[158:159], v9 offset:1024
 v_mfma_f32_16x16x32_bf16 v[132:135], a[208:211], a[176:179], v[132:135]
 ds_read_b128 a[140:143], v4 offset:6144
 v_mfma_f32_16x16x32_bf16 v[140:143], a[208:211], a[180:183], v[140:143]
 ds_read_b64_tr_b16 a[160:161], v10 offset:0
 v_mfma_f32_16x16x32_bf16 v[148:151], a[208:211], a[184:187], v[148:151]
 ds_read_b64_tr_b16 a[162:163], v10 offset:1024
 v_add_u32 v2, 0x80000, v2
 v_add_u32 v3, 0x80000, v3
 v_mfma_f32_16x16x32_bf16 v[156:159], a[208:211], a[188:191], v[156:159]
 s_add_u32 m0, s81, 65536
 ds_read_b64_tr_b16 a[164:165], v11 offset:0
 v_mfma_f32_16x16x32_bf16 v[164:167], a[212:215], a[176:179], v[164:167]
 buffer_load_dwordx4 v0, s[8:11], 0 offen offset:0 lds
 v_mfma_f32_16x16x32_bf16 v[172:175], a[212:215], a[180:183], v[172:175]
 ds_read_b64_tr_b16 a[166:167], v11 offset:1024
 v_mfma_f32_16x16x32_bf16 v[180:183], a[212:215], a[184:187], v[180:183]
 s_add_u32 s83, s87, 266240
 buffer_store_dwordx4 v[184:187], v14, s[4:7], s83 offen offset:3072
 v_mfma_f32_16x16x32_bf16 v[188:191], a[212:215], a[188:191], v[188:191]
 ds_read_b64_tr_b16 a[168:169], v12 offset:0
 v_mfma_f32_16x16x32_bf16 v[196:199], a[216:219], a[176:179], v[196:199]
 buffer_load_dwordx4 v1, s[8:11], s74 offen offset:1024 lds
 v_mfma_f32_16x16x32_bf16 v[204:207], a[216:219], a[180:183], v[204:207]
 ds_read_b64_tr_b16 a[170:171], v12 offset:1024
 v_mfma_f32_16x16x32_bf16 v[212:215], a[216:219], a[184:187], v[212:215]
 ds_read_b64_tr_b16 a[172:173], v13 offset:0
 v_mfma_f32_16x16x32_bf16 v[220:223], a[216:219], a[188:191], v[220:223]
 ds_read_b64_tr_b16 a[174:175], v13 offset:1024
 v_mfma_f32_16x16x32_bf16 v[228:231], a[220:223], a[176:179], v[228:231]
 buffer_load_dwordx4 v0, s[8:11], s75 offen offset:2048 lds
 v_mfma_f32_16x16x32_bf16 v[236:239], a[220:223], a[180:183], v[236:239]
 v_exp_f32 v120, v120
 v_mfma_f32_16x16x32_bf16 v[244:247], a[220:223], a[184:187], v[244:247]
 v_add_f32 v120, 1.0, v120
 v_mfma_f32_16x16x32_bf16 v[252:255], a[220:223], a[188:191], v[252:255]
 s_waitcnt lgkmcnt(15)
 v_rcp_f32 v120, v120
 v_mfma_f32_16x16x32_bf16 v[32:35], a[144:147], a[128:131], v[32:35]
 s_waitcnt lgkmcnt(14)
 buffer_load_dwordx4 v1, s[8:11], s76 offen offset:3072 lds
 s_add_u32 m0, s81, 69632
 v_mfma_f32_16x16x32_bf16 v[40:43], a[144:147], a[132:135], v[40:43]
 s_waitcnt lgkmcnt(11)
 ds_read_b64_tr_b16 a[192:193], v6 offset:8192
 v_readfirstlane_b32 s23, v120
 v_mfma_f32_16x16x32_bf16 v[48:51], a[144:147], a[136:139], v[48:51]
 s_waitcnt lgkmcnt(9)
 ds_read_b64_tr_b16 a[194:195], v6 offset:9216
 v_mov_b32 v120, 0
 v_mfma_f32_16x16x32_bf16 v[56:59], a[144:147], a[140:143], v[56:59]
 ds_read_b128 a[176:179], v5 offset:0
 v_mov_b32 v121, 0
 v_mfma_f32_16x16x32_bf16 v[36:39], a[148:151], a[128:131], v[36:39]
 buffer_load_dwordx4 v0, s[8:11], s77 offen offset:0 lds
 v_mfma_f32_16x16x32_bf16 v[44:47], a[148:151], a[132:135], v[44:47]
 ds_read_b64_tr_b16 a[196:197], v7 offset:8192
 v_mov_b32 v122, 0
 v_mfma_f32_16x16x32_bf16 v[52:55], a[148:151], a[136:139], v[52:55]
 ds_read_b64_tr_b16 a[198:199], v7 offset:9216
 v_mov_b32 v123, 0
 v_mfma_f32_16x16x32_bf16 v[60:63], a[148:151], a[140:143], v[60:63]
 ds_read_b128 a[180:183], v5 offset:2048
 v_mov_b32 v128, 0
 v_mfma_f32_16x16x32_bf16 v[68:71], a[152:155], a[128:131], v[68:71]
 buffer_load_dwordx4 v1, s[8:11], s78 offen offset:1024 lds
 v_mfma_f32_16x16x32_bf16 v[76:79], a[152:155], a[132:135], v[76:79]
 ds_read_b64_tr_b16 a[200:201], v8 offset:8192
 v_mov_b32 v129, 0
 v_mfma_f32_16x16x32_bf16 v[84:87], a[152:155], a[136:139], v[84:87]
 ds_read_b64_tr_b16 a[202:203], v8 offset:9216
 v_mov_b32 v130, 0
 v_mfma_f32_16x16x32_bf16 v[92:95], a[152:155], a[140:143], v[92:95]
 ds_read_b128 a[184:187], v5 offset:4096
 v_mov_b32 v131, 0
 v_mfma_f32_16x16x32_bf16 v[100:103], a[156:159], a[128:131], v[100:103]
 buffer_load_dwordx4 v0, s[8:11], s79 offen offset:2048 lds
 v_mfma_f32_16x16x32_bf16 v[108:111], a[156:159], a[132:135], v[108:111]
 ds_read_b64_tr_b16 a[204:205], v9 offset:8192
 v_mov_b32 v136, 0
 v_mfma_f32_16x16x32_bf16 v[116:119], a[156:159], a[136:139], v[116:119]
 s_add_u32 s83, s87, 393216
 buffer_store_dwordx4 v[192:195], v14, s[4:7], s83 offen offset:0
 v_mfma_f32_16x16x32_bf16 v[124:127], a[156:159], a[140:143], v[124:127]
 s_waitcnt lgkmcnt(15)
 v_mov_b32 v137, 0
 v_mov_b32 v138, 0
 v_mfma_f32_16x16x32_bf16 v[132:135], a[160:163], a[128:131], v[132:135]
 buffer_load_dwordx4 v1, s[8:11], s80 offen offset:3072 lds
 v_mfma_f32_16x16x32_bf16 v[140:143], a[160:163], a[132:135], v[140:143]
 ds_read_b64_tr_b16 a[206:207], v9 offset:9216
 v_mov_b32 v139, 0
 v_mfma_f32_16x16x32_bf16 v[148:151], a[160:163], a[136:139], v[148:151]
 ds_read_b128 a[188:191], v5 offset:6144
 v_mov_b32 v144, 0
 v_mfma_f32_16x16x32_bf16 v[156:159], a[160:163], a[140:143], v[156:159]
 s_waitcnt lgkmcnt(15)
 ds_read_b64_tr_b16 a[208:209], v10 offset:8192
 v_mov_b32 v145, 0
 v_mfma_f32_16x16x32_bf16 v[164:167], a[164:167], a[128:131], v[164:167]
 ds_read_b64_tr_b16 a[210:211], v10 offset:9216
 v_mov_b32 v146, 0
 v_mfma_f32_16x16x32_bf16 v[172:175], a[164:167], a[132:135], v[172:175]
 ds_read_b64_tr_b16 a[212:213], v11 offset:8192
 v_mov_b32 v147, 0
 v_mfma_f32_16x16x32_bf16 v[180:183], a[164:167], a[136:139], v[180:183]
 ds_read_b64_tr_b16 a[214:215], v11 offset:9216
 v_mfma_f32_16x16x32_bf16 v[188:191], a[164:167], a[140:143], v[188:191]
 s_waitcnt lgkmcnt(15)
 ds_read_b64_tr_b16 a[216:217], v12 offset:8192
 v_mfma_f32_16x16x32_bf16 v[196:199], a[168:171], a[128:131], v[196:199]
 ds_read_b64_tr_b16 a[218:219], v12 offset:9216
 v_mfma_f32_16x16x32_bf16 v[204:207], a[168:171], a[132:135], v[204:207]
 ds_read_b64_tr_b16 a[220:221], v13 offset:8192
 v_mfma_f32_16x16x32_bf16 v[212:215], a[168:171], a[136:139], v[212:215]
 ds_read_b64_tr_b16 a[222:223], v13 offset:9216
 v_cmp_eq_u32 vcc, 1, v15
 s_and_b32 s94, vcc_lo, 255
 s_cmp_eq_u32 s94, 255
 s_cbranch_scc0 L_spin_108
L_back_107:
 s_cmp_eq_u32 s1, 0
 s_cbranch_scc1 L_fence_109
L_back_110:
 v_mfma_f32_16x16x32_bf16 v[220:223], a[168:171], a[140:143], v[220:223]
 s_lshl_b32 s64, s3, 19
 v_mfma_f32_16x16x32_bf16 v[228:231], a[172:175], a[128:131], v[228:231]
 s_add_u32 s64, s64, s82
 v_mfma_f32_16x16x32_bf16 v[236:239], a[172:175], a[132:135], v[236:239]
 s_add_u32 s65, s64, 16777216
 v_mfma_f32_16x16x32_bf16 v[244:247], a[172:175], a[136:139], v[244:247]
 s_mov_b32 s66, 0
 v_mfma_f32_16x16x32_bf16 v[252:255], a[172:175], a[140:143], v[252:255]
 s_waitcnt lgkmcnt(15)
 v_mfma_f32_16x16x32_bf16 v[32:35], a[192:195], a[176:179], v[32:35]
 s_waitcnt vmcnt(15) lgkmcnt(0)
 s_barrier
 v_mfma_f32_16x16x32_bf16 v[40:43], a[192:195], a[180:183], v[40:43]
 s_add_u32 m0, s82, 0
 ds_read_b64_tr_b16 a[144:145], v6 offset:16384
 v_mfma_f32_16x16x32_bf16 v[48:51], a[192:195], a[184:187], v[48:51]
 buffer_load_dwordx4 v14, s[4:7], s64 offen offset:0 sc1 lds
 v_mfma_f32_16x16x32_bf16 v[56:59], a[192:195], a[188:191], v[56:59]
 ds_read_b64_tr_b16 a[146:147], v6 offset:17408
 v_mfma_f32_16x16x32_bf16 v[36:39], a[196:199], a[176:179], v[36:39]
 s_add_u32 s83, s87, 393216
 buffer_store_dwordx4 v[200:203], v14, s[4:7], s83 offen offset:1024
 s_cmp_ge_u32 s2, 112
 s_cselect_b32 s24, s70, 0x40000000
 v_mfma_f32_16x16x32_bf16 v[44:47], a[196:199], a[180:183], v[44:47]
 s_mov_b32 s26, 98304
 ds_read_b128 a[128:131], v4 offset:32768
 v_mfma_f32_16x16x32_bf16 v[52:55], a[196:199], a[184:187], v[52:55]
 s_mov_b32 s25, 0
 ds_read_b64_tr_b16 a[148:149], v7 offset:16384
 v_mfma_f32_16x16x32_bf16 v[60:63], a[196:199], a[188:191], v[60:63]
 s_mul_i32 s27, s70, 576
 buffer_load_dwordx4 v14, s[4:7], s64 offen offset:1024 sc1 lds
 v_mfma_f32_16x16x32_bf16 v[68:71], a[200:203], a[176:179], v[68:71]
 s_mul_i32 s20, s60, 288
 ds_read_b64_tr_b16 a[150:151], v7 offset:17408
 v_mfma_f32_16x16x32_bf16 v[76:79], a[200:203], a[180:183], v[76:79]
 s_add_u32 s27, s27, s20
 ds_read_b128 a[132:135], v4 offset:34816
 v_mfma_f32_16x16x32_bf16 v[84:87], a[200:203], a[184:187], v[84:87]
 ds_read_b64_tr_b16 a[152:153], v8 offset:16384
 v_mfma_f32_16x16x32_bf16 v[92:95], a[200:203], a[188:191], v[92:95]
 ds_read_b64_tr_b16 a[154:155], v8 offset:17408
 v_mfma_f32_16x16x32_bf16 v[100:103], a[204:207], a[176:179], v[100:103]
 buffer_load_dwordx4 v14, s[4:7], s64 offen offset:2048 sc1 lds
 v_mfma_f32_16x16x32_bf16 v[108:111], a[204:207], a[180:183], v[108:111]
 ds_read_b128 a[136:139], v4 offset:36864
 v_mfma_f32_16x16x32_bf16 v[116:119], a[204:207], a[184:187], v[116:119]
 ds_read_b64_tr_b16 a[156:157], v9 offset:16384
 v_mfma_f32_16x16x32_bf16 v[124:127], a[204:207], a[188:191], v[124:127]
 ds_read_b64_tr_b16 a[158:159], v9 offset:17408
 v_mfma_f32_16x16x32_bf16 v[132:135], a[208:211], a[176:179], v[132:135]
 ds_read_b128 a[140:143], v4 offset:38912
 v_mfma_f32_16x16x32_bf16 v[140:143], a[208:211], a[180:183], v[140:143]
 buffer_load_dwordx4 v14, s[4:7], s64 offen offset:3072 sc1 lds
 s_add_u32 s64, s64, 16384
 v_mfma_f32_16x16x32_bf16 v[148:151], a[208:211], a[184:187], v[148:151]
 ds_read_b64_tr_b16 a[160:161], v10 offset:16384
 v_mfma_f32_16x16x32_bf16 v[156:159], a[208:211], a[188:191], v[156:159]
 ds_read_b64_tr_b16 a[162:163], v10 offset:17408
 v_mfma_f32_16x16x32_bf16 v[164:167], a[212:215], a[176:179], v[164:167]
 ds_read_b64_tr_b16 a[164:165], v11 offset:16384
 v_mfma_f32_16x16x32_bf16 v[172:175], a[212:215], a[180:183], v[172:175]
 ds_read_b64_tr_b16 a[166:167], v11 offset:17408
 v_mfma_f32_16x16x32_bf16 v[180:183], a[212:215], a[184:187], v[180:183]
 ds_read_b64_tr_b16 a[168:169], v12 offset:16384
 v_mfma_f32_16x16x32_bf16 v[188:191], a[212:215], a[188:191], v[188:191]
 ds_read_b64_tr_b16 a[170:171], v12 offset:17408
 v_mfma_f32_16x16x32_bf16 v[196:199], a[216:219], a[176:179], v[196:199]
 ds_read_b64_tr_b16 a[172:173], v13 offset:16384
 v_mfma_f32_16x16x32_bf16 v[204:207], a[216:219], a[180:183], v[204:207]
 ds_read_b64_tr_b16 a[174:175], v13 offset:17408
 v_mfma_f32_16x16x32_bf16 v[212:215], a[216:219], a[184:187], v[212:215]
 s_add_u32 s83, s87, 393216
 buffer_store_dwordx4 v[208:211], v14, s[4:7], s83 offen offset:2048
 v_mfma_f32_16x16x32_bf16 v[220:223], a[216:219], a[188:191], v[220:223]
 s_and_b32 s94, s60, 1
 s_lshl_b32 s94, s94, 6
 v_lshrrev_b32 v64, 6, v14
 v_add_u32 v64, s94, v64
 v_mfma_f32_16x16x32_bf16 v[228:231], a[220:223], a[176:179], v[228:231]
 v_mul_u32_u24 v64, 0x2400, v64
 v_lshrrev_b32 v65, 4, v14
 v_mfma_f32_16x16x32_bf16 v[236:239], a[220:223], a[180:183], v[236:239]
 v_and_b32 v65, 32, v65
 v_xor_b32 v65, v65, v14
 v_mfma_f32_16x16x32_bf16 v[244:247], a[220:223], a[184:187], v[244:247]
 v_and_b32 v65, 0x30, v65
 v_add_u32 v0, v64, v65
 v_mfma_f32_16x16x32_bf16 v[252:255], a[220:223], a[188:191], v[252:255]
 s_waitcnt lgkmcnt(15)
 v_lshrrev_b32 v64, 8, v14
 v_lshlrev_b32 v2, 4, v64
 v_mfma_f32_16x16x32_bf16 v[32:35], a[144:147], a[128:131], v[32:35]
 s_waitcnt lgkmcnt(14)
 ds_read_b64_tr_b16 a[192:193], v6 offset:24576
 v_add_u32 v2, 147456, v2
 v_mfma_f32_16x16x32_bf16 v[40:43], a[144:147], a[132:135], v[40:43]
 s_waitcnt lgkmcnt(12)
 ds_read_b64_tr_b16 a[194:195], v6 offset:25600
 v_xor_b32 v65, s60, v64
 v_mfma_f32_16x16x32_bf16 v[48:51], a[144:147], a[136:139], v[48:51]
 s_waitcnt lgkmcnt(10)
 ds_read_b128 a[176:179], v5 offset:32768
 v_and_b32 v65, 1, v65
 v_mfma_f32_16x16x32_bf16 v[56:59], a[144:147], a[140:143], v[56:59]
 v_lshlrev_b32 v65, 5, v65
 v_lshl_add_u32 v65, v64, 9, v65
 v_mfma_f32_16x16x32_bf16 v[36:39], a[148:151], a[128:131], v[36:39]
 ds_read_b64_tr_b16 a[196:197], v7 offset:24576
 v_and_b32 v64, 0xc0, v14
 v_mfma_f32_16x16x32_bf16 v[44:47], a[148:151], a[132:135], v[44:47]
 ds_read_b64_tr_b16 a[198:199], v7 offset:25600
 v_add_u32 v65, v65, v64
 v_mfma_f32_16x16x32_bf16 v[52:55], a[148:151], a[136:139], v[52:55]
 ds_read_b128 a[180:183], v5 offset:34816
 v_bfe_u32 v64, v14, 4, 2
 v_mfma_f32_16x16x32_bf16 v[60:63], a[148:151], a[140:143], v[60:63]
 v_lshl_add_u32 v65, v64, 3, v65
 s_lshr_b32 s94, s60, 1
 s_lshl_b32 s94, s94, 13
 s_add_u32 s94, s94, 98304
 v_add_u32 v1, s94, v65
 v_mfma_f32_16x16x32_bf16 v[68:71], a[152:155], a[128:131], v[68:71]
 ds_read_b64_tr_b16 a[200:201], v8 offset:24576
 v_add_u32 v18, 0, v14
 v_mfma_f32_16x16x32_bf16 v[76:79], a[152:155], a[132:135], v[76:79]
 ds_read_b64_tr_b16 a[202:203], v8 offset:25600
 v_add_u32 v19, 0x4000, v19
 v_mfma_f32_16x16x32_bf16 v[84:87], a[152:155], a[136:139], v[84:87]
 ds_read_b128 a[184:187], v5 offset:36864
 v_accvgpr_write_b32 a32, 0
 v_mfma_f32_16x16x32_bf16 v[92:95], a[152:155], a[140:143], v[92:95]
 v_accvgpr_write_b32 a33, 0
 v_accvgpr_write_b32 a34, 0
 v_mfma_f32_16x16x32_bf16 v[100:103], a[156:159], a[128:131], v[100:103]
 ds_read_b64_tr_b16 a[204:205], v9 offset:24576
 v_accvgpr_write_b32 a35, 0
 v_mfma_f32_16x16x32_bf16 v[108:111], a[156:159], a[132:135], v[108:111]
 ds_read_b64_tr_b16 a[206:207], v9 offset:25600
 v_accvgpr_write_b32 a36, 0
 v_mfma_f32_16x16x32_bf16 v[116:119], a[156:159], a[136:139], v[116:119]
 ds_read_b128 a[188:191], v5 offset:38912
 v_accvgpr_write_b32 a37, 0
 v_mfma_f32_16x16x32_bf16 v[124:127], a[156:159], a[140:143], v[124:127]
 s_waitcnt lgkmcnt(15)
 v_accvgpr_write_b32 a38, 0
 v_accvgpr_write_b32 a39, 0
 v_mfma_f32_16x16x32_bf16 v[132:135], a[160:163], a[128:131], v[132:135]
 s_add_u32 s83, s87, 393216
 buffer_store_dwordx4 v[216:219], v14, s[4:7], s83 offen offset:3072
 v_mfma_f32_16x16x32_bf16 v[140:143], a[160:163], a[132:135], v[140:143]
 ds_read_b64_tr_b16 a[208:209], v10 offset:24576
 v_accvgpr_write_b32 a40, 0
 v_mfma_f32_16x16x32_bf16 v[148:151], a[160:163], a[136:139], v[148:151]
 ds_read_b64_tr_b16 a[210:211], v10 offset:25600
 v_accvgpr_write_b32 a41, 0
 v_mfma_f32_16x16x32_bf16 v[156:159], a[160:163], a[140:143], v[156:159]
 ds_read_b64_tr_b16 a[212:213], v11 offset:24576
 v_accvgpr_write_b32 a42, 0
 v_mfma_f32_16x16x32_bf16 v[164:167], a[164:167], a[128:131], v[164:167]
 v_accvgpr_write_b32 a43, 0
 v_accvgpr_write_b32 a44, 0
 v_mfma_f32_16x16x32_bf16 v[172:175], a[164:167], a[132:135], v[172:175]
 ds_read_b64_tr_b16 a[214:215], v11 offset:25600
 v_accvgpr_write_b32 a45, 0
 v_mfma_f32_16x16x32_bf16 v[180:183], a[164:167], a[136:139], v[180:183]
 ds_read_b64_tr_b16 a[216:217], v12 offset:24576
 v_accvgpr_write_b32 a46, 0
 v_mfma_f32_16x16x32_bf16 v[188:191], a[164:167], a[140:143], v[188:191]
 s_waitcnt lgkmcnt(15)
 ds_read_b64_tr_b16 a[218:219], v12 offset:25600
 v_accvgpr_write_b32 a47, 0
 v_mfma_f32_16x16x32_bf16 v[196:199], a[168:171], a[128:131], v[196:199]
 v_accvgpr_write_b32 a48, 0
 v_accvgpr_write_b32 a49, 0
 v_mfma_f32_16x16x32_bf16 v[204:207], a[168:171], a[132:135], v[204:207]
 ds_read_b64_tr_b16 a[220:221], v13 offset:24576
 v_accvgpr_write_b32 a50, 0
 v_mfma_f32_16x16x32_bf16 v[212:215], a[168:171], a[136:139], v[212:215]
 ds_read_b64_tr_b16 a[222:223], v13 offset:25600
 v_accvgpr_write_b32 a51, 0
 v_mfma_f32_16x16x32_bf16 v[220:223], a[168:171], a[140:143], v[220:223]
 v_accvgpr_write_b32 a52, 0
 v_accvgpr_write_b32 a53, 0
 v_mfma_f32_16x16x32_bf16 v[228:231], a[172:175], a[128:131], v[228:231]
 v_accvgpr_write_b32 a54, 0
 v_accvgpr_write_b32 a55, 0
 v_mfma_f32_16x16x32_bf16 v[236:239], a[172:175], a[132:135], v[236:239]
 v_accvgpr_write_b32 a56, 0
 v_accvgpr_write_b32 a57, 0
 v_mfma_f32_16x16x32_bf16 v[244:247], a[172:175], a[136:139], v[244:247]
 v_accvgpr_write_b32 a58, 0
 v_accvgpr_write_b32 a59, 0
 v_mfma_f32_16x16x32_bf16 v[252:255], a[172:175], a[140:143], v[252:255]
 s_waitcnt lgkmcnt(15)
 v_accvgpr_write_b32 a60, 0
 v_accvgpr_write_b32 a61, 0
 v_mfma_f32_16x16x32_bf16 v[32:35], a[192:195], a[176:179], v[32:35]
 s_waitcnt vmcnt(7) lgkmcnt(0)
 s_barrier
 v_accvgpr_write_b32 a62, 0
 v_mfma_f32_16x16x32_bf16 v[40:43], a[192:195], a[180:183], v[40:43]
 s_add_u32 m0, s82, 32768
 ds_read_b64_tr_b16 a[144:145], v6 offset:32768
 v_accvgpr_write_b32 a63, 0
 v_mfma_f32_16x16x32_bf16 v[48:51], a[192:195], a[184:187], v[48:51]
 buffer_load_dwordx4 v14, s[4:7], s64 offen offset:0 sc1 lds
 v_mfma_f32_16x16x32_bf16 v[56:59], a[192:195], a[188:191], v[56:59]
 ds_read_b64_tr_b16 a[146:147], v6 offset:33792
 v_accvgpr_write_b32 a64, 0
 v_mfma_f32_16x16x32_bf16 v[36:39], a[196:199], a[176:179], v[36:39]
 ds_read_b128 a[128:131], v16 offset:0
 v_accvgpr_write_b32 a65, 0
 v_mfma_f32_16x16x32_bf16 v[44:47], a[196:199], a[180:183], v[44:47]
 ds_read_b64_tr_b16 a[148:149], v7 offset:32768
 v_accvgpr_write_b32 a66, 0
 v_mfma_f32_16x16x32_bf16 v[52:55], a[196:199], a[184:187], v[52:55]
 ds_read_b64_tr_b16 a[150:151], v7 offset:33792
 v_accvgpr_write_b32 a67, 0
 v_mfma_f32_16x16x32_bf16 v[60:63], a[196:199], a[188:191], v[60:63]
 buffer_load_dwordx4 v14, s[4:7], s64 offen offset:1024 sc1 lds
 v_mfma_f32_16x16x32_bf16 v[68:71], a[200:203], a[176:179], v[68:71]
 ds_read_b128 a[132:135], v16 offset:2048
 v_accvgpr_write_b32 a68, 0
 v_mfma_f32_16x16x32_bf16 v[76:79], a[200:203], a[180:183], v[76:79]
 s_add_u32 s83, s87, 397312
 buffer_store_dwordx4 v[224:227], v14, s[4:7], s83 offen offset:0
 v_mfma_f32_16x16x32_bf16 v[84:87], a[200:203], a[184:187], v[84:87]
 ds_read_b64_tr_b16 a[152:153], v8 offset:32768
 v_accvgpr_write_b32 a69, 0
 v_mfma_f32_16x16x32_bf16 v[92:95], a[200:203], a[188:191], v[92:95]
 ds_read_b64_tr_b16 a[154:155], v8 offset:33792
 v_accvgpr_write_b32 a70, 0
 v_mfma_f32_16x16x32_bf16 v[100:103], a[204:207], a[176:179], v[100:103]
 buffer_load_dwordx4 v14, s[4:7], s64 offen offset:2048 sc1 lds
 v_mfma_f32_16x16x32_bf16 v[108:111], a[204:207], a[180:183], v[108:111]
 ds_read_b128 a[136:139], v16 offset:4096
 v_accvgpr_write_b32 a71, 0
 v_mfma_f32_16x16x32_bf16 v[116:119], a[204:207], a[184:187], v[116:119]
 ds_read_b64_tr_b16 a[156:157], v9 offset:32768
 v_accvgpr_write_b32 a72, 0
 v_mfma_f32_16x16x32_bf16 v[124:127], a[204:207], a[188:191], v[124:127]
 ds_read_b64_tr_b16 a[158:159], v9 offset:33792
 v_accvgpr_write_b32 a73, 0
 v_mfma_f32_16x16x32_bf16 v[132:135], a[208:211], a[176:179], v[132:135]
 ds_read_b128 a[140:143], v16 offset:6144
 v_accvgpr_write_b32 a74, 0
 v_mfma_f32_16x16x32_bf16 v[140:143], a[208:211], a[180:183], v[140:143]
 buffer_load_dwordx4 v14, s[4:7], s64 offen offset:3072 sc1 lds
 s_add_u32 s64, s64, 16384
 s_add_u32 m0, s82, 49152
 v_mfma_f32_16x16x32_bf16 v[148:151], a[208:211], a[184:187], v[148:151]
 ds_read_b64_tr_b16 a[160:161], v10 offset:32768
 v_accvgpr_write_b32 a75, 0
 v_mfma_f32_16x16x32_bf16 v[156:159], a[208:211], a[188:191], v[156:159]
 ds_read_b64_tr_b16 a[162:163], v10 offset:33792
 v_accvgpr_write_b32 a76, 0
 v_mfma_f32_16x16x32_bf16 v[164:167], a[212:215], a[176:179], v[164:167]
 ds_read_b64_tr_b16 a[164:165], v11 offset:32768
 v_accvgpr_write_b32 a77, 0
 v_mfma_f32_16x16x32_bf16 v[172:175], a[212:215], a[180:183], v[172:175]
 ds_read_b64_tr_b16 a[166:167], v11 offset:33792
 v_accvgpr_write_b32 a78, 0
 v_mfma_f32_16x16x32_bf16 v[180:183], a[212:215], a[184:187], v[180:183]
 buffer_load_dwordx4 v14, s[4:7], s65 offen offset:0 sc1 lds
 v_mfma_f32_16x16x32_bf16 v[188:191], a[212:215], a[188:191], v[188:191]
 ds_read_b64_tr_b16 a[168:169], v12 offset:32768
 v_accvgpr_write_b32 a79, 0
 v_mfma_f32_16x16x32_bf16 v[196:199], a[216:219], a[176:179], v[196:199]
 ds_read_b64_tr_b16 a[170:171], v12 offset:33792
 v_accvgpr_write_b32 a80, 0
 v_mfma_f32_16x16x32_bf16 v[204:207], a[216:219], a[180:183], v[204:207]
 ds_read_b64_tr_b16 a[172:173], v13 offset:32768
 v_accvgpr_write_b32 a81, 0
 v_mfma_f32_16x16x32_bf16 v[212:215], a[216:219], a[184:187], v[212:215]
 ds_read_b64_tr_b16 a[174:175], v13 offset:33792
 v_accvgpr_write_b32 a82, 0
 v_mfma_f32_16x16x32_bf16 v[220:223], a[216:219], a[188:191], v[220:223]
 buffer_load_dwordx4 v14, s[4:7], s65 offen offset:1024 sc1 lds
 v_mfma_f32_16x16x32_bf16 v[228:231], a[220:223], a[176:179], v[228:231]
 v_accvgpr_write_b32 a83, 0
 v_accvgpr_write_b32 a84, 0
 v_mfma_f32_16x16x32_bf16 v[236:239], a[220:223], a[180:183], v[236:239]
 v_accvgpr_write_b32 a85, 0
 v_accvgpr_write_b32 a86, 0
 v_mfma_f32_16x16x32_bf16 v[244:247], a[220:223], a[184:187], v[244:247]
 s_add_u32 s83, s87, 397312
 buffer_store_dwordx4 v[232:235], v14, s[4:7], s83 offen offset:1024
 v_mfma_f32_16x16x32_bf16 v[252:255], a[220:223], a[188:191], v[252:255]
 s_waitcnt lgkmcnt(15)
 v_accvgpr_write_b32 a87, 0
 v_accvgpr_write_b32 a88, 0
 v_mfma_f32_16x16x32_bf16 v[32:35], a[144:147], a[128:131], v[32:35]
 s_waitcnt lgkmcnt(14)
 buffer_load_dwordx4 v14, s[4:7], s65 offen offset:2048 sc1 lds
 v_mfma_f32_16x16x32_bf16 v[40:43], a[144:147], a[132:135], v[40:43]
 s_waitcnt lgkmcnt(11)
 ds_read_b64_tr_b16 a[192:193], v6 offset:40960
 v_accvgpr_write_b32 a89, 0
 v_mfma_f32_16x16x32_bf16 v[48:51], a[144:147], a[136:139], v[48:51]
 s_waitcnt lgkmcnt(9)
 ds_read_b64_tr_b16 a[194:195], v6 offset:41984
 v_accvgpr_write_b32 a90, 0
 v_mfma_f32_16x16x32_bf16 v[56:59], a[144:147], a[140:143], v[56:59]
 ds_read_b128 a[176:179], v17 offset:0
 v_accvgpr_write_b32 a91, 0
 v_mfma_f32_16x16x32_bf16 v[36:39], a[148:151], a[128:131], v[36:39]
 ds_read_b64_tr_b16 a[196:197], v7 offset:40960
 v_accvgpr_write_b32 a92, 0
 v_mfma_f32_16x16x32_bf16 v[44:47], a[148:151], a[132:135], v[44:47]
 buffer_load_dwordx4 v14, s[4:7], s65 offen offset:3072 sc1 lds
 s_add_u32 s65, s65, 16384
 v_mfma_f32_16x16x32_bf16 v[52:55], a[148:151], a[136:139], v[52:55]
 v_accvgpr_write_b32 a93, 0
 v_accvgpr_write_b32 a94, 0
 v_mfma_f32_16x16x32_bf16 v[60:63], a[148:151], a[140:143], v[60:63]
 ds_read_b64_tr_b16 a[198:199], v7 offset:41984
 v_accvgpr_write_b32 a95, 0
 v_mfma_f32_16x16x32_bf16 v[68:71], a[152:155], a[128:131], v[68:71]
 ds_read_b128 a[180:183], v17 offset:2048
 v_accvgpr_write_b32 a96, 0
 v_mfma_f32_16x16x32_bf16 v[76:79], a[152:155], a[132:135], v[76:79]
 ds_read_b64_tr_b16 a[200:201], v8 offset:40960
 v_accvgpr_write_b32 a97, 0
 v_mfma_f32_16x16x32_bf16 v[84:87], a[152:155], a[136:139], v[84:87]
 ds_read_b64_tr_b16 a[202:203], v8 offset:41984
 v_accvgpr_write_b32 a98, 0
 v_mfma_f32_16x16x32_bf16 v[92:95], a[152:155], a[140:143], v[92:95]
 v_accvgpr_write_b32 a99, 0
 v_accvgpr_write_b32 a100, 0
 v_mfma_f32_16x16x32_bf16 v[100:103], a[156:159], a[128:131], v[100:103]
 ds_read_b128 a[184:187], v17 offset:4096
 v_accvgpr_write_b32 a101, 0
 v_mfma_f32_16x16x32_bf16 v[108:111], a[156:159], a[132:135], v[108:111]
 ds_read_b64_tr_b16 a[204:205], v9 offset:40960
 v_accvgpr_write_b32 a102, 0
 v_mfma_f32_16x16x32_bf16 v[116:119], a[156:159], a[136:139], v[116:119]
 ds_read_b64_tr_b16 a[206:207], v9 offset:41984
 v_accvgpr_write_b32 a103, 0
 v_mfma_f32_16x16x32_bf16 v[124:127], a[156:159], a[140:143], v[124:127]
 s_waitcnt lgkmcnt(15)
 ds_read_b128 a[188:191], v17 offset:6144
 v_accvgpr_write_b32 a104, 0
 v_mfma_f32_16x16x32_bf16 v[132:135], a[160:163], a[128:131], v[132:135]
 v_accvgpr_write_b32 a105, 0
 v_accvgpr_write_b32 a106, 0
 v_mfma_f32_16x16x32_bf16 v[140:143], a[160:163], a[132:135], v[140:143]
 ds_read_b64_tr_b16 a[208:209], v10 offset:40960
 v_accvgpr_write_b32 a107, 0
 v_mfma_f32_16x16x32_bf16 v[148:151], a[160:163], a[136:139], v[148:151]
 s_lshl_b32 s68, s63, 3
 ds_read_b64_tr_b16 a[210:211], v10 offset:41984
 v_accvgpr_write_b32 a108, 0
 v_mfma_f32_16x16x32_bf16 v[156:159], a[160:163], a[140:143], v[156:159]
 s_lshl_b32 s94, s60, 1
 s_add_u32 s68, s68, s94
 ds_read_b64_tr_b16 a[212:213], v11 offset:40960
 v_accvgpr_write_b32 a109, 0
 v_mfma_f32_16x16x32_bf16 v[164:167], a[164:167], a[128:131], v[164:167]
 s_add_u32 s83, s87, 397312
 buffer_store_dwordx4 v[240:243], v14, s[4:7], s83 offen offset:2048
 s_cmp_eq_i32 s68, 1
 s_cselect_b32 s73, 1.0, 0
 v_mfma_f32_16x16x32_bf16 v[172:175], a[164:167], a[132:135], v[172:175]
 s_cmp_lt_i32 s68, 1
 s_cselect_b32 s78, 0xf1800000, 0
 ds_read_b64_tr_b16 a[214:215], v11 offset:41984
 v_accvgpr_write_b32 a110, 0
 v_mfma_f32_16x16x32_bf16 v[180:183], a[164:167], a[136:139], v[180:183]
 s_cmp_eq_i32 s68, 0
 s_cselect_b32 s74, 1.0, 0
 v_accvgpr_write_b32 a111, 0
 v_accvgpr_write_b32 a112, 0
 v_mfma_f32_16x16x32_bf16 v[188:191], a[164:167], a[140:143], v[188:191]
 s_waitcnt lgkmcnt(15)
 s_cmp_lt_i32 s68, 0
 s_cselect_b32 s79, 0xf1800000, 0
 ds_read_b64_tr_b16 a[216:217], v12 offset:40960
 v_accvgpr_write_b32 a113, 0
 v_mfma_f32_16x16x32_bf16 v[196:199], a[168:171], a[128:131], v[196:199]
 s_cmp_eq_i32 s68, -1
 s_cselect_b32 s75, 1.0, 0
 ds_read_b64_tr_b16 a[218:219], v12 offset:41984
 v_accvgpr_write_b32 a114, 0
 v_mfma_f32_16x16x32_bf16 v[204:207], a[168:171], a[132:135], v[204:207]
 s_cmp_lt_i32 s68, -1
 s_cselect_b32 s80, 0xf1800000, 0
 ds_read_b64_tr_b16 a[220:221], v13 offset:40960
 v_accvgpr_write_b32 a115, 0
 v_mfma_f32_16x16x32_bf16 v[212:215], a[168:171], a[136:139], v[212:215]
 ds_read_b64_tr_b16 a[222:223], v13 offset:41984
 v_accvgpr_write_b32 a116, 0
 v_mfma_f32_16x16x32_bf16 v[220:223], a[168:171], a[140:143], v[220:223]
 v_accvgpr_write_b32 a117, 0
 v_accvgpr_write_b32 a118, 0
 v_mfma_f32_16x16x32_bf16 v[228:231], a[172:175], a[128:131], v[228:231]
 v_accvgpr_write_b32 a119, 0
 v_accvgpr_write_b32 a120, 0
 v_mfma_f32_16x16x32_bf16 v[236:239], a[172:175], a[132:135], v[236:239]
 v_accvgpr_write_b32 a121, 0
 v_accvgpr_write_b32 a122, 0
 v_mfma_f32_16x16x32_bf16 v[244:247], a[172:175], a[136:139], v[244:247]
 v_accvgpr_write_b32 a123, 0
 v_accvgpr_write_b32 a124, 0
 v_mfma_f32_16x16x32_bf16 v[252:255], a[172:175], a[140:143], v[252:255]
 s_waitcnt lgkmcnt(15)
 v_accvgpr_write_b32 a125, 0
 v_accvgpr_write_b32 a126, 0
 v_mfma_f32_16x16x32_bf16 v[32:35], a[192:195], a[176:179], v[32:35]
 s_waitcnt vmcnt(13) lgkmcnt(0)
 s_barrier
 v_accvgpr_write_b32 a127, 0
 v_mfma_f32_16x16x32_bf16 v[36:39], a[196:199], a[176:179], v[36:39]
 s_add_u32 m0, s82, 65536
 ds_read_b128 a[128:131], v18 offset:0
 v_mfma_f32_16x16x32_bf16 v[68:71], a[200:203], a[176:179], v[68:71]
 buffer_load_dwordx4 v14, s[4:7], s64 offen offset:0 sc1 lds
 v_mfma_f32_16x16x32_bf16 v[100:103], a[204:207], a[176:179], v[100:103]
 v_mfma_f32_16x16x32_bf16 v[132:135], a[208:211], a[176:179], v[132:135]
 ds_read_b128 a[132:135], v18 offset:1024
 v_mfma_f32_16x16x32_bf16 v[164:167], a[212:215], a[176:179], v[164:167]
 v_mul_f32 v32, 0x3e0293ee, v32
 v_mul_f32 v33, 0x3e0293ee, v33
 v_mfma_f32_16x16x32_bf16 v[196:199], a[216:219], a[176:179], v[196:199]
 ds_read_b128 a[136:139], v18 offset:2048
 v_mul_f32 v34, 0x3e0293ee, v34
 v_mfma_f32_16x16x32_bf16 v[228:231], a[220:223], a[176:179], v[228:231]
 buffer_load_dwordx4 v14, s[4:7], s64 offen offset:1024 sc1 lds
 v_mfma_f32_16x16x32_bf16 v[40:43], a[192:195], a[180:183], v[40:43]
 v_mul_f32 v35, 0x3e0293ee, v35
 v_mul_f32 v36, 0x3e0293ee, v36
 v_mfma_f32_16x16x32_bf16 v[44:47], a[196:199], a[180:183], v[44:47]
 ds_read_b128 a[140:143], v18 offset:3072
 v_mul_f32 v37, 0x3e0293ee, v37
 v_mfma_f32_16x16x32_bf16 v[76:79], a[200:203], a[180:183], v[76:79]
 v_mul_f32 v38, 0x3e0293ee, v38
 v_mul_f32 v39, 0x3e0293ee, v39
 v_mfma_f32_16x16x32_bf16 v[108:111], a[204:207], a[180:183], v[108:111]
 ds_read_b128 a[144:147], v18 offset:4096
 v_cvt_pk_bf16_f32 v32, v32, v33
 v_mfma_f32_16x16x32_bf16 v[140:143], a[208:211], a[180:183], v[140:143]
 buffer_load_dwordx4 v14, s[4:7], s64 offen offset:2048 sc1 lds
 v_mfma_f32_16x16x32_bf16 v[172:175], a[212:215], a[180:183], v[172:175]
 v_cvt_pk_bf16_f32 v33, v34, v35
 v_cvt_pk_bf16_f32 v34, v36, v37
 v_mfma_f32_16x16x32_bf16 v[204:207], a[216:219], a[180:183], v[204:207]
 s_add_u32 s83, s87, 397312
 buffer_store_dwordx4 v[248:251], v14, s[4:7], s83 offen offset:3072
 v_mfma_f32_16x16x32_bf16 v[236:239], a[220:223], a[180:183], v[236:239]
 ds_read_b128 a[148:151], v18 offset:5120
 v_cvt_pk_bf16_f32 v35, v38, v39
 v_mfma_f32_16x16x32_bf16 v[48:51], a[192:195], a[184:187], v[48:51]
 v_mul_f32 v68, 0x3e0293ee, v68
 v_mul_f32 v69, 0x3e0293ee, v69
 v_mfma_f32_16x16x32_bf16 v[52:55], a[196:199], a[184:187], v[52:55]
 buffer_load_dwordx4 v14, s[4:7], s64 offen offset:3072 sc1 lds
 s_add_u32 s64, s64, 16384
 s_add_u32 m0, s82, 81920
 v_mfma_f32_16x16x32_bf16 v[84:87], a[200:203], a[184:187], v[84:87]
 ds_read_b128 a[152:155], v18 offset:6144
 v_mul_f32 v70, 0x3e0293ee, v70
 v_mfma_f32_16x16x32_bf16 v[116:119], a[204:207], a[184:187], v[116:119]
 v_mul_f32 v71, 0x3e0293ee, v71
 v_mul_f32 v100, 0x3e0293ee, v100
 v_mfma_f32_16x16x32_bf16 v[148:151], a[208:211], a[184:187], v[148:151]
 ds_read_b128 a[156:159], v18 offset:7168
 v_mul_f32 v101, 0x3e0293ee, v101
 v_mfma_f32_16x16x32_bf16 v[180:183], a[212:215], a[184:187], v[180:183]
 v_mul_f32 v102, 0x3e0293ee, v102
 v_mul_f32 v103, 0x3e0293ee, v103
 v_mfma_f32_16x16x32_bf16 v[212:215], a[216:219], a[184:187], v[212:215]
 buffer_load_dwordx4 v14, s[4:7], s65 offen offset:0 sc1 lds
 v_mfma_f32_16x16x32_bf16 v[244:247], a[220:223], a[184:187], v[244:247]
 v_cvt_pk_bf16_f32 v68, v68, v69
 v_cvt_pk_bf16_f32 v69, v70, v71
 v_mfma_f32_16x16x32_bf16 v[56:59], a[192:195], a[188:191], v[56:59]
 v_cvt_pk_bf16_f32 v70, v100, v101
 v_cvt_pk_bf16_f32 v71, v102, v103
 v_mfma_f32_16x16x32_bf16 v[60:63], a[196:199], a[188:191], v[60:63]
 v_mul_f32 v132, 0x3e0293ee, v132
 v_mul_f32 v133, 0x3e0293ee, v133
 v_mfma_f32_16x16x32_bf16 v[92:95], a[200:203], a[188:191], v[92:95]
 v_mul_f32 v134, 0x3e0293ee, v134
 v_mul_f32 v135, 0x3e0293ee, v135
 v_mfma_f32_16x16x32_bf16 v[124:127], a[204:207], a[188:191], v[124:127]
 buffer_load_dwordx4 v14, s[4:7], s65 offen offset:1024 sc1 lds
 v_mfma_f32_16x16x32_bf16 v[156:159], a[208:211], a[188:191], v[156:159]
 v_mul_f32 v164, 0x3e0293ee, v164
 v_mul_f32 v165, 0x3e0293ee, v165
 v_mfma_f32_16x16x32_bf16 v[188:191], a[212:215], a[188:191], v[188:191]
 v_mul_f32 v166, 0x3e0293ee, v166
 v_mul_f32 v167, 0x3e0293ee, v167
 v_mfma_f32_16x16x32_bf16 v[220:223], a[216:219], a[188:191], v[220:223]
 v_cvt_pk_bf16_f32 v132, v132, v133
 v_cvt_pk_bf16_f32 v133, v134, v135
 v_cvt_pk_bf16_f32 v134, v164, v165
 v_cvt_pk_bf16_f32 v135, v166, v167
 v_mul_f32 v196, 0x3e0293ee, v196
 v_mul_f32 v197, 0x3e0293ee, v197
 v_mul_f32 v198, 0x3e0293ee, v198
 v_mul_f32 v199, 0x3e0293ee, v199
 v_mul_f32 v228, 0x3e0293ee, v228
 v_mul_f32 v229, 0x3e0293ee, v229
 v_mul_f32 v230, 0x3e0293ee, v230
 v_mul_f32 v231, 0x3e0293ee, v231
 v_cvt_pk_bf16_f32 v196, v196, v197
 v_cvt_pk_bf16_f32 v197, v198, v199
 v_cvt_pk_bf16_f32 v198, v228, v229
 v_cvt_pk_bf16_f32 v199, v230, v231
 v_mov_b32 v22, s79
 v_fma_f32 v164, v24, s74, v22
 v_fma_f32 v165, v25, s74, v22
 v_fma_f32 v166, v26, s74, v22
 v_fma_f32 v167, v27, s74, v22
 v_mfma_f32_16x16x32_bf16 v[252:255], a[220:223], a[188:191], v[252:255]
 s_waitcnt lgkmcnt(7)
 v_mul_f32 v40, 0x3e0293ee, v40
 v_mul_f32 v41, 0x3e0293ee, v41
 v_mfma_f32_16x16x32_bf16 v[164:167], a[128:131], v[32:35], v[164:167]
 s_waitcnt lgkmcnt(6)
 buffer_load_dwordx4 v14, s[4:7], s65 offen offset:2048 sc1 lds
 v_mfma_f32_16x16x32_bf16 v[164:167], a[132:135], v[68:71], v[164:167]
 s_waitcnt lgkmcnt(5)
 v_mul_f32 v42, 0x3e0293ee, v42
 v_mul_f32 v43, 0x3e0293ee, v43
 v_mfma_f32_16x16x32_bf16 v[164:167], a[136:139], v[132:135], v[164:167]
 s_waitcnt lgkmcnt(4)
 ds_read_b128 a[160:163], v18 offset:8192
 v_mul_f32 v44, 0x3e0293ee, v44
 v_mul_f32 v45, 0x3e0293ee, v45
 v_mul_f32 v46, 0x3e0293ee, v46
 v_mul_f32 v47, 0x3e0293ee, v47
 v_cvt_pk_bf16_f32 v40, v40, v41
 v_cvt_pk_bf16_f32 v41, v42, v43
 v_cvt_pk_bf16_f32 v42, v44, v45
 v_cvt_pk_bf16_f32 v43, v46, v47
 v_mul_f32 v76, 0x3e0293ee, v76
 v_mul_f32 v77, 0x3e0293ee, v77
 v_mul_f32 v78, 0x3e0293ee, v78
 v_mul_f32 v79, 0x3e0293ee, v79
 v_mul_f32 v108, 0x3e0293ee, v108
 v_mul_f32 v109, 0x3e0293ee, v109
 v_mul_f32 v110, 0x3e0293ee, v110
 v_mul_f32 v111, 0x3e0293ee, v111
 v_cvt_pk_bf16_f32 v76, v76, v77
 v_cvt_pk_bf16_f32 v77, v78, v79
 v_cvt_pk_bf16_f32 v78, v108, v109
 v_cvt_pk_bf16_f32 v79, v110, v111
 v_mul_f32 v140, 0x3e0293ee, v140
 v_mul_f32 v141, 0x3e0293ee, v141
 v_mul_f32 v142, 0x3e0293ee, v142
 v_mul_f32 v143, 0x3e0293ee, v143
 v_mul_f32 v172, 0x3e0293ee, v172
 v_mul_f32 v173, 0x3e0293ee, v173
 v_mul_f32 v174, 0x3e0293ee, v174
 v_mul_f32 v175, 0x3e0293ee, v175
 v_cvt_pk_bf16_f32 v140, v140, v141
 v_cvt_pk_bf16_f32 v141, v142, v143
 v_cvt_pk_bf16_f32 v142, v172, v173
 v_cvt_pk_bf16_f32 v143, v174, v175
 v_mul_f32 v204, 0x3e0293ee, v204
 v_mul_f32 v205, 0x3e0293ee, v205
 v_mul_f32 v206, 0x3e0293ee, v206
 v_mul_f32 v207, 0x3e0293ee, v207
 v_mul_f32 v236, 0x3e0293ee, v236
 v_mul_f32 v237, 0x3e0293ee, v237
 v_mul_f32 v238, 0x3e0293ee, v238
 v_mul_f32 v239, 0x3e0293ee, v239
 v_cvt_pk_bf16_f32 v204, v204, v205
 v_cvt_pk_bf16_f32 v205, v206, v207
 v_cvt_pk_bf16_f32 v206, v236, v237
 v_cvt_pk_bf16_f32 v207, v238, v239
 v_mov_b32 v22, s80
 v_fma_f32 v172, v24, s75, v22
 v_fma_f32 v173, v25, s75, v22
 v_fma_f32 v174, v26, s75, v22
 v_fma_f32 v175, v27, s75, v22
 v_mfma_f32_16x16x32_bf16 v[164:167], a[140:143], v[196:199], v[164:167]
 v_mul_f32 v48, 0x3e0293ee, v48
 v_mul_f32 v49, 0x3e0293ee, v49
 v_mfma_f32_16x16x32_bf16 v[172:175], a[128:131], v[40:43], v[172:175]
 v_mul_f32 v50, 0x3e0293ee, v50
 v_mul_f32 v51, 0x3e0293ee, v51
 v_mfma_f32_16x16x32_bf16 v[172:175], a[132:135], v[76:79], v[172:175]
 buffer_load_dwordx4 v14, s[4:7], s65 offen offset:3072 sc1 lds
 s_add_u32 s65, s65, 16384
 v_mfma_f32_16x16x32_bf16 v[172:175], a[136:139], v[140:143], v[172:175]
 v_mul_f32 v52, 0x3e0293ee, v52
 v_mul_f32 v53, 0x3e0293ee, v53
 v_mul_f32 v54, 0x3e0293ee, v54
 v_mul_f32 v55, 0x3e0293ee, v55
 v_cvt_pk_bf16_f32 v48, v48, v49
 v_cvt_pk_bf16_f32 v49, v50, v51
 v_cvt_pk_bf16_f32 v50, v52, v53
 v_cvt_pk_bf16_f32 v51, v54, v55
 v_mul_f32 v84, 0x3e0293ee, v84
 v_mul_f32 v85, 0x3e0293ee, v85
 v_mul_f32 v86, 0x3e0293ee, v86
 v_mul_f32 v87, 0x3e0293ee, v87
 v_mul_f32 v116, 0x3e0293ee, v116
 v_mul_f32 v117, 0x3e0293ee, v117
 v_mul_f32 v118, 0x3e0293ee, v118
 v_mul_f32 v119, 0x3e0293ee, v119
 v_cvt_pk_bf16_f32 v84, v84, v85
 v_cvt_pk_bf16_f32 v85, v86, v87
 v_cvt_pk_bf16_f32 v86, v116, v117
 v_cvt_pk_bf16_f32 v87, v118, v119
 v_mul_f32 v148, 0x3e0293ee, v148
 v_mul_f32 v149, 0x3e0293ee, v149
 v_mul_f32 v150, 0x3e0293ee, v150
 v_mul_f32 v151, 0x3e0293ee, v151
 v_mul_f32 v180, 0x3e0293ee, v180
 v_mul_f32 v181, 0x3e0293ee, v181
 v_mul_f32 v182, 0x3e0293ee, v182
 v_mul_f32 v183, 0x3e0293ee, v183
 v_cvt_pk_bf16_f32 v148, v148, v149
 v_cvt_pk_bf16_f32 v149, v150, v151
 v_cvt_pk_bf16_f32 v150, v180, v181
 v_cvt_pk_bf16_f32 v151, v182, v183
 v_mul_f32 v212, 0x3e0293ee, v212
 v_mul_f32 v213, 0x3e0293ee, v213
 v_mul_f32 v214, 0x3e0293ee, v214
 v_mul_f32 v215, 0x3e0293ee, v215
 v_mul_f32 v244, 0x3e0293ee, v244
 v_mul_f32 v245, 0x3e0293ee, v245
 v_mul_f32 v246, 0x3e0293ee, v246
 v_mul_f32 v247, 0x3e0293ee, v247
 v_cvt_pk_bf16_f32 v212, v212, v213
 v_cvt_pk_bf16_f32 v213, v214, v215
 v_cvt_pk_bf16_f32 v214, v244, v245
 v_cvt_pk_bf16_f32 v215, v246, v247
 v_mfma_f32_16x16x32_bf16 v[172:175], a[140:143], v[204:207], v[172:175]
 ds_read_b128 a[164:167], v18 offset:9216
 v_mul_f32 v56, 0x3e0293ee, v56
 v_mfma_f32_16x16x32_bf16 v[180:183], a[128:131], v[48:51], 0
 v_mul_f32 v57, 0x3e0293ee, v57
 v_mul_f32 v58, 0x3e0293ee, v58
 v_mfma_f32_16x16x32_bf16 v[180:183], a[132:135], v[84:87], v[180:183]
 v_mul_f32 v59, 0x3e0293ee, v59
 v_mul_f32 v60, 0x3e0293ee, v60
 v_mfma_f32_16x16x32_bf16 v[180:183], a[136:139], v[148:151], v[180:183]
 s_lshr_b32 s94, s82, 2
 s_add_u32 m0, s94, 147456
 v_mul_f32 v61, 0x3e0293ee, v61
 v_mul_f32 v62, 0x3e0293ee, v62
 v_mul_f32 v63, 0x3e0293ee, v63
 v_cvt_pk_bf16_f32 v56, v56, v57
 v_cvt_pk_bf16_f32 v57, v58, v59
 v_cvt_pk_bf16_f32 v58, v60, v61
 v_cvt_pk_bf16_f32 v59, v62, v63
 v_mul_f32 v92, 0x3e0293ee, v92
 v_mul_f32 v93, 0x3e0293ee, v93
 v_mul_f32 v94, 0x3e0293ee, v94
 v_mul_f32 v95, 0x3e0293ee, v95
 v_mul_f32 v124, 0x3e0293ee, v124
 v_mul_f32 v125, 0x3e0293ee, v125
 v_mul_f32 v126, 0x3e0293ee, v126
 v_mul_f32 v127, 0x3e0293ee, v127
 v_cvt_pk_bf16_f32 v92, v92, v93
 v_cvt_pk_bf16_f32 v93, v94, v95
 v_cvt_pk_bf16_f32 v94, v124, v125
 v_cvt_pk_bf16_f32 v95, v126, v127
 v_mul_f32 v156, 0x3e0293ee, v156
 v_mul_f32 v157, 0x3e0293ee, v157
 v_mul_f32 v158, 0x3e0293ee, v158
 v_mul_f32 v159, 0x3e0293ee, v159
 v_mul_f32 v188, 0x3e0293ee, v188
 v_mul_f32 v189, 0x3e0293ee, v189
 v_mul_f32 v190, 0x3e0293ee, v190
 v_mul_f32 v191, 0x3e0293ee, v191
 v_cvt_pk_bf16_f32 v156, v156, v157
 v_cvt_pk_bf16_f32 v157, v158, v159
 v_cvt_pk_bf16_f32 v158, v188, v189
 v_cvt_pk_bf16_f32 v159, v190, v191
 v_mul_f32 v220, 0x3e0293ee, v220
 v_mul_f32 v221, 0x3e0293ee, v221
 v_mul_f32 v222, 0x3e0293ee, v222
 v_mul_f32 v223, 0x3e0293ee, v223
 v_mul_f32 v252, 0x3e0293ee, v252
 v_mul_f32 v253, 0x3e0293ee, v253
 v_mul_f32 v254, 0x3e0293ee, v254
 v_mul_f32 v255, 0x3e0293ee, v255
 v_cvt_pk_bf16_f32 v220, v220, v221
 v_cvt_pk_bf16_f32 v221, v222, v223
 v_cvt_pk_bf16_f32 v222, v252, v253
 v_cvt_pk_bf16_f32 v223, v254, v255
 v_mfma_f32_16x16x32_bf16 v[180:183], a[140:143], v[212:215], v[180:183]
 s_mul_i32 s20, s93, 1152
 s_lshr_b32 s94, s82, 2
 s_add_u32 s20, s20, s94
 buffer_load_dwordx4 v14, s[8:11], s20 offen lds
 v_mfma_f32_16x16x32_bf16 v[188:191], a[128:131], v[56:59], 0
 v_max3_f32 v64, v164, v165, v166
 v_max_f32 v64, v64, v167
 v_mfma_f32_16x16x32_bf16 v[188:191], a[132:135], v[92:95], v[188:191]
 ds_read_b128 a[168:171], v18 offset:10240
 v_mov_b32 v65, v64
 v_mfma_f32_16x16x32_bf16 v[188:191], a[136:139], v[156:159], v[188:191]
 s_nop 0
 v_permlane32_swap_b32 v64, v65
 v_max_f32 v64, v64, v65
 v_mov_b32 v65, v64
 s_nop 1
 v_permlane16_swap_b32 v64, v65
 v_max_f32 v64, v64, v65
 v_sub_f32 v160, 0xc1a00000, v64
 v_sub_f32 v161, 0xc1a00000, v64
 v_sub_f32 v162, 0xc1a00000, v64
 v_sub_f32 v163, 0xc1a00000, v64
 v_add_f32 v22, s79, v160
 v_fma_f32 v36, v24, s74, v22
 v_fma_f32 v37, v25, s74, v22
 v_fma_f32 v38, v26, s74, v22
 v_fma_f32 v39, v27, s74, v22
 v_mfma_f32_16x16x32_bf16 v[188:191], a[140:143], v[220:223], v[188:191]
 s_lshl_b32 s94, s61, 5
 s_lshr_b32 s95, s2, 3
 s_add_u32 s94, s94, s95
 s_lshl_b32 s94, s94, 2
 s_add_u32 s94, s94, s60
 s_mul_i32 s84, s94, 4608
 v_lshlrev_b32 v12, 3, v14
 v_min_u32 v12, 0x1180, v12
 v_mfma_f32_16x16x32_bf16 v[36:39], a[128:131], v[32:35], v[36:39]
 buffer_load_dword v11, v12, s[28:31], s84 offen
 v_mfma_f32_16x16x32_bf16 v[36:39], a[132:135], v[68:71], v[36:39]
 ds_read_b128 a[172:175], v18 offset:11264
 v_add_f32 v22, s78, v160
 v_mfma_f32_16x16x32_bf16 v[36:39], a[136:139], v[132:135], v[36:39]
 v_fma_f32 v100, v24, s73, v22
 v_fma_f32 v101, v25, s73, v22
 v_fma_f32 v102, v26, s73, v22
 v_fma_f32 v103, v27, s73, v22
 v_mfma_f32_16x16x32_bf16 v[36:39], a[140:143], v[196:199], v[36:39]
 s_waitcnt lgkmcnt(7)
 v_max3_f32 v64, v172, v173, v174
 v_max_f32 v64, v64, v175
 v_mfma_f32_16x16x32_bf16 v[100:103], a[144:147], v[32:35], v[100:103]
 s_waitcnt lgkmcnt(6)
 v_mov_b32 v65, v64
 s_nop 1
 v_permlane32_swap_b32 v64, v65
 v_mfma_f32_16x16x32_bf16 v[100:103], a[148:151], v[68:71], v[100:103]
 s_waitcnt lgkmcnt(5)
 v_max_f32 v64, v64, v65
 v_mov_b32 v65, v64
 v_mfma_f32_16x16x32_bf16 v[100:103], a[152:155], v[132:135], v[100:103]
 s_waitcnt lgkmcnt(4)
 ds_read_b128 a[176:179], v18 offset:12288
 v_permlane16_swap_b32 v64, v65
 v_max_f32 v64, v64, v65
 v_sub_f32 v168, 0xc1a00000, v64
 v_sub_f32 v169, 0xc1a00000, v64
 v_sub_f32 v170, 0xc1a00000, v64
 v_sub_f32 v171, 0xc1a00000, v64
 v_add_f32 v22, s80, v168
 v_fma_f32 v44, v24, s75, v22
 v_fma_f32 v45, v25, s75, v22
 v_fma_f32 v46, v26, s75, v22
 v_fma_f32 v47, v27, s75, v22
 v_mfma_f32_16x16x32_bf16 v[100:103], a[156:159], v[196:199], v[100:103]
 v_add_f32 v22, s79, v168
 v_fma_f32 v108, v24, s74, v22
 v_mfma_f32_16x16x32_bf16 v[44:47], a[128:131], v[40:43], v[44:47]
 v_fma_f32 v109, v25, s74, v22
 v_fma_f32 v110, v26, s74, v22
 v_mfma_f32_16x16x32_bf16 v[44:47], a[132:135], v[76:79], v[44:47]
 v_fma_f32 v111, v27, s74, v22
 v_max3_f32 v64, v180, v181, v182
 v_mfma_f32_16x16x32_bf16 v[44:47], a[136:139], v[140:143], v[44:47]
 v_max_f32 v64, v64, v183
 v_mov_b32 v65, v64
 v_mfma_f32_16x16x32_bf16 v[44:47], a[140:143], v[204:207], v[44:47]
 ds_read_b128 a[180:183], v18 offset:13312
 v_permlane32_swap_b32 v64, v65
 v_mfma_f32_16x16x32_bf16 v[108:111], a[144:147], v[40:43], v[108:111]
 v_max_f32 v64, v64, v65
 v_mov_b32 v65, v64
 v_mfma_f32_16x16x32_bf16 v[108:111], a[148:151], v[76:79], v[108:111]
 s_nop 0
 v_permlane16_swap_b32 v64, v65
 v_max_f32 v64, v64, v65
 v_mfma_f32_16x16x32_bf16 v[108:111], a[152:155], v[140:143], v[108:111]
 v_sub_f32 v176, 0xc1a00000, v64
 v_sub_f32 v177, 0xc1a00000, v64
 v_sub_f32 v178, 0xc1a00000, v64
 v_sub_f32 v179, 0xc1a00000, v64
 v_mfma_f32_16x16x32_bf16 v[108:111], a[156:159], v[204:207], v[108:111]
 ds_read_b128 a[184:187], v18 offset:14336
 v_max3_f32 v64, v188, v189, v190
 v_mfma_f32_16x16x32_bf16 v[52:55], a[128:131], v[48:51], v[176:179]
 v_max_f32 v64, v64, v191
 v_mov_b32 v65, v64
 v_mfma_f32_16x16x32_bf16 v[52:55], a[132:135], v[84:87], v[52:55]
 s_nop 0
 v_permlane32_swap_b32 v64, v65
 v_max_f32 v64, v64, v65
 v_mfma_f32_16x16x32_bf16 v[52:55], a[136:139], v[148:151], v[52:55]
 v_mov_b32 v65, v64
 s_nop 1
 v_permlane16_swap_b32 v64, v65
 v_mfma_f32_16x16x32_bf16 v[52:55], a[140:143], v[212:215], v[52:55]
 v_max_f32 v64, v64, v65
 v_sub_f32 v184, 0xc1a00000, v64
 v_mfma_f32_16x16x32_bf16 v[116:119], a[144:147], v[48:51], v[176:179]
 ds_read_b128 a[188:191], v18 offset:15360
 v_sub_f32 v185, 0xc1a00000, v64
 v_mfma_f32_16x16x32_bf16 v[116:119], a[148:151], v[84:87], v[116:119]
 v_sub_f32 v186, 0xc1a00000, v64
 v_sub_f32 v187, 0xc1a00000, v64
 s_sub_u32 s68, s68, 2
 s_cmp_eq_i32 s68, 1
 s_cselect_b32 s73, 1.0, 0
 s_cmp_lt_i32 s68, 1
 s_cselect_b32 s78, 0xf1800000, 0
 s_cmp_eq_i32 s68, 0
 s_cselect_b32 s74, 1.0, 0
 s_cmp_lt_i32 s68, 0
 s_cselect_b32 s79, 0xf1800000, 0
 s_cmp_eq_i32 s68, -1
 s_cselect_b32 s75, 1.0, 0
 s_cmp_lt_i32 s68, -1
 s_cselect_b32 s80, 0xf1800000, 0
 v_mfma_f32_16x16x32_bf16 v[116:119], a[152:155], v[148:151], v[116:119]
 v_accvgpr_write_b32 a216, 0
 v_accvgpr_write_b32 a217, 0
 v_mfma_f32_16x16x32_bf16 v[116:119], a[156:159], v[212:215], v[116:119]
 v_accvgpr_write_b32 a218, 0
 v_accvgpr_write_b32 a219, 0
 v_mfma_f32_16x16x32_bf16 v[60:63], a[128:131], v[56:59], v[184:187]
 v_exp_f32 v20, v36
 v_mfma_f32_16x16x32_bf16 v[60:63], a[132:135], v[92:95], v[60:63]
 v_exp_f32 v21, v37
 v_mfma_f32_16x16x32_bf16 v[60:63], a[136:139], v[156:159], v[60:63]
 v_cvt_pk_bf16_f32 v192, v20, v21
 v_mfma_f32_16x16x32_bf16 v[60:63], a[140:143], v[220:223], v[60:63]
 v_exp_f32 v20, v38
 v_mfma_f32_16x16x32_bf16 v[124:127], a[144:147], v[56:59], v[184:187]
 v_exp_f32 v21, v39
 v_mfma_f32_16x16x32_bf16 v[124:127], a[148:151], v[92:95], v[124:127]
 v_cvt_pk_bf16_f32 v193, v20, v21
 v_or_b32 v13, v192, v193
 v_mfma_f32_16x16x32_bf16 v[124:127], a[152:155], v[156:159], v[124:127]
 v_exp_f32 v20, v100
 v_mfma_f32_16x16x32_bf16 v[124:127], a[156:159], v[220:223], v[124:127]
 s_waitcnt lgkmcnt(7)
 v_exp_f32 v21, v101
 v_mfma_f32_16x16x32_bf16 v[180:183], a[160:163], v[48:51], v[176:179]
 s_waitcnt lgkmcnt(6)
 v_cvt_pk_bf16_f32 v194, v20, v21
 v_mfma_f32_16x16x32_bf16 v[180:183], a[164:167], v[84:87], v[180:183]
 s_waitcnt lgkmcnt(5)
 v_exp_f32 v20, v102
 v_mfma_f32_16x16x32_bf16 v[180:183], a[168:171], v[148:151], v[180:183]
 s_waitcnt lgkmcnt(4)
 v_exp_f32 v21, v103
 v_mfma_f32_16x16x32_bf16 v[180:183], a[172:175], v[212:215], v[180:183]
 v_cvt_pk_bf16_f32 v195, v20, v21
 v_or3_b32 v13, v194, v195, v13
 v_mfma_f32_16x16x32_bf16 v[188:191], a[160:163], v[56:59], v[184:187]
 v_exp_f32 v20, v44
 v_mfma_f32_16x16x32_bf16 v[188:191], a[164:167], v[92:95], v[188:191]
 v_exp_f32 v21, v45
 v_mfma_f32_16x16x32_bf16 v[188:191], a[168:171], v[156:159], v[188:191]
 v_cvt_pk_bf16_f32 v200, v20, v21
 v_exp_f32 v20, v46
 v_exp_f32 v21, v47
 s_nop 0
 v_cvt_pk_bf16_f32 v201, v20, v21
 v_or3_b32 v13, v200, v201, v13
 v_add_f32 v22, s79, v160
 v_fma_f32 v164, v24, s74, v22
 v_fma_f32 v165, v25, s74, v22
 v_fma_f32 v166, v26, s74, v22
 v_fma_f32 v167, v27, s74, v22
 v_mfma_f32_16x16x32_bf16 v[188:191], a[172:175], v[220:223], v[188:191]
 s_add_u32 s67, s66, s82
 v_exp_f32 v20, v108
 v_mfma_f32_16x16x32_bf16 v[164:167], a[160:163], v[32:35], v[164:167]
 s_add_u32 s66, s66, 32768
 v_exp_f32 v21, v109
 v_mfma_f32_16x16x32_bf16 v[164:167], a[164:167], v[68:71], v[164:167]
 s_cmp_eq_u32 s66, 98304
 s_cselect_b32 s66, 0, s66
 v_cvt_pk_bf16_f32 v202, v20, v21
 v_mfma_f32_16x16x32_bf16 v[164:167], a[168:171], v[132:135], v[164:167]
 v_add_u32 v18, s66, v14
 v_exp_f32 v20, v110
 v_exp_f32 v21, v111
 s_nop 0
 v_cvt_pk_bf16_f32 v203, v20, v21
 v_or3_b32 v13, v202, v203, v13
 v_add_f32 v22, s80, v168
 v_fma_f32 v172, v24, s75, v22
 v_fma_f32 v173, v25, s75, v22
 v_fma_f32 v174, v26, s75, v22
 v_fma_f32 v175, v27, s75, v22
 v_mfma_f32_16x16x32_bf16 v[164:167], a[172:175], v[196:199], v[164:167]
 s_waitcnt vmcnt(7) lgkmcnt(0)
 s_barrier
 ds_read_b128 a[128:131], v18 offset:16384
 v_mfma_f32_16x16x32_bf16 v[172:175], a[160:163], v[40:43], v[172:175]
 v_exp_f32 v20, v52
 v_mfma_f32_16x16x32_bf16 v[172:175], a[164:167], v[76:79], v[172:175]
 s_cmp_eq_u32 s1, 0
 s_cbranch_scc1 L_fence_111
L_back_112:
 s_lshl_b32 s94, s2, 6
 s_add_u32 s94, s94, 71385088
 s_cmp_eq_u32 s60, 0
 s_cselect_b32 s94, s94, 0x8000000
 v_lshl_add_u32 v22, v14, 21, s94
 v_mov_b32 v23, 1
 v_mfma_f32_16x16x32_bf16 v[172:175], a[168:171], v[140:143], v[172:175]
 ds_read_b128 a[132:135], v18 offset:17408
 buffer_store_dword v23, v22, s[4:7], 0 offen sc1
 v_mfma_f32_16x16x32_bf16 v[172:175], a[172:175], v[204:207], v[172:175]
 s_add_u32 m0, s26, s82
 v_exp_f32 v21, v53
 v_mfma_f32_16x16x32_bf16 v[244:247], a[176:179], v[48:51], v[176:179]
 s_add_u32 s20, s24, 0
 buffer_load_dwordx4 v0, s[40:43], s20 offen offset:0 lds
 v_mfma_f32_16x16x32_bf16 v[244:247], a[180:183], v[84:87], v[244:247]
 v_cvt_pk_bf16_f32 v208, v20, v21
 v_mfma_f32_16x16x32_bf16 v[244:247], a[184:187], v[148:151], v[244:247]
 ds_read_b128 a[136:139], v18 offset:18432
 v_mfma_f32_16x16x32_bf16 v[244:247], a[188:191], v[212:215], v[244:247]
 s_add_u32 s20, s24, 146432
 buffer_load_dwordx4 v0, s[40:43], s20 offen offset:1024 lds
 v_mfma_f32_16x16x32_bf16 v[252:255], a[176:179], v[56:59], v[184:187]
 v_exp_f32 v20, v54
 v_mfma_f32_16x16x32_bf16 v[252:255], a[180:183], v[92:95], v[252:255]
 ds_read_b128 a[140:143], v18 offset:19456
 v_mfma_f32_16x16x32_bf16 v[252:255], a[184:187], v[156:159], v[252:255]
 s_add_u32 s20, s24, 292864
 buffer_load_dwordx4 v0, s[40:43], s20 offen offset:2048 lds
 v_exp_f32 v21, v55
 s_nop 0
 v_cvt_pk_bf16_f32 v209, v20, v21
 v_or3_b32 v13, v208, v209, v13
 v_exp_f32 v20, v116
 v_exp_f32 v21, v117
 s_nop 0
 v_cvt_pk_bf16_f32 v210, v20, v21
 v_exp_f32 v20, v118
 v_exp_f32 v21, v119
 s_nop 0
 v_cvt_pk_bf16_f32 v211, v20, v21
 v_or3_b32 v13, v210, v211, v13
 v_add_f32 v22, s78, v160
 v_fma_f32 v228, v24, s73, v22
 v_fma_f32 v229, v25, s73, v22
 v_fma_f32 v230, v26, s73, v22
 v_fma_f32 v231, v27, s73, v22
 v_mfma_f32_16x16x32_bf16 v[252:255], a[188:191], v[220:223], v[252:255]
 v_exp_f32 v20, v60
 v_mfma_f32_16x16x32_bf16 v[228:231], a[176:179], v[32:35], v[228:231]
 v_exp_f32 v21, v61
 v_mfma_f32_16x16x32_bf16 v[228:231], a[180:183], v[68:71], v[228:231]
 ds_read_b128 a[144:147], v18 offset:20480
 s_add_u32 s20, s24, 439296
 buffer_load_dwordx4 v0, s[40:43], s20 offen offset:3072 lds
 s_add_u32 s24, s24, 1179648
 v_mfma_f32_16x16x32_bf16 v[228:231], a[184:187], v[132:135], v[228:231]
 v_cvt_pk_bf16_f32 v216, v20, v21
 v_add_f32 v22, s79, v168
 v_fma_f32 v236, v24, s74, v22
 v_fma_f32 v237, v25, s74, v22
 v_fma_f32 v238, v26, s74, v22
 v_fma_f32 v239, v27, s74, v22
 v_mfma_f32_16x16x32_bf16 v[228:231], a[188:191], v[196:199], v[228:231]
 v_exp_f32 v20, v62
 v_mfma_f32_16x16x32_bf16 v[236:239], a[176:179], v[40:43], v[236:239]
 ds_read_b128 a[148:151], v18 offset:21504
 s_add_u32 s26, s26, 16384
 v_mfma_f32_16x16x32_bf16 v[236:239], a[180:183], v[76:79], v[236:239]
 s_cmp_eq_u32 s26, 147456
 s_cselect_b32 s26, 98304, s26
 v_mfma_f32_16x16x32_bf16 v[236:239], a[184:187], v[140:143], v[236:239]
 v_exp_f32 v21, v63
 v_mfma_f32_16x16x32_bf16 v[236:239], a[188:191], v[204:207], v[236:239]
 v_cvt_pk_bf16_f32 v217, v20, v21
 v_or3_b32 v13, v216, v217, v13
 v_exp_f32 v20, v124
 v_exp_f32 v21, v125
 s_nop 0
 v_cvt_pk_bf16_f32 v218, v20, v21
 v_exp_f32 v20, v126
 v_exp_f32 v21, v127
 s_nop 0
 v_cvt_pk_bf16_f32 v219, v20, v21
 v_or3_b32 v13, v218, v219, v13
 s_waitcnt lgkmcnt(5)
 v_and_b32 v13, 0x40004000, v13
 v_cmp_ne_u32 vcc, 0, v13
 s_sub_u32 s68, s68, 2
 s_lshl_b32 s92, s63, 1
 s_mov_b32 s36, 5
 s_cbranch_vccnz L_tr_115
L_back_114:
 s_cmp_eq_u32 s63, 0
 s_cbranch_scc1 L_dd_one
 s_sub_u32 s92, s92, 1
 s_cmp_lt_u32 s2, 112
 s_cbranch_scc1 L_dp
L_dpf:
 v_mfma_f32_16x16x32_bf16 a[0:3], a[128:131], v[192:195], a[0:3]
 s_add_u32 m0, s67, 0
 v_exp_f32 v20, v164
 v_mfma_f32_16x16x32_bf16 a[32:35], a[128:131], v[200:203], a[32:35]
 v_exp_f32 v21, v165
 v_mfma_f32_16x16x32_bf16 a[64:67], a[128:131], v[208:211], a[64:67]
 ds_read_b128 a[152:155], v18 offset:22528
 v_cvt_pk_bf16_f32 v224, v20, v21
 v_mfma_f32_16x16x32_bf16 a[96:99], a[128:131], v[216:219], a[96:99]
 s_waitcnt lgkmcnt(5)
 buffer_load_dwordx4 v14, s[4:7], s64 offen offset:0 sc1 lds
 v_add_u32 v3, s25, v1
 v_mfma_f32_16x16x32_bf16 a[4:7], a[132:135], v[192:195], a[4:7]
 v_exp_f32 v20, v166
 v_mfma_f32_16x16x32_bf16 a[36:39], a[132:135], v[200:203], a[36:39]
 v_exp_f32 v21, v167
 v_mfma_f32_16x16x32_bf16 a[68:71], a[132:135], v[208:211], a[68:71]
 ds_read_b128 a[156:159], v18 offset:23552
 v_cvt_pk_bf16_f32 v225, v20, v21
 v_mfma_f32_16x16x32_bf16 a[100:103], a[132:135], v[216:219], a[100:103]
 s_waitcnt lgkmcnt(5)
 ds_read_b128 a[160:163], v18 offset:0
 v_or_b32 v13, v224, v225
 v_mfma_f32_16x16x32_bf16 a[8:11], a[136:139], v[192:195], a[8:11]
 v_exp_f32 v20, v228
 v_mfma_f32_16x16x32_bf16 a[40:43], a[136:139], v[200:203], a[40:43]
 v_exp_f32 v21, v229
 v_mfma_f32_16x16x32_bf16 a[72:75], a[136:139], v[208:211], a[72:75]
 ds_read_b128 a[164:167], v18 offset:1024
 v_cvt_pk_bf16_f32 v226, v20, v21
 v_mfma_f32_16x16x32_bf16 a[104:107], a[136:139], v[216:219], a[104:107]
 s_waitcnt lgkmcnt(6)
 buffer_load_dwordx4 v14, s[4:7], s64 offen offset:1024 sc1 lds
 v_mfma_f32_16x16x32_bf16 a[12:15], a[140:143], v[192:195], a[12:15]
 v_exp_f32 v20, v230
 v_mfma_f32_16x16x32_bf16 a[44:47], a[140:143], v[200:203], a[44:47]
 v_exp_f32 v21, v231
 v_mfma_f32_16x16x32_bf16 a[76:79], a[140:143], v[208:211], a[76:79]
 ds_read_b128 a[168:171], v18 offset:2048
 v_cvt_pk_bf16_f32 v227, v20, v21
 v_mfma_f32_16x16x32_bf16 a[108:111], a[140:143], v[216:219], a[108:111]
 s_waitcnt lgkmcnt(6)
 ds_read_b128 a[172:175], v18 offset:3072
 v_or3_b32 v13, v226, v227, v13
 v_mfma_f32_16x16x32_bf16 a[16:19], a[144:147], v[192:195], a[16:19]
 v_exp_f32 v20, v172
 v_mfma_f32_16x16x32_bf16 a[48:51], a[144:147], v[200:203], a[48:51]
 v_exp_f32 v21, v173
 v_mfma_f32_16x16x32_bf16 a[80:83], a[144:147], v[208:211], a[80:83]
 ds_read_b128 a[176:179], v18 offset:4096
 v_cvt_pk_bf16_f32 v232, v20, v21
 v_mfma_f32_16x16x32_bf16 a[112:115], a[144:147], v[216:219], a[112:115]
 s_waitcnt lgkmcnt(7)
 buffer_load_dwordx4 v14, s[4:7], s64 offen offset:2048 sc1 lds
 v_mfma_f32_16x16x32_bf16 a[20:23], a[148:151], v[192:195], a[20:23]
 v_exp_f32 v20, v174
 v_mfma_f32_16x16x32_bf16 a[52:55], a[148:151], v[200:203], a[52:55]
 v_exp_f32 v21, v175
 v_mfma_f32_16x16x32_bf16 a[84:87], a[148:151], v[208:211], a[84:87]
 ds_read_b128 a[180:183], v18 offset:5120
 v_cvt_pk_bf16_f32 v233, v20, v21
 v_mfma_f32_16x16x32_bf16 a[116:119], a[148:151], v[216:219], a[116:119]
 s_waitcnt lgkmcnt(7)
 ds_read_b128 a[184:187], v18 offset:6144
 v_or3_b32 v13, v232, v233, v13
 v_mfma_f32_16x16x32_bf16 a[24:27], a[152:155], v[192:195], a[24:27]
 v_exp_f32 v20, v236
 v_mfma_f32_16x16x32_bf16 a[56:59], a[152:155], v[200:203], a[56:59]
 v_exp_f32 v21, v237
 v_mfma_f32_16x16x32_bf16 a[88:91], a[152:155], v[208:211], a[88:91]
 ds_read_b128 a[188:191], v18 offset:7168
 v_cvt_pk_bf16_f32 v234, v20, v21
 v_mfma_f32_16x16x32_bf16 a[120:123], a[152:155], v[216:219], a[120:123]
 s_waitcnt lgkmcnt(8)
 buffer_load_dwordx4 v14, s[4:7], s64 offen offset:3072 sc1 lds
 s_add_u32 s64, s64, 16384
 s_add_u32 m0, s67, 16384
 v_mfma_f32_16x16x32_bf16 a[28:31], a[156:159], v[192:195], a[28:31]
 v_exp_f32 v20, v238
 v_mfma_f32_16x16x32_bf16 a[60:63], a[156:159], v[200:203], a[60:63]
 v_exp_f32 v21, v239
 v_mfma_f32_16x16x32_bf16 a[92:95], a[156:159], v[208:211], a[92:95]
 ds_read_b128 a[128:131], v18 offset:24576
 v_cvt_pk_bf16_f32 v235, v20, v21
 v_mfma_f32_16x16x32_bf16 a[124:127], a[156:159], v[216:219], a[124:127]
 s_waitcnt lgkmcnt(8)
 ds_read_b128 a[132:135], v18 offset:25600
 v_or3_b32 v13, v234, v235, v13
 v_mfma_f32_16x16x32_bf16 v[52:55], a[160:163], v[48:51], v[176:179]
 s_waitcnt lgkmcnt(8)
 v_exp_f32 v20, v180
 v_mfma_f32_16x16x32_bf16 v[52:55], a[164:167], v[84:87], v[52:55]
 s_waitcnt lgkmcnt(7)
 v_exp_f32 v21, v181
 v_mfma_f32_16x16x32_bf16 v[52:55], a[168:171], v[148:151], v[52:55]
 s_waitcnt lgkmcnt(6)
 ds_read_b128 a[136:139], v18 offset:26624
 v_cvt_pk_bf16_f32 v240, v20, v21
 v_mfma_f32_16x16x32_bf16 v[52:55], a[172:175], v[212:215], v[52:55]
 buffer_load_dwordx4 v14, s[4:7], s65 offen offset:0 sc1 lds
 v_mfma_f32_16x16x32_bf16 v[60:63], a[160:163], v[56:59], v[184:187]
 v_exp_f32 v20, v182
 v_mfma_f32_16x16x32_bf16 v[60:63], a[164:167], v[92:95], v[60:63]
 v_exp_f32 v21, v183
 v_mfma_f32_16x16x32_bf16 v[60:63], a[168:171], v[156:159], v[60:63]
 ds_read_b128 a[140:143], v18 offset:27648
 v_cvt_pk_bf16_f32 v241, v20, v21
 v_mfma_f32_16x16x32_bf16 v[60:63], a[172:175], v[220:223], v[60:63]
 ds_read_b128 a[144:147], v18 offset:28672
 v_or3_b32 v13, v240, v241, v13
 v_mfma_f32_16x16x32_bf16 v[36:39], a[160:163], v[32:35], v[160:163]
 v_exp_f32 v20, v244
 v_mfma_f32_16x16x32_bf16 v[36:39], a[164:167], v[68:71], v[36:39]
 v_exp_f32 v21, v245
 v_mfma_f32_16x16x32_bf16 v[36:39], a[168:171], v[132:135], v[36:39]
 ds_read_b128 a[148:151], v18 offset:29696
 v_cvt_pk_bf16_f32 v242, v20, v21
 v_mfma_f32_16x16x32_bf16 v[36:39], a[172:175], v[196:199], v[36:39]
 buffer_load_dwordx4 v14, s[4:7], s65 offen offset:1024 sc1 lds
 v_mfma_f32_16x16x32_bf16 v[44:47], a[160:163], v[40:43], v[168:171]
 v_exp_f32 v20, v246
 v_mfma_f32_16x16x32_bf16 v[44:47], a[164:167], v[76:79], v[44:47]
 v_exp_f32 v21, v247
 v_mfma_f32_16x16x32_bf16 v[44:47], a[168:171], v[140:143], v[44:47]
 ds_read_b128 a[152:155], v18 offset:30720
 v_cvt_pk_bf16_f32 v243, v20, v21
 v_mfma_f32_16x16x32_bf16 v[44:47], a[172:175], v[204:207], v[44:47]
 s_waitcnt lgkmcnt(10)
 ds_read_b128 a[156:159], v18 offset:31744
 v_or3_b32 v13, v242, v243, v13
 v_mfma_f32_16x16x32_bf16 v[116:119], a[176:179], v[48:51], v[176:179]
 s_waitcnt lgkmcnt(10)
 v_exp_f32 v20, v188
 v_mfma_f32_16x16x32_bf16 v[116:119], a[180:183], v[84:87], v[116:119]
 s_waitcnt lgkmcnt(9)
 v_exp_f32 v21, v189
 v_mfma_f32_16x16x32_bf16 v[116:119], a[184:187], v[148:151], v[116:119]
 s_waitcnt lgkmcnt(8)
 ds_read_b128 a[160:163], v18 offset:8192
 v_cvt_pk_bf16_f32 v248, v20, v21
 v_mfma_f32_16x16x32_bf16 v[116:119], a[188:191], v[212:215], v[116:119]
 buffer_load_dwordx4 v14, s[4:7], s65 offen offset:2048 sc1 lds
 v_mfma_f32_16x16x32_bf16 v[124:127], a[176:179], v[56:59], v[184:187]
 v_exp_f32 v20, v190
 v_mfma_f32_16x16x32_bf16 v[124:127], a[180:183], v[92:95], v[124:127]
 v_exp_f32 v21, v191
 v_mfma_f32_16x16x32_bf16 v[124:127], a[184:187], v[156:159], v[124:127]
 ds_read_b128 a[164:167], v18 offset:9216
 v_cvt_pk_bf16_f32 v249, v20, v21
 v_mfma_f32_16x16x32_bf16 v[124:127], a[188:191], v[220:223], v[124:127]
 ds_read_b128 a[168:171], v18 offset:10240
 v_or3_b32 v13, v248, v249, v13
 v_mfma_f32_16x16x32_bf16 v[100:103], a[176:179], v[32:35], v[160:163]
 v_exp_f32 v20, v252
 v_mfma_f32_16x16x32_bf16 v[100:103], a[180:183], v[68:71], v[100:103]
 v_exp_f32 v21, v253
 v_mfma_f32_16x16x32_bf16 v[100:103], a[184:187], v[132:135], v[100:103]
 ds_read_b128 a[172:175], v18 offset:11264
 v_cvt_pk_bf16_f32 v250, v20, v21
 v_mfma_f32_16x16x32_bf16 v[100:103], a[188:191], v[196:199], v[100:103]
 buffer_load_dwordx4 v14, s[4:7], s65 offen offset:3072 sc1 lds
 s_add_u32 s65, s65, 16384
 v_mfma_f32_16x16x32_bf16 v[108:111], a[176:179], v[40:43], v[168:171]
 v_exp_f32 v20, v254
 v_mfma_f32_16x16x32_bf16 v[108:111], a[180:183], v[76:79], v[108:111]
 v_exp_f32 v21, v255
 v_mfma_f32_16x16x32_bf16 v[108:111], a[184:187], v[140:143], v[108:111]
 ds_read_b128 a[176:179], v18 offset:12288
 v_cvt_pk_bf16_f32 v251, v20, v21
 v_mfma_f32_16x16x32_bf16 v[108:111], a[188:191], v[204:207], v[108:111]
 ds_read_b128 a[180:183], v18 offset:13312
 v_or3_b32 v13, v250, v251, v13
 v_mfma_f32_16x16x32_bf16 v[120:123], v[28:31], v[192:195], v[120:123]
 v_and_b32 v13, 0x40004000, v13
 v_cmp_ne_u32 vcc, 0, v13
 v_mfma_f32_16x16x32_bf16 v[128:131], v[28:31], v[200:203], v[128:131]
 ds_read_b128 a[184:187], v18 offset:14336
 v_mfma_f32_16x16x32_bf16 v[136:139], v[28:31], v[208:211], v[136:139]
 ds_read_b128 a[188:191], v18 offset:15360
 v_mfma_f32_16x16x32_bf16 v[144:147], v[28:31], v[216:219], v[144:147]
 s_waitcnt lgkmcnt(15)
 s_cbranch_vccnz L_tr_117
L_back_116:
 v_mfma_f32_16x16x32_bf16 a[0:3], a[128:131], v[224:227], a[0:3]
 s_add_u32 s25, s25, 16384
 v_exp_f32 v20, v36
 v_mfma_f32_16x16x32_bf16 a[32:35], a[128:131], v[232:235], a[32:35]
 s_cmp_eq_u32 s25, 49152
 s_cselect_b32 s25, 0, s25
 v_exp_f32 v21, v37
 v_mfma_f32_16x16x32_bf16 a[64:67], a[128:131], v[240:243], a[64:67]
 s_sub_u32 s36, s36, 1
 v_cvt_pk_bf16_f32 v192, v20, v21
 v_mfma_f32_16x16x32_bf16 a[96:99], a[128:131], v[248:251], a[96:99]
 s_waitcnt vmcnt(12) lgkmcnt(14)
 buffer_load_dword v15, v19, s[4:7], 0 offen sc1
 v_mfma_f32_16x16x32_bf16 a[4:7], a[132:135], v[224:227], a[4:7]
 v_exp_f32 v20, v38
 v_mfma_f32_16x16x32_bf16 a[36:39], a[132:135], v[232:235], a[36:39]
 v_exp_f32 v21, v39
 v_mfma_f32_16x16x32_bf16 a[68:71], a[132:135], v[240:243], a[68:71]
 v_cvt_pk_bf16_f32 v193, v20, v21
 v_mfma_f32_16x16x32_bf16 a[100:103], a[132:135], v[248:251], a[100:103]
 s_waitcnt lgkmcnt(13)
 v_or_b32 v13, v192, v193
 v_mfma_f32_16x16x32_bf16 a[8:11], a[136:139], v[224:227], a[8:11]
 s_add_u32 s67, s66, s82
 v_exp_f32 v20, v100
 v_mfma_f32_16x16x32_bf16 a[40:43], a[136:139], v[232:235], a[40:43]
 s_add_u32 s66, s66, 32768
 v_exp_f32 v21, v101
 v_mfma_f32_16x16x32_bf16 a[72:75], a[136:139], v[240:243], a[72:75]
 s_cmp_eq_u32 s66, 98304
 s_cselect_b32 s66, 0, s66
 v_cvt_pk_bf16_f32 v194, v20, v21
 v_mfma_f32_16x16x32_bf16 a[104:107], a[136:139], v[248:251], a[104:107]
 s_waitcnt lgkmcnt(12)
 v_add_u32 v18, s66, v14
 v_mfma_f32_16x16x32_bf16 a[12:15], a[140:143], v[224:227], a[12:15]
 s_waitcnt vmcnt(9) lgkmcnt(0)
 s_barrier
 v_exp_f32 v20, v102
 v_mfma_f32_16x16x32_bf16 a[44:47], a[140:143], v[232:235], a[44:47]
 v_exp_f32 v21, v103
 v_mfma_f32_16x16x32_bf16 a[76:79], a[140:143], v[240:243], a[76:79]
 ds_read_b128 a[128:131], v18 offset:16384
 s_add_u32 m0, s26, s82
 v_cvt_pk_bf16_f32 v195, v20, v21
 v_mfma_f32_16x16x32_bf16 a[108:111], a[140:143], v[248:251], a[108:111]
 s_add_u32 s20, s24, 0
 buffer_load_dwordx4 v0, s[40:43], s20 offen offset:0 lds
 v_or3_b32 v13, v194, v195, v13
 v_mfma_f32_16x16x32_bf16 a[16:19], a[144:147], v[224:227], a[16:19]
 v_exp_f32 v20, v44
 v_mfma_f32_16x16x32_bf16 a[48:51], a[144:147], v[232:235], a[48:51]
 v_exp_f32 v21, v45
 v_mfma_f32_16x16x32_bf16 a[80:83], a[144:147], v[240:243], a[80:83]
 ds_read_b64_tr_b16 a[192:193], v3 offset:0
 v_cvt_pk_bf16_f32 v200, v20, v21
 v_mfma_f32_16x16x32_bf16 a[112:115], a[144:147], v[248:251], a[112:115]
 ds_read_b64_tr_b16 a[194:195], v3 offset:256
 v_mfma_f32_16x16x32_bf16 a[20:23], a[148:151], v[224:227], a[20:23]
 v_exp_f32 v20, v46
 v_mfma_f32_16x16x32_bf16 a[52:55], a[148:151], v[232:235], a[52:55]
 v_exp_f32 v21, v47
 v_mfma_f32_16x16x32_bf16 a[84:87], a[148:151], v[240:243], a[84:87]
 ds_read_b128 a[224:227], v2 offset:0
 v_cvt_pk_bf16_f32 v201, v20, v21
 v_mfma_f32_16x16x32_bf16 a[116:119], a[148:151], v[248:251], a[116:119]
 ds_read_b128 a[132:135], v18 offset:17408
 v_or3_b32 v13, v200, v201, v13
 v_mfma_f32_16x16x32_bf16 a[24:27], a[152:155], v[224:227], a[24:27]
 v_exp_f32 v20, v108
 v_mfma_f32_16x16x32_bf16 a[56:59], a[152:155], v[232:235], a[56:59]
 v_exp_f32 v21, v109
 v_mfma_f32_16x16x32_bf16 a[88:91], a[152:155], v[240:243], a[88:91]
 ds_read_b64_tr_b16 a[196:197], v3 offset:2048
 v_cvt_pk_bf16_f32 v202, v20, v21
 v_mfma_f32_16x16x32_bf16 a[120:123], a[152:155], v[248:251], a[120:123]
 s_add_u32 s20, s24, 146432
 buffer_load_dwordx4 v0, s[40:43], s20 offen offset:1024 lds
 v_mfma_f32_16x16x32_bf16 a[28:31], a[156:159], v[224:227], a[28:31]
 v_exp_f32 v20, v110
 v_mfma_f32_16x16x32_bf16 a[60:63], a[156:159], v[232:235], a[60:63]
 v_exp_f32 v21, v111
 v_mfma_f32_16x16x32_bf16 a[92:95], a[156:159], v[240:243], a[92:95]
 ds_read_b64_tr_b16 a[198:199], v3 offset:2304
 v_cvt_pk_bf16_f32 v203, v20, v21
 v_mfma_f32_16x16x32_bf16 a[124:127], a[156:159], v[248:251], a[124:127]
 ds_read_b128 a[228:231], v2 offset:64
 v_or3_b32 v13, v202, v203, v13
 v_mfma_f32_16x16x32_bf16 v[180:183], a[160:163], v[48:51], v[176:179]
 s_sub_u32 s68, s68, 4
 v_exp_f32 v20, v52
 v_mfma_f32_16x16x32_bf16 v[180:183], a[164:167], v[84:87], v[180:183]
 v_exp_f32 v21, v53
 v_mfma_f32_16x16x32_bf16 v[180:183], a[168:171], v[148:151], v[180:183]
 ds_read_b64_tr_b16 a[200:201], v3 offset:4096
 v_cvt_pk_bf16_f32 v208, v20, v21
 v_mfma_f32_16x16x32_bf16 v[180:183], a[172:175], v[212:215], v[180:183]
 ds_read_b128 a[136:139], v18 offset:18432
 v_mfma_f32_16x16x32_bf16 v[188:191], a[160:163], v[56:59], v[184:187]
 v_exp_f32 v20, v54
 v_mfma_f32_16x16x32_bf16 v[188:191], a[164:167], v[92:95], v[188:191]
 v_exp_f32 v21, v55
 v_mfma_f32_16x16x32_bf16 v[188:191], a[168:171], v[156:159], v[188:191]
 ds_read_b64_tr_b16 a[202:203], v3 offset:4352
 v_cvt_pk_bf16_f32 v209, v20, v21
 v_mfma_f32_16x16x32_bf16 v[188:191], a[172:175], v[220:223], v[188:191]
 s_add_u32 s20, s24, 292864
 buffer_load_dwordx4 v0, s[40:43], s20 offen offset:2048 lds
 v_or3_b32 v13, v208, v209, v13
 v_mfma_f32_16x16x32_bf16 v[164:167], a[160:163], v[32:35], v[160:163]
 v_exp_f32 v20, v116
 v_mfma_f32_16x16x32_bf16 v[164:167], a[164:167], v[68:71], v[164:167]
 v_exp_f32 v21, v117
 v_mfma_f32_16x16x32_bf16 v[164:167], a[168:171], v[132:135], v[164:167]
 ds_read_b128 a[232:235], v2 offset:128
 v_cvt_pk_bf16_f32 v210, v20, v21
 v_mfma_f32_16x16x32_bf16 v[164:167], a[172:175], v[196:199], v[164:167]
 ds_read_b64_tr_b16 a[204:205], v3 offset:6144
 v_mfma_f32_16x16x32_bf16 v[172:175], a[160:163], v[40:43], v[168:171]
 v_exp_f32 v20, v118
 v_mfma_f32_16x16x32_bf16 v[172:175], a[164:167], v[76:79], v[172:175]
 v_exp_f32 v21, v119
 v_mfma_f32_16x16x32_bf16 v[172:175], a[168:171], v[140:143], v[172:175]
 ds_read_b128 a[140:143], v18 offset:19456
 v_cvt_pk_bf16_f32 v211, v20, v21
 v_mfma_f32_16x16x32_bf16 v[172:175], a[172:175], v[204:207], v[172:175]
 ds_read_b64_tr_b16 a[206:207], v3 offset:6400
 v_or3_b32 v13, v210, v211, v13
 v_mfma_f32_16x16x32_bf16 v[244:247], a[176:179], v[48:51], v[176:179]
 v_exp_f32 v20, v60
 v_mfma_f32_16x16x32_bf16 v[244:247], a[180:183], v[84:87], v[244:247]
 v_exp_f32 v21, v61
 v_mfma_f32_16x16x32_bf16 v[244:247], a[184:187], v[148:151], v[244:247]
 v_cvt_pk_bf16_f32 v216, v20, v21
 v_mfma_f32_16x16x32_bf16 v[244:247], a[188:191], v[212:215], v[244:247]
 s_add_u32 s20, s24, 439296
 buffer_load_dwordx4 v0, s[40:43], s20 offen offset:3072 lds
 s_add_u32 s24, s24, 1179648
 v_mfma_f32_16x16x32_bf16 v[252:255], a[176:179], v[56:59], v[184:187]
 v_exp_f32 v20, v62
 v_mfma_f32_16x16x32_bf16 v[252:255], a[180:183], v[92:95], v[252:255]
 v_exp_f32 v21, v63
 v_mfma_f32_16x16x32_bf16 v[252:255], a[184:187], v[156:159], v[252:255]
 v_cvt_pk_bf16_f32 v217, v20, v21
 v_mfma_f32_16x16x32_bf16 v[252:255], a[188:191], v[220:223], v[252:255]
 v_or3_b32 v13, v216, v217, v13
 v_mfma_f32_16x16x32_bf16 v[228:231], a[176:179], v[32:35], v[160:163]
 v_exp_f32 v20, v124
 v_mfma_f32_16x16x32_bf16 v[228:231], a[180:183], v[68:71], v[228:231]
 v_exp_f32 v21, v125
 v_mfma_f32_16x16x32_bf16 v[228:231], a[184:187], v[132:135], v[228:231]
 ds_read_b128 a[144:147], v18 offset:20480
 v_cvt_pk_bf16_f32 v218, v20, v21
 v_mfma_f32_16x16x32_bf16 v[228:231], a[188:191], v[196:199], v[228:231]
 ds_read_b128 a[236:239], v2 offset:192
 v_mfma_f32_16x16x32_bf16 v[236:239], a[176:179], v[40:43], v[168:171]
 v_exp_f32 v20, v126
 v_mfma_f32_16x16x32_bf16 v[236:239], a[180:183], v[76:79], v[236:239]
 v_exp_f32 v21, v127
 v_mfma_f32_16x16x32_bf16 v[236:239], a[184:187], v[140:143], v[236:239]
 s_sub_u32 s92, s92, 1
 v_cvt_pk_bf16_f32 v219, v20, v21
 v_mfma_f32_16x16x32_bf16 v[236:239], a[188:191], v[204:207], v[236:239]
 s_add_u32 s26, s26, 16384
 v_or3_b32 v13, v218, v219, v13
 v_mfma_f32_16x16x32_bf16 v[120:123], v[28:31], v[224:227], v[120:123]
 s_cmp_eq_u32 s26, 147456
 s_cselect_b32 s26, 98304, s26
 v_and_b32 v13, 0x40004000, v13
 v_cmp_ne_u32 vcc, 0, v13
 v_mfma_f32_16x16x32_bf16 v[128:131], v[28:31], v[232:235], v[128:131]
 v_mfma_f32_16x16x32_bf16 v[136:139], v[28:31], v[240:243], v[136:139]
 ds_read_b128 a[148:151], v18 offset:21504
 v_mfma_f32_16x16x32_bf16 v[144:147], v[28:31], v[248:251], v[144:147]
 s_waitcnt lgkmcnt(14)
 v_mfma_f32_16x16x32_bf16 a[216:219], a[192:195], a[224:227], a[216:219]
 s_waitcnt lgkmcnt(10)
 v_mfma_f32_16x16x32_bf16 a[216:219], a[196:199], a[228:231], a[216:219]
 s_waitcnt lgkmcnt(6)
 v_add_u32 v2, 0x100, v2
 v_mfma_f32_16x16x32_bf16 a[216:219], a[200:203], a[232:235], a[216:219]
 s_waitcnt lgkmcnt(1)
 v_mfma_f32_16x16x32_bf16 a[216:219], a[204:207], a[236:239], a[216:219]
 s_cmp_lg_u32 s36, 0
 s_cbranch_vccnz L_tr_119
L_back_118:
 s_cbranch_scc1 L_dpf
 s_waitcnt vmcnt(4)
 v_cmp_eq_u32 vcc, 1, v15
 s_and_b32 s94, vcc_lo, 255
 s_cmp_eq_u32 s94, 255
 s_cbranch_scc0 L_spin_124
L_back_123:
 s_cmp_eq_u32 s1, 0
 s_cbranch_scc1 L_fence_125
L_back_126:
 s_cmp_eq_u32 s92, 0
 s_cbranch_scc1 L_dpx
L_dp:
 v_mfma_f32_16x16x32_bf16 a[0:3], a[128:131], v[192:195], a[0:3]
 s_add_u32 m0, s67, 0
 v_exp_f32 v20, v164
 v_mfma_f32_16x16x32_bf16 a[32:35], a[128:131], v[200:203], a[32:35]
 v_exp_f32 v21, v165
 v_mfma_f32_16x16x32_bf16 a[64:67], a[128:131], v[208:211], a[64:67]
 ds_read_b128 a[152:155], v18 offset:22528
 v_cvt_pk_bf16_f32 v224, v20, v21
 v_mfma_f32_16x16x32_bf16 a[96:99], a[128:131], v[216:219], a[96:99]
 s_waitcnt lgkmcnt(5)
 buffer_load_dwordx4 v14, s[4:7], s64 offen offset:0 sc1 lds
 v_mfma_f32_16x16x32_bf16 a[4:7], a[132:135], v[192:195], a[4:7]
 v_exp_f32 v20, v166
 v_mfma_f32_16x16x32_bf16 a[36:39], a[132:135], v[200:203], a[36:39]
 v_exp_f32 v21, v167
 v_mfma_f32_16x16x32_bf16 a[68:71], a[132:135], v[208:211], a[68:71]
 ds_read_b128 a[156:159], v18 offset:23552
 v_cvt_pk_bf16_f32 v225, v20, v21
 v_mfma_f32_16x16x32_bf16 a[100:103], a[132:135], v[216:219], a[100:103]
 s_waitcnt lgkmcnt(5)
 ds_read_b128 a[160:163], v18 offset:0
 v_or_b32 v13, v224, v225
 v_mfma_f32_16x16x32_bf16 a[8:11], a[136:139], v[192:195], a[8:11]
 v_exp_f32 v20, v228
 v_mfma_f32_16x16x32_bf16 a[40:43], a[136:139], v[200:203], a[40:43]
 v_exp_f32 v21, v229
 v_mfma_f32_16x16x32_bf16 a[72:75], a[136:139], v[208:211], a[72:75]
 ds_read_b128 a[164:167], v18 offset:1024
 v_cvt_pk_bf16_f32 v226, v20, v21
 v_mfma_f32_16x16x32_bf16 a[104:107], a[136:139], v[216:219], a[104:107]
 s_waitcnt lgkmcnt(6)
 buffer_load_dwordx4 v14, s[4:7], s64 offen offset:1024 sc1 lds
 v_mfma_f32_16x16x32_bf16 a[12:15], a[140:143], v[192:195], a[12:15]
 v_exp_f32 v20, v230
 v_mfma_f32_16x16x32_bf16 a[44:47], a[140:143], v[200:203], a[44:47]
 v_exp_f32 v21, v231
 v_mfma_f32_16x16x32_bf16 a[76:79], a[140:143], v[208:211], a[76:79]
 ds_read_b128 a[168:171], v18 offset:2048
 v_cvt_pk_bf16_f32 v227, v20, v21
 v_mfma_f32_16x16x32_bf16 a[108:111], a[140:143], v[216:219], a[108:111]
 s_waitcnt lgkmcnt(6)
 ds_read_b128 a[172:175], v18 offset:3072
 v_or3_b32 v13, v226, v227, v13
 v_mfma_f32_16x16x32_bf16 a[16:19], a[144:147], v[192:195], a[16:19]
 v_exp_f32 v20, v172
 v_mfma_f32_16x16x32_bf16 a[48:51], a[144:147], v[200:203], a[48:51]
 v_exp_f32 v21, v173
 v_mfma_f32_16x16x32_bf16 a[80:83], a[144:147], v[208:211], a[80:83]
 ds_read_b128 a[176:179], v18 offset:4096
 v_cvt_pk_bf16_f32 v232, v20, v21
 v_mfma_f32_16x16x32_bf16 a[112:115], a[144:147], v[216:219], a[112:115]
 s_waitcnt lgkmcnt(7)
 buffer_load_dwordx4 v14, s[4:7], s64 offen offset:2048 sc1 lds
 v_mfma_f32_16x16x32_bf16 a[20:23], a[148:151], v[192:195], a[20:23]
 v_exp_f32 v20, v174
 v_mfma_f32_16x16x32_bf16 a[52:55], a[148:151], v[200:203], a[52:55]
 v_exp_f32 v21, v175
 v_mfma_f32_16x16x32_bf16 a[84:87], a[148:151], v[208:211], a[84:87]
 ds_read_b128 a[180:183], v18 offset:5120
 v_cvt_pk_bf16_f32 v233, v20, v21
 v_mfma_f32_16x16x32_bf16 a[116:119], a[148:151], v[216:219], a[116:119]
 s_waitcnt lgkmcnt(7)
 ds_read_b128 a[184:187], v18 offset:6144
 v_or3_b32 v13, v232, v233, v13
 v_mfma_f32_16x16x32_bf16 a[24:27], a[152:155], v[192:195], a[24:27]
 v_exp_f32 v20, v236
 v_mfma_f32_16x16x32_bf16 a[56:59], a[152:155], v[200:203], a[56:59]
 v_exp_f32 v21, v237
 v_mfma_f32_16x16x32_bf16 a[88:91], a[152:155], v[208:211], a[88:91]
 ds_read_b128 a[188:191], v18 offset:7168
 v_cvt_pk_bf16_f32 v234, v20, v21
 v_mfma_f32_16x16x32_bf16 a[120:123], a[152:155], v[216:219], a[120:123]
 s_waitcnt lgkmcnt(8)
 buffer_load_dwordx4 v14, s[4:7], s64 offen offset:3072 sc1 lds
 s_add_u32 s64, s64, 16384
 s_add_u32 m0, s67, 16384
 v_mfma_f32_16x16x32_bf16 a[28:31], a[156:159], v[192:195], a[28:31]
 v_exp_f32 v20, v238
 v_mfma_f32_16x16x32_bf16 a[60:63], a[156:159], v[200:203], a[60:63]
 v_exp_f32 v21, v239
 v_mfma_f32_16x16x32_bf16 a[92:95], a[156:159], v[208:211], a[92:95]
 ds_read_b128 a[128:131], v18 offset:24576
 v_cvt_pk_bf16_f32 v235, v20, v21
 v_mfma_f32_16x16x32_bf16 a[124:127], a[156:159], v[216:219], a[124:127]
 s_waitcnt lgkmcnt(8)
 ds_read_b128 a[132:135], v18 offset:25600
 v_or3_b32 v13, v234, v235, v13
 v_mfma_f32_16x16x32_bf16 v[52:55], a[160:163], v[48:51], v[176:179]
 s_waitcnt lgkmcnt(8)
 v_exp_f32 v20, v180
 v_mfma_f32_16x16x32_bf16 v[52:55], a[164:167], v[84:87], v[52:55]
 s_waitcnt lgkmcnt(7)
 v_exp_f32 v21, v181
 v_mfma_f32_16x16x32_bf16 v[52:55], a[168:171], v[148:151], v[52:55]
 s_waitcnt lgkmcnt(6)
 ds_read_b128 a[136:139], v18 offset:26624
 v_cvt_pk_bf16_f32 v240, v20, v21
 v_mfma_f32_16x16x32_bf16 v[52:55], a[172:175], v[212:215], v[52:55]
 buffer_load_dwordx4 v14, s[4:7], s65 offen offset:0 sc1 lds
 v_mfma_f32_16x16x32_bf16 v[60:63], a[160:163], v[56:59], v[184:187]
 v_exp_f32 v20, v182
 v_mfma_f32_16x16x32_bf16 v[60:63], a[164:167], v[92:95], v[60:63]
 v_exp_f32 v21, v183
 v_mfma_f32_16x16x32_bf16 v[60:63], a[168:171], v[156:159], v[60:63]
 ds_read_b128 a[140:143], v18 offset:27648
 v_cvt_pk_bf16_f32 v241, v20, v21
 v_mfma_f32_16x16x32_bf16 v[60:63], a[172:175], v[220:223], v[60:63]
 ds_read_b128 a[144:147], v18 offset:28672
 v_or3_b32 v13, v240, v241, v13
 v_mfma_f32_16x16x32_bf16 v[36:39], a[160:163], v[32:35], v[160:163]
 v_exp_f32 v20, v244
 v_mfma_f32_16x16x32_bf16 v[36:39], a[164:167], v[68:71], v[36:39]
 v_exp_f32 v21, v245
 v_mfma_f32_16x16x32_bf16 v[36:39], a[168:171], v[132:135], v[36:39]
 ds_read_b128 a[148:151], v18 offset:29696
 v_cvt_pk_bf16_f32 v242, v20, v21
 v_mfma_f32_16x16x32_bf16 v[36:39], a[172:175], v[196:199], v[36:39]
 buffer_load_dwordx4 v14, s[4:7], s65 offen offset:1024 sc1 lds
 v_mfma_f32_16x16x32_bf16 v[44:47], a[160:163], v[40:43], v[168:171]
 v_exp_f32 v20, v246
 v_mfma_f32_16x16x32_bf16 v[44:47], a[164:167], v[76:79], v[44:47]
 v_exp_f32 v21, v247
 v_mfma_f32_16x16x32_bf16 v[44:47], a[168:171], v[140:143], v[44:47]
 ds_read_b128 a[152:155], v18 offset:30720
 v_cvt_pk_bf16_f32 v243, v20, v21
 v_mfma_f32_16x16x32_bf16 v[44:47], a[172:175], v[204:207], v[44:47]
 s_waitcnt lgkmcnt(10)
 ds_read_b128 a[156:159], v18 offset:31744
 v_or3_b32 v13, v242, v243, v13
 v_mfma_f32_16x16x32_bf16 v[116:119], a[176:179], v[48:51], v[176:179]
 s_waitcnt lgkmcnt(10)
 v_exp_f32 v20, v188
 v_mfma_f32_16x16x32_bf16 v[116:119], a[180:183], v[84:87], v[116:119]
 s_waitcnt lgkmcnt(9)
 v_exp_f32 v21, v189
 v_mfma_f32_16x16x32_bf16 v[116:119], a[184:187], v[148:151], v[116:119]
 s_waitcnt lgkmcnt(8)
 ds_read_b128 a[160:163], v18 offset:8192
 v_cvt_pk_bf16_f32 v248, v20, v21
 v_mfma_f32_16x16x32_bf16 v[116:119], a[188:191], v[212:215], v[116:119]
 buffer_load_dwordx4 v14, s[4:7], s65 offen offset:2048 sc1 lds
 v_mfma_f32_16x16x32_bf16 v[124:127], a[176:179], v[56:59], v[184:187]
 v_exp_f32 v20, v190
 v_mfma_f32_16x16x32_bf16 v[124:127], a[180:183], v[92:95], v[124:127]
 v_exp_f32 v21, v191
 v_mfma_f32_16x16x32_bf16 v[124:127], a[184:187], v[156:159], v[124:127]
 ds_read_b128 a[164:167], v18 offset:9216
 v_cvt_pk_bf16_f32 v249, v20, v21
 v_mfma_f32_16x16x32_bf16 v[124:127], a[188:191], v[220:223], v[124:127]
 ds_read_b128 a[168:171], v18 offset:10240
 v_or3_b32 v13, v248, v249, v13
 v_mfma_f32_16x16x32_bf16 v[100:103], a[176:179], v[32:35], v[160:163]
 v_exp_f32 v20, v252
 v_mfma_f32_16x16x32_bf16 v[100:103], a[180:183], v[68:71], v[100:103]
 v_exp_f32 v21, v253
 v_mfma_f32_16x16x32_bf16 v[100:103], a[184:187], v[132:135], v[100:103]
 ds_read_b128 a[172:175], v18 offset:11264
 v_cvt_pk_bf16_f32 v250, v20, v21
 v_mfma_f32_16x16x32_bf16 v[100:103], a[188:191], v[196:199], v[100:103]
 buffer_load_dwordx4 v14, s[4:7], s65 offen offset:3072 sc1 lds
 s_add_u32 s65, s65, 16384
 v_mfma_f32_16x16x32_bf16 v[108:111], a[176:179], v[40:43], v[168:171]
 v_exp_f32 v20, v254
 v_mfma_f32_16x16x32_bf16 v[108:111], a[180:183], v[76:79], v[108:111]
 v_exp_f32 v21, v255
 v_mfma_f32_16x16x32_bf16 v[108:111], a[184:187], v[140:143], v[108:111]
 ds_read_b128 a[176:179], v18 offset:12288
 v_cvt_pk_bf16_f32 v251, v20, v21
 v_mfma_f32_16x16x32_bf16 v[108:111], a[188:191], v[204:207], v[108:111]
 ds_read_b128 a[180:183], v18 offset:13312
 v_or3_b32 v13, v250, v251, v13
 v_mfma_f32_16x16x32_bf16 v[120:123], v[28:31], v[192:195], v[120:123]
 v_and_b32 v13, 0x40004000, v13
 v_cmp_ne_u32 vcc, 0, v13
 v_mfma_f32_16x16x32_bf16 v[128:131], v[28:31], v[200:203], v[128:131]
 ds_read_b128 a[184:187], v18 offset:14336
 v_mfma_f32_16x16x32_bf16 v[136:139], v[28:31], v[208:211], v[136:139]
 ds_read_b128 a[188:191], v18 offset:15360
 v_mfma_f32_16x16x32_bf16 v[144:147], v[28:31], v[216:219], v[144:147]
 s_waitcnt lgkmcnt(15)
 s_cbranch_vccnz L_tr_128
L_back_127:
 v_mfma_f32_16x16x32_bf16 a[0:3], a[128:131], v[224:227], a[0:3]
 v_exp_f32 v20, v36
 v_mfma_f32_16x16x32_bf16 a[32:35], a[128:131], v[232:235], a[32:35]
 v_exp_f32 v21, v37
 v_mfma_f32_16x16x32_bf16 a[64:67], a[128:131], v[240:243], a[64:67]
 v_cvt_pk_bf16_f32 v192, v20, v21
 v_mfma_f32_16x16x32_bf16 a[96:99], a[128:131], v[248:251], a[96:99]
 s_waitcnt vmcnt(8) lgkmcnt(14)
 buffer_load_dword v15, v19, s[4:7], 0 offen sc1
 v_mfma_f32_16x16x32_bf16 a[4:7], a[132:135], v[224:227], a[4:7]
 v_exp_f32 v20, v38
 v_mfma_f32_16x16x32_bf16 a[36:39], a[132:135], v[232:235], a[36:39]
 v_exp_f32 v21, v39
 v_mfma_f32_16x16x32_bf16 a[68:71], a[132:135], v[240:243], a[68:71]
 v_cvt_pk_bf16_f32 v193, v20, v21
 v_mfma_f32_16x16x32_bf16 a[100:103], a[132:135], v[248:251], a[100:103]
 s_waitcnt lgkmcnt(13)
 v_or_b32 v13, v192, v193
 v_mfma_f32_16x16x32_bf16 a[8:11], a[136:139], v[224:227], a[8:11]
 v_exp_f32 v20, v100
 v_mfma_f32_16x16x32_bf16 a[40:43], a[136:139], v[232:235], a[40:43]
 v_exp_f32 v21, v101
 v_mfma_f32_16x16x32_bf16 a[72:75], a[136:139], v[240:243], a[72:75]
 v_cvt_pk_bf16_f32 v194, v20, v21
 v_mfma_f32_16x16x32_bf16 a[104:107], a[136:139], v[248:251], a[104:107]
 s_waitcnt lgkmcnt(12)
 v_mfma_f32_16x16x32_bf16 a[12:15], a[140:143], v[224:227], a[12:15]
 v_exp_f32 v20, v102
 v_mfma_f32_16x16x32_bf16 a[44:47], a[140:143], v[232:235], a[44:47]
 v_exp_f32 v21, v103
 v_mfma_f32_16x16x32_bf16 a[76:79], a[140:143], v[240:243], a[76:79]
 v_cvt_pk_bf16_f32 v195, v20, v21
 v_mfma_f32_16x16x32_bf16 a[108:111], a[140:143], v[248:251], a[108:111]
 s_waitcnt lgkmcnt(11)
 v_or3_b32 v13, v194, v195, v13
 v_mfma_f32_16x16x32_bf16 a[16:19], a[144:147], v[224:227], a[16:19]
 v_exp_f32 v20, v44
 v_mfma_f32_16x16x32_bf16 a[48:51], a[144:147], v[232:235], a[48:51]
 v_exp_f32 v21, v45
 v_mfma_f32_16x16x32_bf16 a[80:83], a[144:147], v[240:243], a[80:83]
 v_cvt_pk_bf16_f32 v200, v20, v21
 v_mfma_f32_16x16x32_bf16 a[112:115], a[144:147], v[248:251], a[112:115]
 s_waitcnt lgkmcnt(10)
 v_mfma_f32_16x16x32_bf16 a[20:23], a[148:151], v[224:227], a[20:23]
 v_exp_f32 v20, v46
 v_mfma_f32_16x16x32_bf16 a[52:55], a[148:151], v[232:235], a[52:55]
 v_exp_f32 v21, v47
 v_mfma_f32_16x16x32_bf16 a[84:87], a[148:151], v[240:243], a[84:87]
 v_cvt_pk_bf16_f32 v201, v20, v21
 v_mfma_f32_16x16x32_bf16 a[116:119], a[148:151], v[248:251], a[116:119]
 s_waitcnt lgkmcnt(9)
 v_or3_b32 v13, v200, v201, v13
 v_mfma_f32_16x16x32_bf16 a[24:27], a[152:155], v[224:227], a[24:27]
 v_exp_f32 v20, v108
 v_mfma_f32_16x16x32_bf16 a[56:59], a[152:155], v[232:235], a[56:59]
 v_exp_f32 v21, v109
 v_mfma_f32_16x16x32_bf16 a[88:91], a[152:155], v[240:243], a[88:91]
 v_cvt_pk_bf16_f32 v202, v20, v21
 v_mfma_f32_16x16x32_bf16 a[120:123], a[152:155], v[248:251], a[120:123]
 s_waitcnt lgkmcnt(8)
 v_mfma_f32_16x16x32_bf16 a[28:31], a[156:159], v[224:227], a[28:31]
 v_exp_f32 v20, v110
 v_mfma_f32_16x16x32_bf16 a[60:63], a[156:159], v[232:235], a[60:63]
 v_exp_f32 v21, v111
 v_mfma_f32_16x16x32_bf16 a[92:95], a[156:159], v[240:243], a[92:95]
 v_cvt_pk_bf16_f32 v203, v20, v21
 v_mfma_f32_16x16x32_bf16 a[124:127], a[156:159], v[248:251], a[124:127]
 s_waitcnt lgkmcnt(7)
 v_or3_b32 v13, v202, v203, v13
 v_mfma_f32_16x16x32_bf16 v[180:183], a[160:163], v[48:51], v[176:179]
 s_waitcnt lgkmcnt(6)
 s_sub_u32 s68, s68, 4
 v_exp_f32 v20, v52
 v_mfma_f32_16x16x32_bf16 v[180:183], a[164:167], v[84:87], v[180:183]
 s_waitcnt lgkmcnt(5)
 v_exp_f32 v21, v53
 v_mfma_f32_16x16x32_bf16 v[180:183], a[168:171], v[148:151], v[180:183]
 s_waitcnt lgkmcnt(4)
 v_cvt_pk_bf16_f32 v208, v20, v21
 v_mfma_f32_16x16x32_bf16 v[180:183], a[172:175], v[212:215], v[180:183]
 v_mfma_f32_16x16x32_bf16 v[188:191], a[160:163], v[56:59], v[184:187]
 v_exp_f32 v20, v54
 v_mfma_f32_16x16x32_bf16 v[188:191], a[164:167], v[92:95], v[188:191]
 v_exp_f32 v21, v55
 v_mfma_f32_16x16x32_bf16 v[188:191], a[168:171], v[156:159], v[188:191]
 v_cvt_pk_bf16_f32 v209, v20, v21
 v_mfma_f32_16x16x32_bf16 v[188:191], a[172:175], v[220:223], v[188:191]
 v_or3_b32 v13, v208, v209, v13
 v_mfma_f32_16x16x32_bf16 v[164:167], a[160:163], v[32:35], v[160:163]
 s_add_u32 s67, s66, s82
 v_exp_f32 v20, v116
 v_mfma_f32_16x16x32_bf16 v[164:167], a[164:167], v[68:71], v[164:167]
 s_add_u32 s66, s66, 32768
 v_exp_f32 v21, v117
 v_mfma_f32_16x16x32_bf16 v[164:167], a[168:171], v[132:135], v[164:167]
 s_cmp_eq_u32 s66, 98304
 s_cselect_b32 s66, 0, s66
 v_cvt_pk_bf16_f32 v210, v20, v21
 v_mfma_f32_16x16x32_bf16 v[164:167], a[172:175], v[196:199], v[164:167]
 v_add_u32 v18, s66, v14
 v_mfma_f32_16x16x32_bf16 v[172:175], a[160:163], v[40:43], v[168:171]
 s_waitcnt vmcnt(16) lgkmcnt(0)
 s_barrier
 v_exp_f32 v20, v118
 v_mfma_f32_16x16x32_bf16 v[172:175], a[164:167], v[76:79], v[172:175]
 v_exp_f32 v21, v119
 v_mfma_f32_16x16x32_bf16 v[172:175], a[168:171], v[140:143], v[172:175]
 ds_read_b128 a[128:131], v18 offset:16384
 v_cvt_pk_bf16_f32 v211, v20, v21
 v_mfma_f32_16x16x32_bf16 v[172:175], a[172:175], v[204:207], v[172:175]
 v_or3_b32 v13, v210, v211, v13
 v_mfma_f32_16x16x32_bf16 v[244:247], a[176:179], v[48:51], v[176:179]
 v_exp_f32 v20, v60
 v_mfma_f32_16x16x32_bf16 v[244:247], a[180:183], v[84:87], v[244:247]
 v_exp_f32 v21, v61
 v_mfma_f32_16x16x32_bf16 v[244:247], a[184:187], v[148:151], v[244:247]
 ds_read_b128 a[132:135], v18 offset:17408
 v_cvt_pk_bf16_f32 v216, v20, v21
 v_mfma_f32_16x16x32_bf16 v[244:247], a[188:191], v[212:215], v[244:247]
 v_mfma_f32_16x16x32_bf16 v[252:255], a[176:179], v[56:59], v[184:187]
 v_exp_f32 v20, v62
 v_mfma_f32_16x16x32_bf16 v[252:255], a[180:183], v[92:95], v[252:255]
 v_exp_f32 v21, v63
 v_mfma_f32_16x16x32_bf16 v[252:255], a[184:187], v[156:159], v[252:255]
 ds_read_b128 a[136:139], v18 offset:18432
 v_cvt_pk_bf16_f32 v217, v20, v21
 v_mfma_f32_16x16x32_bf16 v[252:255], a[188:191], v[220:223], v[252:255]
 v_or3_b32 v13, v216, v217, v13
 v_mfma_f32_16x16x32_bf16 v[228:231], a[176:179], v[32:35], v[160:163]
 v_exp_f32 v20, v124
 v_mfma_f32_16x16x32_bf16 v[228:231], a[180:183], v[68:71], v[228:231]
 v_exp_f32 v21, v125
 v_mfma_f32_16x16x32_bf16 v[228:231], a[184:187], v[132:135], v[228:231]
 s_sub_u32 s92, s92, 1
 ds_read_b128 a[140:143], v18 offset:19456
 v_cvt_pk_bf16_f32 v218, v20, v21
 v_mfma_f32_16x16x32_bf16 v[228:231], a[188:191], v[196:199], v[228:231]
 v_mfma_f32_16x16x32_bf16 v[236:239], a[176:179], v[40:43], v[168:171]
 v_exp_f32 v20, v126
 v_mfma_f32_16x16x32_bf16 v[236:239], a[180:183], v[76:79], v[236:239]
 v_exp_f32 v21, v127
 v_mfma_f32_16x16x32_bf16 v[236:239], a[184:187], v[140:143], v[236:239]
 ds_read_b128 a[144:147], v18 offset:20480
 v_cvt_pk_bf16_f32 v219, v20, v21
 v_mfma_f32_16x16x32_bf16 v[236:239], a[188:191], v[204:207], v[236:239]
 v_or3_b32 v13, v218, v219, v13
 v_mfma_f32_16x16x32_bf16 v[120:123], v[28:31], v[224:227], v[120:123]
 v_and_b32 v13, 0x40004000, v13
 v_cmp_ne_u32 vcc, 0, v13
 v_mfma_f32_16x16x32_bf16 v[128:131], v[28:31], v[232:235], v[128:131]
 ds_read_b128 a[148:151], v18 offset:21504
 v_mfma_f32_16x16x32_bf16 v[136:139], v[28:31], v[240:243], v[136:139]
 v_mfma_f32_16x16x32_bf16 v[144:147], v[28:31], v[248:251], v[144:147]
 s_waitcnt lgkmcnt(5)
 s_cmp_lg_u32 s92, 0
 s_cbranch_vccnz L_tr_130
L_back_129:
 s_cbranch_scc1 L_dp
L_dpx:
 s_waitcnt vmcnt(0)
 v_cmp_eq_u32 vcc, 1, v15
 s_and_b32 s94, vcc_lo, 255
 s_cmp_eq_u32 s94, 255
 s_cbranch_scc0 L_spin_134
L_back_133:
 s_cmp_eq_u32 s1, 0
 s_cbranch_scc1 L_fence_135
L_back_136:
 s_mov_b32 s92, 1
L_dd_one:
 s_add_u32 s92, s92, 1
L_dd:
 v_mfma_f32_16x16x32_bf16 a[0:3], a[128:131], v[192:195], a[0:3]
 s_add_u32 m0, s67, 0
 v_exp_f32 v20, v164
 v_mfma_f32_16x16x32_bf16 a[32:35], a[128:131], v[200:203], a[32:35]
 v_exp_f32 v21, v165
 v_mfma_f32_16x16x32_bf16 a[64:67], a[128:131], v[208:211], a[64:67]
 s_cmp_eq_i32 s68, 1
 s_cselect_b32 s73, 1.0, 0
 v_cvt_pk_bf16_f32 v224, v20, v21
 v_mfma_f32_16x16x32_bf16 a[96:99], a[128:131], v[216:219], a[96:99]
 s_waitcnt lgkmcnt(4)
 s_cmp_lt_i32 s68, 1
 s_cselect_b32 s78, 0xf1800000, 0
 buffer_load_dwordx4 v14, s[4:7], s64 offen offset:0 sc1 lds
 v_mfma_f32_16x16x32_bf16 a[4:7], a[132:135], v[192:195], a[4:7]
 s_cmp_eq_i32 s68, 0
 s_cselect_b32 s74, 1.0, 0
 v_exp_f32 v20, v166
 v_mfma_f32_16x16x32_bf16 a[36:39], a[132:135], v[200:203], a[36:39]
 s_cmp_lt_i32 s68, 0
 s_cselect_b32 s79, 0xf1800000, 0
 v_exp_f32 v21, v167
 v_mfma_f32_16x16x32_bf16 a[68:71], a[132:135], v[208:211], a[68:71]
 s_cmp_eq_i32 s68, -1
 s_cselect_b32 s75, 1.0, 0
 buffer_load_dwordx4 v14, s[4:7], s64 offen offset:1024 sc1 lds
 v_cvt_pk_bf16_f32 v225, v20, v21
 v_mfma_f32_16x16x32_bf16 a[100:103], a[132:135], v[216:219], a[100:103]
 s_waitcnt lgkmcnt(3)
 s_cmp_lt_i32 s68, -1
 s_cselect_b32 s80, 0xf1800000, 0
 v_or_b32 v13, v224, v225
 v_mfma_f32_16x16x32_bf16 a[8:11], a[136:139], v[192:195], a[8:11]
 s_sub_u32 s68, s68, 2
 v_exp_f32 v20, v228
 v_mfma_f32_16x16x32_bf16 a[40:43], a[136:139], v[200:203], a[40:43]
 v_exp_f32 v21, v229
 v_mfma_f32_16x16x32_bf16 a[72:75], a[136:139], v[208:211], a[72:75]
 ds_read_b128 a[152:155], v18 offset:22528
 v_cvt_pk_bf16_f32 v226, v20, v21
 v_mfma_f32_16x16x32_bf16 a[104:107], a[136:139], v[216:219], a[104:107]
 s_waitcnt lgkmcnt(3)
 buffer_load_dwordx4 v14, s[4:7], s64 offen offset:2048 sc1 lds
 v_mfma_f32_16x16x32_bf16 a[12:15], a[140:143], v[192:195], a[12:15]
 v_exp_f32 v20, v230
 v_mfma_f32_16x16x32_bf16 a[44:47], a[140:143], v[200:203], a[44:47]
 v_exp_f32 v21, v231
 v_mfma_f32_16x16x32_bf16 a[76:79], a[140:143], v[208:211], a[76:79]
 ds_read_b128 a[156:159], v18 offset:23552
 v_cvt_pk_bf16_f32 v227, v20, v21
 v_mfma_f32_16x16x32_bf16 a[108:111], a[140:143], v[216:219], a[108:111]
 s_waitcnt lgkmcnt(3)
 ds_read_b128 a[160:163], v18 offset:0
 v_or3_b32 v13, v226, v227, v13
 v_mfma_f32_16x16x32_bf16 a[16:19], a[144:147], v[192:195], a[16:19]
 v_exp_f32 v20, v172
 v_mfma_f32_16x16x32_bf16 a[48:51], a[144:147], v[200:203], a[48:51]
 v_exp_f32 v21, v173
 v_mfma_f32_16x16x32_bf16 a[80:83], a[144:147], v[208:211], a[80:83]
 ds_read_b128 a[164:167], v18 offset:1024
 v_cvt_pk_bf16_f32 v232, v20, v21
 v_mfma_f32_16x16x32_bf16 a[112:115], a[144:147], v[216:219], a[112:115]
 s_waitcnt lgkmcnt(4)
 buffer_load_dwordx4 v14, s[4:7], s64 offen offset:3072 sc1 lds
 s_add_u32 s64, s64, 16384
 s_add_u32 m0, s67, 16384
 v_mfma_f32_16x16x32_bf16 a[20:23], a[148:151], v[192:195], a[20:23]
 v_exp_f32 v20, v174
 v_mfma_f32_16x16x32_bf16 a[52:55], a[148:151], v[200:203], a[52:55]
 v_exp_f32 v21, v175
 v_mfma_f32_16x16x32_bf16 a[84:87], a[148:151], v[208:211], a[84:87]
 buffer_load_dwordx4 v14, s[4:7], s65 offen offset:0 sc1 lds
 v_cvt_pk_bf16_f32 v233, v20, v21
 v_mfma_f32_16x16x32_bf16 a[116:119], a[148:151], v[216:219], a[116:119]
 s_waitcnt lgkmcnt(3)
 ds_read_b128 a[168:171], v18 offset:2048
 v_or3_b32 v13, v232, v233, v13
 v_mfma_f32_16x16x32_bf16 a[24:27], a[152:155], v[192:195], a[24:27]
 v_exp_f32 v20, v236
 v_mfma_f32_16x16x32_bf16 a[56:59], a[152:155], v[200:203], a[56:59]
 v_exp_f32 v21, v237
 v_mfma_f32_16x16x32_bf16 a[88:91], a[152:155], v[208:211], a[88:91]
 ds_read_b128 a[172:175], v18 offset:3072
 v_cvt_pk_bf16_f32 v234, v20, v21
 v_mfma_f32_16x16x32_bf16 a[120:123], a[152:155], v[216:219], a[120:123]
 s_waitcnt lgkmcnt(4)
 buffer_load_dwordx4 v14, s[4:7], s65 offen offset:1024 sc1 lds
 v_mfma_f32_16x16x32_bf16 a[28:31], a[156:159], v[192:195], a[28:31]
 v_exp_f32 v20, v238
 v_mfma_f32_16x16x32_bf16 a[60:63], a[156:159], v[200:203], a[60:63]
 v_exp_f32 v21, v239
 v_mfma_f32_16x16x32_bf16 a[92:95], a[156:159], v[208:211], a[92:95]
 ds_read_b128 a[176:179], v18 offset:4096
 v_cvt_pk_bf16_f32 v235, v20, v21
 v_mfma_f32_16x16x32_bf16 a[124:127], a[156:159], v[216:219], a[124:127]
 s_waitcnt lgkmcnt(4)
 buffer_load_dwordx4 v14, s[4:7], s65 offen offset:2048 sc1 lds
 v_or3_b32 v13, v234, v235, v13
 v_mfma_f32_16x16x32_bf16 v[52:55], a[160:163], v[48:51], v[176:179]
 s_waitcnt lgkmcnt(3)
 v_exp_f32 v20, v180
 v_mfma_f32_16x16x32_bf16 v[52:55], a[164:167], v[84:87], v[52:55]
 s_waitcnt lgkmcnt(2)
 v_exp_f32 v21, v181
 v_mfma_f32_16x16x32_bf16 v[52:55], a[168:171], v[148:151], v[52:55]
 s_waitcnt lgkmcnt(1)
 ds_read_b128 a[180:183], v18 offset:5120
 v_cvt_pk_bf16_f32 v240, v20, v21
 v_mfma_f32_16x16x32_bf16 v[52:55], a[172:175], v[212:215], v[52:55]
 buffer_load_dwordx4 v14, s[4:7], s65 offen offset:3072 sc1 lds
 s_add_u32 s65, s65, 16384
 v_mfma_f32_16x16x32_bf16 v[60:63], a[160:163], v[56:59], v[184:187]
 s_add_u32 m0, s85, 98304
 v_exp_f32 v20, v182
 v_mfma_f32_16x16x32_bf16 v[60:63], a[164:167], v[92:95], v[60:63]
 v_exp_f32 v21, v183
 v_add_f32 v22, s79, v160
 v_fma_f32 v36, v24, s74, v22
 v_fma_f32 v37, v25, s74, v22
 v_fma_f32 v38, v26, s74, v22
 v_fma_f32 v39, v27, s74, v22
 v_mfma_f32_16x16x32_bf16 v[60:63], a[168:171], v[156:159], v[60:63]
 ds_read_b128 a[184:187], v18 offset:6144
 v_cvt_pk_bf16_f32 v241, v20, v21
 v_mfma_f32_16x16x32_bf16 v[60:63], a[172:175], v[220:223], v[60:63]
 ds_read_b128 a[188:191], v18 offset:7168
 v_or3_b32 v13, v240, v241, v13
 v_mfma_f32_16x16x32_bf16 v[36:39], a[160:163], v[32:35], v[36:39]
 v_exp_f32 v20, v244
 v_mfma_f32_16x16x32_bf16 v[36:39], a[164:167], v[68:71], v[36:39]
 v_exp_f32 v21, v245
 v_add_f32 v22, s80, v168
 v_fma_f32 v44, v24, s75, v22
 v_fma_f32 v45, v25, s75, v22
 v_fma_f32 v46, v26, s75, v22
 v_fma_f32 v47, v27, s75, v22
 v_mfma_f32_16x16x32_bf16 v[36:39], a[168:171], v[132:135], v[36:39]
 ds_read_b128 a[128:131], v18 offset:24576
 v_cvt_pk_bf16_f32 v242, v20, v21
 v_mfma_f32_16x16x32_bf16 v[36:39], a[172:175], v[196:199], v[36:39]
 buffer_load_dwordx4 v96, s[56:59], s27 offen offset:0 lds
 v_mfma_f32_16x16x32_bf16 v[44:47], a[160:163], v[40:43], v[44:47]
 v_exp_f32 v20, v246
 v_mfma_f32_16x16x32_bf16 v[44:47], a[164:167], v[76:79], v[44:47]
 v_exp_f32 v21, v247
 v_mfma_f32_16x16x32_bf16 v[44:47], a[168:171], v[140:143], v[44:47]
 buffer_load_dwordx4 v97, s[56:59], s27 offen offset:1024 lds
 v_cvt_pk_bf16_f32 v243, v20, v21
 v_mfma_f32_16x16x32_bf16 v[44:47], a[172:175], v[204:207], v[44:47]
 s_waitcnt lgkmcnt(4)
 ds_read_b128 a[132:135], v18 offset:25600
 v_or3_b32 v13, v242, v243, v13
 v_mfma_f32_16x16x32_bf16 v[116:119], a[176:179], v[48:51], v[176:179]
 s_waitcnt lgkmcnt(4)
 v_exp_f32 v20, v188
 v_mfma_f32_16x16x32_bf16 v[116:119], a[180:183], v[84:87], v[116:119]
 s_waitcnt lgkmcnt(3)
 v_exp_f32 v21, v189
 v_mfma_f32_16x16x32_bf16 v[116:119], a[184:187], v[148:151], v[116:119]
 s_waitcnt lgkmcnt(2)
 ds_read_b128 a[136:139], v18 offset:26624
 v_cvt_pk_bf16_f32 v248, v20, v21
 v_mfma_f32_16x16x32_bf16 v[116:119], a[188:191], v[212:215], v[116:119]
 buffer_load_dwordx4 v98, s[56:59], s27 offen offset:2048 lds
 v_mfma_f32_16x16x32_bf16 v[124:127], a[176:179], v[56:59], v[184:187]
 v_exp_f32 v20, v190
 v_mfma_f32_16x16x32_bf16 v[124:127], a[180:183], v[92:95], v[124:127]
 v_exp_f32 v21, v191
 v_add_f32 v22, s78, v160
 v_fma_f32 v100, v24, s73, v22
 v_fma_f32 v101, v25, s73, v22
 v_fma_f32 v102, v26, s73, v22
 v_fma_f32 v103, v27, s73, v22
 v_mfma_f32_16x16x32_bf16 v[124:127], a[184:187], v[156:159], v[124:127]
 ds_read_b128 a[140:143], v18 offset:27648
 v_cvt_pk_bf16_f32 v249, v20, v21
 v_mfma_f32_16x16x32_bf16 v[124:127], a[188:191], v[220:223], v[124:127]
 ds_read_b128 a[144:147], v18 offset:28672
 v_or3_b32 v13, v248, v249, v13
 v_mfma_f32_16x16x32_bf16 v[100:103], a[176:179], v[32:35], v[100:103]
 v_exp_f32 v20, v252
 v_mfma_f32_16x16x32_bf16 v[100:103], a[180:183], v[68:71], v[100:103]
 v_exp_f32 v21, v253
 v_add_f32 v22, s79, v168
 v_fma_f32 v108, v24, s74, v22
 v_fma_f32 v109, v25, s74, v22
 v_fma_f32 v110, v26, s74, v22
 v_fma_f32 v111, v27, s74, v22
 v_mfma_f32_16x16x32_bf16 v[100:103], a[184:187], v[132:135], v[100:103]
 ds_read_b128 a[148:151], v18 offset:29696
 v_cvt_pk_bf16_f32 v250, v20, v21
 v_mfma_f32_16x16x32_bf16 v[100:103], a[188:191], v[196:199], v[100:103]
 buffer_load_dwordx4 v99, s[56:59], s27 offen offset:3072 lds
 s_add_u32 m0, s85, 102400
 v_mfma_f32_16x16x32_bf16 v[108:111], a[176:179], v[40:43], v[108:111]
 v_exp_f32 v20, v254
 v_mfma_f32_16x16x32_bf16 v[108:111], a[180:183], v[76:79], v[108:111]
 v_exp_f32 v21, v255
 v_mfma_f32_16x16x32_bf16 v[108:111], a[184:187], v[140:143], v[108:111]
 ds_read_b128 a[152:155], v18 offset:30720
 v_cvt_pk_bf16_f32 v251, v20, v21
 v_mfma_f32_16x16x32_bf16 v[108:111], a[188:191], v[204:207], v[108:111]
 ds_read_b128 a[156:159], v18 offset:31744
 v_or3_b32 v13, v250, v251, v13
 v_mfma_f32_16x16x32_bf16 v[120:123], v[28:31], v[192:195], v[120:123]
 v_and_b32 v13, 0x40004000, v13
 v_cmp_ne_u32 vcc, 0, v13
 v_mfma_f32_16x16x32_bf16 v[128:131], v[28:31], v[200:203], v[128:131]
 buffer_load_dwordx4 v104, s[56:59], s27 offen offset:0 lds
 v_mfma_f32_16x16x32_bf16 v[136:139], v[28:31], v[208:211], v[136:139]
 buffer_load_dwordx4 v105, s[56:59], s27 offen offset:1024 lds
 v_mfma_f32_16x16x32_bf16 v[144:147], v[28:31], v[216:219], v[144:147]
 s_waitcnt lgkmcnt(7)
 ds_read_b128 a[160:163], v18 offset:8192
 s_cbranch_vccnz L_tr_138
L_back_137:
 v_mfma_f32_16x16x32_bf16 a[0:3], a[128:131], v[224:227], a[0:3]
 v_exp_f32 v20, v36
 v_mfma_f32_16x16x32_bf16 a[32:35], a[128:131], v[232:235], a[32:35]
 v_exp_f32 v21, v37
 v_mfma_f32_16x16x32_bf16 a[64:67], a[128:131], v[240:243], a[64:67]
 s_cmp_eq_i32 s68, 1
 s_cselect_b32 s73, 1.0, 0
 v_cvt_pk_bf16_f32 v192, v20, v21
 v_mfma_f32_16x16x32_bf16 a[96:99], a[128:131], v[248:251], a[96:99]
 s_waitcnt lgkmcnt(7)
 s_cmp_lt_i32 s68, 1
 s_cselect_b32 s78, 0xf1800000, 0
 buffer_load_dwordx4 v106, s[56:59], s27 offen offset:2048 lds
 v_mfma_f32_16x16x32_bf16 a[4:7], a[132:135], v[224:227], a[4:7]
 s_cmp_eq_i32 s68, 0
 s_cselect_b32 s74, 1.0, 0
 v_exp_f32 v20, v38
 v_mfma_f32_16x16x32_bf16 a[36:39], a[132:135], v[232:235], a[36:39]
 s_cmp_lt_i32 s68, 0
 s_cselect_b32 s79, 0xf1800000, 0
 v_exp_f32 v21, v39
 v_mfma_f32_16x16x32_bf16 a[68:71], a[132:135], v[240:243], a[68:71]
 s_cmp_eq_i32 s68, -1
 s_cselect_b32 s75, 1.0, 0
 v_cvt_pk_bf16_f32 v193, v20, v21
 v_mfma_f32_16x16x32_bf16 a[100:103], a[132:135], v[248:251], a[100:103]
 s_waitcnt lgkmcnt(6)
 buffer_load_dwordx4 v107, s[56:59], s27 offen offset:3072 lds
 s_add_u32 m0, s85, 106496
 v_or_b32 v13, v192, v193
 s_cmp_lt_i32 s68, -1
 s_cselect_b32 s80, 0xf1800000, 0
 v_mfma_f32_16x16x32_bf16 a[8:11], a[136:139], v[224:227], a[8:11]
 s_sub_u32 s68, s68, 2
 v_exp_f32 v20, v100
 v_mfma_f32_16x16x32_bf16 a[40:43], a[136:139], v[232:235], a[40:43]
 v_exp_f32 v21, v101
 v_mfma_f32_16x16x32_bf16 a[72:75], a[136:139], v[240:243], a[72:75]
 ds_read_b128 a[164:167], v18 offset:9216
 v_cvt_pk_bf16_f32 v194, v20, v21
 v_mfma_f32_16x16x32_bf16 a[104:107], a[136:139], v[248:251], a[104:107]
 s_waitcnt lgkmcnt(6)
 buffer_load_dwordx4 v112, s[56:59], s27 offen offset:0 lds
 v_mfma_f32_16x16x32_bf16 a[12:15], a[140:143], v[224:227], a[12:15]
 s_add_u32 m0, s22, 135168
 v_exp_f32 v20, v102
 v_mfma_f32_16x16x32_bf16 a[44:47], a[140:143], v[232:235], a[44:47]
 v_exp_f32 v21, v103
 v_mfma_f32_16x16x32_bf16 a[76:79], a[140:143], v[240:243], a[76:79]
 ds_read_b128 a[168:171], v18 offset:10240
 v_cvt_pk_bf16_f32 v195, v20, v21
 v_mfma_f32_16x16x32_bf16 a[108:111], a[140:143], v[248:251], a[108:111]
 s_waitcnt lgkmcnt(6)
 ds_read_b128 a[172:175], v18 offset:11264
 v_or3_b32 v13, v194, v195, v13
 v_mfma_f32_16x16x32_bf16 a[16:19], a[144:147], v[224:227], a[16:19]
 v_exp_f32 v20, v44
 v_mfma_f32_16x16x32_bf16 a[48:51], a[144:147], v[232:235], a[48:51]
 v_exp_f32 v21, v45
 v_mfma_f32_16x16x32_bf16 a[80:83], a[144:147], v[240:243], a[80:83]
 ds_read_b128 a[176:179], v18 offset:12288
 v_cvt_pk_bf16_f32 v200, v20, v21
 v_mfma_f32_16x16x32_bf16 a[112:115], a[144:147], v[248:251], a[112:115]
 s_waitcnt lgkmcnt(7)
 buffer_load_dwordx4 v96, s[28:31], s86 offen offset:0 lds
 v_mfma_f32_16x16x32_bf16 a[20:23], a[148:151], v[224:227], a[20:23]
 v_exp_f32 v20, v46
 v_mfma_f32_16x16x32_bf16 a[52:55], a[148:151], v[232:235], a[52:55]
 v_exp_f32 v21, v47
 v_mfma_f32_16x16x32_bf16 a[84:87], a[148:151], v[240:243], a[84:87]
 buffer_load_dwordx4 v97, s[28:31], s86 offen offset:1024 lds
 v_cvt_pk_bf16_f32 v201, v20, v21
 v_mfma_f32_16x16x32_bf16 a[116:119], a[148:151], v[248:251], a[116:119]
 s_waitcnt lgkmcnt(6)
 ds_read_b128 a[180:183], v18 offset:13312
 v_or3_b32 v13, v200, v201, v13
 v_mfma_f32_16x16x32_bf16 a[24:27], a[152:155], v[224:227], a[24:27]
 v_exp_f32 v20, v108
 v_mfma_f32_16x16x32_bf16 a[56:59], a[152:155], v[232:235], a[56:59]
 v_exp_f32 v21, v109
 v_mfma_f32_16x16x32_bf16 a[88:91], a[152:155], v[240:243], a[88:91]
 ds_read_b128 a[184:187], v18 offset:14336
 v_cvt_pk_bf16_f32 v202, v20, v21
 v_mfma_f32_16x16x32_bf16 a[120:123], a[152:155], v[248:251], a[120:123]
 s_waitcnt lgkmcnt(7)
 buffer_load_dwordx4 v98, s[28:31], s86 offen offset:2048 lds
 v_mfma_f32_16x16x32_bf16 a[28:31], a[156:159], v[224:227], a[28:31]
 v_exp_f32 v20, v110
 v_mfma_f32_16x16x32_bf16 a[60:63], a[156:159], v[232:235], a[60:63]
 v_exp_f32 v21, v111
 v_mfma_f32_16x16x32_bf16 a[92:95], a[156:159], v[240:243], a[92:95]
 ds_read_b128 a[188:191], v18 offset:15360
 v_cvt_pk_bf16_f32 v203, v20, v21
 v_mfma_f32_16x16x32_bf16 a[124:127], a[156:159], v[248:251], a[124:127]
 s_waitcnt lgkmcnt(7)
 v_or3_b32 v13, v202, v203, v13
 v_add_f32 v22, s79, v160
 v_mfma_f32_16x16x32_bf16 v[180:183], a[160:163], v[48:51], v[176:179]
 s_waitcnt lgkmcnt(6)
 v_exp_f32 v20, v52
 v_mfma_f32_16x16x32_bf16 v[180:183], a[164:167], v[84:87], v[180:183]
 s_waitcnt lgkmcnt(5)
 v_exp_f32 v21, v53
 v_mfma_f32_16x16x32_bf16 v[180:183], a[168:171], v[148:151], v[180:183]
 s_waitcnt lgkmcnt(4)
 v_cvt_pk_bf16_f32 v208, v20, v21
 v_fma_f32 v164, v24, s74, v22
 v_mfma_f32_16x16x32_bf16 v[180:183], a[172:175], v[212:215], v[180:183]
 buffer_load_dwordx4 v99, s[28:31], s86 offen offset:3072 lds
 s_add_u32 m0, s22, 139264
 v_mfma_f32_16x16x32_bf16 v[188:191], a[160:163], v[56:59], v[184:187]
 v_exp_f32 v20, v54
 v_mfma_f32_16x16x32_bf16 v[188:191], a[164:167], v[92:95], v[188:191]
 v_exp_f32 v21, v55
 v_fma_f32 v165, v25, s74, v22
 v_fma_f32 v166, v26, s74, v22
 v_fma_f32 v167, v27, s74, v22
 v_mfma_f32_16x16x32_bf16 v[188:191], a[168:171], v[156:159], v[188:191]
 buffer_load_dwordx4 v104, s[28:31], s86 offen offset:0 lds
 v_cvt_pk_bf16_f32 v209, v20, v21
 v_mfma_f32_16x16x32_bf16 v[188:191], a[172:175], v[220:223], v[188:191]
 v_or3_b32 v13, v208, v209, v13
 v_add_f32 v22, s80, v168
 v_mfma_f32_16x16x32_bf16 v[164:167], a[160:163], v[32:35], v[164:167]
 s_add_u32 s67, s66, s82
 v_exp_f32 v20, v116
 v_mfma_f32_16x16x32_bf16 v[164:167], a[164:167], v[68:71], v[164:167]
 s_add_u32 s66, s66, 32768
 v_exp_f32 v21, v117
 v_fma_f32 v172, v24, s75, v22
 v_fma_f32 v173, v25, s75, v22
 v_fma_f32 v174, v26, s75, v22
 v_fma_f32 v175, v27, s75, v22
 v_mfma_f32_16x16x32_bf16 v[164:167], a[168:171], v[132:135], v[164:167]
 s_cmp_eq_u32 s66, 98304
 s_cselect_b32 s66, 0, s66
 v_cvt_pk_bf16_f32 v210, v20, v21
 v_mfma_f32_16x16x32_bf16 v[164:167], a[172:175], v[196:199], v[164:167]
 buffer_load_dwordx4 v105, s[28:31], s86 offen offset:1024 lds
 v_add_u32 v18, s66, v14
 v_mfma_f32_16x16x32_bf16 v[172:175], a[160:163], v[40:43], v[172:175]
 s_waitcnt vmcnt(30) lgkmcnt(0)
 s_barrier
 v_exp_f32 v20, v118
 v_mfma_f32_16x16x32_bf16 v[172:175], a[164:167], v[76:79], v[172:175]
 v_exp_f32 v21, v119
 v_mfma_f32_16x16x32_bf16 v[172:175], a[168:171], v[140:143], v[172:175]
 ds_read_b128 a[128:131], v18 offset:16384
 v_cvt_pk_bf16_f32 v211, v20, v21
 v_mfma_f32_16x16x32_bf16 v[172:175], a[172:175], v[204:207], v[172:175]
 buffer_load_dwordx4 v106, s[28:31], s86 offen offset:2048 lds
 v_or3_b32 v13, v210, v211, v13
 v_mfma_f32_16x16x32_bf16 v[244:247], a[176:179], v[48:51], v[176:179]
 v_exp_f32 v20, v60
 v_mfma_f32_16x16x32_bf16 v[244:247], a[180:183], v[84:87], v[244:247]
 v_exp_f32 v21, v61
 v_mfma_f32_16x16x32_bf16 v[244:247], a[184:187], v[148:151], v[244:247]
 ds_read_b128 a[132:135], v18 offset:17408
 v_cvt_pk_bf16_f32 v216, v20, v21
 v_mfma_f32_16x16x32_bf16 v[244:247], a[188:191], v[212:215], v[244:247]
 buffer_load_dwordx4 v107, s[28:31], s86 offen offset:3072 lds
 s_add_u32 m0, s22, 143360
 v_mfma_f32_16x16x32_bf16 v[252:255], a[176:179], v[56:59], v[184:187]
 v_exp_f32 v20, v62
 v_mfma_f32_16x16x32_bf16 v[252:255], a[180:183], v[92:95], v[252:255]
 v_exp_f32 v21, v63
 v_add_f32 v22, s78, v160
 v_fma_f32 v228, v24, s73, v22
 v_fma_f32 v229, v25, s73, v22
 v_fma_f32 v230, v26, s73, v22
 v_fma_f32 v231, v27, s73, v22
 v_mfma_f32_16x16x32_bf16 v[252:255], a[184:187], v[156:159], v[252:255]
 ds_read_b128 a[136:139], v18 offset:18432
 v_cvt_pk_bf16_f32 v217, v20, v21
 v_mfma_f32_16x16x32_bf16 v[252:255], a[188:191], v[220:223], v[252:255]
 v_or3_b32 v13, v216, v217, v13
 v_add_f32 v22, s79, v168
 v_mfma_f32_16x16x32_bf16 v[228:231], a[176:179], v[32:35], v[228:231]
 v_exp_f32 v20, v124
 v_mfma_f32_16x16x32_bf16 v[228:231], a[180:183], v[68:71], v[228:231]
 v_exp_f32 v21, v125
 v_fma_f32 v236, v24, s74, v22
 v_fma_f32 v237, v25, s74, v22
 v_fma_f32 v238, v26, s74, v22
 v_fma_f32 v239, v27, s74, v22
 v_mfma_f32_16x16x32_bf16 v[228:231], a[184:187], v[132:135], v[228:231]
 s_sub_u32 s92, s92, 1
 ds_read_b128 a[140:143], v18 offset:19456
 v_cvt_pk_bf16_f32 v218, v20, v21
 v_mfma_f32_16x16x32_bf16 v[228:231], a[188:191], v[196:199], v[228:231]
 buffer_load_dwordx4 v112, s[28:31], s86 offen offset:0 lds
 v_mfma_f32_16x16x32_bf16 v[236:239], a[176:179], v[40:43], v[236:239]
 v_exp_f32 v20, v126
 v_mfma_f32_16x16x32_bf16 v[236:239], a[180:183], v[76:79], v[236:239]
 v_exp_f32 v21, v127
 v_mfma_f32_16x16x32_bf16 v[236:239], a[184:187], v[140:143], v[236:239]
 ds_read_b128 a[144:147], v18 offset:20480
 v_cvt_pk_bf16_f32 v219, v20, v21
 v_mfma_f32_16x16x32_bf16 v[236:239], a[188:191], v[204:207], v[236:239]
 v_or3_b32 v13, v218, v219, v13
 v_mfma_f32_16x16x32_bf16 v[120:123], v[28:31], v[224:227], v[120:123]
 v_and_b32 v13, 0x40004000, v13
 v_cmp_ne_u32 vcc, 0, v13
 v_mfma_f32_16x16x32_bf16 v[128:131], v[28:31], v[232:235], v[128:131]
 ds_read_b128 a[148:151], v18 offset:21504
 v_mfma_f32_16x16x32_bf16 v[136:139], v[28:31], v[240:243], v[136:139]
 v_mfma_f32_16x16x32_bf16 v[144:147], v[28:31], v[248:251], v[144:147]
 s_waitcnt lgkmcnt(5)
 s_cmp_lg_u32 s92, 0
 s_cbranch_vccnz L_tr_140
L_back_139:
 s_cbranch_scc1 L_dd
L_tr:
 v_mfma_f32_16x16x32_bf16 a[0:3], a[128:131], v[192:195], a[0:3]
 s_add_u32 m0, s67, 0
 ds_read_b128 a[152:155], v18 offset:22528
 v_exp_f32 v20, v164
 v_mfma_f32_16x16x32_bf16 a[32:35], a[128:131], v[200:203], a[32:35]
 s_lshl_b32 s94, s63, 4
 s_sub_u32 s68, 112, s94
 ds_read_b128 a[156:159], v18 offset:23552
 v_exp_f32 v21, v165
 v_mfma_f32_16x16x32_bf16 a[64:67], a[128:131], v[208:211], a[64:67]
 s_lshl_b32 s94, s60, 1
 s_add_u32 s68, s68, s94
 ds_read_b128 a[160:163], v18 offset:0
 v_cvt_pk_bf16_f32 v224, v20, v21
 v_mfma_f32_16x16x32_bf16 a[96:99], a[128:131], v[216:219], a[96:99]
 s_waitcnt lgkmcnt(7)
 s_cmp_eq_i32 s68, 3
 s_cselect_b32 s71, 1.0, 0
 buffer_load_dwordx4 v14, s[4:7], s64 offen offset:0 sc1 lds
 v_mfma_f32_16x16x32_bf16 a[4:7], a[132:135], v[192:195], a[4:7]
 s_cmp_lt_i32 s68, 3
 s_cselect_b32 s76, 0xf1800000, 0
 ds_read_b128 a[164:167], v18 offset:1024
 v_exp_f32 v20, v166
 v_mfma_f32_16x16x32_bf16 a[36:39], a[132:135], v[200:203], a[36:39]
 s_cmp_eq_i32 s68, 2
 s_cselect_b32 s72, 1.0, 0
 ds_read_b128 a[168:171], v18 offset:2048
 v_exp_f32 v21, v167
 v_mfma_f32_16x16x32_bf16 a[68:71], a[132:135], v[208:211], a[68:71]
 s_cmp_lt_i32 s68, 2
 s_cselect_b32 s77, 0xf1800000, 0
 buffer_load_dwordx4 v14, s[4:7], s64 offen offset:1024 sc1 lds
 v_cvt_pk_bf16_f32 v225, v20, v21
 v_mfma_f32_16x16x32_bf16 a[100:103], a[132:135], v[216:219], a[100:103]
 s_waitcnt lgkmcnt(8)
 s_cmp_eq_i32 s68, 1
 s_cselect_b32 s73, 1.0, 0
 ds_read_b128 a[172:175], v18 offset:3072
 v_or_b32 v13, v224, v225
 v_mfma_f32_16x16x32_bf16 a[8:11], a[136:139], v[192:195], a[8:11]
 s_cmp_lt_i32 s68, 1
 s_cselect_b32 s78, 0xf1800000, 0
 ds_read_b128 a[176:179], v18 offset:4096
 v_exp_f32 v20, v228
 v_mfma_f32_16x16x32_bf16 a[40:43], a[136:139], v[200:203], a[40:43]
 s_cmp_eq_i32 s68, 0
 s_cselect_b32 s74, 1.0, 0
 ds_read_b128 a[180:183], v18 offset:5120
 v_exp_f32 v21, v229
 v_mfma_f32_16x16x32_bf16 a[72:75], a[136:139], v[208:211], a[72:75]
 s_cmp_lt_i32 s68, 0
 s_cselect_b32 s79, 0xf1800000, 0
 ds_read_b128 a[184:187], v18 offset:6144
 v_cvt_pk_bf16_f32 v226, v20, v21
 v_mfma_f32_16x16x32_bf16 a[104:107], a[136:139], v[216:219], a[104:107]
 s_waitcnt lgkmcnt(11)
 s_cmp_eq_i32 s68, -1
 s_cselect_b32 s75, 1.0, 0
 buffer_load_dwordx4 v14, s[4:7], s64 offen offset:2048 sc1 lds
 v_mfma_f32_16x16x32_bf16 a[12:15], a[140:143], v[192:195], a[12:15]
 s_cmp_lt_i32 s68, -1
 s_cselect_b32 s80, 0xf1800000, 0
 ds_read_b128 a[188:191], v18 offset:7168
 v_exp_f32 v20, v230
 v_mfma_f32_16x16x32_bf16 a[44:47], a[140:143], v[200:203], a[44:47]
 ds_read_b128 a[128:131], v18 offset:8192
 v_exp_f32 v21, v231
 v_mfma_f32_16x16x32_bf16 a[76:79], a[140:143], v[208:211], a[76:79]
 ds_read_b128 a[132:135], v18 offset:9216
 v_cvt_pk_bf16_f32 v227, v20, v21
 v_mfma_f32_16x16x32_bf16 a[108:111], a[140:143], v[216:219], a[108:111]
 s_waitcnt lgkmcnt(13)
 buffer_load_dwordx4 v14, s[4:7], s64 offen offset:3072 sc1 lds
 s_add_u32 s64, s64, 16384
 s_add_u32 m0, s67, 16384
 v_or3_b32 v13, v226, v227, v13
 v_mfma_f32_16x16x32_bf16 a[16:19], a[144:147], v[192:195], a[16:19]
 v_exp_f32 v20, v172
 v_mfma_f32_16x16x32_bf16 a[48:51], a[144:147], v[200:203], a[48:51]
 v_exp_f32 v21, v173
 v_mfma_f32_16x16x32_bf16 a[80:83], a[144:147], v[208:211], a[80:83]
 ds_read_b128 a[136:139], v18 offset:10240
 v_cvt_pk_bf16_f32 v232, v20, v21
 v_mfma_f32_16x16x32_bf16 a[112:115], a[144:147], v[216:219], a[112:115]
 s_waitcnt lgkmcnt(13)
 buffer_load_dwordx4 v14, s[4:7], s65 offen offset:0 sc1 lds
 v_mfma_f32_16x16x32_bf16 a[20:23], a[148:151], v[192:195], a[20:23]
 v_exp_f32 v20, v174
 v_mfma_f32_16x16x32_bf16 a[52:55], a[148:151], v[200:203], a[52:55]
 v_exp_f32 v21, v175
 v_mfma_f32_16x16x32_bf16 a[84:87], a[148:151], v[208:211], a[84:87]
 ds_read_b128 a[140:143], v18 offset:11264
 v_cvt_pk_bf16_f32 v233, v20, v21
 v_mfma_f32_16x16x32_bf16 a[116:119], a[148:151], v[216:219], a[116:119]
 s_waitcnt lgkmcnt(13)
 ds_read_b128 a[144:147], v18 offset:12288
 v_or3_b32 v13, v232, v233, v13
 v_mfma_f32_16x16x32_bf16 a[24:27], a[152:155], v[192:195], a[24:27]
 v_exp_f32 v20, v236
 v_mfma_f32_16x16x32_bf16 a[56:59], a[152:155], v[200:203], a[56:59]
 v_exp_f32 v21, v237
 v_mfma_f32_16x16x32_bf16 a[88:91], a[152:155], v[208:211], a[88:91]
 ds_read_b128 a[148:151], v18 offset:13312
 v_cvt_pk_bf16_f32 v234, v20, v21
 v_mfma_f32_16x16x32_bf16 a[120:123], a[152:155], v[216:219], a[120:123]
 s_waitcnt lgkmcnt(14)
 buffer_load_dwordx4 v14, s[4:7], s65 offen offset:1024 sc1 lds
 v_mfma_f32_16x16x32_bf16 a[28:31], a[156:159], v[192:195], a[28:31]
 v_exp_f32 v20, v238
 v_mfma_f32_16x16x32_bf16 a[60:63], a[156:159], v[200:203], a[60:63]
 v_exp_f32 v21, v239
 v_add_f32 v22, s79, v176
 v_fma_f32 v36, v24, s74, v22
 v_fma_f32 v37, v25, s74, v22
 v_fma_f32 v38, v26, s74, v22
 v_fma_f32 v39, v27, s74, v22
 v_mfma_f32_16x16x32_bf16 a[92:95], a[156:159], v[208:211], a[92:95]
 buffer_load_dwordx4 v14, s[4:7], s65 offen offset:2048 sc1 lds
 v_cvt_pk_bf16_f32 v235, v20, v21
 v_mfma_f32_16x16x32_bf16 a[124:127], a[156:159], v[216:219], a[124:127]
 s_waitcnt lgkmcnt(13)
 ds_read_b128 a[152:155], v18 offset:14336
 v_or3_b32 v13, v234, v235, v13
 v_mfma_f32_16x16x32_bf16 v[36:39], a[160:163], v[48:51], v[36:39]
 s_waitcnt lgkmcnt(13)
 v_exp_f32 v20, v180
 v_mfma_f32_16x16x32_bf16 v[36:39], a[164:167], v[84:87], v[36:39]
 s_waitcnt lgkmcnt(12)
 v_exp_f32 v21, v181
 v_add_f32 v22, s80, v184
 v_fma_f32 v52, v24, s75, v22
 v_fma_f32 v53, v25, s75, v22
 v_fma_f32 v54, v26, s75, v22
 v_fma_f32 v55, v27, s75, v22
 v_mfma_f32_16x16x32_bf16 v[36:39], a[168:171], v[148:151], v[36:39]
 s_waitcnt lgkmcnt(11)
 ds_read_b128 a[156:159], v18 offset:15360
 v_cvt_pk_bf16_f32 v240, v20, v21
 v_mfma_f32_16x16x32_bf16 v[36:39], a[172:175], v[212:215], v[36:39]
 buffer_load_dwordx4 v14, s[4:7], s65 offen offset:3072 sc1 lds
 s_add_u32 s65, s65, 16384
 v_mfma_f32_16x16x32_bf16 v[52:55], a[160:163], v[56:59], v[52:55]
 ds_read_b128 a[160:163], v18 offset:24576
 v_exp_f32 v20, v182
 v_mfma_f32_16x16x32_bf16 v[52:55], a[164:167], v[92:95], v[52:55]
 v_exp_f32 v21, v183
 v_add_f32 v22, s78, v176
 v_fma_f32 v100, v24, s73, v22
 v_fma_f32 v101, v25, s73, v22
 v_fma_f32 v102, v26, s73, v22
 v_fma_f32 v103, v27, s73, v22
 v_mfma_f32_16x16x32_bf16 v[52:55], a[168:171], v[156:159], v[52:55]
 v_cvt_pk_bf16_f32 v241, v20, v21
 v_add_u32 v3, s85, v113
 v_mfma_f32_16x16x32_bf16 v[52:55], a[172:175], v[220:223], v[52:55]
 s_waitcnt vmcnt(17) lgkmcnt(12)
 ds_read_b128 a[164:167], v18 offset:25600
 v_or3_b32 v13, v240, v241, v13
 v_mfma_f32_16x16x32_bf16 v[100:103], a[176:179], v[48:51], v[100:103]
 s_waitcnt lgkmcnt(12)
 ds_read_b64_tr_b16 a[224:225], v3 offset:0
 v_exp_f32 v20, v244
 v_mfma_f32_16x16x32_bf16 v[100:103], a[180:183], v[84:87], v[100:103]
 s_waitcnt lgkmcnt(12)
 ds_read_b64_tr_b16 a[226:227], v3 offset:4608
 v_exp_f32 v21, v245
 v_add_f32 v22, s79, v184
 v_fma_f32 v116, v24, s74, v22
 v_fma_f32 v117, v25, s74, v22
 v_fma_f32 v118, v26, s74, v22
 v_fma_f32 v119, v27, s74, v22
 v_mfma_f32_16x16x32_bf16 v[100:103], a[184:187], v[148:151], v[100:103]
 s_waitcnt lgkmcnt(12)
 ds_read_b64_tr_b16 a[228:229], v3 offset:32
 v_cvt_pk_bf16_f32 v242, v20, v21
 v_mfma_f32_16x16x32_bf16 v[100:103], a[188:191], v[212:215], v[100:103]
 ds_read_b128 a[168:171], v18 offset:26624
 v_add_f32 v22, s77, v176
 v_mfma_f32_16x16x32_bf16 v[116:119], a[176:179], v[56:59], v[116:119]
 buffer_load_dword v15, v19, s[4:7], 0 offen sc1
 v_exp_f32 v20, v246
 v_mfma_f32_16x16x32_bf16 v[116:119], a[180:183], v[92:95], v[116:119]
 ds_read_b64_tr_b16 a[230:231], v3 offset:4640
 v_exp_f32 v21, v247
 v_fma_f32 v44, v24, s72, v22
 v_fma_f32 v45, v25, s72, v22
 v_fma_f32 v46, v26, s72, v22
 v_fma_f32 v47, v27, s72, v22
 v_mfma_f32_16x16x32_bf16 v[116:119], a[184:187], v[156:159], v[116:119]
 ds_read_b64_tr_b16 a[232:233], v3 offset:64
 v_cvt_pk_bf16_f32 v243, v20, v21
 v_mfma_f32_16x16x32_bf16 v[116:119], a[188:191], v[220:223], v[116:119]
 s_waitcnt lgkmcnt(15)
 ds_read_b64_tr_b16 a[234:235], v3 offset:4672
 v_or3_b32 v13, v242, v243, v13
 v_mfma_f32_16x16x32_bf16 v[44:47], a[128:131], v[48:51], v[44:47]
 s_waitcnt lgkmcnt(15)
 v_exp_f32 v20, v188
 v_mfma_f32_16x16x32_bf16 v[44:47], a[132:135], v[84:87], v[44:47]
 s_waitcnt lgkmcnt(14)
 ds_read_b64_tr_b16 a[236:237], v3 offset:96
 v_exp_f32 v21, v189
 v_add_f32 v22, s78, v184
 v_fma_f32 v60, v24, s73, v22
 v_fma_f32 v61, v25, s73, v22
 v_fma_f32 v62, v26, s73, v22
 v_fma_f32 v63, v27, s73, v22
 v_mfma_f32_16x16x32_bf16 v[44:47], a[136:139], v[148:151], v[44:47]
 s_waitcnt lgkmcnt(14)
 ds_read_b64_tr_b16 a[238:239], v3 offset:4704
 v_cvt_pk_bf16_f32 v248, v20, v21
 v_mfma_f32_16x16x32_bf16 v[44:47], a[140:143], v[212:215], v[44:47]
 ds_read_b64_tr_b16 a[240:241], v3 offset:128
 v_add_f32 v22, s76, v176
 v_mfma_f32_16x16x32_bf16 v[60:63], a[128:131], v[56:59], v[60:63]
 v_exp_f32 v20, v190
 v_mfma_f32_16x16x32_bf16 v[60:63], a[132:135], v[92:95], v[60:63]
 ds_read_b64_tr_b16 a[242:243], v3 offset:4736
 v_exp_f32 v21, v191
 v_fma_f32 v108, v24, s71, v22
 v_fma_f32 v109, v25, s71, v22
 v_fma_f32 v110, v26, s71, v22
 v_fma_f32 v111, v27, s71, v22
 v_mfma_f32_16x16x32_bf16 v[60:63], a[136:139], v[156:159], v[60:63]
 ds_read_b64_tr_b16 a[244:245], v3 offset:160
 v_cvt_pk_bf16_f32 v249, v20, v21
 v_mfma_f32_16x16x32_bf16 v[60:63], a[140:143], v[220:223], v[60:63]
 s_waitcnt lgkmcnt(15)
 ds_read_b64_tr_b16 a[246:247], v3 offset:4768
 v_or3_b32 v13, v248, v249, v13
 v_mfma_f32_16x16x32_bf16 v[108:111], a[144:147], v[48:51], v[108:111]
 v_exp_f32 v20, v252
 v_mfma_f32_16x16x32_bf16 v[108:111], a[148:151], v[84:87], v[108:111]
 ds_read_b64_tr_b16 a[248:249], v3 offset:192
 v_exp_f32 v21, v253
 v_add_f32 v22, s77, v184
 v_fma_f32 v124, v24, s72, v22
 v_fma_f32 v125, v25, s72, v22
 v_fma_f32 v126, v26, s72, v22
 v_fma_f32 v127, v27, s72, v22
 v_mfma_f32_16x16x32_bf16 v[108:111], a[152:155], v[148:151], v[108:111]
 s_waitcnt lgkmcnt(15)
 ds_read_b64_tr_b16 a[250:251], v3 offset:4800
 v_cvt_pk_bf16_f32 v250, v20, v21
 v_mfma_f32_16x16x32_bf16 v[108:111], a[156:159], v[212:215], v[108:111]
 ds_read_b64_tr_b16 a[252:253], v3 offset:224
 v_mfma_f32_16x16x32_bf16 v[124:127], a[144:147], v[56:59], v[124:127]
 v_exp_f32 v20, v254
 v_mfma_f32_16x16x32_bf16 v[124:127], a[148:151], v[92:95], v[124:127]
 ds_read_b64_tr_b16 a[254:255], v3 offset:4832
 v_exp_f32 v21, v255
 v_mfma_f32_16x16x32_bf16 v[124:127], a[152:155], v[156:159], v[124:127]
 ds_read_b64_tr_b16 v[152:153], v3 offset:256
 v_cvt_pk_bf16_f32 v251, v20, v21
 v_mfma_f32_16x16x32_bf16 v[124:127], a[156:159], v[220:223], v[124:127]
 ds_read_b64_tr_b16 v[154:155], v3 offset:4864
 v_or3_b32 v13, v250, v251, v13
 v_mfma_f32_16x16x32_bf16 v[120:123], v[28:31], v[192:195], v[120:123]
 v_and_b32 v13, 0x40004000, v13
 v_cmp_ne_u32 vcc, 0, v13
 v_mfma_f32_16x16x32_bf16 v[128:131], v[28:31], v[200:203], v[128:131]
 ds_read_b128 a[172:175], v18 offset:27648
 v_mfma_f32_16x16x32_bf16 v[136:139], v[28:31], v[208:211], v[136:139]
 s_sub_u32 s68, s68, 4
 ds_read_b128 a[176:179], v18 offset:28672
 v_mfma_f32_16x16x32_bf16 v[144:147], v[28:31], v[216:219], v[144:147]
 ds_read_b128 a[180:183], v18 offset:29696
 s_cbranch_vccnz L_tr_150
L_back_149:
 v_mfma_f32_16x16x32_bf16 v[120:123], v[28:31], v[224:227], v[120:123]
 s_waitcnt lgkmcnt(0)
 v_exp_f32 v20, v36
 v_mfma_f32_16x16x32_bf16 v[128:131], v[28:31], v[232:235], v[128:131]
 s_add_u32 m0, s85, 98304
 v_exp_f32 v21, v37
 v_mfma_f32_16x16x32_bf16 v[136:139], v[28:31], v[240:243], v[136:139]
 buffer_load_dwordx4 v96, s[28:31], s12 offen offset:0 lds
 v_cvt_pk_bf16_f32 v192, v20, v21
 v_mfma_f32_16x16x32_bf16 v[144:147], v[28:31], v[248:251], v[144:147]
 s_mov_b32 s94, s63
 s_lshl_b32 s95, s3, 4
 s_add_u32 s94, s94, s95
 s_lshl_b32 s94, s94, 15
 s_add_u32 s94, s94, s81
 s_add_u32 s83, s94, 33554432
 s_add_u32 s84, s94, 33558528
 v_mfma_f32_16x16x32_bf16 a[0:3], a[160:163], v[224:227], a[0:3]
 v_exp_f32 v20, v38
 v_mfma_f32_16x16x32_bf16 a[32:35], a[160:163], v[232:235], a[32:35]
 v_exp_f32 v21, v39
 v_mfma_f32_16x16x32_bf16 a[64:67], a[160:163], v[240:243], a[64:67]
 buffer_load_dwordx4 v97, s[28:31], s12 offen offset:1024 lds
 v_cvt_pk_bf16_f32 v193, v20, v21
 v_mfma_f32_16x16x32_bf16 a[96:99], a[160:163], v[248:251], a[96:99]
 ds_read_b128 a[184:187], v18 offset:30720
 v_or_b32 v13, v192, v193
 v_mfma_f32_16x16x32_bf16 a[4:7], a[164:167], v[224:227], a[4:7]
 v_exp_f32 v20, v100
 v_mfma_f32_16x16x32_bf16 a[36:39], a[164:167], v[232:235], a[36:39]
 v_exp_f32 v21, v101
 v_mfma_f32_16x16x32_bf16 a[68:71], a[164:167], v[240:243], a[68:71]
 buffer_load_dwordx4 v98, s[28:31], s12 offen offset:2048 lds
 v_cvt_pk_bf16_f32 v194, v20, v21
 v_mfma_f32_16x16x32_bf16 a[100:103], a[164:167], v[248:251], a[100:103]
 v_rcp_f32 v120, v120
 v_mfma_f32_16x16x32_bf16 a[8:11], a[168:171], v[224:227], a[8:11]
 v_exp_f32 v20, v102
 v_mfma_f32_16x16x32_bf16 a[40:43], a[168:171], v[232:235], a[40:43]
 v_exp_f32 v21, v103
 v_mfma_f32_16x16x32_bf16 a[72:75], a[168:171], v[240:243], a[72:75]
 buffer_load_dwordx4 v99, s[28:31], s12 offen offset:3072 lds
 s_add_u32 m0, s85, 102400
 v_cvt_pk_bf16_f32 v195, v20, v21
 v_mfma_f32_16x16x32_bf16 a[104:107], a[168:171], v[248:251], a[104:107]
 ds_read_b128 a[188:191], v18 offset:31744
 v_or3_b32 v13, v194, v195, v13
 v_mfma_f32_16x16x32_bf16 a[12:15], a[172:175], v[224:227], a[12:15]
 v_exp_f32 v20, v44
 v_mfma_f32_16x16x32_bf16 a[44:47], a[172:175], v[232:235], a[44:47]
 v_exp_f32 v21, v45
 v_mfma_f32_16x16x32_bf16 a[76:79], a[172:175], v[240:243], a[76:79]
 s_add_u32 s67, s66, s82
 buffer_load_dwordx4 v104, s[28:31], s12 offen offset:0 lds
 v_cvt_pk_bf16_f32 v200, v20, v21
 v_mfma_f32_16x16x32_bf16 a[108:111], a[172:175], v[248:251], a[108:111]
 s_add_u32 s66, s66, 32768
 v_rcp_f32 v128, v128
 v_mfma_f32_16x16x32_bf16 a[16:19], a[176:179], v[224:227], a[16:19]
 s_cmp_eq_u32 s66, 98304
 s_cselect_b32 s66, 0, s66
 v_exp_f32 v20, v46
 v_mfma_f32_16x16x32_bf16 a[48:51], a[176:179], v[232:235], a[48:51]
 v_exp_f32 v21, v47
 v_add_u32 v18, s66, v14
 v_mfma_f32_16x16x32_bf16 a[80:83], a[176:179], v[240:243], a[80:83]
 s_waitcnt lgkmcnt(0)
 s_barrier
 buffer_load_dwordx4 v105, s[28:31], s12 offen offset:1024 lds
 v_cvt_pk_bf16_f32 v201, v20, v21
 v_mfma_f32_16x16x32_bf16 a[112:115], a[176:179], v[248:251], a[112:115]
 ds_read_b128 a[128:131], v18 offset:0
 v_or3_b32 v13, v200, v201, v13
 v_mfma_f32_16x16x32_bf16 a[20:23], a[180:183], v[224:227], a[20:23]
 v_exp_f32 v20, v108
 v_mfma_f32_16x16x32_bf16 a[52:55], a[180:183], v[232:235], a[52:55]
 v_exp_f32 v21, v109
 v_mfma_f32_16x16x32_bf16 a[84:87], a[180:183], v[240:243], a[84:87]
 ds_read_b128 a[132:135], v18 offset:1024
 buffer_load_dwordx4 v106, s[28:31], s12 offen offset:2048 lds
 v_cvt_pk_bf16_f32 v202, v20, v21
 v_mfma_f32_16x16x32_bf16 a[116:119], a[180:183], v[248:251], a[116:119]
 v_accvgpr_read_b32 v64, a0
 v_accvgpr_read_b32 v65, a1
 v_mfma_f32_16x16x32_bf16 a[24:27], a[184:187], v[224:227], a[24:27]
 v_exp_f32 v20, v110
 v_mfma_f32_16x16x32_bf16 a[56:59], a[184:187], v[232:235], a[56:59]
 v_exp_f32 v21, v111
 v_mfma_f32_16x16x32_bf16 a[88:91], a[184:187], v[240:243], a[88:91]
 ds_read_b128 a[136:139], v18 offset:2048
 buffer_load_dwordx4 v107, s[28:31], s12 offen offset:3072 lds
 s_add_u32 m0, s85, 106496
 v_cvt_pk_bf16_f32 v203, v20, v21
 v_mfma_f32_16x16x32_bf16 a[120:123], a[184:187], v[248:251], a[120:123]
 ds_read_b128 a[140:143], v18 offset:3072
 v_or3_b32 v13, v202, v203, v13
 v_mfma_f32_16x16x32_bf16 a[28:31], a[188:191], v[224:227], a[28:31]
 v_accvgpr_read_b32 v66, a2
 v_accvgpr_read_b32 v67, a3
 v_mfma_f32_16x16x32_bf16 a[60:63], a[188:191], v[232:235], a[60:63]
 ds_read_b128 a[144:147], v18 offset:4096
 v_accvgpr_read_b32 v72, a4
 v_mfma_f32_16x16x32_bf16 a[92:95], a[188:191], v[240:243], a[92:95]
 ds_read_b128 a[148:151], v18 offset:5120
 buffer_load_dwordx4 v112, s[28:31], s12 offen offset:0 lds
 v_mfma_f32_16x16x32_bf16 a[124:127], a[188:191], v[248:251], a[124:127]
 v_accvgpr_read_b32 v73, a5
 v_accvgpr_read_b32 v74, a6
 v_accvgpr_read_b32 v75, a7
 v_mul_f32 v64, v64, v120
 v_mul_f32 v65, v65, v120
 v_mul_f32 v66, v66, v120
 v_mul_f32 v67, v67, v120
 v_mul_f32 v72, v72, v120
 v_mul_f32 v73, v73, v120
 v_mul_f32 v74, v74, v120
 v_mul_f32 v75, v75, v120
 v_cvt_pk_bf16_f32 v32, v64, v65
 v_cvt_pk_bf16_f32 v33, v66, v67
 v_cvt_pk_bf16_f32 v34, v72, v73
 v_cvt_pk_bf16_f32 v35, v74, v75
 buffer_store_dwordx4 v[32:35], v14, s[4:7], s83 offen offset:0 sc1
 v_accvgpr_read_b32 v80, a32
 v_accvgpr_read_b32 v81, a33
 v_accvgpr_read_b32 v82, a34
 v_accvgpr_read_b32 v83, a35
 v_accvgpr_read_b32 v88, a36
 v_accvgpr_read_b32 v89, a37
 v_accvgpr_read_b32 v90, a38
 v_accvgpr_read_b32 v91, a39
 v_mul_f32 v80, v80, v128
 v_mul_f32 v81, v81, v128
 v_mul_f32 v82, v82, v128
 v_mul_f32 v83, v83, v128
 v_mul_f32 v88, v88, v128
 v_mul_f32 v89, v89, v128
 v_mul_f32 v90, v90, v128
 v_mul_f32 v91, v91, v128
 v_cvt_pk_bf16_f32 v40, v80, v81
 v_cvt_pk_bf16_f32 v41, v82, v83
 v_cvt_pk_bf16_f32 v42, v88, v89
 v_cvt_pk_bf16_f32 v43, v90, v91
 buffer_store_dwordx4 v[40:43], v14, s[4:7], s84 offen offset:0 sc1
 v_accvgpr_read_b32 v64, a8
 v_accvgpr_read_b32 v65, a9
 v_accvgpr_read_b32 v66, a10
 v_accvgpr_read_b32 v67, a11
 v_accvgpr_read_b32 v72, a12
 v_accvgpr_read_b32 v73, a13
 v_accvgpr_read_b32 v74, a14
 v_accvgpr_read_b32 v75, a15
 v_mul_f32 v64, v64, v120
 v_mul_f32 v65, v65, v120
 v_mul_f32 v66, v66, v120
 v_mul_f32 v67, v67, v120
 v_mul_f32 v72, v72, v120
 v_mul_f32 v73, v73, v120
 v_mul_f32 v74, v74, v120
 v_mul_f32 v75, v75, v120
 v_cvt_pk_bf16_f32 v68, v64, v65
 v_cvt_pk_bf16_f32 v69, v66, v67
 v_cvt_pk_bf16_f32 v70, v72, v73
 v_cvt_pk_bf16_f32 v71, v74, v75
 buffer_store_dwordx4 v[68:71], v14, s[4:7], s83 offen offset:1024 sc1
 v_accvgpr_read_b32 v80, a40
 v_accvgpr_read_b32 v81, a41
 v_accvgpr_read_b32 v82, a42
 v_accvgpr_read_b32 v83, a43
 v_accvgpr_read_b32 v88, a44
 v_accvgpr_read_b32 v89, a45
 v_accvgpr_read_b32 v90, a46
 v_accvgpr_read_b32 v91, a47
 v_mul_f32 v80, v80, v128
 v_mul_f32 v81, v81, v128
 v_mul_f32 v82, v82, v128
 v_mul_f32 v83, v83, v128
 v_mul_f32 v88, v88, v128
 v_mul_f32 v89, v89, v128
 v_mul_f32 v90, v90, v128
 v_mul_f32 v91, v91, v128
 v_cvt_pk_bf16_f32 v76, v80, v81
 v_cvt_pk_bf16_f32 v77, v82, v83
 v_cvt_pk_bf16_f32 v78, v88, v89
 v_cvt_pk_bf16_f32 v79, v90, v91
 buffer_store_dwordx4 v[76:79], v14, s[4:7], s84 offen offset:1024 sc1
 v_accvgpr_read_b32 v64, a16
 v_accvgpr_read_b32 v65, a17
 v_accvgpr_read_b32 v66, a18
 v_accvgpr_read_b32 v67, a19
 v_accvgpr_read_b32 v72, a20
 v_accvgpr_read_b32 v73, a21
 v_accvgpr_read_b32 v74, a22
 v_accvgpr_read_b32 v75, a23
 v_mul_f32 v64, v64, v120
 v_mul_f32 v65, v65, v120
 v_mul_f32 v66, v66, v120
 v_mul_f32 v67, v67, v120
 v_mul_f32 v72, v72, v120
 v_mul_f32 v73, v73, v120
 v_mul_f32 v74, v74, v120
 v_mul_f32 v75, v75, v120
 v_cvt_pk_bf16_f32 v132, v64, v65
 v_cvt_pk_bf16_f32 v133, v66, v67
 v_cvt_pk_bf16_f32 v134, v72, v73
 v_cvt_pk_bf16_f32 v135, v74, v75
 buffer_store_dwordx4 v[132:135], v14, s[4:7], s83 offen offset:2048 sc1
 v_accvgpr_read_b32 v80, a48
 v_accvgpr_read_b32 v81, a49
 v_accvgpr_read_b32 v82, a50
 v_accvgpr_read_b32 v83, a51
 v_accvgpr_read_b32 v88, a52
 v_accvgpr_read_b32 v89, a53
 v_accvgpr_read_b32 v90, a54
 v_accvgpr_read_b32 v91, a55
 v_mul_f32 v80, v80, v128
 v_mul_f32 v81, v81, v128
 v_mul_f32 v82, v82, v128
 v_mul_f32 v83, v83, v128
 v_mul_f32 v88, v88, v128
 v_mul_f32 v89, v89, v128
 v_mul_f32 v90, v90, v128
 v_mul_f32 v91, v91, v128
 v_cvt_pk_bf16_f32 v140, v80, v81
 v_cvt_pk_bf16_f32 v141, v82, v83
 v_cvt_pk_bf16_f32 v142, v88, v89
 v_cvt_pk_bf16_f32 v143, v90, v91
 buffer_store_dwordx4 v[140:143], v14, s[4:7], s84 offen offset:2048 sc1
 v_accvgpr_read_b32 v64, a24
 v_accvgpr_read_b32 v65, a25
 v_accvgpr_read_b32 v66, a26
 v_accvgpr_read_b32 v67, a27
 v_accvgpr_read_b32 v72, a28
 v_accvgpr_read_b32 v73, a29
 v_accvgpr_read_b32 v74, a30
 v_accvgpr_read_b32 v75, a31
 v_mul_f32 v64, v64, v120
 v_mul_f32 v65, v65, v120
 v_mul_f32 v66, v66, v120
 v_mul_f32 v67, v67, v120
 v_mul_f32 v72, v72, v120
 v_mul_f32 v73, v73, v120
 v_mul_f32 v74, v74, v120
 v_mul_f32 v75, v75, v120
 v_cvt_pk_bf16_f32 v196, v64, v65
 v_cvt_pk_bf16_f32 v197, v66, v67
 v_cvt_pk_bf16_f32 v198, v72, v73
 v_cvt_pk_bf16_f32 v199, v74, v75
 buffer_store_dwordx4 v[196:199], v14, s[4:7], s83 offen offset:3072 sc1
 v_accvgpr_read_b32 v80, a56
 v_accvgpr_read_b32 v81, a57
 v_accvgpr_read_b32 v82, a58
 v_accvgpr_read_b32 v83, a59
 v_accvgpr_read_b32 v88, a60
 v_accvgpr_read_b32 v89, a61
 v_accvgpr_read_b32 v90, a62
 v_accvgpr_read_b32 v91, a63
 v_mul_f32 v80, v80, v128
 v_mul_f32 v81, v81, v128
 v_mul_f32 v82, v82, v128
 v_mul_f32 v83, v83, v128
 v_mul_f32 v88, v88, v128
 v_mul_f32 v89, v89, v128
 v_mul_f32 v90, v90, v128
 v_mul_f32 v91, v91, v128
 v_cvt_pk_bf16_f32 v204, v80, v81
 v_cvt_pk_bf16_f32 v205, v82, v83
 v_cvt_pk_bf16_f32 v206, v88, v89
 v_cvt_pk_bf16_f32 v207, v90, v91
 buffer_store_dwordx4 v[204:207], v14, s[4:7], s84 offen offset:3072 sc1
 v_mov_b32 v224, 0
 v_mov_b32 v225, 0
 v_mov_b32 v226, 0
 v_mov_b32 v227, 0
 v_mov_b32 v232, 0
 v_mov_b32 v233, 0
 v_mov_b32 v234, 0
 v_mov_b32 v235, 0
 v_mov_b32 v240, 0
 v_mov_b32 v241, 0
 v_mov_b32 v242, 0
 v_mov_b32 v243, 0
 v_mov_b32 v248, 0
 v_mov_b32 v249, 0
 v_mov_b32 v250, 0
 v_mov_b32 v251, 0
 s_waitcnt vmcnt(17) lgkmcnt(5)
 v_cmp_eq_u32 vcc, 1, v15
 s_and_b32 s94, vcc_lo, 255
 s_cmp_eq_u32 s94, 255
 s_cbranch_scc0 L_spin_157
L_back_156:
 s_cmp_eq_u32 s1, 0
 s_cbranch_scc1 L_fence_158
L_back_159:
 v_lshrrev_b32 v64, 8, v14
 s_lshl_b32 s94, s60, 6
 s_add_u32 s94, s94, 162816
 v_lshl_add_u32 v64, v64, 4, s94
 ds_write_b128 v64, a[216:219]
 s_sub_u32 s94, 3, s60
 s_mul_i32 s94, s94, 36864
 s_add_u32 s87, s13, s94
 s_lshl_b32 s94, s60, 6
 v_lshrrev_b32 v65, 4, v14
 v_add_u32 v65, s94, v65
 v_mul_u32_u24 v66, 0xe39, v65
 v_lshrrev_b32 v66, 16, v66
 v_mul_u32_u24 v66, 0x360, v66
 v_lshl_add_u32 v16, v65, 4, v66
 v_add_u32 v65, 0x100, v65
 v_mul_u32_u24 v66, 0xe39, v65
 v_lshrrev_b32 v66, 16, v66
 v_mul_u32_u24 v66, 0x360, v66
 v_lshl_add_u32 v17, v65, 4, v66
 v_mul_u32_u24 v19, 32, v14
 s_and_b32 s94, s2, 0xe7
 s_lshl_b32 s94, s94, 6
 s_add_u32 s94, s94, 71401472
 v_add_u32 v19, s94, v19
 v_mov_b32 v23, 2147483632
 v_cmp_gt_u32 vcc, 64, v14
 s_nop 1
 v_cndmask_b32 v19, v23, v19, vcc
 s_cmp_ge_u32 s2, 112
 s_cbranch_scc1 L_ffb_160
L_back_161:
 s_lshl_b32 s94, s63, 1
 s_sub_u32 s92, 13, s94
 s_cmp_eq_u32 s63, 7
 s_cbranch_scc1 L_pub7
L_sp:
 v_mfma_f32_16x16x32_bf16 v[164:167], a[128:131], v[48:51], v[176:179]
 s_waitcnt lgkmcnt(4)
 s_add_u32 m0, s67, 0
 ds_read_b128 a[152:155], v18 offset:6144
 v_exp_f32 v20, v52
 v_mfma_f32_16x16x32_bf16 v[164:167], a[132:135], v[84:87], v[164:167]
 s_waitcnt lgkmcnt(4)
 ds_read_b128 a[156:159], v18 offset:7168
 v_exp_f32 v21, v53
 v_mfma_f32_16x16x32_bf16 v[164:167], a[136:139], v[148:151], v[164:167]
 s_waitcnt lgkmcnt(4)
 ds_read_b128 a[160:163], v18 offset:8192
 v_cvt_pk_bf16_f32 v208, v20, v21
 v_mfma_f32_16x16x32_bf16 v[164:167], a[140:143], v[212:215], v[164:167]
 buffer_load_dwordx4 v14, s[4:7], s64 offen offset:0 sc1 lds
 v_mfma_f32_16x16x32_bf16 v[180:183], a[128:131], v[56:59], v[184:187]
 ds_read_b128 a[164:167], v18 offset:9216
 v_exp_f32 v20, v54
 v_mfma_f32_16x16x32_bf16 v[180:183], a[132:135], v[92:95], v[180:183]
 ds_read_b128 a[168:171], v18 offset:10240
 v_exp_f32 v21, v55
 v_mfma_f32_16x16x32_bf16 v[180:183], a[136:139], v[156:159], v[180:183]
 ds_read_b128 a[172:175], v18 offset:11264
 v_cvt_pk_bf16_f32 v209, v20, v21
 v_mfma_f32_16x16x32_bf16 v[180:183], a[140:143], v[220:223], v[180:183]
 s_waitcnt lgkmcnt(7)
 ds_read_b128 a[176:179], v18 offset:12288
 v_or3_b32 v13, v208, v209, v13
 v_mfma_f32_16x16x32_bf16 v[228:231], a[144:147], v[48:51], v[176:179]
 s_waitcnt lgkmcnt(7)
 ds_read_b128 a[180:183], v18 offset:13312
 v_exp_f32 v20, v116
 v_mfma_f32_16x16x32_bf16 v[228:231], a[148:151], v[84:87], v[228:231]
 s_waitcnt lgkmcnt(7)
 ds_read_b128 a[184:187], v18 offset:14336
 v_exp_f32 v21, v117
 v_mfma_f32_16x16x32_bf16 v[228:231], a[152:155], v[148:151], v[228:231]
 s_waitcnt lgkmcnt(7)
 ds_read_b128 a[188:191], v18 offset:15360
 v_cvt_pk_bf16_f32 v210, v20, v21
 v_mfma_f32_16x16x32_bf16 v[228:231], a[156:159], v[212:215], v[228:231]
 buffer_load_dwordx4 v14, s[4:7], s64 offen offset:1024 sc1 lds
 v_mfma_f32_16x16x32_bf16 v[244:247], a[144:147], v[56:59], v[184:187]
 ds_read_b128 a[128:131], v18 offset:16384
 v_exp_f32 v20, v118
 v_mfma_f32_16x16x32_bf16 v[244:247], a[148:151], v[92:95], v[244:247]
 v_exp_f32 v21, v119
 v_mfma_f32_16x16x32_bf16 v[244:247], a[152:155], v[156:159], v[244:247]
 ds_read_b128 a[132:135], v18 offset:24576
 v_cvt_pk_bf16_f32 v211, v20, v21
 v_mfma_f32_16x16x32_bf16 v[244:247], a[156:159], v[220:223], v[244:247]
 s_waitcnt lgkmcnt(9)
 buffer_load_dwordx4 v14, s[4:7], s64 offen offset:2048 sc1 lds
 v_or3_b32 v13, v210, v211, v13
 v_mfma_f32_16x16x32_bf16 v[172:175], a[160:163], v[48:51], v[176:179]
 s_waitcnt lgkmcnt(8)
 v_exp_f32 v20, v60
 v_mfma_f32_16x16x32_bf16 v[172:175], a[164:167], v[84:87], v[172:175]
 s_waitcnt lgkmcnt(7)
 v_exp_f32 v21, v61
 v_mfma_f32_16x16x32_bf16 v[172:175], a[168:171], v[148:151], v[172:175]
 s_waitcnt lgkmcnt(6)
 ds_read_b128 a[136:139], v18 offset:17408
 v_cvt_pk_bf16_f32 v216, v20, v21
 v_mfma_f32_16x16x32_bf16 v[172:175], a[172:175], v[212:215], v[172:175]
 buffer_load_dwordx4 v14, s[4:7], s64 offen offset:3072 sc1 lds
 s_add_u32 s64, s64, 16384
 s_add_u32 m0, s67, 16384
 v_mfma_f32_16x16x32_bf16 v[188:191], a[160:163], v[56:59], v[184:187]
 v_exp_f32 v20, v62
 v_mfma_f32_16x16x32_bf16 v[188:191], a[164:167], v[92:95], v[188:191]
 v_exp_f32 v21, v63
 v_mfma_f32_16x16x32_bf16 v[188:191], a[168:171], v[156:159], v[188:191]
 ds_read_b128 a[140:143], v18 offset:25600
 v_cvt_pk_bf16_f32 v217, v20, v21
 v_mfma_f32_16x16x32_bf16 v[188:191], a[172:175], v[220:223], v[188:191]
 s_waitcnt lgkmcnt(7)
 ds_read_b128 a[144:147], v18 offset:18432
 v_or3_b32 v13, v216, v217, v13
 v_mfma_f32_16x16x32_bf16 v[236:239], a[176:179], v[48:51], v[176:179]
 s_waitcnt lgkmcnt(7)
 v_exp_f32 v20, v124
 v_mfma_f32_16x16x32_bf16 v[236:239], a[180:183], v[84:87], v[236:239]
 s_waitcnt lgkmcnt(6)
 v_exp_f32 v21, v125
 v_mfma_f32_16x16x32_bf16 v[236:239], a[184:187], v[148:151], v[236:239]
 s_waitcnt lgkmcnt(5)
 ds_read_b128 a[148:151], v18 offset:26624
 v_cvt_pk_bf16_f32 v218, v20, v21
 v_mfma_f32_16x16x32_bf16 v[236:239], a[188:191], v[212:215], v[236:239]
 buffer_load_dwordx4 v14, s[4:7], s65 offen offset:0 sc1 lds
 v_mfma_f32_16x16x32_bf16 v[252:255], a[176:179], v[56:59], v[184:187]
 v_exp_f32 v20, v126
 v_mfma_f32_16x16x32_bf16 v[252:255], a[180:183], v[92:95], v[252:255]
 v_exp_f32 v21, v127
 v_mfma_f32_16x16x32_bf16 v[252:255], a[184:187], v[156:159], v[252:255]
 ds_read_b128 a[152:155], v18 offset:19456
 v_cvt_pk_bf16_f32 v219, v20, v21
 v_mfma_f32_16x16x32_bf16 v[252:255], a[188:191], v[220:223], v[252:255]
 ds_read_b128 a[156:159], v18 offset:27648
 v_or3_b32 v13, v218, v219, v13
 v_mfma_f32_16x16x32_bf16 v[136:139], v[28:31], v[224:227], v[136:139]
 v_and_b32 v13, 0x40004000, v13
 v_cmp_ne_u32 vcc, 0, v13
 v_mfma_f32_16x16x32_bf16 v[136:139], v[28:31], v[232:235], v[136:139]
 ds_read_b128 a[160:163], v18 offset:20480
 v_mfma_f32_16x16x32_bf16 v[144:147], v[28:31], v[240:243], v[144:147]
 buffer_load_dwordx4 v14, s[4:7], s65 offen offset:1024 sc1 lds
 v_mfma_f32_16x16x32_bf16 v[144:147], v[28:31], v[248:251], v[144:147]
 s_waitcnt lgkmcnt(8)
 ds_read_b128 a[164:167], v18 offset:28672
 s_cbranch_vccnz L_tr_165
L_back_164:
 v_mfma_f32_16x16x32_bf16 a[64:67], a[128:131], v[192:195], a[64:67]
 s_waitcnt lgkmcnt(8)
 v_exp_f32 v20, v164
 v_mfma_f32_16x16x32_bf16 a[64:67], a[132:135], v[200:203], a[64:67]
 s_sub_u32 s68, s68, 4
 v_exp_f32 v21, v165
 v_mfma_f32_16x16x32_bf16 a[96:99], a[128:131], v[208:211], a[96:99]
 ds_read_b128 a[168:171], v18 offset:21504
 v_cvt_pk_bf16_f32 v224, v20, v21
 v_mfma_f32_16x16x32_bf16 a[96:99], a[132:135], v[216:219], a[96:99]
 s_waitcnt lgkmcnt(8)
 buffer_load_dwordx4 v14, s[4:7], s65 offen offset:2048 sc1 lds
 v_mfma_f32_16x16x32_bf16 a[68:71], a[136:139], v[192:195], a[68:71]
 s_waitcnt lgkmcnt(7)
 v_exp_f32 v20, v166
 v_mfma_f32_16x16x32_bf16 a[68:71], a[140:143], v[200:203], a[68:71]
 v_exp_f32 v21, v167
 v_mfma_f32_16x16x32_bf16 a[100:103], a[136:139], v[208:211], a[100:103]
 ds_read_b128 a[172:175], v18 offset:29696
 v_cvt_pk_bf16_f32 v225, v20, v21
 v_mfma_f32_16x16x32_bf16 a[100:103], a[140:143], v[216:219], a[100:103]
 s_waitcnt lgkmcnt(7)
 ds_read_b128 a[176:179], v18 offset:22528
 v_or_b32 v13, v224, v225
 v_mfma_f32_16x16x32_bf16 a[72:75], a[144:147], v[192:195], a[72:75]
 s_waitcnt lgkmcnt(7)
 v_exp_f32 v20, v228
 v_mfma_f32_16x16x32_bf16 a[72:75], a[148:151], v[200:203], a[72:75]
 v_exp_f32 v21, v229
 v_mfma_f32_16x16x32_bf16 a[104:107], a[144:147], v[208:211], a[104:107]
 ds_read_b128 a[180:183], v18 offset:30720
 v_cvt_pk_bf16_f32 v226, v20, v21
 v_mfma_f32_16x16x32_bf16 a[104:107], a[148:151], v[216:219], a[104:107]
 s_waitcnt lgkmcnt(7)
 buffer_load_dwordx4 v14, s[4:7], s65 offen offset:3072 sc1 lds
 s_add_u32 s65, s65, 16384
 v_mfma_f32_16x16x32_bf16 a[76:79], a[152:155], v[192:195], a[76:79]
 s_waitcnt lgkmcnt(6)
 v_exp_f32 v20, v230
 v_mfma_f32_16x16x32_bf16 a[76:79], a[156:159], v[200:203], a[76:79]
 v_exp_f32 v21, v231
 v_mfma_f32_16x16x32_bf16 a[108:111], a[152:155], v[208:211], a[108:111]
 ds_read_b128 a[184:187], v18 offset:23552
 v_cvt_pk_bf16_f32 v227, v20, v21
 v_mfma_f32_16x16x32_bf16 a[108:111], a[156:159], v[216:219], a[108:111]
 s_waitcnt lgkmcnt(6)
 ds_read_b128 a[188:191], v18 offset:31744
 v_or3_b32 v13, v226, v227, v13
 v_mfma_f32_16x16x32_bf16 a[80:83], a[160:163], v[192:195], a[80:83]
 s_waitcnt lgkmcnt(6)
 s_add_u32 s67, s66, s82
 v_exp_f32 v20, v172
 v_mfma_f32_16x16x32_bf16 a[80:83], a[164:167], v[200:203], a[80:83]
 s_add_u32 s66, s66, 32768
 v_exp_f32 v21, v173
 v_mfma_f32_16x16x32_bf16 a[112:115], a[160:163], v[208:211], a[112:115]
 s_cmp_eq_u32 s66, 98304
 s_cselect_b32 s66, 0, s66
 v_cvt_pk_bf16_f32 v232, v20, v21
 v_mfma_f32_16x16x32_bf16 a[112:115], a[164:167], v[216:219], a[112:115]
 s_waitcnt lgkmcnt(5)
 v_add_u32 v18, s66, v14
 v_mfma_f32_16x16x32_bf16 a[84:87], a[168:171], v[192:195], a[84:87]
 s_waitcnt vmcnt(8) lgkmcnt(0)
 s_barrier
 v_exp_f32 v20, v174
 v_mfma_f32_16x16x32_bf16 a[84:87], a[172:175], v[200:203], a[84:87]
 v_exp_f32 v21, v175
 v_mfma_f32_16x16x32_bf16 a[116:119], a[168:171], v[208:211], a[116:119]
 ds_read_b128 a[128:131], v18 offset:0
 v_cvt_pk_bf16_f32 v233, v20, v21
 v_mfma_f32_16x16x32_bf16 a[116:119], a[172:175], v[216:219], a[116:119]
 ds_read_b128 a[132:135], v18 offset:1024
 v_or3_b32 v13, v232, v233, v13
 v_mfma_f32_16x16x32_bf16 a[88:91], a[176:179], v[192:195], a[88:91]
 v_exp_f32 v20, v236
 v_mfma_f32_16x16x32_bf16 a[88:91], a[180:183], v[200:203], a[88:91]
 v_exp_f32 v21, v237
 v_mfma_f32_16x16x32_bf16 a[120:123], a[176:179], v[208:211], a[120:123]
 ds_read_b128 a[136:139], v18 offset:2048
 v_cvt_pk_bf16_f32 v234, v20, v21
 v_mfma_f32_16x16x32_bf16 a[120:123], a[180:183], v[216:219], a[120:123]
 ds_read_b128 a[140:143], v18 offset:3072
 v_mfma_f32_16x16x32_bf16 a[92:95], a[184:187], v[192:195], a[92:95]
 v_exp_f32 v20, v238
 v_mfma_f32_16x16x32_bf16 a[92:95], a[188:191], v[200:203], a[92:95]
 v_exp_f32 v21, v239
 v_mfma_f32_16x16x32_bf16 a[124:127], a[184:187], v[208:211], a[124:127]
 ds_read_b128 a[144:147], v18 offset:4096
 v_cvt_pk_bf16_f32 v235, v20, v21
 v_mfma_f32_16x16x32_bf16 a[124:127], a[188:191], v[216:219], a[124:127]
 s_waitcnt lgkmcnt(4)
 ds_read_b128 a[148:151], v18 offset:5120
 v_or3_b32 v13, v234, v235, v13
L_sp1:
 v_mfma_f32_16x16x32_bf16 v[36:39], a[128:131], v[48:51], v[176:179]
 s_waitcnt lgkmcnt(4)
 s_add_u32 m0, s67, 0
 ds_read_b128 a[152:155], v18 offset:6144
 v_exp_f32 v20, v180
 v_mfma_f32_16x16x32_bf16 v[36:39], a[132:135], v[84:87], v[36:39]
 s_waitcnt lgkmcnt(4)
 ds_read_b128 a[156:159], v18 offset:7168
 v_exp_f32 v21, v181
 v_mfma_f32_16x16x32_bf16 v[36:39], a[136:139], v[148:151], v[36:39]
 s_waitcnt lgkmcnt(4)
 ds_read_b128 a[160:163], v18 offset:8192
 v_cvt_pk_bf16_f32 v240, v20, v21
 v_mfma_f32_16x16x32_bf16 v[36:39], a[140:143], v[212:215], v[36:39]
 buffer_load_dwordx4 v14, s[4:7], s64 offen offset:0 sc1 lds
 v_mfma_f32_16x16x32_bf16 v[52:55], a[128:131], v[56:59], v[184:187]
 ds_read_b128 a[164:167], v18 offset:9216
 v_exp_f32 v20, v182
 v_mfma_f32_16x16x32_bf16 v[52:55], a[132:135], v[92:95], v[52:55]
 ds_read_b128 a[168:171], v18 offset:10240
 v_exp_f32 v21, v183
 v_mfma_f32_16x16x32_bf16 v[52:55], a[136:139], v[156:159], v[52:55]
 ds_read_b128 a[172:175], v18 offset:11264
 v_cvt_pk_bf16_f32 v241, v20, v21
 v_mfma_f32_16x16x32_bf16 v[52:55], a[140:143], v[220:223], v[52:55]
 s_waitcnt lgkmcnt(7)
 ds_read_b128 a[176:179], v18 offset:12288
 v_or3_b32 v13, v240, v241, v13
 v_mfma_f32_16x16x32_bf16 v[100:103], a[144:147], v[48:51], v[176:179]
 s_waitcnt lgkmcnt(7)
 ds_read_b128 a[180:183], v18 offset:13312
 v_exp_f32 v20, v244
 v_mfma_f32_16x16x32_bf16 v[100:103], a[148:151], v[84:87], v[100:103]
 s_waitcnt lgkmcnt(7)
 ds_read_b128 a[184:187], v18 offset:14336
 v_exp_f32 v21, v245
 v_mfma_f32_16x16x32_bf16 v[100:103], a[152:155], v[148:151], v[100:103]
 s_waitcnt lgkmcnt(7)
 ds_read_b128 a[188:191], v18 offset:15360
 v_cvt_pk_bf16_f32 v242, v20, v21
 v_mfma_f32_16x16x32_bf16 v[100:103], a[156:159], v[212:215], v[100:103]
 buffer_load_dwordx4 v14, s[4:7], s64 offen offset:1024 sc1 lds
 v_mfma_f32_16x16x32_bf16 v[116:119], a[144:147], v[56:59], v[184:187]
 ds_read_b128 a[128:131], v18 offset:16384
 v_exp_f32 v20, v246
 v_mfma_f32_16x16x32_bf16 v[116:119], a[148:151], v[92:95], v[116:119]
 v_exp_f32 v21, v247
 v_mfma_f32_16x16x32_bf16 v[116:119], a[152:155], v[156:159], v[116:119]
 ds_read_b128 a[132:135], v18 offset:24576
 v_cvt_pk_bf16_f32 v243, v20, v21
 v_mfma_f32_16x16x32_bf16 v[116:119], a[156:159], v[220:223], v[116:119]
 s_waitcnt lgkmcnt(9)
 buffer_load_dwordx4 v14, s[4:7], s64 offen offset:2048 sc1 lds
 v_or3_b32 v13, v242, v243, v13
 v_mfma_f32_16x16x32_bf16 v[44:47], a[160:163], v[48:51], v[176:179]
 s_waitcnt lgkmcnt(8)
 v_exp_f32 v20, v188
 v_mfma_f32_16x16x32_bf16 v[44:47], a[164:167], v[84:87], v[44:47]
 s_waitcnt lgkmcnt(7)
 v_exp_f32 v21, v189
 v_mfma_f32_16x16x32_bf16 v[44:47], a[168:171], v[148:151], v[44:47]
 s_waitcnt lgkmcnt(6)
 ds_read_b128 a[136:139], v18 offset:17408
 v_cvt_pk_bf16_f32 v248, v20, v21
 v_mfma_f32_16x16x32_bf16 v[44:47], a[172:175], v[212:215], v[44:47]
 buffer_load_dwordx4 v14, s[4:7], s64 offen offset:3072 sc1 lds
 s_add_u32 s64, s64, 16384
 s_add_u32 m0, s67, 16384
 v_mfma_f32_16x16x32_bf16 v[60:63], a[160:163], v[56:59], v[184:187]
 v_exp_f32 v20, v190
 v_mfma_f32_16x16x32_bf16 v[60:63], a[164:167], v[92:95], v[60:63]
 v_exp_f32 v21, v191
 v_mfma_f32_16x16x32_bf16 v[60:63], a[168:171], v[156:159], v[60:63]
 ds_read_b128 a[140:143], v18 offset:25600
 v_cvt_pk_bf16_f32 v249, v20, v21
 v_mfma_f32_16x16x32_bf16 v[60:63], a[172:175], v[220:223], v[60:63]
 s_waitcnt lgkmcnt(7)
 ds_read_b128 a[144:147], v18 offset:18432
 v_or3_b32 v13, v248, v249, v13
 v_mfma_f32_16x16x32_bf16 v[108:111], a[176:179], v[48:51], v[176:179]
 s_waitcnt lgkmcnt(7)
 v_exp_f32 v20, v252
 v_mfma_f32_16x16x32_bf16 v[108:111], a[180:183], v[84:87], v[108:111]
 s_waitcnt lgkmcnt(6)
 v_exp_f32 v21, v253
 v_mfma_f32_16x16x32_bf16 v[108:111], a[184:187], v[148:151], v[108:111]
 s_waitcnt lgkmcnt(5)
 ds_read_b128 a[148:151], v18 offset:26624
 v_cvt_pk_bf16_f32 v250, v20, v21
 v_mfma_f32_16x16x32_bf16 v[108:111], a[188:191], v[212:215], v[108:111]
 buffer_load_dwordx4 v14, s[4:7], s65 offen offset:0 sc1 lds
 v_mfma_f32_16x16x32_bf16 v[124:127], a[176:179], v[56:59], v[184:187]
 v_exp_f32 v20, v254
 v_mfma_f32_16x16x32_bf16 v[124:127], a[180:183], v[92:95], v[124:127]
 v_exp_f32 v21, v255
 v_mfma_f32_16x16x32_bf16 v[124:127], a[184:187], v[156:159], v[124:127]
 ds_read_b128 a[152:155], v18 offset:19456
 v_cvt_pk_bf16_f32 v251, v20, v21
 v_mfma_f32_16x16x32_bf16 v[124:127], a[188:191], v[220:223], v[124:127]
 ds_read_b128 a[156:159], v18 offset:27648
 v_or3_b32 v13, v250, v251, v13
 v_mfma_f32_16x16x32_bf16 v[136:139], v[28:31], v[192:195], v[136:139]
 v_and_b32 v13, 0x40004000, v13
 v_cmp_ne_u32 vcc, 0, v13
 v_mfma_f32_16x16x32_bf16 v[136:139], v[28:31], v[200:203], v[136:139]
 ds_read_b128 a[160:163], v18 offset:20480
 v_mfma_f32_16x16x32_bf16 v[144:147], v[28:31], v[208:211], v[144:147]
 buffer_load_dwordx4 v14, s[4:7], s65 offen offset:1024 sc1 lds
 v_mfma_f32_16x16x32_bf16 v[144:147], v[28:31], v[216:219], v[144:147]
 s_waitcnt lgkmcnt(8)
 ds_read_b128 a[164:167], v18 offset:28672
 s_cbranch_vccnz L_tr_169
L_back_168:
 v_mfma_f32_16x16x32_bf16 a[64:67], a[128:131], v[224:227], a[64:67]
 s_waitcnt lgkmcnt(8)
 v_exp_f32 v20, v36
 v_mfma_f32_16x16x32_bf16 a[64:67], a[132:135], v[232:235], a[64:67]
 s_sub_u32 s68, s68, 4
 v_exp_f32 v21, v37
 v_mfma_f32_16x16x32_bf16 a[96:99], a[128:131], v[240:243], a[96:99]
 ds_read_b128 a[168:171], v18 offset:21504
 v_cvt_pk_bf16_f32 v192, v20, v21
 v_mfma_f32_16x16x32_bf16 a[96:99], a[132:135], v[248:251], a[96:99]
 s_waitcnt lgkmcnt(8)
 buffer_load_dwordx4 v14, s[4:7], s65 offen offset:2048 sc1 lds
 v_mfma_f32_16x16x32_bf16 a[68:71], a[136:139], v[224:227], a[68:71]
 s_waitcnt lgkmcnt(7)
 v_exp_f32 v20, v38
 v_mfma_f32_16x16x32_bf16 a[68:71], a[140:143], v[232:235], a[68:71]
 v_exp_f32 v21, v39
 v_mfma_f32_16x16x32_bf16 a[100:103], a[136:139], v[240:243], a[100:103]
 ds_read_b128 a[172:175], v18 offset:29696
 v_cvt_pk_bf16_f32 v193, v20, v21
 v_mfma_f32_16x16x32_bf16 a[100:103], a[140:143], v[248:251], a[100:103]
 s_waitcnt lgkmcnt(7)
 ds_read_b128 a[176:179], v18 offset:22528
 v_or_b32 v13, v192, v193
 v_mfma_f32_16x16x32_bf16 a[72:75], a[144:147], v[224:227], a[72:75]
 s_waitcnt lgkmcnt(7)
 v_exp_f32 v20, v100
 v_mfma_f32_16x16x32_bf16 a[72:75], a[148:151], v[232:235], a[72:75]
 v_exp_f32 v21, v101
 v_mfma_f32_16x16x32_bf16 a[104:107], a[144:147], v[240:243], a[104:107]
 ds_read_b128 a[180:183], v18 offset:30720
 v_cvt_pk_bf16_f32 v194, v20, v21
 v_mfma_f32_16x16x32_bf16 a[104:107], a[148:151], v[248:251], a[104:107]
 s_waitcnt lgkmcnt(7)
 buffer_load_dwordx4 v14, s[4:7], s65 offen offset:3072 sc1 lds
 s_add_u32 s65, s65, 16384
 v_mfma_f32_16x16x32_bf16 a[76:79], a[152:155], v[224:227], a[76:79]
 s_waitcnt lgkmcnt(6)
 v_exp_f32 v20, v102
 v_mfma_f32_16x16x32_bf16 a[76:79], a[156:159], v[232:235], a[76:79]
 v_exp_f32 v21, v103
 v_mfma_f32_16x16x32_bf16 a[108:111], a[152:155], v[240:243], a[108:111]
 ds_read_b128 a[184:187], v18 offset:23552
 v_cvt_pk_bf16_f32 v195, v20, v21
 v_mfma_f32_16x16x32_bf16 a[108:111], a[156:159], v[248:251], a[108:111]
 s_waitcnt lgkmcnt(6)
 ds_read_b128 a[188:191], v18 offset:31744
 v_or3_b32 v13, v194, v195, v13
 v_mfma_f32_16x16x32_bf16 a[80:83], a[160:163], v[224:227], a[80:83]
 s_waitcnt lgkmcnt(6)
 s_add_u32 s67, s66, s82
 v_exp_f32 v20, v44
 v_mfma_f32_16x16x32_bf16 a[80:83], a[164:167], v[232:235], a[80:83]
 s_add_u32 s66, s66, 32768
 v_exp_f32 v21, v45
 v_mfma_f32_16x16x32_bf16 a[112:115], a[160:163], v[240:243], a[112:115]
 s_cmp_eq_u32 s66, 98304
 s_cselect_b32 s66, 0, s66
 v_cvt_pk_bf16_f32 v200, v20, v21
 v_mfma_f32_16x16x32_bf16 a[112:115], a[164:167], v[248:251], a[112:115]
 s_waitcnt lgkmcnt(5)
 v_add_u32 v18, s66, v14
 v_mfma_f32_16x16x32_bf16 a[84:87], a[168:171], v[224:227], a[84:87]
 s_waitcnt vmcnt(8) lgkmcnt(0)
 s_barrier
 v_exp_f32 v20, v46
 v_mfma_f32_16x16x32_bf16 a[84:87], a[172:175], v[232:235], a[84:87]
 v_exp_f32 v21, v47
 v_mfma_f32_16x16x32_bf16 a[116:119], a[168:171], v[240:243], a[116:119]
 ds_read_b128 a[128:131], v18 offset:0
 v_cvt_pk_bf16_f32 v201, v20, v21
 v_mfma_f32_16x16x32_bf16 a[116:119], a[172:175], v[248:251], a[116:119]
 ds_read_b128 a[132:135], v18 offset:1024
 v_or3_b32 v13, v200, v201, v13
 v_mfma_f32_16x16x32_bf16 a[88:91], a[176:179], v[224:227], a[88:91]
 s_sub_u32 s92, s92, 1
 v_exp_f32 v20, v108
 v_mfma_f32_16x16x32_bf16 a[88:91], a[180:183], v[232:235], a[88:91]
 v_exp_f32 v21, v109
 v_mfma_f32_16x16x32_bf16 a[120:123], a[176:179], v[240:243], a[120:123]
 ds_read_b128 a[136:139], v18 offset:2048
 v_cvt_pk_bf16_f32 v202, v20, v21
 v_mfma_f32_16x16x32_bf16 a[120:123], a[180:183], v[248:251], a[120:123]
 ds_read_b128 a[140:143], v18 offset:3072
 v_mfma_f32_16x16x32_bf16 a[92:95], a[184:187], v[224:227], a[92:95]
 v_exp_f32 v20, v110
 v_mfma_f32_16x16x32_bf16 a[92:95], a[188:191], v[232:235], a[92:95]
 v_exp_f32 v21, v111
 v_mfma_f32_16x16x32_bf16 a[124:127], a[184:187], v[240:243], a[124:127]
 ds_read_b128 a[144:147], v18 offset:4096
 v_cvt_pk_bf16_f32 v203, v20, v21
 v_mfma_f32_16x16x32_bf16 a[124:127], a[188:191], v[248:251], a[124:127]
 s_waitcnt lgkmcnt(4)
 ds_read_b128 a[148:151], v18 offset:5120
 v_or3_b32 v13, v202, v203, v13
 s_cmp_lg_u32 s92, 0
 s_cbranch_scc1 L_sp
L_s1:
 v_mfma_f32_16x16x32_bf16 v[164:167], a[128:131], v[48:51], v[176:179]
 s_waitcnt lgkmcnt(4)
 s_add_u32 m0, s67, 0
 ds_read_b128 a[152:155], v18 offset:6144
 v_exp_f32 v20, v52
 v_mfma_f32_16x16x32_bf16 v[164:167], a[132:135], v[84:87], v[164:167]
 s_waitcnt lgkmcnt(4)
 ds_read_b128 a[156:159], v18 offset:7168
 v_exp_f32 v21, v53
 v_mfma_f32_16x16x32_bf16 v[164:167], a[136:139], v[148:151], v[164:167]
 s_waitcnt lgkmcnt(4)
 ds_read_b128 a[160:163], v18 offset:8192
 v_cvt_pk_bf16_f32 v208, v20, v21
 v_mfma_f32_16x16x32_bf16 v[164:167], a[140:143], v[212:215], v[164:167]
 buffer_load_dwordx4 v14, s[4:7], s64 offen offset:0 sc1 lds
 v_mfma_f32_16x16x32_bf16 v[180:183], a[128:131], v[56:59], v[184:187]
 ds_read_b128 a[164:167], v18 offset:9216
 v_exp_f32 v20, v54
 v_mfma_f32_16x16x32_bf16 v[180:183], a[132:135], v[92:95], v[180:183]
 ds_read_b128 a[168:171], v18 offset:10240
 v_exp_f32 v21, v55
 v_mfma_f32_16x16x32_bf16 v[180:183], a[136:139], v[156:159], v[180:183]
 ds_read_b128 a[172:175], v18 offset:11264
 v_cvt_pk_bf16_f32 v209, v20, v21
 v_mfma_f32_16x16x32_bf16 v[180:183], a[140:143], v[220:223], v[180:183]
 s_waitcnt lgkmcnt(7)
 ds_read_b128 a[176:179], v18 offset:12288
 v_or3_b32 v13, v208, v209, v13
 v_mfma_f32_16x16x32_bf16 v[228:231], a[144:147], v[48:51], v[176:179]
 s_waitcnt lgkmcnt(7)
 ds_read_b128 a[180:183], v18 offset:13312
 v_exp_f32 v20, v116
 v_mfma_f32_16x16x32_bf16 v[228:231], a[148:151], v[84:87], v[228:231]
 s_waitcnt lgkmcnt(7)
 ds_read_b128 a[184:187], v18 offset:14336
 v_exp_f32 v21, v117
 v_mfma_f32_16x16x32_bf16 v[228:231], a[152:155], v[148:151], v[228:231]
 s_waitcnt lgkmcnt(7)
 ds_read_b128 a[188:191], v18 offset:15360
 v_cvt_pk_bf16_f32 v210, v20, v21
 v_mfma_f32_16x16x32_bf16 v[228:231], a[156:159], v[212:215], v[228:231]
 buffer_load_dwordx4 v14, s[4:7], s64 offen offset:1024 sc1 lds
 v_mfma_f32_16x16x32_bf16 v[244:247], a[144:147], v[56:59], v[184:187]
 ds_read_b128 a[128:131], v18 offset:16384
 v_exp_f32 v20, v118
 v_mfma_f32_16x16x32_bf16 v[244:247], a[148:151], v[92:95], v[244:247]
 ds_read_b128 a[132:135], v18 offset:24576
 v_exp_f32 v21, v119
 v_mfma_f32_16x16x32_bf16 v[244:247], a[152:155], v[156:159], v[244:247]
 ds_read_b128 a[136:139], v18 offset:17408
 v_cvt_pk_bf16_f32 v211, v20, v21
 v_mfma_f32_16x16x32_bf16 v[244:247], a[156:159], v[220:223], v[244:247]
 s_waitcnt lgkmcnt(10)
 buffer_load_dwordx4 v14, s[4:7], s64 offen offset:2048 sc1 lds
 v_or3_b32 v13, v210, v211, v13
 v_mfma_f32_16x16x32_bf16 v[172:175], a[160:163], v[48:51], v[176:179]
 s_waitcnt lgkmcnt(9)
 ds_read_b128 a[140:143], v18 offset:25600
 v_exp_f32 v20, v60
 v_mfma_f32_16x16x32_bf16 v[172:175], a[164:167], v[84:87], v[172:175]
 s_waitcnt lgkmcnt(9)
 ds_read_b128 a[144:147], v18 offset:18432
 v_exp_f32 v21, v61
 v_mfma_f32_16x16x32_bf16 v[172:175], a[168:171], v[148:151], v[172:175]
 s_waitcnt lgkmcnt(9)
 ds_read_b128 a[148:151], v18 offset:26624
 v_cvt_pk_bf16_f32 v216, v20, v21
 v_mfma_f32_16x16x32_bf16 v[172:175], a[172:175], v[212:215], v[172:175]
 buffer_load_dwordx4 v14, s[4:7], s64 offen offset:3072 sc1 lds
 s_add_u32 s64, s64, 16384
 s_add_u32 m0, s67, 16384
 v_mfma_f32_16x16x32_bf16 v[188:191], a[160:163], v[56:59], v[184:187]
 ds_read_b128 a[152:155], v18 offset:19456
 v_exp_f32 v20, v62
 v_mfma_f32_16x16x32_bf16 v[188:191], a[164:167], v[92:95], v[188:191]
 v_exp_f32 v21, v63
 v_mfma_f32_16x16x32_bf16 v[188:191], a[168:171], v[156:159], v[188:191]
 ds_read_b128 a[156:159], v18 offset:27648
 v_cvt_pk_bf16_f32 v217, v20, v21
 v_mfma_f32_16x16x32_bf16 v[188:191], a[172:175], v[220:223], v[188:191]
 s_waitcnt lgkmcnt(11)
 ds_read_b128 a[160:163], v18 offset:20480
 v_or3_b32 v13, v216, v217, v13
 v_mfma_f32_16x16x32_bf16 v[236:239], a[176:179], v[48:51], v[176:179]
 s_waitcnt lgkmcnt(11)
 v_exp_f32 v20, v124
 v_mfma_f32_16x16x32_bf16 v[236:239], a[180:183], v[84:87], v[236:239]
 s_waitcnt lgkmcnt(10)
 v_exp_f32 v21, v125
 v_mfma_f32_16x16x32_bf16 v[236:239], a[184:187], v[148:151], v[236:239]
 s_waitcnt lgkmcnt(9)
 ds_read_b128 a[164:167], v18 offset:28672
 v_cvt_pk_bf16_f32 v218, v20, v21
 v_mfma_f32_16x16x32_bf16 v[236:239], a[188:191], v[212:215], v[236:239]
 buffer_load_dwordx4 v14, s[4:7], s65 offen offset:0 sc1 lds
 v_mfma_f32_16x16x32_bf16 v[252:255], a[176:179], v[56:59], v[184:187]
 v_exp_f32 v20, v126
 v_mfma_f32_16x16x32_bf16 v[252:255], a[180:183], v[92:95], v[252:255]
 v_exp_f32 v21, v127
 v_mfma_f32_16x16x32_bf16 v[252:255], a[184:187], v[156:159], v[252:255]
 ds_read_b128 a[168:171], v18 offset:21504
 v_cvt_pk_bf16_f32 v219, v20, v21
 v_mfma_f32_16x16x32_bf16 v[252:255], a[188:191], v[220:223], v[252:255]
 ds_read_b128 a[172:175], v18 offset:29696
 v_or3_b32 v13, v218, v219, v13
 v_mfma_f32_16x16x32_bf16 v[136:139], v[28:31], v[224:227], v[136:139]
 v_and_b32 v13, 0x40004000, v13
 v_cmp_ne_u32 vcc, 0, v13
 v_mfma_f32_16x16x32_bf16 v[136:139], v[28:31], v[232:235], v[136:139]
 ds_read_b128 a[176:179], v18 offset:22528
 v_mfma_f32_16x16x32_bf16 v[144:147], v[28:31], v[240:243], v[144:147]
 buffer_load_dwordx4 v14, s[4:7], s65 offen offset:1024 sc1 lds
 v_mfma_f32_16x16x32_bf16 v[144:147], v[28:31], v[248:251], v[144:147]
 s_waitcnt lgkmcnt(12)
 ds_read_b128 a[180:183], v18 offset:30720
 s_cbranch_vccnz L_tr_173
L_back_172:
 v_mfma_f32_16x16x32_bf16 a[64:67], a[128:131], v[192:195], a[64:67]
 s_waitcnt lgkmcnt(12)
 v_exp_f32 v20, v164
 v_mfma_f32_16x16x32_bf16 a[64:67], a[132:135], v[200:203], a[64:67]
 s_sub_u32 s68, s68, 4
 v_exp_f32 v21, v165
 v_mfma_f32_16x16x32_bf16 a[96:99], a[128:131], v[208:211], a[96:99]
 s_cmp_eq_i32 s68, 3
 s_cselect_b32 s71, 1.0, 0
 v_cvt_pk_bf16_f32 v224, v20, v21
 v_mfma_f32_16x16x32_bf16 a[96:99], a[132:135], v[216:219], a[96:99]
 s_waitcnt lgkmcnt(11)
 s_cmp_lt_i32 s68, 3
 s_cselect_b32 s76, 0xf1800000, 0
 buffer_load_dwordx4 v14, s[4:7], s65 offen offset:2048 sc1 lds
 v_mfma_f32_16x16x32_bf16 a[68:71], a[136:139], v[192:195], a[68:71]
 s_waitcnt lgkmcnt(10)
 s_cmp_eq_i32 s68, 2
 s_cselect_b32 s72, 1.0, 0
 v_exp_f32 v20, v166
 v_mfma_f32_16x16x32_bf16 a[68:71], a[140:143], v[200:203], a[68:71]
 s_cmp_lt_i32 s68, 2
 s_cselect_b32 s77, 0xf1800000, 0
 v_exp_f32 v21, v167
 v_mfma_f32_16x16x32_bf16 a[100:103], a[136:139], v[208:211], a[100:103]
 s_cmp_eq_i32 s68, 1
 s_cselect_b32 s73, 1.0, 0
 v_cvt_pk_bf16_f32 v225, v20, v21
 v_mfma_f32_16x16x32_bf16 a[100:103], a[140:143], v[216:219], a[100:103]
 s_waitcnt lgkmcnt(9)
 s_cmp_lt_i32 s68, 1
 s_cselect_b32 s78, 0xf1800000, 0
 v_or_b32 v13, v224, v225
 v_mfma_f32_16x16x32_bf16 a[72:75], a[144:147], v[192:195], a[72:75]
 s_waitcnt lgkmcnt(8)
 s_cmp_eq_i32 s68, 0
 s_cselect_b32 s74, 1.0, 0
 v_exp_f32 v20, v228
 v_mfma_f32_16x16x32_bf16 a[72:75], a[148:151], v[200:203], a[72:75]
 s_cmp_lt_i32 s68, 0
 s_cselect_b32 s79, 0xf1800000, 0
 v_exp_f32 v21, v229
 v_mfma_f32_16x16x32_bf16 a[104:107], a[144:147], v[208:211], a[104:107]
 s_cmp_eq_i32 s68, -1
 s_cselect_b32 s75, 1.0, 0
 v_cvt_pk_bf16_f32 v226, v20, v21
 v_mfma_f32_16x16x32_bf16 a[104:107], a[148:151], v[216:219], a[104:107]
 s_waitcnt lgkmcnt(7)
 buffer_load_dwordx4 v14, s[4:7], s65 offen offset:3072 sc1 lds
 s_add_u32 s65, s65, 16384
 s_cmp_lt_i32 s68, -1
 s_cselect_b32 s80, 0xf1800000, 0
 v_mfma_f32_16x16x32_bf16 a[76:79], a[152:155], v[192:195], a[76:79]
 s_waitcnt lgkmcnt(6)
 v_exp_f32 v20, v230
 v_mfma_f32_16x16x32_bf16 a[76:79], a[156:159], v[200:203], a[76:79]
 v_exp_f32 v21, v231
 v_mfma_f32_16x16x32_bf16 a[108:111], a[152:155], v[208:211], a[108:111]
 ds_read_b128 a[184:187], v18 offset:23552
 v_cvt_pk_bf16_f32 v227, v20, v21
 v_mfma_f32_16x16x32_bf16 a[108:111], a[156:159], v[216:219], a[108:111]
 s_waitcnt lgkmcnt(6)
 ds_read_b128 a[188:191], v18 offset:31744
 v_or3_b32 v13, v226, v227, v13
 v_mfma_f32_16x16x32_bf16 a[80:83], a[160:163], v[192:195], a[80:83]
 s_waitcnt lgkmcnt(6)
 s_add_u32 s67, s66, s82
 v_exp_f32 v20, v172
 v_mfma_f32_16x16x32_bf16 a[80:83], a[164:167], v[200:203], a[80:83]
 s_add_u32 s66, s66, 32768
 v_exp_f32 v21, v173
 v_mfma_f32_16x16x32_bf16 a[112:115], a[160:163], v[208:211], a[112:115]
 s_cmp_eq_u32 s66, 98304
 s_cselect_b32 s66, 0, s66
 v_cvt_pk_bf16_f32 v232, v20, v21
 v_mfma_f32_16x16x32_bf16 a[112:115], a[164:167], v[216:219], a[112:115]
 s_waitcnt lgkmcnt(5)
 v_add_u32 v18, s66, v14
 v_mfma_f32_16x16x32_bf16 a[84:87], a[168:171], v[192:195], a[84:87]
 s_waitcnt vmcnt(8) lgkmcnt(0)
 s_barrier
 s_lshl_b32 s94, s2, 6
 s_add_u32 s94, s94, 71401472
 s_cmp_eq_u32 s60, 0
 s_cselect_b32 s94, s94, 0x8000000
 v_lshl_add_u32 v22, v14, 21, s94
 v_mov_b32 v23, 1
 buffer_store_dword v23, v22, s[4:7], 0 offen sc1
 s_lshl_b32 s94, s2, 6
 s_add_u32 s94, s94, 71467008
 s_cmp_eq_u32 s60, 0
 s_cselect_b32 s94, s94, 0x8000000
 v_lshl_add_u32 v22, v14, 21, s94
 v_mov_b32 v23, 1
 buffer_store_dword v23, v22, s[4:7], 0 offen sc1
 v_exp_f32 v20, v174
 v_mfma_f32_16x16x32_bf16 a[84:87], a[172:175], v[200:203], a[84:87]
 v_exp_f32 v21, v175
 v_mfma_f32_16x16x32_bf16 a[116:119], a[168:171], v[208:211], a[116:119]
 ds_read_b128 a[128:131], v18 offset:0
 v_cvt_pk_bf16_f32 v233, v20, v21
 v_mfma_f32_16x16x32_bf16 a[116:119], a[172:175], v[216:219], a[116:119]
 ds_read_b128 a[132:135], v18 offset:1024
 v_or3_b32 v13, v232, v233, v13
 v_mfma_f32_16x16x32_bf16 a[88:91], a[176:179], v[192:195], a[88:91]
 v_exp_f32 v20, v236
 v_mfma_f32_16x16x32_bf16 a[88:91], a[180:183], v[200:203], a[88:91]
 v_exp_f32 v21, v237
 v_mfma_f32_16x16x32_bf16 a[120:123], a[176:179], v[208:211], a[120:123]
 ds_read_b128 a[136:139], v18 offset:2048
 v_cvt_pk_bf16_f32 v234, v20, v21
 v_mfma_f32_16x16x32_bf16 a[120:123], a[180:183], v[216:219], a[120:123]
 ds_read_b128 a[140:143], v18 offset:3072
 v_mfma_f32_16x16x32_bf16 a[92:95], a[184:187], v[192:195], a[92:95]
 v_exp_f32 v20, v238
 v_mfma_f32_16x16x32_bf16 a[92:95], a[188:191], v[200:203], a[92:95]
 v_exp_f32 v21, v239
 v_mfma_f32_16x16x32_bf16 a[124:127], a[184:187], v[208:211], a[124:127]
 ds_read_b128 a[144:147], v18 offset:4096
 v_cvt_pk_bf16_f32 v235, v20, v21
 v_mfma_f32_16x16x32_bf16 a[124:127], a[188:191], v[216:219], a[124:127]
 s_waitcnt lgkmcnt(4)
 ds_read_b128 a[148:151], v18 offset:5120
 v_or3_b32 v13, v234, v235, v13
L_s2:
 v_add_f32 v22, s79, v176
 v_fma_f32 v36, v24, s74, v22
 v_fma_f32 v37, v25, s74, v22
 v_fma_f32 v38, v26, s74, v22
 v_fma_f32 v39, v27, s74, v22
 s_nop 1
 v_mfma_f32_16x16x32_bf16 v[36:39], a[128:131], v[48:51], v[36:39]
 s_waitcnt lgkmcnt(4)
 s_add_u32 m0, s67, 16384
 ds_read_b128 a[152:155], v18 offset:6144
 v_exp_f32 v20, v180
 v_mfma_f32_16x16x32_bf16 v[36:39], a[132:135], v[84:87], v[36:39]
 s_waitcnt lgkmcnt(4)
 ds_read_b128 a[156:159], v18 offset:7168
 v_exp_f32 v21, v181
 v_add_f32 v22, s80, v184
 v_fma_f32 v52, v24, s75, v22
 v_fma_f32 v53, v25, s75, v22
 v_fma_f32 v54, v26, s75, v22
 v_fma_f32 v55, v27, s75, v22
 v_mfma_f32_16x16x32_bf16 v[36:39], a[136:139], v[148:151], v[36:39]
 s_waitcnt lgkmcnt(4)
 ds_read_b128 a[160:163], v18 offset:8192
 v_cvt_pk_bf16_f32 v240, v20, v21
 v_mfma_f32_16x16x32_bf16 v[36:39], a[140:143], v[212:215], v[36:39]
 buffer_load_dwordx4 v14, s[4:7], s65 offen offset:0 sc1 lds
 v_mfma_f32_16x16x32_bf16 v[52:55], a[128:131], v[56:59], v[52:55]
 ds_read_b128 a[164:167], v18 offset:9216
 v_exp_f32 v20, v182
 v_mfma_f32_16x16x32_bf16 v[52:55], a[132:135], v[92:95], v[52:55]
 ds_read_b128 a[168:171], v18 offset:10240
 v_exp_f32 v21, v183
 v_add_f32 v22, s78, v176
 v_fma_f32 v100, v24, s73, v22
 v_fma_f32 v101, v25, s73, v22
 v_fma_f32 v102, v26, s73, v22
 v_fma_f32 v103, v27, s73, v22
 v_mfma_f32_16x16x32_bf16 v[52:55], a[136:139], v[156:159], v[52:55]
 ds_read_b128 a[172:175], v18 offset:11264
 v_cvt_pk_bf16_f32 v241, v20, v21
 v_mfma_f32_16x16x32_bf16 v[52:55], a[140:143], v[220:223], v[52:55]
 s_waitcnt lgkmcnt(7)
 ds_read_b128 a[176:179], v18 offset:12288
 v_or3_b32 v13, v240, v241, v13
 v_mfma_f32_16x16x32_bf16 v[100:103], a[144:147], v[48:51], v[100:103]
 s_waitcnt lgkmcnt(7)
 ds_read_b128 a[180:183], v18 offset:13312
 v_exp_f32 v20, v244
 v_mfma_f32_16x16x32_bf16 v[100:103], a[148:151], v[84:87], v[100:103]
 s_waitcnt lgkmcnt(7)
 ds_read_b128 a[184:187], v18 offset:14336
 v_exp_f32 v21, v245
 v_add_f32 v22, s79, v184
 v_fma_f32 v116, v24, s74, v22
 v_fma_f32 v117, v25, s74, v22
 v_fma_f32 v118, v26, s74, v22
 v_fma_f32 v119, v27, s74, v22
 v_mfma_f32_16x16x32_bf16 v[100:103], a[152:155], v[148:151], v[100:103]
 s_waitcnt lgkmcnt(7)
 ds_read_b128 a[188:191], v18 offset:15360
 v_cvt_pk_bf16_f32 v242, v20, v21
 v_mfma_f32_16x16x32_bf16 v[100:103], a[156:159], v[212:215], v[100:103]
 buffer_load_dwordx4 v14, s[4:7], s65 offen offset:1024 sc1 lds
 v_mfma_f32_16x16x32_bf16 v[116:119], a[144:147], v[56:59], v[116:119]
 ds_read_b128 a[128:131], v18 offset:16384
 v_exp_f32 v20, v246
 v_mfma_f32_16x16x32_bf16 v[116:119], a[148:151], v[92:95], v[116:119]
 v_exp_f32 v21, v247
 v_add_f32 v22, s77, v176
 v_fma_f32 v44, v24, s72, v22
 v_fma_f32 v45, v25, s72, v22
 v_fma_f32 v46, v26, s72, v22
 v_fma_f32 v47, v27, s72, v22
 v_mfma_f32_16x16x32_bf16 v[116:119], a[152:155], v[156:159], v[116:119]
 ds_read_b128 a[132:135], v18 offset:24576
 v_cvt_pk_bf16_f32 v243, v20, v21
 v_mfma_f32_16x16x32_bf16 v[116:119], a[156:159], v[220:223], v[116:119]
 s_waitcnt lgkmcnt(9)
 ds_read_b128 a[136:139], v18 offset:17408
 v_or3_b32 v13, v242, v243, v13
 v_mfma_f32_16x16x32_bf16 v[44:47], a[160:163], v[48:51], v[44:47]
 s_waitcnt lgkmcnt(9)
 v_exp_f32 v20, v188
 v_mfma_f32_16x16x32_bf16 v[44:47], a[164:167], v[84:87], v[44:47]
 s_waitcnt lgkmcnt(8)
 v_exp_f32 v21, v189
 v_add_f32 v22, s78, v184
 v_fma_f32 v60, v24, s73, v22
 v_fma_f32 v61, v25, s73, v22
 v_fma_f32 v62, v26, s73, v22
 v_fma_f32 v63, v27, s73, v22
 v_mfma_f32_16x16x32_bf16 v[44:47], a[168:171], v[148:151], v[44:47]
 s_waitcnt lgkmcnt(7)
 ds_read_b128 a[140:143], v18 offset:25600
 v_cvt_pk_bf16_f32 v248, v20, v21
 v_mfma_f32_16x16x32_bf16 v[44:47], a[172:175], v[212:215], v[44:47]
 buffer_load_dwordx4 v14, s[4:7], s65 offen offset:2048 sc1 lds
 v_mfma_f32_16x16x32_bf16 v[60:63], a[160:163], v[56:59], v[60:63]
 v_exp_f32 v20, v190
 v_mfma_f32_16x16x32_bf16 v[60:63], a[164:167], v[92:95], v[60:63]
 v_exp_f32 v21, v191
 v_add_f32 v22, s76, v176
 v_fma_f32 v108, v24, s71, v22
 v_fma_f32 v109, v25, s71, v22
 v_fma_f32 v110, v26, s71, v22
 v_fma_f32 v111, v27, s71, v22
 v_mfma_f32_16x16x32_bf16 v[60:63], a[168:171], v[156:159], v[60:63]
 ds_read_b128 a[144:147], v18 offset:18432
 v_cvt_pk_bf16_f32 v249, v20, v21
 v_mfma_f32_16x16x32_bf16 v[60:63], a[172:175], v[220:223], v[60:63]
 s_waitcnt lgkmcnt(8)
 ds_read_b128 a[148:151], v18 offset:26624
 v_or3_b32 v13, v248, v249, v13
 v_mfma_f32_16x16x32_bf16 v[108:111], a[176:179], v[48:51], v[108:111]
 s_waitcnt lgkmcnt(8)
 v_exp_f32 v20, v252
 v_mfma_f32_16x16x32_bf16 v[108:111], a[180:183], v[84:87], v[108:111]
 s_waitcnt lgkmcnt(7)
 v_exp_f32 v21, v253
 v_add_f32 v22, s77, v184
 v_fma_f32 v124, v24, s72, v22
 v_fma_f32 v125, v25, s72, v22
 v_fma_f32 v126, v26, s72, v22
 v_fma_f32 v127, v27, s72, v22
 v_mfma_f32_16x16x32_bf16 v[108:111], a[184:187], v[148:151], v[108:111]
 s_waitcnt lgkmcnt(6)
 ds_read_b128 a[152:155], v18 offset:19456
 v_cvt_pk_bf16_f32 v250, v20, v21
 v_mfma_f32_16x16x32_bf16 v[108:111], a[188:191], v[212:215], v[108:111]
 buffer_load_dwordx4 v14, s[4:7], s65 offen offset:3072 sc1 lds
 s_add_u32 s65, s65, 16384
 v_mfma_f32_16x16x32_bf16 v[124:127], a[176:179], v[56:59], v[124:127]
 v_exp_f32 v20, v254
 v_mfma_f32_16x16x32_bf16 v[124:127], a[180:183], v[92:95], v[124:127]
 v_exp_f32 v21, v255
 v_mfma_f32_16x16x32_bf16 v[124:127], a[184:187], v[156:159], v[124:127]
 ds_read_b128 a[156:159], v18 offset:27648
 v_cvt_pk_bf16_f32 v251, v20, v21
 v_mfma_f32_16x16x32_bf16 v[124:127], a[188:191], v[220:223], v[124:127]
 ds_read_b128 a[160:163], v18 offset:20480
 v_or3_b32 v13, v250, v251, v13
 v_mfma_f32_16x16x32_bf16 v[136:139], v[28:31], v[192:195], v[136:139]
 v_and_b32 v13, 0x40004000, v13
 v_cmp_ne_u32 vcc, 0, v13
 v_mfma_f32_16x16x32_bf16 v[136:139], v[28:31], v[200:203], v[136:139]
 ds_read_b128 a[164:167], v18 offset:28672
 v_mfma_f32_16x16x32_bf16 v[144:147], v[28:31], v[208:211], v[144:147]
 ds_read_b128 a[168:171], v18 offset:21504
 v_mfma_f32_16x16x32_bf16 v[144:147], v[28:31], v[216:219], v[144:147]
 s_waitcnt lgkmcnt(10)
 ds_read_b128 a[172:175], v18 offset:29696
 s_cbranch_vccnz L_tr_176
L_back_175:
 v_mfma_f32_16x16x32_bf16 a[64:67], a[128:131], v[224:227], a[64:67]
 s_waitcnt lgkmcnt(10)
 v_exp_f32 v20, v36
 v_mfma_f32_16x16x32_bf16 a[64:67], a[132:135], v[232:235], a[64:67]
 s_sub_u32 s68, s68, 4
 v_exp_f32 v21, v37
 v_mfma_f32_16x16x32_bf16 a[96:99], a[128:131], v[240:243], a[96:99]
 s_cmp_eq_i32 s68, 3
 s_cselect_b32 s71, 1.0, 0
 v_cvt_pk_bf16_f32 v192, v20, v21
 v_mfma_f32_16x16x32_bf16 a[96:99], a[132:135], v[248:251], a[96:99]
 s_waitcnt lgkmcnt(9)
 s_cmp_lt_i32 s68, 3
 s_cselect_b32 s76, 0xf1800000, 0
 ds_read_b128 a[176:179], v18 offset:22528
 v_mfma_f32_16x16x32_bf16 a[68:71], a[136:139], v[224:227], a[68:71]
 s_waitcnt lgkmcnt(9)
 s_cmp_eq_i32 s68, 2
 s_cselect_b32 s72, 1.0, 0
 v_exp_f32 v20, v38
 v_mfma_f32_16x16x32_bf16 a[68:71], a[140:143], v[232:235], a[68:71]
 s_cmp_lt_i32 s68, 2
 s_cselect_b32 s77, 0xf1800000, 0
 v_exp_f32 v21, v39
 v_mfma_f32_16x16x32_bf16 a[100:103], a[136:139], v[240:243], a[100:103]
 s_cmp_eq_i32 s68, 1
 s_cselect_b32 s73, 1.0, 0
 v_cvt_pk_bf16_f32 v193, v20, v21
 v_mfma_f32_16x16x32_bf16 a[100:103], a[140:143], v[248:251], a[100:103]
 s_waitcnt lgkmcnt(8)
 s_cmp_lt_i32 s68, 1
 s_cselect_b32 s78, 0xf1800000, 0
 v_or_b32 v13, v192, v193
 v_mfma_f32_16x16x32_bf16 a[72:75], a[144:147], v[224:227], a[72:75]
 s_waitcnt lgkmcnt(7)
 s_cmp_eq_i32 s68, 0
 s_cselect_b32 s74, 1.0, 0
 v_exp_f32 v20, v100
 v_mfma_f32_16x16x32_bf16 a[72:75], a[148:151], v[232:235], a[72:75]
 s_cmp_lt_i32 s68, 0
 s_cselect_b32 s79, 0xf1800000, 0
 v_exp_f32 v21, v101
 v_mfma_f32_16x16x32_bf16 a[104:107], a[144:147], v[240:243], a[104:107]
 s_cmp_eq_i32 s68, -1
 s_cselect_b32 s75, 1.0, 0
 v_cvt_pk_bf16_f32 v194, v20, v21
 v_mfma_f32_16x16x32_bf16 a[104:107], a[148:151], v[248:251], a[104:107]
 s_waitcnt lgkmcnt(6)
 s_cmp_lt_i32 s68, -1
 s_cselect_b32 s80, 0xf1800000, 0
 ds_read_b128 a[180:183], v18 offset:30720
 v_mfma_f32_16x16x32_bf16 a[76:79], a[152:155], v[224:227], a[76:79]
 s_waitcnt lgkmcnt(6)
 v_exp_f32 v20, v102
 v_mfma_f32_16x16x32_bf16 a[76:79], a[156:159], v[232:235], a[76:79]
 v_exp_f32 v21, v103
 v_mfma_f32_16x16x32_bf16 a[108:111], a[152:155], v[240:243], a[108:111]
 ds_read_b128 a[184:187], v18 offset:23552
 v_cvt_pk_bf16_f32 v195, v20, v21
 v_mfma_f32_16x16x32_bf16 a[108:111], a[156:159], v[248:251], a[108:111]
 s_waitcnt lgkmcnt(6)
 ds_read_b128 a[188:191], v18 offset:31744
 v_or3_b32 v13, v194, v195, v13
 v_mfma_f32_16x16x32_bf16 a[80:83], a[160:163], v[224:227], a[80:83]
 s_waitcnt lgkmcnt(6)
 s_add_u32 s67, s66, s82
 v_exp_f32 v20, v44
 v_mfma_f32_16x16x32_bf16 a[80:83], a[164:167], v[232:235], a[80:83]
 s_add_u32 s66, s66, 32768
 v_exp_f32 v21, v45
 v_mfma_f32_16x16x32_bf16 a[112:115], a[160:163], v[240:243], a[112:115]
 s_cmp_eq_u32 s66, 98304
 s_cselect_b32 s66, 0, s66
 v_cvt_pk_bf16_f32 v200, v20, v21
 v_mfma_f32_16x16x32_bf16 a[112:115], a[164:167], v[248:251], a[112:115]
 s_waitcnt lgkmcnt(5)
 v_add_u32 v18, s66, v14
 v_mfma_f32_16x16x32_bf16 a[84:87], a[168:171], v[224:227], a[84:87]
 s_waitcnt vmcnt(6) lgkmcnt(0)
 s_barrier
 v_exp_f32 v20, v46
 v_mfma_f32_16x16x32_bf16 a[84:87], a[172:175], v[232:235], a[84:87]
 v_exp_f32 v21, v47
 v_mfma_f32_16x16x32_bf16 a[116:119], a[168:171], v[240:243], a[116:119]
 ds_read_b128 a[128:131], v18 offset:0
 v_cvt_pk_bf16_f32 v201, v20, v21
 v_mfma_f32_16x16x32_bf16 a[116:119], a[172:175], v[248:251], a[116:119]
 ds_read_b128 a[132:135], v18 offset:1024
 v_or3_b32 v13, v200, v201, v13
 v_mfma_f32_16x16x32_bf16 a[88:91], a[176:179], v[224:227], a[88:91]
 v_exp_f32 v20, v108
 v_mfma_f32_16x16x32_bf16 a[88:91], a[180:183], v[232:235], a[88:91]
 v_exp_f32 v21, v109
 v_mfma_f32_16x16x32_bf16 a[120:123], a[176:179], v[240:243], a[120:123]
 ds_read_b128 a[136:139], v18 offset:2048
 v_cvt_pk_bf16_f32 v202, v20, v21
 v_mfma_f32_16x16x32_bf16 a[120:123], a[180:183], v[248:251], a[120:123]
 ds_read_b128 a[140:143], v18 offset:3072
 v_mfma_f32_16x16x32_bf16 a[92:95], a[184:187], v[224:227], a[92:95]
 v_exp_f32 v20, v110
 v_mfma_f32_16x16x32_bf16 a[92:95], a[188:191], v[232:235], a[92:95]
 v_exp_f32 v21, v111
 v_mfma_f32_16x16x32_bf16 a[124:127], a[184:187], v[240:243], a[124:127]
 ds_read_b128 a[144:147], v18 offset:4096
 v_cvt_pk_bf16_f32 v203, v20, v21
 v_mfma_f32_16x16x32_bf16 a[124:127], a[188:191], v[248:251], a[124:127]
 s_waitcnt lgkmcnt(4)
 ds_read_b128 a[148:151], v18 offset:5120
 v_or3_b32 v13, v202, v203, v13
L_s3:
 v_add_f32 v22, s79, v176
 v_fma_f32 v164, v24, s74, v22
 v_fma_f32 v165, v25, s74, v22
 v_fma_f32 v166, v26, s74, v22
 v_fma_f32 v167, v27, s74, v22
 s_nop 1
 v_mfma_f32_16x16x32_bf16 v[164:167], a[128:131], v[48:51], v[164:167]
 s_waitcnt lgkmcnt(4)
 ds_read_b128 a[152:155], v18 offset:6144
 v_exp_f32 v20, v52
 v_mfma_f32_16x16x32_bf16 v[164:167], a[132:135], v[84:87], v[164:167]
 s_waitcnt lgkmcnt(4)
 ds_read_b128 a[156:159], v18 offset:7168
 v_exp_f32 v21, v53
 v_add_f32 v22, s80, v184
 v_fma_f32 v180, v24, s75, v22
 v_fma_f32 v181, v25, s75, v22
 v_fma_f32 v182, v26, s75, v22
 v_fma_f32 v183, v27, s75, v22
 v_mfma_f32_16x16x32_bf16 v[164:167], a[136:139], v[148:151], v[164:167]
 s_waitcnt lgkmcnt(4)
 ds_read_b128 a[160:163], v18 offset:8192
 v_cvt_pk_bf16_f32 v208, v20, v21
 v_mfma_f32_16x16x32_bf16 v[164:167], a[140:143], v[212:215], v[164:167]
 buffer_load_dword v15, v19, s[4:7], 0 offen sc1
 v_mfma_f32_16x16x32_bf16 v[180:183], a[128:131], v[56:59], v[180:183]
 ds_read_b128 a[164:167], v18 offset:9216
 v_exp_f32 v20, v54
 v_mfma_f32_16x16x32_bf16 v[180:183], a[132:135], v[92:95], v[180:183]
 v_exp_f32 v21, v55
 v_add_f32 v22, s78, v176
 v_fma_f32 v228, v24, s73, v22
 v_fma_f32 v229, v25, s73, v22
 v_fma_f32 v230, v26, s73, v22
 v_fma_f32 v231, v27, s73, v22
 v_mfma_f32_16x16x32_bf16 v[180:183], a[136:139], v[156:159], v[180:183]
 ds_read_b128 a[168:171], v18 offset:10240
 v_cvt_pk_bf16_f32 v209, v20, v21
 v_mfma_f32_16x16x32_bf16 v[180:183], a[140:143], v[220:223], v[180:183]
 s_waitcnt lgkmcnt(6)
 ds_read_b128 a[172:175], v18 offset:11264
 v_or3_b32 v13, v208, v209, v13
 v_mfma_f32_16x16x32_bf16 v[228:231], a[144:147], v[48:51], v[228:231]
 s_waitcnt lgkmcnt(6)
 v_exp_f32 v20, v116
 v_mfma_f32_16x16x32_bf16 v[228:231], a[148:151], v[84:87], v[228:231]
 s_waitcnt lgkmcnt(5)
 v_exp_f32 v21, v117
 v_add_f32 v22, s79, v184
 v_fma_f32 v244, v24, s74, v22
 v_fma_f32 v245, v25, s74, v22
 v_fma_f32 v246, v26, s74, v22
 v_fma_f32 v247, v27, s74, v22
 v_mfma_f32_16x16x32_bf16 v[228:231], a[152:155], v[148:151], v[228:231]
 s_waitcnt lgkmcnt(4)
 ds_read_b128 a[176:179], v18 offset:12288
 v_cvt_pk_bf16_f32 v210, v20, v21
 v_mfma_f32_16x16x32_bf16 v[228:231], a[156:159], v[212:215], v[228:231]
 ds_read_b128 a[180:183], v18 offset:13312
 v_add_f32 v22, s77, v176
 v_mfma_f32_16x16x32_bf16 v[244:247], a[144:147], v[56:59], v[244:247]
 v_exp_f32 v20, v118
 v_mfma_f32_16x16x32_bf16 v[244:247], a[148:151], v[92:95], v[244:247]
 v_exp_f32 v21, v119
 v_fma_f32 v172, v24, s72, v22
 v_fma_f32 v173, v25, s72, v22
 v_fma_f32 v174, v26, s72, v22
 v_fma_f32 v175, v27, s72, v22
 v_mfma_f32_16x16x32_bf16 v[244:247], a[152:155], v[156:159], v[244:247]
 ds_read_b128 a[184:187], v18 offset:14336
 v_cvt_pk_bf16_f32 v211, v20, v21
 v_mfma_f32_16x16x32_bf16 v[244:247], a[156:159], v[220:223], v[244:247]
 s_waitcnt lgkmcnt(6)
 ds_read_b128 a[188:191], v18 offset:15360
 v_or3_b32 v13, v210, v211, v13
 v_mfma_f32_16x16x32_bf16 v[172:175], a[160:163], v[48:51], v[172:175]
 s_waitcnt lgkmcnt(6)
 v_exp_f32 v20, v60
 v_mfma_f32_16x16x32_bf16 v[172:175], a[164:167], v[84:87], v[172:175]
 s_waitcnt lgkmcnt(5)
 v_exp_f32 v21, v61
 v_add_f32 v22, s78, v184
 v_fma_f32 v188, v24, s73, v22
 v_fma_f32 v189, v25, s73, v22
 v_fma_f32 v190, v26, s73, v22
 v_fma_f32 v191, v27, s73, v22
 v_mfma_f32_16x16x32_bf16 v[172:175], a[168:171], v[148:151], v[172:175]
 s_waitcnt lgkmcnt(4)
 ds_read_b128 a[128:131], v18 offset:16384
 v_cvt_pk_bf16_f32 v216, v20, v21
 v_mfma_f32_16x16x32_bf16 v[172:175], a[172:175], v[212:215], v[172:175]
 ds_read_b128 a[132:135], v18 offset:24576
 v_add_f32 v22, s76, v176
 v_mfma_f32_16x16x32_bf16 v[188:191], a[160:163], v[56:59], v[188:191]
 v_exp_f32 v20, v62
 v_mfma_f32_16x16x32_bf16 v[188:191], a[164:167], v[92:95], v[188:191]
 v_exp_f32 v21, v63
 v_fma_f32 v236, v24, s71, v22
 v_fma_f32 v237, v25, s71, v22
 v_fma_f32 v238, v26, s71, v22
 v_fma_f32 v239, v27, s71, v22
 v_mfma_f32_16x16x32_bf16 v[188:191], a[168:171], v[156:159], v[188:191]
 ds_read_b128 a[136:139], v18 offset:17408
 v_cvt_pk_bf16_f32 v217, v20, v21
 v_mfma_f32_16x16x32_bf16 v[188:191], a[172:175], v[220:223], v[188:191]
 s_waitcnt lgkmcnt(6)
 ds_read_b128 a[140:143], v18 offset:25600
 v_or3_b32 v13, v216, v217, v13
 v_mfma_f32_16x16x32_bf16 v[236:239], a[176:179], v[48:51], v[236:239]
 s_waitcnt lgkmcnt(6)
 v_exp_f32 v20, v124
 v_mfma_f32_16x16x32_bf16 v[236:239], a[180:183], v[84:87], v[236:239]
 s_waitcnt lgkmcnt(5)
 v_exp_f32 v21, v125
 v_add_f32 v22, s77, v184
 v_fma_f32 v252, v24, s72, v22
 v_fma_f32 v253, v25, s72, v22
 v_fma_f32 v254, v26, s72, v22
 v_fma_f32 v255, v27, s72, v22
 v_mfma_f32_16x16x32_bf16 v[236:239], a[184:187], v[148:151], v[236:239]
 s_waitcnt lgkmcnt(4)
 ds_read_b128 a[144:147], v18 offset:18432
 v_cvt_pk_bf16_f32 v218, v20, v21
 v_mfma_f32_16x16x32_bf16 v[236:239], a[188:191], v[212:215], v[236:239]
 s_waitcnt vmcnt(0)
 v_cmp_eq_u32 vcc, 1, v15
 s_and_b32 s94, vcc_lo, 15
 s_cmp_eq_u32 s94, 15
 s_cbranch_scc0 L_spin_178
L_back_177:
 v_mfma_f32_16x16x32_bf16 v[252:255], a[176:179], v[56:59], v[252:255]
 v_exp_f32 v20, v126
 v_mfma_f32_16x16x32_bf16 v[252:255], a[180:183], v[92:95], v[252:255]
 s_add_u32 s65, s16, 4096
 buffer_load_dwordx4 a[0:3], v14, s[4:7], s16 offen offset:0 sc1
 v_exp_f32 v21, v127
 v_mfma_f32_16x16x32_bf16 v[252:255], a[184:187], v[156:159], v[252:255]
 ds_read_b128 a[148:151], v18 offset:26624
 v_cvt_pk_bf16_f32 v219, v20, v21
 v_mfma_f32_16x16x32_bf16 v[252:255], a[188:191], v[220:223], v[252:255]
 ds_read_b128 a[152:155], v18 offset:19456
 v_or3_b32 v13, v218, v219, v13
 v_mfma_f32_16x16x32_bf16 v[136:139], v[28:31], v[224:227], v[136:139]
 v_and_b32 v13, 0x40004000, v13
 v_cmp_ne_u32 vcc, 0, v13
 v_mfma_f32_16x16x32_bf16 v[136:139], v[28:31], v[232:235], v[136:139]
 ds_read_b128 a[156:159], v18 offset:27648
 v_mfma_f32_16x16x32_bf16 v[144:147], v[28:31], v[240:243], v[144:147]
 buffer_load_dwordx4 a[16:19], v14, s[4:7], s65 offen offset:0 sc1
 v_mfma_f32_16x16x32_bf16 v[144:147], v[28:31], v[248:251], v[144:147]
 s_waitcnt lgkmcnt(7)
 ds_read_b128 a[160:163], v18 offset:20480
 s_cbranch_vccnz L_tr_180
L_back_179:
 v_mfma_f32_16x16x32_bf16 a[64:67], a[128:131], v[192:195], a[64:67]
 s_waitcnt lgkmcnt(7)
 v_exp_f32 v20, v164
 v_mfma_f32_16x16x32_bf16 a[64:67], a[132:135], v[200:203], a[64:67]
 s_sub_u32 s68, s68, 4
 v_exp_f32 v21, v165
 v_mfma_f32_16x16x32_bf16 a[96:99], a[128:131], v[208:211], a[96:99]
 ds_read_b128 a[164:167], v18 offset:28672
 v_cvt_pk_bf16_f32 v224, v20, v21
 v_mfma_f32_16x16x32_bf16 a[96:99], a[132:135], v[216:219], a[96:99]
 s_waitcnt lgkmcnt(7)
 buffer_load_dwordx4 a[4:7], v14, s[4:7], s16 offen offset:1024 sc1
 v_mfma_f32_16x16x32_bf16 a[68:71], a[136:139], v[192:195], a[68:71]
 s_waitcnt lgkmcnt(6)
 v_exp_f32 v20, v166
 v_mfma_f32_16x16x32_bf16 a[68:71], a[140:143], v[200:203], a[68:71]
 v_exp_f32 v21, v167
 v_mfma_f32_16x16x32_bf16 a[100:103], a[136:139], v[208:211], a[100:103]
 ds_read_b128 a[168:171], v18 offset:21504
 v_cvt_pk_bf16_f32 v225, v20, v21
 v_mfma_f32_16x16x32_bf16 a[100:103], a[140:143], v[216:219], a[100:103]
 s_waitcnt lgkmcnt(6)
 ds_read_b128 a[172:175], v18 offset:29696
 v_or_b32 v13, v224, v225
 v_mfma_f32_16x16x32_bf16 a[72:75], a[144:147], v[192:195], a[72:75]
 s_waitcnt lgkmcnt(6)
 buffer_load_dwordx4 a[20:23], v14, s[4:7], s65 offen offset:1024 sc1
 v_exp_f32 v20, v228
 v_mfma_f32_16x16x32_bf16 a[72:75], a[148:151], v[200:203], a[72:75]
 v_exp_f32 v21, v229
 v_mfma_f32_16x16x32_bf16 a[104:107], a[144:147], v[208:211], a[104:107]
 ds_read_b128 a[176:179], v18 offset:22528
 v_cvt_pk_bf16_f32 v226, v20, v21
 v_mfma_f32_16x16x32_bf16 a[104:107], a[148:151], v[216:219], a[104:107]
 s_waitcnt lgkmcnt(6)
 ds_read_b128 a[180:183], v18 offset:30720
 v_mfma_f32_16x16x32_bf16 a[76:79], a[152:155], v[192:195], a[76:79]
 s_waitcnt lgkmcnt(6)
 v_exp_f32 v20, v230
 v_mfma_f32_16x16x32_bf16 a[76:79], a[156:159], v[200:203], a[76:79]
 buffer_load_dwordx4 a[8:11], v14, s[4:7], s16 offen offset:2048 sc1
 v_exp_f32 v21, v231
 v_mfma_f32_16x16x32_bf16 a[108:111], a[152:155], v[208:211], a[108:111]
 ds_read_b128 a[184:187], v18 offset:23552
 v_cvt_pk_bf16_f32 v227, v20, v21
 v_mfma_f32_16x16x32_bf16 a[108:111], a[156:159], v[216:219], a[108:111]
 s_waitcnt lgkmcnt(6)
 ds_read_b128 a[188:191], v18 offset:31744
 v_or3_b32 v13, v226, v227, v13
 v_mfma_f32_16x16x32_bf16 a[80:83], a[160:163], v[192:195], a[80:83]
 s_waitcnt lgkmcnt(6)
 s_add_u32 s67, s66, s82
 v_exp_f32 v20, v172
 v_mfma_f32_16x16x32_bf16 a[80:83], a[164:167], v[200:203], a[80:83]
 s_add_u32 s66, s66, 32768
 v_exp_f32 v21, v173
 v_mfma_f32_16x16x32_bf16 a[112:115], a[160:163], v[208:211], a[112:115]
 s_cmp_eq_u32 s66, 98304
 s_cselect_b32 s66, 0, s66
 buffer_load_dwordx4 a[24:27], v14, s[4:7], s65 offen offset:2048 sc1
 v_cvt_pk_bf16_f32 v232, v20, v21
 v_mfma_f32_16x16x32_bf16 a[112:115], a[164:167], v[216:219], a[112:115]
 s_waitcnt lgkmcnt(5)
 v_add_u32 v18, s66, v14
 v_mfma_f32_16x16x32_bf16 a[84:87], a[168:171], v[192:195], a[84:87]
 s_waitcnt lgkmcnt(0)
 s_barrier
 v_exp_f32 v20, v174
 v_mfma_f32_16x16x32_bf16 a[84:87], a[172:175], v[200:203], a[84:87]
 v_exp_f32 v21, v175
 v_mfma_f32_16x16x32_bf16 a[116:119], a[168:171], v[208:211], a[116:119]
 ds_read_b128 a[128:131], v18 offset:16384
 v_cvt_pk_bf16_f32 v233, v20, v21
 v_mfma_f32_16x16x32_bf16 a[116:119], a[172:175], v[216:219], a[116:119]
 ds_read_b128 a[132:135], v18 offset:24576
 buffer_load_dwordx4 a[12:15], v14, s[4:7], s16 offen offset:3072 sc1
 v_or3_b32 v13, v232, v233, v13
 v_mfma_f32_16x16x32_bf16 a[88:91], a[176:179], v[192:195], a[88:91]
 v_exp_f32 v20, v236
 v_mfma_f32_16x16x32_bf16 a[88:91], a[180:183], v[200:203], a[88:91]
 v_exp_f32 v21, v237
 v_mfma_f32_16x16x32_bf16 a[120:123], a[176:179], v[208:211], a[120:123]
 ds_read_b128 a[136:139], v18 offset:17408
 v_cvt_pk_bf16_f32 v234, v20, v21
 v_mfma_f32_16x16x32_bf16 a[120:123], a[180:183], v[216:219], a[120:123]
 ds_read_b128 a[140:143], v18 offset:25600
 v_mfma_f32_16x16x32_bf16 a[92:95], a[184:187], v[192:195], a[92:95]
 buffer_load_dwordx4 a[28:31], v14, s[4:7], s65 offen offset:3072 sc1
 v_exp_f32 v20, v238
 v_mfma_f32_16x16x32_bf16 a[92:95], a[188:191], v[200:203], a[92:95]
 v_exp_f32 v21, v239
 v_mfma_f32_16x16x32_bf16 a[124:127], a[184:187], v[208:211], a[124:127]
 ds_read_b128 a[144:147], v18 offset:18432
 v_cvt_pk_bf16_f32 v235, v20, v21
 v_mfma_f32_16x16x32_bf16 a[124:127], a[188:191], v[216:219], a[124:127]
 ds_read_b128 a[148:151], v18 offset:26624
 v_or3_b32 v13, v234, v235, v13
 v_mfma_f32_16x16x32_bf16 v[136:139], v[28:31], v[192:195], v[136:139]
 v_exp_f32 v20, v180
 v_exp_f32 v21, v181
 s_nop 0
 v_cvt_pk_bf16_f32 v240, v20, v21
 s_add_u32 s65, s17, 4096
 buffer_load_dwordx4 a[32:35], v14, s[4:7], s17 offen offset:0 sc1
 v_exp_f32 v20, v182
 v_exp_f32 v21, v183
 s_nop 0
 v_cvt_pk_bf16_f32 v241, v20, v21
 v_or3_b32 v13, v240, v241, v13
 v_mfma_f32_16x16x32_bf16 v[136:139], v[28:31], v[200:203], v[136:139]
 v_exp_f32 v20, v244
 v_exp_f32 v21, v245
 s_nop 0
 v_cvt_pk_bf16_f32 v242, v20, v21
 v_exp_f32 v20, v246
 v_exp_f32 v21, v247
 s_nop 0
 v_cvt_pk_bf16_f32 v243, v20, v21
 v_or3_b32 v13, v242, v243, v13
 v_mfma_f32_16x16x32_bf16 v[144:147], v[28:31], v[208:211], v[144:147]
 v_exp_f32 v20, v188
 v_exp_f32 v21, v189
 s_nop 0
 v_cvt_pk_bf16_f32 v248, v20, v21
 buffer_load_dwordx4 a[48:51], v14, s[4:7], s65 offen offset:0 sc1
 v_exp_f32 v20, v190
 v_exp_f32 v21, v191
 s_nop 0
 v_cvt_pk_bf16_f32 v249, v20, v21
 v_or3_b32 v13, v248, v249, v13
 v_mfma_f32_16x16x32_bf16 v[144:147], v[28:31], v[216:219], v[144:147]
 v_exp_f32 v20, v252
 v_exp_f32 v21, v253
 s_nop 0
 v_cvt_pk_bf16_f32 v250, v20, v21
 v_exp_f32 v20, v254
 v_exp_f32 v21, v255
 s_nop 0
 v_cvt_pk_bf16_f32 v251, v20, v21
 v_or3_b32 v13, v250, v251, v13
 v_and_b32 v13, 0x40004000, v13
 v_cmp_ne_u32 vcc, 0, v13
 s_cbranch_vccnz L_tr_182
L_back_181:
 buffer_load_dwordx4 a[36:39], v14, s[4:7], s17 offen offset:1024 sc1
 v_mfma_f32_16x16x32_bf16 v[136:139], v[28:31], v[224:227], v[136:139]
 ds_read_b128 a[152:155], v18 offset:19456
 s_sub_u32 s94, 15, s63
 s_lshl_b32 s95, s3, 4
 s_add_u32 s94, s94, s95
 s_lshl_b32 s94, s94, 15
 s_add_u32 s94, s94, s81
 s_add_u32 s83, s94, 33554432
 s_add_u32 s84, s94, 33558528
 v_mfma_f32_16x16x32_bf16 v[136:139], v[28:31], v[232:235], v[136:139]
 buffer_load_dwordx4 a[52:55], v14, s[4:7], s65 offen offset:1024 sc1
 v_mfma_f32_16x16x32_bf16 v[144:147], v[28:31], v[240:243], v[144:147]
 ds_read_b128 a[156:159], v18 offset:27648
 v_mfma_f32_16x16x32_bf16 v[144:147], v[28:31], v[248:251], v[144:147]
 s_waitcnt lgkmcnt(7)
 v_mfma_f32_16x16x32_bf16 a[64:67], a[128:131], v[224:227], a[64:67]
 s_waitcnt lgkmcnt(6)
 ds_read_b128 a[160:163], v18 offset:20480
 v_mfma_f32_16x16x32_bf16 a[64:67], a[132:135], v[232:235], a[64:67]
 v_mfma_f32_16x16x32_bf16 a[96:99], a[128:131], v[240:243], a[96:99]
 ds_read_b128 a[164:167], v18 offset:28672
 buffer_load_dwordx4 a[40:43], v14, s[4:7], s17 offen offset:2048 sc1
 v_mfma_f32_16x16x32_bf16 a[96:99], a[132:135], v[248:251], a[96:99]
 s_waitcnt lgkmcnt(7)
 v_mfma_f32_16x16x32_bf16 a[68:71], a[136:139], v[224:227], a[68:71]
 s_waitcnt lgkmcnt(6)
 ds_read_b128 a[168:171], v18 offset:21504
 v_rcp_f32 v136, v136
 v_mfma_f32_16x16x32_bf16 a[68:71], a[140:143], v[232:235], a[68:71]
 v_rcp_f32 v144, v144
 v_mfma_f32_16x16x32_bf16 a[100:103], a[136:139], v[240:243], a[100:103]
 ds_read_b128 a[172:175], v18 offset:29696
 v_mfma_f32_16x16x32_bf16 a[100:103], a[140:143], v[248:251], a[100:103]
 s_waitcnt lgkmcnt(7)
 buffer_load_dwordx4 a[56:59], v14, s[4:7], s65 offen offset:2048 sc1
 v_mfma_f32_16x16x32_bf16 a[72:75], a[144:147], v[224:227], a[72:75]
 s_waitcnt lgkmcnt(6)
 ds_read_b128 a[176:179], v18 offset:22528
 v_mfma_f32_16x16x32_bf16 a[72:75], a[148:151], v[232:235], a[72:75]
 v_mfma_f32_16x16x32_bf16 a[104:107], a[144:147], v[240:243], a[104:107]
 ds_read_b128 a[180:183], v18 offset:30720
 v_mfma_f32_16x16x32_bf16 a[104:107], a[148:151], v[248:251], a[104:107]
 s_waitcnt lgkmcnt(7)
 v_mfma_f32_16x16x32_bf16 a[76:79], a[152:155], v[224:227], a[76:79]
 s_waitcnt lgkmcnt(6)
 ds_read_b128 a[184:187], v18 offset:23552
 buffer_load_dwordx4 a[44:47], v14, s[4:7], s17 offen offset:3072 sc1
 v_mfma_f32_16x16x32_bf16 a[76:79], a[156:159], v[232:235], a[76:79]
 v_accvgpr_read_b32 v64, a64
 v_accvgpr_read_b32 v65, a65
 v_mfma_f32_16x16x32_bf16 a[108:111], a[152:155], v[240:243], a[108:111]
 ds_read_b128 a[188:191], v18 offset:31744
 v_accvgpr_read_b32 v66, a66
 v_accvgpr_read_b32 v67, a67
 v_mfma_f32_16x16x32_bf16 a[108:111], a[156:159], v[248:251], a[108:111]
 s_waitcnt lgkmcnt(7)
 v_accvgpr_read_b32 v72, a68
 v_accvgpr_read_b32 v73, a69
 v_mfma_f32_16x16x32_bf16 a[80:83], a[160:163], v[224:227], a[80:83]
 s_waitcnt lgkmcnt(6)
 v_accvgpr_read_b32 v74, a70
 v_accvgpr_read_b32 v75, a71
 v_mfma_f32_16x16x32_bf16 a[80:83], a[164:167], v[232:235], a[80:83]
 v_mul_f32 v64, v64, v136
 v_mul_f32 v65, v65, v136
 v_mul_f32 v66, v66, v136
 v_mfma_f32_16x16x32_bf16 a[112:115], a[160:163], v[240:243], a[112:115]
 v_mul_f32 v67, v67, v136
 v_mul_f32 v72, v72, v136
 v_mfma_f32_16x16x32_bf16 a[112:115], a[164:167], v[248:251], a[112:115]
 s_waitcnt lgkmcnt(5)
 v_mul_f32 v73, v73, v136
 v_mul_f32 v74, v74, v136
 v_mfma_f32_16x16x32_bf16 a[84:87], a[168:171], v[224:227], a[84:87]
 s_waitcnt lgkmcnt(4)
 v_mul_f32 v75, v75, v136
 v_cvt_pk_bf16_f32 v48, v64, v65
 v_cvt_pk_bf16_f32 v49, v66, v67
 v_mfma_f32_16x16x32_bf16 a[84:87], a[172:175], v[232:235], a[84:87]
 s_waitcnt lgkmcnt(0)
 s_barrier
 v_cvt_pk_bf16_f32 v50, v72, v73
 v_mfma_f32_16x16x32_bf16 a[116:119], a[168:171], v[240:243], a[116:119]
 ds_read_b64_tr_b16 a[128:129], v113 offset:0
 s_lshr_b32 m0, s82, 2
 v_cvt_pk_bf16_f32 v51, v74, v75
 v_mfma_f32_16x16x32_bf16 a[116:119], a[172:175], v[248:251], a[116:119]
 ds_read_b64_tr_b16 a[130:131], v113 offset:4608
 buffer_load_dwordx4 v16, s[28:31], s87 offen lds
 s_add_u32 m0, m0, 4096
 v_mfma_f32_16x16x32_bf16 a[88:91], a[176:179], v[224:227], a[88:91]
 ds_read_b64_tr_b16 a[132:133], v113 offset:32
 v_accvgpr_read_b32 v80, a96
 v_mfma_f32_16x16x32_bf16 a[88:91], a[180:183], v[232:235], a[88:91]
 ds_read_b64_tr_b16 a[134:135], v113 offset:4640
 v_accvgpr_read_b32 v81, a97
 v_mfma_f32_16x16x32_bf16 a[120:123], a[176:179], v[240:243], a[120:123]
 ds_read_b64_tr_b16 a[136:137], v113 offset:64
 v_accvgpr_read_b32 v82, a98
 v_accvgpr_read_b32 v83, a99
 v_mfma_f32_16x16x32_bf16 a[120:123], a[180:183], v[248:251], a[120:123]
 ds_read_b64_tr_b16 a[138:139], v113 offset:4672
 v_accvgpr_read_b32 v88, a100
 v_mfma_f32_16x16x32_bf16 a[92:95], a[184:187], v[224:227], a[92:95]
 ds_read_b64_tr_b16 a[140:141], v113 offset:96
 buffer_load_dwordx4 v17, s[28:31], s87 offen lds
 s_mov_b32 m0, 8192
 v_mfma_f32_16x16x32_bf16 a[92:95], a[188:191], v[232:235], a[92:95]
 ds_read_b64_tr_b16 a[142:143], v113 offset:4704
 v_accvgpr_read_b32 v89, a101
 v_accvgpr_read_b32 v90, a102
 v_mfma_f32_16x16x32_bf16 a[124:127], a[184:187], v[240:243], a[124:127]
 ds_read_b64_tr_b16 a[144:145], v113 offset:128
 v_accvgpr_read_b32 v91, a103
 v_mfma_f32_16x16x32_bf16 a[124:127], a[188:191], v[248:251], a[124:127]
 s_waitcnt lgkmcnt(7)
 ds_read_b64_tr_b16 a[146:147], v113 offset:4736
 v_mul_f32 v80, v80, v144
 v_mfma_f32_16x16x32_bf16 v[36:39], a[128:131], v[32:35], 0
 ds_read_b64_tr_b16 a[148:149], v113 offset:160
 v_mul_f32 v81, v81, v144
 v_mul_f32 v82, v82, v144
 v_mfma_f32_16x16x32_bf16 v[100:103], a[128:131], v[40:43], 0
 s_waitcnt lgkmcnt(7)
 ds_read_b64_tr_b16 a[150:151], v113 offset:4768
 buffer_load_dwordx4 v112, s[28:31], s87 offen lds
 v_mfma_f32_16x16x32_bf16 v[164:167], a[132:135], v[32:35], 0
 ds_read_b64_tr_b16 a[152:153], v113 offset:192
 v_mul_f32 v83, v83, v144
 v_mfma_f32_16x16x32_bf16 v[228:231], a[132:135], v[40:43], 0
 s_waitcnt lgkmcnt(7)
 ds_read_b64_tr_b16 a[154:155], v113 offset:4800
 v_mul_f32 v88, v88, v144
 v_mul_f32 v89, v89, v144
 v_mfma_f32_16x16x32_bf16 v[44:47], a[136:139], v[32:35], 0
 ds_read_b64_tr_b16 a[156:157], v113 offset:224
 buffer_store_dwordx4 v[48:51], v14, s[4:7], s83 offen offset:0 sc1
 v_mfma_f32_16x16x32_bf16 v[108:111], a[136:139], v[40:43], 0
 s_waitcnt lgkmcnt(7)
 ds_read_b64_tr_b16 a[158:159], v113 offset:4832
 v_mul_f32 v90, v90, v144
 v_mfma_f32_16x16x32_bf16 v[172:175], a[140:143], v[32:35], 0
 ds_read_b64_tr_b16 a[160:161], v113 offset:256
 s_add_u32 m0, s85, 9216
 v_mul_f32 v91, v91, v144
 v_cvt_pk_bf16_f32 v56, v80, v81
 v_mfma_f32_16x16x32_bf16 v[236:239], a[140:143], v[40:43], 0
 s_waitcnt lgkmcnt(7)
 ds_read_b64_tr_b16 a[162:163], v113 offset:4864
 buffer_load_dwordx4 v96, s[28:31], s14 offen offset:0 lds
 v_mfma_f32_16x16x32_bf16 v[52:55], a[144:147], v[32:35], 0
 ds_read_b64_tr_b16 a[164:165], v113 offset:9216
 v_cvt_pk_bf16_f32 v57, v82, v83
 v_mfma_f32_16x16x32_bf16 v[116:119], a[144:147], v[40:43], 0
 s_waitcnt lgkmcnt(7)
 ds_read_b64_tr_b16 a[166:167], v113 offset:13824
 v_cvt_pk_bf16_f32 v58, v88, v89
 v_cvt_pk_bf16_f32 v59, v90, v91
 v_mfma_f32_16x16x32_bf16 v[180:183], a[148:151], v[32:35], 0
 ds_read_b64_tr_b16 a[168:169], v113 offset:9248
 v_accvgpr_read_b32 v64, a72
 v_mfma_f32_16x16x32_bf16 v[244:247], a[148:151], v[40:43], 0
 s_waitcnt lgkmcnt(7)
 ds_read_b64_tr_b16 a[170:171], v113 offset:13856
 v_accvgpr_read_b32 v65, a73
 v_mfma_f32_16x16x32_bf16 v[60:63], a[152:155], v[32:35], 0
 ds_read_b64_tr_b16 a[172:173], v113 offset:9280
 buffer_load_dwordx4 v97, s[28:31], s14 offen offset:1024 lds
 v_mfma_f32_16x16x32_bf16 v[124:127], a[152:155], v[40:43], 0
 s_waitcnt lgkmcnt(7)
 ds_read_b64_tr_b16 a[174:175], v113 offset:13888
 v_accvgpr_read_b32 v66, a74
 v_mfma_f32_16x16x32_bf16 v[188:191], a[156:159], v[32:35], 0
 ds_read_b64_tr_b16 a[176:177], v113 offset:9312
 v_accvgpr_read_b32 v67, a75
 v_mfma_f32_16x16x32_bf16 v[252:255], a[156:159], v[40:43], 0
 s_waitcnt lgkmcnt(7)
 ds_read_b64_tr_b16 a[178:179], v113 offset:13920
 v_accvgpr_read_b32 v72, a76
 v_accvgpr_read_b32 v73, a77
 v_mfma_f32_16x16x32_bf16 v[192:195], a[160:163], v[32:35], 0
 ds_read_b64_tr_b16 a[180:181], v113 offset:9344
 v_accvgpr_read_b32 v74, a78
 v_mfma_f32_16x16x32_bf16 v[200:203], a[160:163], v[40:43], 0
 s_waitcnt lgkmcnt(7)
 ds_read_b64_tr_b16 a[182:183], v113 offset:13952
 buffer_load_dwordx4 v98, s[28:31], s14 offen offset:2048 lds
 v_mfma_f32_16x16x32_bf16 v[36:39], a[164:167], v[68:71], v[36:39]
 ds_read_b64_tr_b16 a[184:185], v113 offset:9376
 v_accvgpr_read_b32 v75, a79
 v_mul_f32 v64, v64, v136
 v_mfma_f32_16x16x32_bf16 v[100:103], a[164:167], v[76:79], v[100:103]
 s_waitcnt lgkmcnt(7)
 ds_read_b64_tr_b16 a[186:187], v113 offset:13984
 v_mul_f32 v65, v65, v136
 v_mfma_f32_16x16x32_bf16 v[164:167], a[168:171], v[68:71], v[164:167]
 ds_read_b64_tr_b16 a[188:189], v113 offset:9408
 v_mul_f32 v66, v66, v136
 v_mfma_f32_16x16x32_bf16 v[228:231], a[168:171], v[76:79], v[228:231]
 s_waitcnt lgkmcnt(7)
 ds_read_b64_tr_b16 a[190:191], v113 offset:14016
 v_mul_f32 v67, v67, v136
 v_mul_f32 v72, v72, v136
 v_mfma_f32_16x16x32_bf16 v[44:47], a[172:175], v[68:71], v[44:47]
 ds_read_b64_tr_b16 a[128:129], v113 offset:9440
 buffer_load_dwordx4 v99, s[28:31], s14 offen offset:3072 lds
 s_add_u32 m0, s85, 13312
 v_mfma_f32_16x16x32_bf16 v[108:111], a[172:175], v[76:79], v[108:111]
 s_waitcnt lgkmcnt(7)
 ds_read_b64_tr_b16 a[130:131], v113 offset:14048
 v_mul_f32 v73, v73, v136
 v_mfma_f32_16x16x32_bf16 v[172:175], a[176:179], v[68:71], v[172:175]
 ds_read_b64_tr_b16 a[132:133], v113 offset:9472
 buffer_store_dwordx4 v[56:59], v14, s[4:7], s84 offen offset:0 sc1
 v_mfma_f32_16x16x32_bf16 v[236:239], a[176:179], v[76:79], v[236:239]
 s_waitcnt lgkmcnt(7)
 ds_read_b64_tr_b16 a[134:135], v113 offset:14080
 v_mul_f32 v74, v74, v136
 v_mfma_f32_16x16x32_bf16 v[52:55], a[180:183], v[68:71], v[52:55]
 ds_read_b64_tr_b16 a[136:137], v113 offset:18432
 v_mul_f32 v75, v75, v136
 v_mfma_f32_16x16x32_bf16 v[116:119], a[180:183], v[76:79], v[116:119]
 s_waitcnt lgkmcnt(7)
 ds_read_b64_tr_b16 a[138:139], v113 offset:23040
 buffer_load_dwordx4 v104, s[28:31], s14 offen offset:0 lds
 v_mfma_f32_16x16x32_bf16 v[180:183], a[184:187], v[68:71], v[180:183]
 ds_read_b64_tr_b16 a[140:141], v113 offset:18464
 v_cvt_pk_bf16_f32 v84, v64, v65
 v_mfma_f32_16x16x32_bf16 v[244:247], a[184:187], v[76:79], v[244:247]
 s_waitcnt lgkmcnt(7)
 ds_read_b64_tr_b16 a[142:143], v113 offset:23072
 v_cvt_pk_bf16_f32 v85, v66, v67
 v_mfma_f32_16x16x32_bf16 v[60:63], a[188:191], v[68:71], v[60:63]
 ds_read_b64_tr_b16 a[144:145], v113 offset:18496
 v_cvt_pk_bf16_f32 v86, v72, v73
 v_cvt_pk_bf16_f32 v87, v74, v75
 v_mfma_f32_16x16x32_bf16 v[124:127], a[188:191], v[76:79], v[124:127]
 s_waitcnt lgkmcnt(7)
 ds_read_b64_tr_b16 a[146:147], v113 offset:23104
 v_accvgpr_read_b32 v80, a104
 v_mfma_f32_16x16x32_bf16 v[188:191], a[128:131], v[68:71], v[188:191]
 ds_read_b64_tr_b16 a[148:149], v113 offset:18528
 buffer_load_dwordx4 v105, s[28:31], s14 offen offset:1024 lds
 v_mfma_f32_16x16x32_bf16 v[252:255], a[128:131], v[76:79], v[252:255]
 s_waitcnt lgkmcnt(7)
 ds_read_b64_tr_b16 a[150:151], v113 offset:23136
 v_accvgpr_read_b32 v81, a105
 v_accvgpr_read_b32 v82, a106
 v_mfma_f32_16x16x32_bf16 v[192:195], a[132:135], v[68:71], v[192:195]
 ds_read_b64_tr_b16 a[152:153], v113 offset:18560
 v_accvgpr_read_b32 v83, a107
 v_mfma_f32_16x16x32_bf16 v[200:203], a[132:135], v[76:79], v[200:203]
 s_waitcnt lgkmcnt(7)
 ds_read_b64_tr_b16 a[154:155], v113 offset:23168
 v_accvgpr_read_b32 v88, a108
 v_mfma_f32_16x16x32_bf16 v[36:39], a[136:139], v[132:135], v[36:39]
 ds_read_b64_tr_b16 a[156:157], v113 offset:18592
 v_accvgpr_read_b32 v89, a109
 v_accvgpr_read_b32 v90, a110
 v_mfma_f32_16x16x32_bf16 v[100:103], a[136:139], v[140:143], v[100:103]
 s_waitcnt lgkmcnt(7)
 ds_read_b64_tr_b16 a[158:159], v113 offset:23200
 buffer_load_dwordx4 v106, s[28:31], s14 offen offset:2048 lds
 v_mfma_f32_16x16x32_bf16 v[164:167], a[140:143], v[132:135], v[164:167]
 ds_read_b64_tr_b16 a[160:161], v113 offset:18624
 v_accvgpr_read_b32 v91, a111
 v_mfma_f32_16x16x32_bf16 v[228:231], a[140:143], v[140:143], v[228:231]
 s_waitcnt lgkmcnt(7)
 ds_read_b64_tr_b16 a[162:163], v113 offset:23232
 v_mul_f32 v80, v80, v144
 v_mul_f32 v81, v81, v144
 v_mfma_f32_16x16x32_bf16 v[44:47], a[144:147], v[132:135], v[44:47]
 ds_read_b64_tr_b16 a[164:165], v113 offset:18656
 v_mul_f32 v82, v82, v144
 v_mfma_f32_16x16x32_bf16 v[108:111], a[144:147], v[140:143], v[108:111]
 s_waitcnt lgkmcnt(7)
 ds_read_b64_tr_b16 a[166:167], v113 offset:23264
 v_mul_f32 v83, v83, v144
 v_mfma_f32_16x16x32_bf16 v[172:175], a[148:151], v[132:135], v[172:175]
 ds_read_b64_tr_b16 a[168:169], v113 offset:18688
 buffer_load_dwordx4 v107, s[28:31], s14 offen offset:3072 lds
 s_add_u32 m0, s85, 17408
 v_mfma_f32_16x16x32_bf16 v[236:239], a[148:151], v[140:143], v[236:239]
 s_waitcnt lgkmcnt(7)
 ds_read_b64_tr_b16 a[170:171], v113 offset:23296
 v_mul_f32 v88, v88, v144
 v_mfma_f32_16x16x32_bf16 v[52:55], a[152:155], v[132:135], v[52:55]
 ds_read_b64_tr_b16 a[172:173], v113 offset:27648
 buffer_store_dwordx4 v[84:87], v14, s[4:7], s83 offen offset:1024 sc1
 v_mfma_f32_16x16x32_bf16 v[116:119], a[152:155], v[140:143], v[116:119]
 s_waitcnt lgkmcnt(7)
 ds_read_b64_tr_b16 a[174:175], v113 offset:32256
 v_mul_f32 v89, v89, v144
 v_mul_f32 v90, v90, v144
 v_mfma_f32_16x16x32_bf16 v[180:183], a[156:159], v[132:135], v[180:183]
 ds_read_b64_tr_b16 a[176:177], v113 offset:27680
 v_mul_f32 v91, v91, v144
 v_mfma_f32_16x16x32_bf16 v[244:247], a[156:159], v[140:143], v[244:247]
 s_waitcnt lgkmcnt(7)
 ds_read_b64_tr_b16 a[178:179], v113 offset:32288
 buffer_load_dwordx4 v112, s[28:31], s14 offen offset:0 lds
 v_mfma_f32_16x16x32_bf16 v[60:63], a[160:163], v[132:135], v[60:63]
 ds_read_b64_tr_b16 a[180:181], v113 offset:27712
 v_cvt_pk_bf16_f32 v92, v80, v81
 v_cvt_pk_bf16_f32 v93, v82, v83
 v_mfma_f32_16x16x32_bf16 v[124:127], a[160:163], v[140:143], v[124:127]
 s_waitcnt lgkmcnt(7)
 ds_read_b64_tr_b16 a[182:183], v113 offset:32320
 v_cvt_pk_bf16_f32 v94, v88, v89
 v_mfma_f32_16x16x32_bf16 v[188:191], a[164:167], v[132:135], v[188:191]
 ds_read_b64_tr_b16 a[184:185], v113 offset:27744
 v_cvt_pk_bf16_f32 v95, v90, v91
 v_mfma_f32_16x16x32_bf16 v[252:255], a[164:167], v[140:143], v[252:255]
 s_waitcnt lgkmcnt(7)
 ds_read_b64_tr_b16 a[186:187], v113 offset:32352
 v_accvgpr_read_b32 v64, a80
 v_accvgpr_read_b32 v65, a81
 v_mfma_f32_16x16x32_bf16 v[192:195], a[168:171], v[132:135], v[192:195]
 ds_read_b64_tr_b16 a[188:189], v113 offset:27776
 buffer_load_dwordx4 a[60:63], v14, s[4:7], s65 offen offset:3072 sc1
 v_mfma_f32_16x16x32_bf16 v[200:203], a[168:171], v[140:143], v[200:203]
 s_waitcnt lgkmcnt(7)
 ds_read_b64_tr_b16 a[190:191], v113 offset:32384
 v_accvgpr_read_b32 v66, a82
 v_mfma_f32_16x16x32_bf16 v[36:39], a[172:175], v[196:199], v[36:39]
 ds_read_b64_tr_b16 a[128:129], v113 offset:27808
 v_accvgpr_read_b32 v67, a83
 v_accvgpr_read_b32 v72, a84
 v_mfma_f32_16x16x32_bf16 v[100:103], a[172:175], v[204:207], v[100:103]
 s_waitcnt lgkmcnt(7)
 ds_read_b64_tr_b16 a[130:131], v113 offset:32416
 v_accvgpr_read_b32 v73, a85
 v_mfma_f32_16x16x32_bf16 v[164:167], a[176:179], v[196:199], v[164:167]
 ds_read_b64_tr_b16 a[132:133], v113 offset:27840
 v_accvgpr_read_b32 v74, a86
 v_mfma_f32_16x16x32_bf16 v[228:231], a[176:179], v[204:207], v[228:231]
 s_waitcnt lgkmcnt(7)
 ds_read_b64_tr_b16 a[134:135], v113 offset:32448
 v_accvgpr_read_b32 v75, a87
 v_mul_f32 v64, v64, v136
 v_mfma_f32_16x16x32_bf16 v[44:47], a[180:183], v[196:199], v[44:47]
 ds_read_b64_tr_b16 a[136:137], v113 offset:27872
 s_add_u32 s65, s18, 4096
 buffer_load_dwordx4 a[192:195], v14, s[4:7], s18 offen offset:0 sc1
 v_mfma_f32_16x16x32_bf16 v[108:111], a[180:183], v[204:207], v[108:111]
 s_waitcnt lgkmcnt(7)
 ds_read_b64_tr_b16 a[138:139], v113 offset:32480
 v_mul_f32 v65, v65, v136
 v_mfma_f32_16x16x32_bf16 v[172:175], a[184:187], v[196:199], v[172:175]
 ds_read_b64_tr_b16 a[140:141], v113 offset:27904
 v_mul_f32 v66, v66, v136
 v_mul_f32 v67, v67, v136
 v_mfma_f32_16x16x32_bf16 v[236:239], a[184:187], v[204:207], v[236:239]
 s_waitcnt lgkmcnt(7)
 ds_read_b64_tr_b16 a[142:143], v113 offset:32512
 buffer_store_dwordx4 v[92:95], v14, s[4:7], s84 offen offset:1024 sc1
 v_mfma_f32_16x16x32_bf16 v[52:55], a[188:191], v[196:199], v[52:55]
 ds_read_b64_tr_b16 a[144:145], v113 offset:36864
 v_mul_f32 v72, v72, v136
 v_mfma_f32_16x16x32_bf16 v[116:119], a[188:191], v[204:207], v[116:119]
 s_waitcnt lgkmcnt(7)
 ds_read_b64_tr_b16 a[146:147], v113 offset:41472
 v_mul_f32 v73, v73, v136
 v_mul_f32 v74, v74, v136
 v_mfma_f32_16x16x32_bf16 v[180:183], a[128:131], v[196:199], v[180:183]
 ds_read_b64_tr_b16 a[148:149], v113 offset:36896
 buffer_load_dwordx4 a[208:211], v14, s[4:7], s65 offen offset:0 sc1
 v_mfma_f32_16x16x32_bf16 v[244:247], a[128:131], v[204:207], v[244:247]
 s_waitcnt lgkmcnt(7)
 ds_read_b64_tr_b16 a[150:151], v113 offset:41504
 v_mul_f32 v75, v75, v136
 v_mfma_f32_16x16x32_bf16 v[60:63], a[132:135], v[196:199], v[60:63]
 ds_read_b64_tr_b16 a[152:153], v113 offset:36928
 v_cvt_pk_bf16_f32 v148, v64, v65
 v_cvt_pk_bf16_f32 v149, v66, v67
 v_mfma_f32_16x16x32_bf16 v[124:127], a[132:135], v[204:207], v[124:127]
 s_waitcnt lgkmcnt(7)
 ds_read_b64_tr_b16 a[154:155], v113 offset:41536
 v_cvt_pk_bf16_f32 v150, v72, v73
 v_mfma_f32_16x16x32_bf16 v[188:191], a[136:139], v[196:199], v[188:191]
 ds_read_b64_tr_b16 a[156:157], v113 offset:36960
 v_cvt_pk_bf16_f32 v151, v74, v75
 v_mfma_f32_16x16x32_bf16 v[252:255], a[136:139], v[204:207], v[252:255]
 s_waitcnt lgkmcnt(7)
 ds_read_b64_tr_b16 a[158:159], v113 offset:41568
 v_accvgpr_read_b32 v80, a112
 v_accvgpr_read_b32 v81, a113
 v_mfma_f32_16x16x32_bf16 v[192:195], a[140:143], v[196:199], v[192:195]
 ds_read_b64_tr_b16 a[160:161], v113 offset:36992
 buffer_load_dwordx4 a[196:199], v14, s[4:7], s18 offen offset:1024 sc1
 v_mfma_f32_16x16x32_bf16 v[200:203], a[140:143], v[204:207], v[200:203]
 s_waitcnt vmcnt(34) lgkmcnt(7)
 ds_read_b64_tr_b16 a[162:163], v113 offset:41600
 v_accvgpr_read_b32 v82, a114
 v_mfma_f32_16x16x32_bf16 v[36:39], a[144:147], a[0:3], v[36:39]
 s_waitcnt vmcnt(33)
 ds_read_b64_tr_b16 a[164:165], v113 offset:37024
 v_accvgpr_read_b32 v83, a115
 v_accvgpr_read_b32 v88, a116
 v_mfma_f32_16x16x32_bf16 v[100:103], a[144:147], a[16:19], v[100:103]
 s_waitcnt lgkmcnt(7)
 ds_read_b64_tr_b16 a[166:167], v113 offset:41632
 v_accvgpr_read_b32 v89, a117
 v_mfma_f32_16x16x32_bf16 v[164:167], a[148:151], a[0:3], v[164:167]
 ds_read_b64_tr_b16 a[168:169], v113 offset:37056
 v_accvgpr_read_b32 v90, a118
 v_mfma_f32_16x16x32_bf16 v[228:231], a[148:151], a[16:19], v[228:231]
 s_waitcnt lgkmcnt(7)
 ds_read_b64_tr_b16 a[170:171], v113 offset:41664
 v_accvgpr_read_b32 v91, a119
 v_mul_f32 v80, v80, v144
 v_mfma_f32_16x16x32_bf16 v[44:47], a[152:155], a[0:3], v[44:47]
 ds_read_b64_tr_b16 a[172:173], v113 offset:37088
 buffer_load_dwordx4 a[212:215], v14, s[4:7], s65 offen offset:1024 sc1
 v_mfma_f32_16x16x32_bf16 v[108:111], a[152:155], a[16:19], v[108:111]
 s_waitcnt lgkmcnt(7)
 ds_read_b64_tr_b16 a[174:175], v113 offset:41696
 v_mul_f32 v81, v81, v144
 v_mfma_f32_16x16x32_bf16 v[172:175], a[156:159], a[0:3], v[172:175]
 ds_read_b64_tr_b16 a[176:177], v113 offset:37120
 buffer_store_dwordx4 v[148:151], v14, s[4:7], s83 offen offset:2048 sc1
 v_mfma_f32_16x16x32_bf16 v[236:239], a[156:159], a[16:19], v[236:239]
 s_waitcnt lgkmcnt(7)
 ds_read_b64_tr_b16 a[178:179], v113 offset:41728
 v_mul_f32 v82, v82, v144
 v_mfma_f32_16x16x32_bf16 v[52:55], a[160:163], a[0:3], v[52:55]
 ds_read_b64_tr_b16 a[180:181], v113 offset:46080
 v_mul_f32 v83, v83, v144
 v_mfma_f32_16x16x32_bf16 v[116:119], a[160:163], a[16:19], v[116:119]
 s_waitcnt lgkmcnt(7)
 ds_read_b64_tr_b16 a[182:183], v113 offset:50688
 v_mul_f32 v88, v88, v144
 v_mul_f32 v89, v89, v144
 v_mfma_f32_16x16x32_bf16 v[180:183], a[164:167], a[0:3], v[180:183]
 ds_read_b64_tr_b16 a[184:185], v113 offset:46112
 buffer_load_dwordx4 a[200:203], v14, s[4:7], s18 offen offset:2048 sc1
 v_mfma_f32_16x16x32_bf16 v[244:247], a[164:167], a[16:19], v[244:247]
 s_waitcnt lgkmcnt(7)
 ds_read_b64_tr_b16 a[186:187], v113 offset:50720
 v_mul_f32 v90, v90, v144
 v_mfma_f32_16x16x32_bf16 v[60:63], a[168:171], a[0:3], v[60:63]
 ds_read_b64_tr_b16 a[188:189], v113 offset:46144
 v_mul_f32 v91, v91, v144
 v_cvt_pk_bf16_f32 v156, v80, v81
 v_mfma_f32_16x16x32_bf16 v[124:127], a[168:171], a[16:19], v[124:127]
 s_waitcnt lgkmcnt(7)
 ds_read_b64_tr_b16 a[190:191], v113 offset:50752
 v_cvt_pk_bf16_f32 v157, v82, v83
 v_mfma_f32_16x16x32_bf16 v[188:191], a[172:175], a[0:3], v[188:191]
 ds_read_b64_tr_b16 a[128:129], v113 offset:46176
 v_cvt_pk_bf16_f32 v158, v88, v89
 v_mfma_f32_16x16x32_bf16 v[252:255], a[172:175], a[16:19], v[252:255]
 s_waitcnt lgkmcnt(7)
 ds_read_b64_tr_b16 a[130:131], v113 offset:50784
 v_cvt_pk_bf16_f32 v159, v90, v91
 v_accvgpr_read_b32 v64, a88
 v_mfma_f32_16x16x32_bf16 v[192:195], a[176:179], a[0:3], v[192:195]
 ds_read_b64_tr_b16 a[132:133], v113 offset:46208
 buffer_load_dwordx4 a[216:219], v14, s[4:7], s65 offen offset:2048 sc1
 v_mfma_f32_16x16x32_bf16 v[200:203], a[176:179], a[16:19], v[200:203]
 s_waitcnt vmcnt(36) lgkmcnt(7)
 ds_read_b64_tr_b16 a[134:135], v113 offset:50816
 v_accvgpr_read_b32 v65, a89
 v_mfma_f32_16x16x32_bf16 v[36:39], a[180:183], a[4:7], v[36:39]
 s_waitcnt vmcnt(35)
 ds_read_b64_tr_b16 a[136:137], v113 offset:46240
 v_accvgpr_read_b32 v66, a90
 v_accvgpr_read_b32 v67, a91
 v_mfma_f32_16x16x32_bf16 v[100:103], a[180:183], a[20:23], v[100:103]
 s_waitcnt lgkmcnt(7)
 ds_read_b64_tr_b16 a[138:139], v113 offset:50848
 v_accvgpr_read_b32 v72, a92
 v_mfma_f32_16x16x32_bf16 v[164:167], a[184:187], a[4:7], v[164:167]
 ds_read_b64_tr_b16 a[140:141], v113 offset:46272
 v_accvgpr_read_b32 v73, a93
 v_mfma_f32_16x16x32_bf16 v[228:231], a[184:187], a[20:23], v[228:231]
 s_waitcnt lgkmcnt(7)
 ds_read_b64_tr_b16 a[142:143], v113 offset:50880
 v_accvgpr_read_b32 v74, a94
 v_accvgpr_read_b32 v75, a95
 v_mfma_f32_16x16x32_bf16 v[44:47], a[188:191], a[4:7], v[44:47]
 ds_read_b64_tr_b16 a[144:145], v113 offset:46304
 buffer_load_dwordx4 a[204:207], v14, s[4:7], s18 offen offset:3072 sc1
 v_mfma_f32_16x16x32_bf16 v[108:111], a[188:191], a[20:23], v[108:111]
 s_waitcnt lgkmcnt(7)
 ds_read_b64_tr_b16 a[146:147], v113 offset:50912
 v_mul_f32 v64, v64, v136
 v_mfma_f32_16x16x32_bf16 v[172:175], a[128:131], a[4:7], v[172:175]
 ds_read_b64_tr_b16 a[148:149], v113 offset:46336
 buffer_store_dwordx4 v[156:159], v14, s[4:7], s84 offen offset:2048 sc1
 v_mfma_f32_16x16x32_bf16 v[236:239], a[128:131], a[20:23], v[236:239]
 s_waitcnt lgkmcnt(7)
 ds_read_b64_tr_b16 a[150:151], v113 offset:50944
 v_mul_f32 v65, v65, v136
 v_mfma_f32_16x16x32_bf16 v[52:55], a[132:135], a[4:7], v[52:55]
 ds_read_b64_tr_b16 a[152:153], v113 offset:55296
 v_mul_f32 v66, v66, v136
 v_mfma_f32_16x16x32_bf16 v[116:119], a[132:135], a[20:23], v[116:119]
 s_waitcnt lgkmcnt(7)
 ds_read_b64_tr_b16 a[154:155], v113 offset:59904
 v_mul_f32 v67, v67, v136
 v_mul_f32 v72, v72, v136
 v_mfma_f32_16x16x32_bf16 v[180:183], a[136:139], a[4:7], v[180:183]
 ds_read_b64_tr_b16 a[156:157], v113 offset:55328
 buffer_load_dwordx4 a[220:223], v14, s[4:7], s65 offen offset:3072 sc1
 v_mfma_f32_16x16x32_bf16 v[244:247], a[136:139], a[20:23], v[244:247]
 s_waitcnt lgkmcnt(7)
 ds_read_b64_tr_b16 a[158:159], v113 offset:59936
 v_mul_f32 v73, v73, v136
 v_mfma_f32_16x16x32_bf16 v[60:63], a[140:143], a[4:7], v[60:63]
 ds_read_b64_tr_b16 a[160:161], v113 offset:55360
 v_mul_f32 v74, v74, v136
 v_mul_f32 v75, v75, v136
 v_mfma_f32_16x16x32_bf16 v[124:127], a[140:143], a[20:23], v[124:127]
 s_waitcnt lgkmcnt(7)
 ds_read_b64_tr_b16 a[162:163], v113 offset:59968
 v_cvt_pk_bf16_f32 v212, v64, v65
 v_mfma_f32_16x16x32_bf16 v[188:191], a[144:147], a[4:7], v[188:191]
 ds_read_b64_tr_b16 a[164:165], v113 offset:55392
 v_cvt_pk_bf16_f32 v213, v66, v67
 v_mfma_f32_16x16x32_bf16 v[252:255], a[144:147], a[20:23], v[252:255]
 s_waitcnt lgkmcnt(7)
 ds_read_b64_tr_b16 a[166:167], v113 offset:60000
 v_cvt_pk_bf16_f32 v214, v72, v73
 v_cvt_pk_bf16_f32 v215, v74, v75
 v_mfma_f32_16x16x32_bf16 v[192:195], a[148:151], a[4:7], v[192:195]
 ds_read_b64_tr_b16 a[168:169], v113 offset:55424
 s_add_u32 m0, s85, 46080
 v_accvgpr_read_b32 v80, a120
 v_mfma_f32_16x16x32_bf16 v[200:203], a[148:151], a[20:23], v[200:203]
 s_waitcnt vmcnt(37) lgkmcnt(7)
 ds_read_b64_tr_b16 a[170:171], v113 offset:60032
 buffer_load_dwordx4 v96, s[28:31], s15 offen offset:0 lds
 v_mfma_f32_16x16x32_bf16 v[36:39], a[152:155], a[8:11], v[36:39]
 s_waitcnt vmcnt(37)
 ds_read_b64_tr_b16 a[172:173], v113 offset:55456
 v_accvgpr_read_b32 v81, a121
 v_accvgpr_read_b32 v82, a122
 v_mfma_f32_16x16x32_bf16 v[100:103], a[152:155], a[24:27], v[100:103]
 s_waitcnt lgkmcnt(7)
 ds_read_b64_tr_b16 a[174:175], v113 offset:60064
 v_accvgpr_read_b32 v83, a123
 v_mfma_f32_16x16x32_bf16 v[164:167], a[156:159], a[8:11], v[164:167]
 ds_read_b64_tr_b16 a[176:177], v113 offset:55488
 v_accvgpr_read_b32 v88, a124
 v_mfma_f32_16x16x32_bf16 v[228:231], a[156:159], a[24:27], v[228:231]
 s_waitcnt lgkmcnt(7)
 ds_read_b64_tr_b16 a[178:179], v113 offset:60096
 v_accvgpr_read_b32 v89, a125
 v_accvgpr_read_b32 v90, a126
 v_mfma_f32_16x16x32_bf16 v[44:47], a[160:163], a[8:11], v[44:47]
 ds_read_b64_tr_b16 a[180:181], v113 offset:55520
 v_accvgpr_read_b32 v91, a127
 v_mfma_f32_16x16x32_bf16 v[108:111], a[160:163], a[24:27], v[108:111]
 s_waitcnt lgkmcnt(7)
 ds_read_b64_tr_b16 a[182:183], v113 offset:60128
 buffer_load_dwordx4 v97, s[28:31], s15 offen offset:1024 lds
 v_mfma_f32_16x16x32_bf16 v[172:175], a[164:167], a[8:11], v[172:175]
 ds_read_b64_tr_b16 a[184:185], v113 offset:55552
 v_mul_f32 v80, v80, v144
 v_mul_f32 v81, v81, v144
 v_mfma_f32_16x16x32_bf16 v[236:239], a[164:167], a[24:27], v[236:239]
 ds_read_b64_tr_b16 a[186:187], v113 offset:60160
 buffer_store_dwordx4 v[212:215], v14, s[4:7], s83 offen offset:3072 sc1
 s_waitcnt vmcnt(15) lgkmcnt(8)
 s_barrier
 v_mfma_f32_16x16x32_bf16 v[52:55], a[168:171], a[8:11], v[52:55]
 ds_read_b64_tr_b16 a[188:189], v114 offset:0
 v_mul_f32 v82, v82, v144
 v_mfma_f32_16x16x32_bf16 v[116:119], a[168:171], a[24:27], v[116:119]
 s_waitcnt lgkmcnt(7)
 ds_read_b64_tr_b16 a[190:191], v114 offset:4608
 v_mul_f32 v83, v83, v144
 v_mul_f32 v88, v88, v144
 v_mfma_f32_16x16x32_bf16 v[180:183], a[172:175], a[8:11], v[180:183]
 ds_read_b64_tr_b16 a[128:129], v114 offset:32
 v_mul_f32 v89, v89, v144
 v_mfma_f32_16x16x32_bf16 v[244:247], a[172:175], a[24:27], v[244:247]
 s_waitcnt lgkmcnt(7)
 ds_read_b64_tr_b16 a[130:131], v114 offset:4640
 buffer_load_dwordx4 v98, s[28:31], s15 offen offset:2048 lds
 v_mfma_f32_16x16x32_bf16 v[60:63], a[176:179], a[8:11], v[60:63]
 ds_read_b64_tr_b16 a[132:133], v114 offset:64
 v_mul_f32 v90, v90, v144
 v_mul_f32 v91, v91, v144
 v_mfma_f32_16x16x32_bf16 v[124:127], a[176:179], a[24:27], v[124:127]
 s_waitcnt lgkmcnt(7)
 ds_read_b64_tr_b16 a[134:135], v114 offset:4672
 v_cvt_pk_bf16_f32 v220, v80, v81
 v_mfma_f32_16x16x32_bf16 v[188:191], a[180:183], a[8:11], v[188:191]
 ds_read_b64_tr_b16 a[136:137], v114 offset:96
 v_cvt_pk_bf16_f32 v221, v82, v83
 v_mfma_f32_16x16x32_bf16 v[252:255], a[180:183], a[24:27], v[252:255]
 s_waitcnt lgkmcnt(7)
 ds_read_b64_tr_b16 a[138:139], v114 offset:4704
 v_cvt_pk_bf16_f32 v222, v88, v89
 v_cvt_pk_bf16_f32 v223, v90, v91
 v_mfma_f32_16x16x32_bf16 v[192:195], a[184:187], a[8:11], v[192:195]
 ds_read_b64_tr_b16 a[140:141], v114 offset:128
 v_mfma_f32_16x16x32_bf16 v[200:203], a[184:187], a[24:27], v[200:203]
 s_waitcnt lgkmcnt(7)
 ds_read_b64_tr_b16 a[142:143], v114 offset:4736
 buffer_load_dwordx4 v99, s[28:31], s15 offen offset:3072 lds
 s_add_u32 m0, s85, 50176
 v_mfma_f32_16x16x32_bf16 v[36:39], a[188:191], a[12:15], v[36:39]
 ds_read_b64_tr_b16 a[144:145], v114 offset:160
 v_mfma_f32_16x16x32_bf16 v[100:103], a[188:191], a[28:31], v[100:103]
 s_waitcnt lgkmcnt(7)
 ds_read_b64_tr_b16 a[146:147], v114 offset:4768
 v_mfma_f32_16x16x32_bf16 v[164:167], a[128:131], a[12:15], v[164:167]
 ds_read_b64_tr_b16 a[148:149], v114 offset:192
 v_mfma_f32_16x16x32_bf16 v[228:231], a[128:131], a[28:31], v[228:231]
 s_waitcnt lgkmcnt(7)
 ds_read_b64_tr_b16 a[150:151], v114 offset:4800
 v_mfma_f32_16x16x32_bf16 v[44:47], a[132:135], a[12:15], v[44:47]
 ds_read_b64_tr_b16 a[152:153], v114 offset:224
 v_mfma_f32_16x16x32_bf16 v[108:111], a[132:135], a[28:31], v[108:111]
 s_waitcnt lgkmcnt(7)
 ds_read_b64_tr_b16 a[154:155], v114 offset:4832
 buffer_load_dwordx4 v104, s[28:31], s15 offen offset:0 lds
 v_mfma_f32_16x16x32_bf16 v[172:175], a[136:139], a[12:15], v[172:175]
 ds_read_b64_tr_b16 a[156:157], v114 offset:256
 v_mfma_f32_16x16x32_bf16 v[236:239], a[136:139], a[28:31], v[236:239]
 s_waitcnt lgkmcnt(7)
 ds_read_b64_tr_b16 a[158:159], v114 offset:4864
 buffer_store_dwordx4 v[220:223], v14, s[4:7], s84 offen offset:3072 sc1
 v_mfma_f32_16x16x32_bf16 v[52:55], a[140:143], a[12:15], v[52:55]
 ds_read_b64_tr_b16 a[160:161], v114 offset:9216
 v_mfma_f32_16x16x32_bf16 v[116:119], a[140:143], a[28:31], v[116:119]
 s_waitcnt lgkmcnt(7)
 ds_read_b64_tr_b16 a[162:163], v114 offset:13824
 v_mfma_f32_16x16x32_bf16 v[180:183], a[144:147], a[12:15], v[180:183]
 ds_read_b64_tr_b16 a[164:165], v114 offset:9248
 v_mfma_f32_16x16x32_bf16 v[244:247], a[144:147], a[28:31], v[244:247]
 s_waitcnt lgkmcnt(7)
 ds_read_b64_tr_b16 a[166:167], v114 offset:13856
 buffer_load_dwordx4 v105, s[28:31], s15 offen offset:1024 lds
 v_mfma_f32_16x16x32_bf16 v[60:63], a[148:151], a[12:15], v[60:63]
 ds_read_b64_tr_b16 a[168:169], v114 offset:9280
 v_mfma_f32_16x16x32_bf16 v[124:127], a[148:151], a[28:31], v[124:127]
 s_waitcnt lgkmcnt(7)
 ds_read_b64_tr_b16 a[170:171], v114 offset:13888
 v_mfma_f32_16x16x32_bf16 v[188:191], a[152:155], a[12:15], v[188:191]
 ds_read_b64_tr_b16 a[172:173], v114 offset:9312
 v_mfma_f32_16x16x32_bf16 v[252:255], a[152:155], a[28:31], v[252:255]
 s_waitcnt lgkmcnt(7)
 ds_read_b64_tr_b16 a[174:175], v114 offset:13920
 v_mfma_f32_16x16x32_bf16 v[192:195], a[156:159], a[12:15], v[192:195]
 ds_read_b64_tr_b16 a[176:177], v114 offset:9344
 v_mfma_f32_16x16x32_bf16 v[200:203], a[156:159], a[28:31], v[200:203]
 s_waitcnt lgkmcnt(7)
 ds_read_b64_tr_b16 a[178:179], v114 offset:13952
 buffer_load_dwordx4 v106, s[28:31], s15 offen offset:2048 lds
 v_mfma_f32_16x16x32_bf16 v[36:39], a[160:163], a[32:35], v[36:39]
 ds_read_b64_tr_b16 a[180:181], v114 offset:9376
 v_mfma_f32_16x16x32_bf16 v[100:103], a[160:163], a[48:51], v[100:103]
 s_waitcnt lgkmcnt(7)
 ds_read_b64_tr_b16 a[182:183], v114 offset:13984
 v_mfma_f32_16x16x32_bf16 v[164:167], a[164:167], a[32:35], v[164:167]
 ds_read_b64_tr_b16 a[184:185], v114 offset:9408
 v_mfma_f32_16x16x32_bf16 v[228:231], a[164:167], a[48:51], v[228:231]
 s_waitcnt lgkmcnt(7)
 ds_read_b64_tr_b16 a[186:187], v114 offset:14016
 v_mfma_f32_16x16x32_bf16 v[44:47], a[168:171], a[32:35], v[44:47]
 ds_read_b64_tr_b16 a[188:189], v114 offset:9440
 v_mfma_f32_16x16x32_bf16 v[108:111], a[168:171], a[48:51], v[108:111]
 s_waitcnt lgkmcnt(7)
 ds_read_b64_tr_b16 a[190:191], v114 offset:14048
 buffer_load_dwordx4 v107, s[28:31], s15 offen offset:3072 lds
 s_add_u32 m0, s85, 54272
 v_mfma_f32_16x16x32_bf16 v[172:175], a[172:175], a[32:35], v[172:175]
 ds_read_b64_tr_b16 a[128:129], v114 offset:9472
 v_mfma_f32_16x16x32_bf16 v[236:239], a[172:175], a[48:51], v[236:239]
 s_waitcnt lgkmcnt(7)
 ds_read_b64_tr_b16 a[130:131], v114 offset:14080
 v_mfma_f32_16x16x32_bf16 v[52:55], a[176:179], a[32:35], v[52:55]
 ds_read_b64_tr_b16 a[132:133], v114 offset:18432
 v_mfma_f32_16x16x32_bf16 v[116:119], a[176:179], a[48:51], v[116:119]
 s_waitcnt lgkmcnt(7)
 ds_read_b64_tr_b16 a[134:135], v114 offset:23040
 v_mfma_f32_16x16x32_bf16 v[180:183], a[180:183], a[32:35], v[180:183]
 ds_read_b64_tr_b16 a[136:137], v114 offset:18464
 v_mfma_f32_16x16x32_bf16 v[244:247], a[180:183], a[48:51], v[244:247]
 s_waitcnt lgkmcnt(7)
 ds_read_b64_tr_b16 a[138:139], v114 offset:23072
 buffer_load_dwordx4 v112, s[28:31], s15 offen offset:0 lds
 v_mfma_f32_16x16x32_bf16 v[60:63], a[184:187], a[32:35], v[60:63]
 ds_read_b64_tr_b16 a[140:141], v114 offset:18496
 v_mfma_f32_16x16x32_bf16 v[124:127], a[184:187], a[48:51], v[124:127]
 s_waitcnt lgkmcnt(7)
 ds_read_b64_tr_b16 a[142:143], v114 offset:23104
 v_mfma_f32_16x16x32_bf16 v[188:191], a[188:191], a[32:35], v[188:191]
 ds_read_b64_tr_b16 a[144:145], v114 offset:18528
 v_mfma_f32_16x16x32_bf16 v[252:255], a[188:191], a[48:51], v[252:255]
 s_waitcnt lgkmcnt(7)
 ds_read_b64_tr_b16 a[146:147], v114 offset:23136
 v_mfma_f32_16x16x32_bf16 v[192:195], a[128:131], a[32:35], v[192:195]
 ds_read_b64_tr_b16 a[148:149], v114 offset:18560
 v_mfma_f32_16x16x32_bf16 v[200:203], a[128:131], a[48:51], v[200:203]
 s_waitcnt lgkmcnt(7)
 ds_read_b64_tr_b16 a[150:151], v114 offset:23168
 v_mfma_f32_16x16x32_bf16 v[36:39], a[132:135], a[36:39], v[36:39]
 ds_read_b64_tr_b16 a[152:153], v114 offset:18592
 v_mfma_f32_16x16x32_bf16 v[100:103], a[132:135], a[52:55], v[100:103]
 s_waitcnt lgkmcnt(7)
 ds_read_b64_tr_b16 a[154:155], v114 offset:23200
 v_mfma_f32_16x16x32_bf16 v[164:167], a[136:139], a[36:39], v[164:167]
 ds_read_b64_tr_b16 a[156:157], v114 offset:18624
 v_mfma_f32_16x16x32_bf16 v[228:231], a[136:139], a[52:55], v[228:231]
 s_waitcnt lgkmcnt(7)
 ds_read_b64_tr_b16 a[158:159], v114 offset:23232
 v_mfma_f32_16x16x32_bf16 v[44:47], a[140:143], a[36:39], v[44:47]
 ds_read_b64_tr_b16 a[160:161], v114 offset:18656
 v_mfma_f32_16x16x32_bf16 v[108:111], a[140:143], a[52:55], v[108:111]
 s_waitcnt lgkmcnt(7)
 ds_read_b64_tr_b16 a[162:163], v114 offset:23264
 v_mfma_f32_16x16x32_bf16 v[172:175], a[144:147], a[36:39], v[172:175]
 ds_read_b64_tr_b16 a[164:165], v114 offset:18688
 v_mfma_f32_16x16x32_bf16 v[236:239], a[144:147], a[52:55], v[236:239]
 s_waitcnt lgkmcnt(7)
 ds_read_b64_tr_b16 a[166:167], v114 offset:23296
 v_mfma_f32_16x16x32_bf16 v[52:55], a[148:151], a[36:39], v[52:55]
 ds_read_b64_tr_b16 a[168:169], v114 offset:27648
 v_mfma_f32_16x16x32_bf16 v[116:119], a[148:151], a[52:55], v[116:119]
 s_waitcnt lgkmcnt(7)
 ds_read_b64_tr_b16 a[170:171], v114 offset:32256
 v_mfma_f32_16x16x32_bf16 v[180:183], a[152:155], a[36:39], v[180:183]
 ds_read_b64_tr_b16 a[172:173], v114 offset:27680
 v_mfma_f32_16x16x32_bf16 v[244:247], a[152:155], a[52:55], v[244:247]
 s_waitcnt lgkmcnt(7)
 ds_read_b64_tr_b16 a[174:175], v114 offset:32288
 v_mfma_f32_16x16x32_bf16 v[60:63], a[156:159], a[36:39], v[60:63]
 ds_read_b64_tr_b16 a[176:177], v114 offset:27712
 v_mfma_f32_16x16x32_bf16 v[124:127], a[156:159], a[52:55], v[124:127]
 s_waitcnt lgkmcnt(7)
 ds_read_b64_tr_b16 a[178:179], v114 offset:32320
 v_mfma_f32_16x16x32_bf16 v[188:191], a[160:163], a[36:39], v[188:191]
 ds_read_b64_tr_b16 a[180:181], v114 offset:27744
 v_mfma_f32_16x16x32_bf16 v[252:255], a[160:163], a[52:55], v[252:255]
 s_waitcnt lgkmcnt(7)
 ds_read_b64_tr_b16 a[182:183], v114 offset:32352
 v_mfma_f32_16x16x32_bf16 v[192:195], a[164:167], a[36:39], v[192:195]
 ds_read_b64_tr_b16 a[184:185], v114 offset:27776
 v_mfma_f32_16x16x32_bf16 v[200:203], a[164:167], a[52:55], v[200:203]
 s_waitcnt lgkmcnt(7)
 ds_read_b64_tr_b16 a[186:187], v114 offset:32384
 v_mfma_f32_16x16x32_bf16 v[36:39], a[168:171], a[40:43], v[36:39]
 ds_read_b64_tr_b16 a[188:189], v114 offset:27808
 v_mfma_f32_16x16x32_bf16 v[100:103], a[168:171], a[56:59], v[100:103]
 s_waitcnt lgkmcnt(7)
 ds_read_b64_tr_b16 a[190:191], v114 offset:32416
 v_mfma_f32_16x16x32_bf16 v[164:167], a[172:175], a[40:43], v[164:167]
 ds_read_b64_tr_b16 a[128:129], v114 offset:27840
 v_mfma_f32_16x16x32_bf16 v[228:231], a[172:175], a[56:59], v[228:231]
 s_waitcnt lgkmcnt(7)
 ds_read_b64_tr_b16 a[130:131], v114 offset:32448
 v_mfma_f32_16x16x32_bf16 v[44:47], a[176:179], a[40:43], v[44:47]
 ds_read_b64_tr_b16 a[132:133], v114 offset:27872
 v_mfma_f32_16x16x32_bf16 v[108:111], a[176:179], a[56:59], v[108:111]
 s_waitcnt lgkmcnt(7)
 ds_read_b64_tr_b16 a[134:135], v114 offset:32480
 v_mfma_f32_16x16x32_bf16 v[172:175], a[180:183], a[40:43], v[172:175]
 ds_read_b64_tr_b16 a[136:137], v114 offset:27904
 v_mfma_f32_16x16x32_bf16 v[236:239], a[180:183], a[56:59], v[236:239]
 s_waitcnt lgkmcnt(7)
 ds_read_b64_tr_b16 a[138:139], v114 offset:32512
 v_mfma_f32_16x16x32_bf16 v[52:55], a[184:187], a[40:43], v[52:55]
 ds_read_b64_tr_b16 a[140:141], v114 offset:36864
 v_mfma_f32_16x16x32_bf16 v[116:119], a[184:187], a[56:59], v[116:119]
 s_waitcnt lgkmcnt(7)
 ds_read_b64_tr_b16 a[142:143], v114 offset:41472
 v_mfma_f32_16x16x32_bf16 v[180:183], a[188:191], a[40:43], v[180:183]
 ds_read_b64_tr_b16 a[144:145], v114 offset:36896
 v_mfma_f32_16x16x32_bf16 v[244:247], a[188:191], a[56:59], v[244:247]
 s_waitcnt lgkmcnt(7)
 ds_read_b64_tr_b16 a[146:147], v114 offset:41504
 v_mfma_f32_16x16x32_bf16 v[60:63], a[128:131], a[40:43], v[60:63]
 ds_read_b64_tr_b16 a[148:149], v114 offset:36928
 v_mfma_f32_16x16x32_bf16 v[124:127], a[128:131], a[56:59], v[124:127]
 s_waitcnt lgkmcnt(7)
 ds_read_b64_tr_b16 a[150:151], v114 offset:41536
 v_mfma_f32_16x16x32_bf16 v[188:191], a[132:135], a[40:43], v[188:191]
 ds_read_b64_tr_b16 a[152:153], v114 offset:36960
 v_mfma_f32_16x16x32_bf16 v[252:255], a[132:135], a[56:59], v[252:255]
 s_waitcnt lgkmcnt(7)
 ds_read_b64_tr_b16 a[154:155], v114 offset:41568
 v_mfma_f32_16x16x32_bf16 v[192:195], a[136:139], a[40:43], v[192:195]
 ds_read_b64_tr_b16 a[156:157], v114 offset:36992
 v_mfma_f32_16x16x32_bf16 v[200:203], a[136:139], a[56:59], v[200:203]
 s_waitcnt lgkmcnt(7)
 ds_read_b64_tr_b16 a[158:159], v114 offset:41600
 v_mfma_f32_16x16x32_bf16 v[36:39], a[140:143], a[44:47], v[36:39]
 s_waitcnt vmcnt(22)
 ds_read_b64_tr_b16 a[160:161], v114 offset:37024
 v_mfma_f32_16x16x32_bf16 v[100:103], a[140:143], a[60:63], v[100:103]
 s_waitcnt lgkmcnt(7)
 ds_read_b64_tr_b16 a[162:163], v114 offset:41632
 v_mfma_f32_16x16x32_bf16 v[164:167], a[144:147], a[44:47], v[164:167]
 ds_read_b64_tr_b16 a[164:165], v114 offset:37056
 v_mfma_f32_16x16x32_bf16 v[228:231], a[144:147], a[60:63], v[228:231]
 s_waitcnt lgkmcnt(7)
 ds_read_b64_tr_b16 a[166:167], v114 offset:41664
 v_mfma_f32_16x16x32_bf16 v[44:47], a[148:151], a[44:47], v[44:47]
 ds_read_b64_tr_b16 a[168:169], v114 offset:37088
 v_mfma_f32_16x16x32_bf16 v[108:111], a[148:151], a[60:63], v[108:111]
 s_waitcnt lgkmcnt(7)
 ds_read_b64_tr_b16 a[170:171], v114 offset:41696
 v_mfma_f32_16x16x32_bf16 v[172:175], a[152:155], a[44:47], v[172:175]
 ds_read_b64_tr_b16 a[172:173], v114 offset:37120
 v_mfma_f32_16x16x32_bf16 v[236:239], a[152:155], a[60:63], v[236:239]
 ds_read_b64_tr_b16 a[174:175], v114 offset:41728
 s_waitcnt vmcnt(0) lgkmcnt(8)
 s_barrier
 v_mfma_f32_16x16x32_bf16 v[52:55], a[156:159], a[44:47], v[52:55]
 ds_read_b64_tr_b16 a[176:177], v114 offset:46080
 s_lshl_b32 s94, s2, 6
 s_add_u32 s94, s94, 71417856
 s_cmp_eq_u32 s60, 0
 s_cselect_b32 s94, s94, 0x8000000
 v_lshl_add_u32 v22, v14, 21, s94
 v_mov_b32 v23, 1
 v_mfma_f32_16x16x32_bf16 v[116:119], a[156:159], a[60:63], v[116:119]
 s_waitcnt lgkmcnt(7)
 ds_read_b64_tr_b16 a[178:179], v114 offset:50688
 buffer_store_dword v23, v22, s[4:7], 0 offen sc1
 v_mfma_f32_16x16x32_bf16 v[180:183], a[160:163], a[44:47], v[180:183]
 ds_read_b64_tr_b16 a[180:181], v114 offset:46112
 v_mfma_f32_16x16x32_bf16 v[244:247], a[160:163], a[60:63], v[244:247]
 s_waitcnt lgkmcnt(7)
 ds_read_b64_tr_b16 a[182:183], v114 offset:50720
 v_mfma_f32_16x16x32_bf16 v[60:63], a[164:167], a[44:47], v[60:63]
 ds_read_b64_tr_b16 a[184:185], v114 offset:46144
 v_mfma_f32_16x16x32_bf16 v[124:127], a[164:167], a[60:63], v[124:127]
 s_waitcnt lgkmcnt(7)
 ds_read_b64_tr_b16 a[186:187], v114 offset:50752
 v_mfma_f32_16x16x32_bf16 v[188:191], a[168:171], a[44:47], v[188:191]
 ds_read_b64_tr_b16 a[188:189], v114 offset:46176
 v_mfma_f32_16x16x32_bf16 v[252:255], a[168:171], a[60:63], v[252:255]
 s_waitcnt lgkmcnt(7)
 ds_read_b64_tr_b16 a[190:191], v114 offset:50784
 v_mfma_f32_16x16x32_bf16 v[192:195], a[172:175], a[44:47], v[192:195]
 ds_read_b64_tr_b16 a[128:129], v114 offset:46208
 v_mfma_f32_16x16x32_bf16 v[200:203], a[172:175], a[60:63], v[200:203]
 s_waitcnt lgkmcnt(7)
 ds_read_b64_tr_b16 a[130:131], v114 offset:50816
 v_add_u32 v19, 0x4000, v19
 v_mfma_f32_16x16x32_bf16 v[36:39], a[176:179], a[192:195], v[36:39]
 ds_read_b64_tr_b16 a[132:133], v114 offset:46240
 v_mfma_f32_16x16x32_bf16 v[100:103], a[176:179], a[208:211], v[100:103]
 s_waitcnt lgkmcnt(7)
 ds_read_b64_tr_b16 a[134:135], v114 offset:50848
 v_mfma_f32_16x16x32_bf16 v[164:167], a[180:183], a[192:195], v[164:167]
 ds_read_b64_tr_b16 a[136:137], v114 offset:46272
 v_mfma_f32_16x16x32_bf16 v[228:231], a[180:183], a[208:211], v[228:231]
 s_waitcnt lgkmcnt(7)
 ds_read_b64_tr_b16 a[138:139], v114 offset:50880
 v_mfma_f32_16x16x32_bf16 v[44:47], a[184:187], a[192:195], v[44:47]
 ds_read_b64_tr_b16 a[140:141], v114 offset:46304
 v_mfma_f32_16x16x32_bf16 v[108:111], a[184:187], a[208:211], v[108:111]
 s_waitcnt lgkmcnt(7)
 ds_read_b64_tr_b16 a[142:143], v114 offset:50912
 v_mfma_f32_16x16x32_bf16 v[172:175], a[188:191], a[192:195], v[172:175]
 ds_read_b64_tr_b16 a[144:145], v114 offset:46336
 v_mfma_f32_16x16x32_bf16 v[236:239], a[188:191], a[208:211], v[236:239]
 s_waitcnt lgkmcnt(7)
 ds_read_b64_tr_b16 a[146:147], v114 offset:50944
 v_mfma_f32_16x16x32_bf16 v[52:55], a[128:131], a[192:195], v[52:55]
 ds_read_b64_tr_b16 a[148:149], v114 offset:55296
 v_mfma_f32_16x16x32_bf16 v[116:119], a[128:131], a[208:211], v[116:119]
 s_waitcnt lgkmcnt(7)
 s_lshl_b32 s95, s61, 10
 s_mov_b32 s94, s63
 s_lshl_b32 s94, s94, 2
 s_add_u32 s94, s94, s62
 s_lshl_b32 s94, s94, 2
 s_add_u32 s94, s94, s60
 s_mul_i32 s94, s94, 73728
 s_add_u32 s94, s94, 50331648
 s_add_u32 s19, s94, s95
 ds_read_b64_tr_b16 a[150:151], v114 offset:59904
 v_mfma_f32_16x16x32_bf16 v[180:183], a[132:135], a[192:195], v[180:183]
 ds_read_b64_tr_b16 a[152:153], v114 offset:55328
 v_mfma_f32_16x16x32_bf16 v[244:247], a[132:135], a[208:211], v[244:247]
 s_waitcnt lgkmcnt(7)
 ds_read_b64_tr_b16 a[154:155], v114 offset:59936
 v_mfma_f32_16x16x32_bf16 v[60:63], a[136:139], a[192:195], v[60:63]
 ds_read_b64_tr_b16 a[156:157], v114 offset:55360
 v_mfma_f32_16x16x32_bf16 v[124:127], a[136:139], a[208:211], v[124:127]
 s_waitcnt lgkmcnt(7)
 s_lshl_b32 s95, s61, 10
 s_sub_u32 s94, 15, s63
 s_lshl_b32 s94, s94, 2
 s_add_u32 s94, s94, s62
 s_lshl_b32 s94, s94, 2
 s_add_u32 s94, s94, s60
 s_mul_i32 s94, s94, 73728
 s_add_u32 s94, s94, 50331648
 s_add_u32 s64, s94, s95
 ds_read_b64_tr_b16 a[158:159], v114 offset:59968
 v_mfma_f32_16x16x32_bf16 v[188:191], a[140:143], a[192:195], v[188:191]
 ds_read_b64_tr_b16 a[160:161], v114 offset:55392
 v_mfma_f32_16x16x32_bf16 v[252:255], a[140:143], a[208:211], v[252:255]
 s_waitcnt lgkmcnt(7)
 ds_read_b64_tr_b16 a[162:163], v114 offset:60000
 v_mfma_f32_16x16x32_bf16 v[192:195], a[144:147], a[192:195], v[192:195]
 ds_read_b64_tr_b16 a[164:165], v114 offset:55424
 v_mfma_f32_16x16x32_bf16 v[200:203], a[144:147], a[208:211], v[200:203]
 s_waitcnt lgkmcnt(7)
 ds_read_b64_tr_b16 a[166:167], v114 offset:60032
 v_mfma_f32_16x16x32_bf16 v[36:39], a[148:151], a[196:199], v[36:39]
 ds_read_b64_tr_b16 a[168:169], v114 offset:55456
 v_mfma_f32_16x16x32_bf16 v[100:103], a[148:151], a[212:215], v[100:103]
 s_waitcnt lgkmcnt(7)
 ds_read_b64_tr_b16 a[170:171], v114 offset:60064
 buffer_load_dword v15, v19, s[4:7], 0 offen sc1
 v_mfma_f32_16x16x32_bf16 v[164:167], a[152:155], a[196:199], v[164:167]
 ds_read_b64_tr_b16 a[172:173], v114 offset:55488
 v_mfma_f32_16x16x32_bf16 v[228:231], a[152:155], a[212:215], v[228:231]
 s_waitcnt lgkmcnt(7)
 ds_read_b64_tr_b16 a[174:175], v114 offset:60096
 v_mfma_f32_16x16x32_bf16 v[44:47], a[156:159], a[196:199], v[44:47]
 ds_read_b64_tr_b16 a[176:177], v114 offset:55520
 v_mfma_f32_16x16x32_bf16 v[108:111], a[156:159], a[212:215], v[108:111]
 s_waitcnt lgkmcnt(7)
 ds_read_b64_tr_b16 a[178:179], v114 offset:60128
 v_mfma_f32_16x16x32_bf16 v[172:175], a[160:163], a[196:199], v[172:175]
 ds_read_b64_tr_b16 a[180:181], v114 offset:55552
 v_mfma_f32_16x16x32_bf16 v[236:239], a[160:163], a[212:215], v[236:239]
 s_waitcnt lgkmcnt(7)
 ds_read_b64_tr_b16 a[182:183], v114 offset:60160
 v_mfma_f32_16x16x32_bf16 v[52:55], a[164:167], a[196:199], v[52:55]
 ds_read_b64_tr_b16 a[184:185], v115 offset:0
 v_mfma_f32_16x16x32_bf16 v[116:119], a[164:167], a[212:215], v[116:119]
 s_waitcnt lgkmcnt(7)
 ds_read_b64_tr_b16 a[186:187], v115 offset:4608
 v_mfma_f32_16x16x32_bf16 v[180:183], a[168:171], a[196:199], v[180:183]
 ds_read_b64_tr_b16 a[188:189], v115 offset:32
 v_mfma_f32_16x16x32_bf16 v[244:247], a[168:171], a[212:215], v[244:247]
 s_waitcnt lgkmcnt(7)
 ds_read_b64_tr_b16 a[190:191], v115 offset:4640
 v_mfma_f32_16x16x32_bf16 v[60:63], a[172:175], a[196:199], v[60:63]
 ds_read_b64_tr_b16 a[128:129], v115 offset:64
 v_mfma_f32_16x16x32_bf16 v[124:127], a[172:175], a[212:215], v[124:127]
 s_waitcnt lgkmcnt(7)
 ds_read_b64_tr_b16 a[130:131], v115 offset:4672
 v_mfma_f32_16x16x32_bf16 v[188:191], a[176:179], a[196:199], v[188:191]
 ds_read_b64_tr_b16 a[132:133], v115 offset:96
 v_mfma_f32_16x16x32_bf16 v[252:255], a[176:179], a[212:215], v[252:255]
 s_waitcnt lgkmcnt(7)
 ds_read_b64_tr_b16 a[134:135], v115 offset:4704
 v_mfma_f32_16x16x32_bf16 v[192:195], a[180:183], a[196:199], v[192:195]
 ds_read_b64_tr_b16 a[136:137], v115 offset:128
 v_mfma_f32_16x16x32_bf16 v[200:203], a[180:183], a[212:215], v[200:203]
 s_waitcnt lgkmcnt(7)
 ds_read_b64_tr_b16 a[138:139], v115 offset:4736
 v_mfma_f32_16x16x32_bf16 v[36:39], a[184:187], a[200:203], v[36:39]
 ds_read_b64_tr_b16 a[140:141], v115 offset:160
 v_mfma_f32_16x16x32_bf16 v[100:103], a[184:187], a[216:219], v[100:103]
 s_waitcnt lgkmcnt(7)
 ds_read_b64_tr_b16 a[142:143], v115 offset:4768
 v_mfma_f32_16x16x32_bf16 v[164:167], a[188:191], a[200:203], v[164:167]
 ds_read_b64_tr_b16 a[144:145], v115 offset:192
 v_mfma_f32_16x16x32_bf16 v[228:231], a[188:191], a[216:219], v[228:231]
 s_waitcnt lgkmcnt(7)
 ds_read_b64_tr_b16 a[146:147], v115 offset:4800
 v_mfma_f32_16x16x32_bf16 v[44:47], a[128:131], a[200:203], v[44:47]
 ds_read_b64_tr_b16 a[148:149], v115 offset:224
 v_mfma_f32_16x16x32_bf16 v[108:111], a[128:131], a[216:219], v[108:111]
 s_waitcnt lgkmcnt(7)
 ds_read_b64_tr_b16 a[150:151], v115 offset:4832
 v_mfma_f32_16x16x32_bf16 v[172:175], a[132:135], a[200:203], v[172:175]
 ds_read_b64_tr_b16 a[152:153], v115 offset:256
 v_mfma_f32_16x16x32_bf16 v[236:239], a[132:135], a[216:219], v[236:239]
 s_waitcnt lgkmcnt(7)
 ds_read_b64_tr_b16 a[154:155], v115 offset:4864
 v_mfma_f32_16x16x32_bf16 v[52:55], a[136:139], a[200:203], v[52:55]
 s_waitcnt vmcnt(0)
 ds_read_b64_tr_b16 a[156:157], v115 offset:9216
 v_cmp_eq_u32 vcc, 1, v15
 s_and_b32 s94, vcc_lo, 15
 s_cmp_eq_u32 s94, 15
 s_cbranch_scc0 L_spin_193
L_back_192:
 v_mfma_f32_16x16x32_bf16 v[116:119], a[136:139], a[216:219], v[116:119]
 s_waitcnt lgkmcnt(7)
 ds_read_b64_tr_b16 a[158:159], v115 offset:13824
 v_mfma_f32_16x16x32_bf16 v[180:183], a[140:143], a[200:203], v[180:183]
 ds_read_b64_tr_b16 a[160:161], v115 offset:9248
 s_lshl_b32 s94, s63, 1
 s_sub_u32 s94, 15, s94
 s_lshl_b32 s94, s94, 15
 s_add_u32 s16, s16, s94
 s_add_u32 s65, s16, 4096
 buffer_load_dwordx4 a[64:67], v14, s[4:7], s16 offen offset:0 sc1
 v_mfma_f32_16x16x32_bf16 v[244:247], a[140:143], a[216:219], v[244:247]
 s_waitcnt lgkmcnt(7)
 ds_read_b64_tr_b16 a[162:163], v115 offset:13856
 v_mfma_f32_16x16x32_bf16 v[60:63], a[144:147], a[200:203], v[60:63]
 ds_read_b64_tr_b16 a[164:165], v115 offset:9280
 v_mfma_f32_16x16x32_bf16 v[124:127], a[144:147], a[216:219], v[124:127]
 s_waitcnt lgkmcnt(7)
 ds_read_b64_tr_b16 a[166:167], v115 offset:13888
 v_mfma_f32_16x16x32_bf16 v[188:191], a[148:151], a[200:203], v[188:191]
 ds_read_b64_tr_b16 a[168:169], v115 offset:9312
 v_mfma_f32_16x16x32_bf16 v[252:255], a[148:151], a[216:219], v[252:255]
 s_waitcnt lgkmcnt(7)
 ds_read_b64_tr_b16 a[170:171], v115 offset:13920
 v_mfma_f32_16x16x32_bf16 v[192:195], a[152:155], a[200:203], v[192:195]
 ds_read_b64_tr_b16 a[172:173], v115 offset:9344
 buffer_load_dwordx4 a[80:83], v14, s[4:7], s65 offen offset:0 sc1
 v_mfma_f32_16x16x32_bf16 v[200:203], a[152:155], a[216:219], v[200:203]
 s_waitcnt lgkmcnt(7)
 ds_read_b64_tr_b16 a[174:175], v115 offset:13952
 v_mfma_f32_16x16x32_bf16 v[36:39], a[156:159], a[204:207], v[36:39]
 ds_read_b64_tr_b16 a[176:177], v115 offset:9376
 v_mfma_f32_16x16x32_bf16 v[100:103], a[156:159], a[220:223], v[100:103]
 s_waitcnt lgkmcnt(7)
 ds_read_b64_tr_b16 a[178:179], v115 offset:13984
 v_mfma_f32_16x16x32_bf16 v[164:167], a[160:163], a[204:207], v[164:167]
 ds_read_b64_tr_b16 a[180:181], v115 offset:9408
 v_mfma_f32_16x16x32_bf16 v[228:231], a[160:163], a[220:223], v[228:231]
 s_waitcnt lgkmcnt(7)
 ds_read_b64_tr_b16 a[182:183], v115 offset:14016
 v_mfma_f32_16x16x32_bf16 v[44:47], a[164:167], a[204:207], v[44:47]
 ds_read_b64_tr_b16 a[184:185], v115 offset:9440
 buffer_load_dwordx4 a[68:71], v14, s[4:7], s16 offen offset:1024 sc1
 v_mfma_f32_16x16x32_bf16 v[108:111], a[164:167], a[220:223], v[108:111]
 s_waitcnt lgkmcnt(7)
 ds_read_b64_tr_b16 a[186:187], v115 offset:14048
 v_cvt_pk_bf16_f32 v36, v36, v37
 v_mfma_f32_16x16x32_bf16 v[172:175], a[168:171], a[204:207], v[172:175]
 ds_read_b64_tr_b16 a[188:189], v115 offset:9472
 v_cvt_pk_bf16_f32 v37, v38, v39
 v_mfma_f32_16x16x32_bf16 v[236:239], a[168:171], a[220:223], v[236:239]
 s_waitcnt lgkmcnt(7)
 ds_read_b64_tr_b16 a[190:191], v115 offset:14080
 v_cvt_pk_bf16_f32 v38, v100, v101
 v_mfma_f32_16x16x32_bf16 v[52:55], a[172:175], a[204:207], v[52:55]
 ds_read_b64_tr_b16 a[128:129], v113 offset:0
 v_cvt_pk_bf16_f32 v39, v102, v103
 v_mfma_f32_16x16x32_bf16 v[116:119], a[172:175], a[220:223], v[116:119]
 s_waitcnt lgkmcnt(7)
 ds_read_b64_tr_b16 a[130:131], v113 offset:4608
 v_cvt_pk_bf16_f32 v164, v164, v165
 v_mfma_f32_16x16x32_bf16 v[180:183], a[176:179], a[204:207], v[180:183]
 ds_read_b64_tr_b16 a[132:133], v113 offset:32
 buffer_load_dwordx4 a[84:87], v14, s[4:7], s65 offen offset:1024 sc1
 v_mfma_f32_16x16x32_bf16 v[244:247], a[176:179], a[220:223], v[244:247]
 s_waitcnt lgkmcnt(7)
 ds_read_b64_tr_b16 a[134:135], v113 offset:4640
 v_cvt_pk_bf16_f32 v165, v166, v167
 v_mfma_f32_16x16x32_bf16 v[60:63], a[180:183], a[204:207], v[60:63]
 ds_read_b64_tr_b16 a[136:137], v113 offset:64
 buffer_store_dwordx4 v[36:39], v14, s[4:7], s19 offen sc1
 s_add_u32 s19, s19, 8192
 v_mfma_f32_16x16x32_bf16 v[124:127], a[180:183], a[220:223], v[124:127]
 s_waitcnt lgkmcnt(7)
 ds_read_b64_tr_b16 a[138:139], v113 offset:4672
 v_cvt_pk_bf16_f32 v166, v228, v229
 v_mfma_f32_16x16x32_bf16 v[188:191], a[184:187], a[204:207], v[188:191]
 ds_read_b64_tr_b16 a[140:141], v113 offset:96
 v_cvt_pk_bf16_f32 v167, v230, v231
 v_mfma_f32_16x16x32_bf16 v[252:255], a[184:187], a[220:223], v[252:255]
 s_waitcnt lgkmcnt(7)
 ds_read_b64_tr_b16 a[142:143], v113 offset:4704
 v_cvt_pk_bf16_f32 v44, v44, v45
 v_mfma_f32_16x16x32_bf16 v[192:195], a[188:191], a[204:207], v[192:195]
 ds_read_b64_tr_b16 a[144:145], v113 offset:128
 buffer_load_dwordx4 a[72:75], v14, s[4:7], s16 offen offset:2048 sc1
 v_mfma_f32_16x16x32_bf16 v[200:203], a[188:191], a[220:223], v[200:203]
 s_waitcnt lgkmcnt(7)
 ds_read_b64_tr_b16 a[146:147], v113 offset:4736
 v_cvt_pk_bf16_f32 v45, v46, v47
 v_mfma_f32_16x16x32_bf16 v[32:35], a[128:131], v[48:51], 0
 ds_read_b64_tr_b16 a[148:149], v113 offset:160
 v_cvt_pk_bf16_f32 v46, v108, v109
 v_mfma_f32_16x16x32_bf16 v[68:71], a[128:131], v[56:59], 0
 s_waitcnt lgkmcnt(7)
 ds_read_b64_tr_b16 a[150:151], v113 offset:4768
 v_cvt_pk_bf16_f32 v47, v110, v111
 v_mfma_f32_16x16x32_bf16 v[132:135], a[132:135], v[48:51], 0
 ds_read_b64_tr_b16 a[152:153], v113 offset:192
 v_cvt_pk_bf16_f32 v172, v172, v173
 v_mfma_f32_16x16x32_bf16 v[196:199], a[132:135], v[56:59], 0
 s_waitcnt lgkmcnt(7)
 ds_read_b64_tr_b16 a[154:155], v113 offset:4800
 v_cvt_pk_bf16_f32 v173, v174, v175
 v_mfma_f32_16x16x32_bf16 v[40:43], a[136:139], v[48:51], 0
 ds_read_b64_tr_b16 a[156:157], v113 offset:224
 buffer_load_dwordx4 a[88:91], v14, s[4:7], s65 offen offset:2048 sc1
 v_mfma_f32_16x16x32_bf16 v[76:79], a[136:139], v[56:59], 0
 s_waitcnt lgkmcnt(7)
 ds_read_b64_tr_b16 a[158:159], v113 offset:4832
 v_cvt_pk_bf16_f32 v174, v236, v237
 v_mfma_f32_16x16x32_bf16 v[140:143], a[140:143], v[48:51], 0
 ds_read_b64_tr_b16 a[160:161], v113 offset:256
 v_cvt_pk_bf16_f32 v175, v238, v239
 v_mfma_f32_16x16x32_bf16 v[204:207], a[140:143], v[56:59], 0
 s_waitcnt lgkmcnt(7)
 ds_read_b64_tr_b16 a[162:163], v113 offset:4864
 v_cvt_pk_bf16_f32 v52, v52, v53
 v_mfma_f32_16x16x32_bf16 v[208:211], a[144:147], v[48:51], 0
 ds_read_b64_tr_b16 a[164:165], v113 offset:9216
 buffer_store_dwordx4 v[164:167], v14, s[4:7], s19 offen sc1
 s_add_u32 s19, s19, 8192
 v_mfma_f32_16x16x32_bf16 v[216:219], a[144:147], v[56:59], 0
 s_waitcnt lgkmcnt(7)
 ds_read_b64_tr_b16 a[166:167], v113 offset:13824
 v_cvt_pk_bf16_f32 v53, v54, v55
 v_mfma_f32_16x16x32_bf16 v[224:227], a[148:151], v[48:51], 0
 ds_read_b64_tr_b16 a[168:169], v113 offset:9248
 buffer_load_dwordx4 a[76:79], v14, s[4:7], s16 offen offset:3072 sc1
 v_mfma_f32_16x16x32_bf16 v[232:235], a[148:151], v[56:59], 0
 s_waitcnt lgkmcnt(7)
 ds_read_b64_tr_b16 a[170:171], v113 offset:13856
 v_cvt_pk_bf16_f32 v54, v116, v117
 v_mfma_f32_16x16x32_bf16 v[240:243], a[152:155], v[48:51], 0
 ds_read_b64_tr_b16 a[172:173], v113 offset:9280
 v_cvt_pk_bf16_f32 v55, v118, v119
 v_mfma_f32_16x16x32_bf16 v[248:251], a[152:155], v[56:59], 0
 s_waitcnt lgkmcnt(7)
 ds_read_b64_tr_b16 a[174:175], v113 offset:13888
 v_cvt_pk_bf16_f32 v180, v180, v181
 v_mfma_f32_16x16x32_bf16 v[160:163], a[156:159], v[48:51], 0
 ds_read_b64_tr_b16 a[176:177], v113 offset:9312
 v_cvt_pk_bf16_f32 v181, v182, v183
 v_mfma_f32_16x16x32_bf16 v[168:171], a[156:159], v[56:59], 0
 s_waitcnt lgkmcnt(7)
 ds_read_b64_tr_b16 a[178:179], v113 offset:13920
 v_cvt_pk_bf16_f32 v182, v244, v245
 v_mfma_f32_16x16x32_bf16 v[176:179], a[160:163], v[48:51], 0
 ds_read_b64_tr_b16 a[180:181], v113 offset:9344
 buffer_load_dwordx4 a[92:95], v14, s[4:7], s65 offen offset:3072 sc1
 v_mfma_f32_16x16x32_bf16 v[184:187], a[160:163], v[56:59], 0
 s_waitcnt lgkmcnt(7)
 ds_read_b64_tr_b16 a[182:183], v113 offset:13952
 v_cvt_pk_bf16_f32 v183, v246, v247
 v_mfma_f32_16x16x32_bf16 v[32:35], a[164:167], v[84:87], v[32:35]
 ds_read_b64_tr_b16 a[184:185], v113 offset:9376
 v_cvt_pk_bf16_f32 v60, v60, v61
 v_mfma_f32_16x16x32_bf16 v[68:71], a[164:167], v[92:95], v[68:71]
 s_waitcnt lgkmcnt(7)
 ds_read_b64_tr_b16 a[186:187], v113 offset:13984
 v_cvt_pk_bf16_f32 v61, v62, v63
 v_mfma_f32_16x16x32_bf16 v[132:135], a[168:171], v[84:87], v[132:135]
 ds_read_b64_tr_b16 a[188:189], v113 offset:9408
 v_cvt_pk_bf16_f32 v62, v124, v125
 v_mfma_f32_16x16x32_bf16 v[196:199], a[168:171], v[92:95], v[196:199]
 s_waitcnt lgkmcnt(7)
 ds_read_b64_tr_b16 a[190:191], v113 offset:14016
 v_cvt_pk_bf16_f32 v63, v126, v127
 v_mfma_f32_16x16x32_bf16 v[40:43], a[172:175], v[84:87], v[40:43]
 ds_read_b64_tr_b16 a[128:129], v113 offset:9440
 s_lshl_b32 s94, s63, 1
 s_sub_u32 s94, 15, s94
 s_lshl_b32 s94, s94, 15
 s_add_u32 s17, s17, s94
 s_add_u32 s65, s17, 4096
 buffer_load_dwordx4 a[96:99], v14, s[4:7], s17 offen offset:0 sc1
 v_mfma_f32_16x16x32_bf16 v[76:79], a[172:175], v[92:95], v[76:79]
 s_waitcnt lgkmcnt(7)
 ds_read_b64_tr_b16 a[130:131], v113 offset:14048
 v_cvt_pk_bf16_f32 v188, v188, v189
 v_mfma_f32_16x16x32_bf16 v[140:143], a[176:179], v[84:87], v[140:143]
 ds_read_b64_tr_b16 a[132:133], v113 offset:9472
 buffer_store_dwordx4 v[44:47], v14, s[4:7], s19 offen sc1
 s_add_u32 s19, s19, 8192
 v_mfma_f32_16x16x32_bf16 v[204:207], a[176:179], v[92:95], v[204:207]
 s_waitcnt lgkmcnt(7)
 ds_read_b64_tr_b16 a[134:135], v113 offset:14080
 v_cvt_pk_bf16_f32 v189, v190, v191
 v_mfma_f32_16x16x32_bf16 v[208:211], a[180:183], v[84:87], v[208:211]
 ds_read_b64_tr_b16 a[136:137], v113 offset:18432
 v_cvt_pk_bf16_f32 v190, v252, v253
 v_mfma_f32_16x16x32_bf16 v[216:219], a[180:183], v[92:95], v[216:219]
 s_waitcnt lgkmcnt(7)
 ds_read_b64_tr_b16 a[138:139], v113 offset:23040
 v_cvt_pk_bf16_f32 v191, v254, v255
 v_mfma_f32_16x16x32_bf16 v[224:227], a[184:187], v[84:87], v[224:227]
 ds_read_b64_tr_b16 a[140:141], v113 offset:18464
 buffer_load_dwordx4 a[112:115], v14, s[4:7], s65 offen offset:0 sc1
 v_mfma_f32_16x16x32_bf16 v[232:235], a[184:187], v[92:95], v[232:235]
 s_waitcnt lgkmcnt(7)
 ds_read_b64_tr_b16 a[142:143], v113 offset:23072
 v_cvt_pk_bf16_f32 v192, v192, v193
 v_mfma_f32_16x16x32_bf16 v[240:243], a[188:191], v[84:87], v[240:243]
 ds_read_b64_tr_b16 a[144:145], v113 offset:18496
 v_cvt_pk_bf16_f32 v193, v194, v195
 v_mfma_f32_16x16x32_bf16 v[248:251], a[188:191], v[92:95], v[248:251]
 s_waitcnt lgkmcnt(7)
 ds_read_b64_tr_b16 a[146:147], v113 offset:23104
 v_cvt_pk_bf16_f32 v194, v200, v201
 v_mfma_f32_16x16x32_bf16 v[160:163], a[128:131], v[84:87], v[160:163]
 ds_read_b64_tr_b16 a[148:149], v113 offset:18528
 v_cvt_pk_bf16_f32 v195, v202, v203
 v_mfma_f32_16x16x32_bf16 v[168:171], a[128:131], v[92:95], v[168:171]
 s_waitcnt lgkmcnt(7)
 ds_read_b64_tr_b16 a[150:151], v113 offset:23136
 v_mfma_f32_16x16x32_bf16 v[176:179], a[132:135], v[84:87], v[176:179]
 ds_read_b64_tr_b16 a[152:153], v113 offset:18560
 buffer_load_dwordx4 a[100:103], v14, s[4:7], s17 offen offset:1024 sc1
 v_mfma_f32_16x16x32_bf16 v[184:187], a[132:135], v[92:95], v[184:187]
 s_waitcnt lgkmcnt(7)
 ds_read_b64_tr_b16 a[154:155], v113 offset:23168
 v_mfma_f32_16x16x32_bf16 v[32:35], a[136:139], v[148:151], v[32:35]
 ds_read_b64_tr_b16 a[156:157], v113 offset:18592
 v_mfma_f32_16x16x32_bf16 v[68:71], a[136:139], v[156:159], v[68:71]
 s_waitcnt lgkmcnt(7)
 ds_read_b64_tr_b16 a[158:159], v113 offset:23200
 v_mfma_f32_16x16x32_bf16 v[132:135], a[140:143], v[148:151], v[132:135]
 ds_read_b64_tr_b16 a[160:161], v113 offset:18624
 v_mfma_f32_16x16x32_bf16 v[196:199], a[140:143], v[156:159], v[196:199]
 s_waitcnt lgkmcnt(7)
 ds_read_b64_tr_b16 a[162:163], v113 offset:23232
 v_mfma_f32_16x16x32_bf16 v[40:43], a[144:147], v[148:151], v[40:43]
 ds_read_b64_tr_b16 a[164:165], v113 offset:18656
 buffer_load_dwordx4 a[116:119], v14, s[4:7], s65 offen offset:1024 sc1
 v_mfma_f32_16x16x32_bf16 v[76:79], a[144:147], v[156:159], v[76:79]
 s_waitcnt lgkmcnt(7)
 ds_read_b64_tr_b16 a[166:167], v113 offset:23264
 v_mfma_f32_16x16x32_bf16 v[140:143], a[148:151], v[148:151], v[140:143]
 ds_read_b64_tr_b16 a[168:169], v113 offset:18688
 buffer_store_dwordx4 v[172:175], v14, s[4:7], s19 offen sc1
 s_add_u32 s19, s19, 8192
 v_mfma_f32_16x16x32_bf16 v[204:207], a[148:151], v[156:159], v[204:207]
 s_waitcnt lgkmcnt(7)
 ds_read_b64_tr_b16 a[170:171], v113 offset:23296
 v_mfma_f32_16x16x32_bf16 v[208:211], a[152:155], v[148:151], v[208:211]
 ds_read_b64_tr_b16 a[172:173], v113 offset:27648
 v_mfma_f32_16x16x32_bf16 v[216:219], a[152:155], v[156:159], v[216:219]
 s_waitcnt lgkmcnt(7)
 ds_read_b64_tr_b16 a[174:175], v113 offset:32256
 v_mfma_f32_16x16x32_bf16 v[224:227], a[156:159], v[148:151], v[224:227]
 ds_read_b64_tr_b16 a[176:177], v113 offset:27680
 buffer_load_dwordx4 a[104:107], v14, s[4:7], s17 offen offset:2048 sc1
 v_mfma_f32_16x16x32_bf16 v[232:235], a[156:159], v[156:159], v[232:235]
 s_waitcnt lgkmcnt(7)
 ds_read_b64_tr_b16 a[178:179], v113 offset:32288
 v_mfma_f32_16x16x32_bf16 v[240:243], a[160:163], v[148:151], v[240:243]
 ds_read_b64_tr_b16 a[180:181], v113 offset:27712
 v_mfma_f32_16x16x32_bf16 v[248:251], a[160:163], v[156:159], v[248:251]
 s_waitcnt lgkmcnt(7)
 ds_read_b64_tr_b16 a[182:183], v113 offset:32320
 v_mfma_f32_16x16x32_bf16 v[160:163], a[164:167], v[148:151], v[160:163]
 ds_read_b64_tr_b16 a[184:185], v113 offset:27744
 v_mfma_f32_16x16x32_bf16 v[168:171], a[164:167], v[156:159], v[168:171]
 s_waitcnt lgkmcnt(7)
 ds_read_b64_tr_b16 a[186:187], v113 offset:32352
 v_mfma_f32_16x16x32_bf16 v[176:179], a[168:171], v[148:151], v[176:179]
 ds_read_b64_tr_b16 a[188:189], v113 offset:27776
 buffer_load_dwordx4 a[120:123], v14, s[4:7], s65 offen offset:2048 sc1
 v_mfma_f32_16x16x32_bf16 v[184:187], a[168:171], v[156:159], v[184:187]
 s_waitcnt lgkmcnt(7)
 ds_read_b64_tr_b16 a[190:191], v113 offset:32384
 v_mfma_f32_16x16x32_bf16 v[32:35], a[172:175], v[212:215], v[32:35]
 ds_read_b64_tr_b16 a[128:129], v113 offset:27808
 v_mfma_f32_16x16x32_bf16 v[68:71], a[172:175], v[220:223], v[68:71]
 s_waitcnt lgkmcnt(7)
 ds_read_b64_tr_b16 a[130:131], v113 offset:32416
 v_mfma_f32_16x16x32_bf16 v[132:135], a[176:179], v[212:215], v[132:135]
 ds_read_b64_tr_b16 a[132:133], v113 offset:27840
 buffer_store_dwordx4 v[52:55], v14, s[4:7], s19 offen sc1
 s_add_u32 s19, s19, 8192
 v_mfma_f32_16x16x32_bf16 v[196:199], a[176:179], v[220:223], v[196:199]
 s_waitcnt lgkmcnt(7)
 ds_read_b64_tr_b16 a[134:135], v113 offset:32448
 v_mfma_f32_16x16x32_bf16 v[40:43], a[180:183], v[212:215], v[40:43]
 ds_read_b64_tr_b16 a[136:137], v113 offset:27872
 buffer_load_dwordx4 a[108:111], v14, s[4:7], s17 offen offset:3072 sc1
 v_mfma_f32_16x16x32_bf16 v[76:79], a[180:183], v[220:223], v[76:79]
 s_waitcnt lgkmcnt(7)
 ds_read_b64_tr_b16 a[138:139], v113 offset:32480
 v_mfma_f32_16x16x32_bf16 v[140:143], a[184:187], v[212:215], v[140:143]
 ds_read_b64_tr_b16 a[140:141], v113 offset:27904
 v_mfma_f32_16x16x32_bf16 v[204:207], a[184:187], v[220:223], v[204:207]
 s_waitcnt lgkmcnt(7)
 ds_read_b64_tr_b16 a[142:143], v113 offset:32512
 v_mfma_f32_16x16x32_bf16 v[208:211], a[188:191], v[212:215], v[208:211]
 ds_read_b64_tr_b16 a[144:145], v113 offset:36864
 v_mfma_f32_16x16x32_bf16 v[216:219], a[188:191], v[220:223], v[216:219]
 s_waitcnt lgkmcnt(7)
 ds_read_b64_tr_b16 a[146:147], v113 offset:41472
 v_mfma_f32_16x16x32_bf16 v[224:227], a[128:131], v[212:215], v[224:227]
 ds_read_b64_tr_b16 a[148:149], v113 offset:36896
 buffer_load_dwordx4 a[124:127], v14, s[4:7], s65 offen offset:3072 sc1
 v_mfma_f32_16x16x32_bf16 v[232:235], a[128:131], v[220:223], v[232:235]
 s_waitcnt lgkmcnt(7)
 ds_read_b64_tr_b16 a[150:151], v113 offset:41504
 v_mfma_f32_16x16x32_bf16 v[240:243], a[132:135], v[212:215], v[240:243]
 ds_read_b64_tr_b16 a[152:153], v113 offset:36928
 v_mfma_f32_16x16x32_bf16 v[248:251], a[132:135], v[220:223], v[248:251]
 s_waitcnt lgkmcnt(7)
 ds_read_b64_tr_b16 a[154:155], v113 offset:41536
 v_mfma_f32_16x16x32_bf16 v[160:163], a[136:139], v[212:215], v[160:163]
 ds_read_b64_tr_b16 a[156:157], v113 offset:36960
 v_mfma_f32_16x16x32_bf16 v[168:171], a[136:139], v[220:223], v[168:171]
 s_waitcnt lgkmcnt(7)
 ds_read_b64_tr_b16 a[158:159], v113 offset:41568
 v_mfma_f32_16x16x32_bf16 v[176:179], a[140:143], v[212:215], v[176:179]
 ds_read_b64_tr_b16 a[160:161], v113 offset:36992
 s_lshl_b32 s94, s63, 1
 s_sub_u32 s94, 15, s94
 s_lshl_b32 s94, s94, 15
 s_add_u32 s18, s18, s94
 s_add_u32 s65, s18, 4096
 buffer_load_dwordx4 a[224:227], v14, s[4:7], s18 offen offset:0 sc1
 v_mfma_f32_16x16x32_bf16 v[184:187], a[140:143], v[220:223], v[184:187]
 s_waitcnt vmcnt(21) lgkmcnt(7)
 ds_read_b64_tr_b16 a[162:163], v113 offset:41600
 v_mfma_f32_16x16x32_bf16 v[32:35], a[144:147], a[64:67], v[32:35]
 s_waitcnt vmcnt(20)
 ds_read_b64_tr_b16 a[164:165], v113 offset:37024
 buffer_store_dwordx4 v[180:183], v14, s[4:7], s19 offen sc1
 s_add_u32 s19, s19, 8192
 v_mfma_f32_16x16x32_bf16 v[68:71], a[144:147], a[80:83], v[68:71]
 s_waitcnt lgkmcnt(7)
 ds_read_b64_tr_b16 a[166:167], v113 offset:41632
 v_mfma_f32_16x16x32_bf16 v[132:135], a[148:151], a[64:67], v[132:135]
 ds_read_b64_tr_b16 a[168:169], v113 offset:37056
 v_mfma_f32_16x16x32_bf16 v[196:199], a[148:151], a[80:83], v[196:199]
 s_waitcnt lgkmcnt(7)
 ds_read_b64_tr_b16 a[170:171], v113 offset:41664
 v_mfma_f32_16x16x32_bf16 v[40:43], a[152:155], a[64:67], v[40:43]
 ds_read_b64_tr_b16 a[172:173], v113 offset:37088
 buffer_load_dwordx4 a[240:243], v14, s[4:7], s65 offen offset:0 sc1
 v_mfma_f32_16x16x32_bf16 v[76:79], a[152:155], a[80:83], v[76:79]
 s_waitcnt lgkmcnt(7)
 ds_read_b64_tr_b16 a[174:175], v113 offset:41696
 v_mfma_f32_16x16x32_bf16 v[140:143], a[156:159], a[64:67], v[140:143]
 ds_read_b64_tr_b16 a[176:177], v113 offset:37120
 v_mfma_f32_16x16x32_bf16 v[204:207], a[156:159], a[80:83], v[204:207]
 s_waitcnt lgkmcnt(7)
 ds_read_b64_tr_b16 a[178:179], v113 offset:41728
 v_mfma_f32_16x16x32_bf16 v[208:211], a[160:163], a[64:67], v[208:211]
 ds_read_b64_tr_b16 a[180:181], v113 offset:46080
 v_mfma_f32_16x16x32_bf16 v[216:219], a[160:163], a[80:83], v[216:219]
 s_waitcnt lgkmcnt(7)
 ds_read_b64_tr_b16 a[182:183], v113 offset:50688
 v_mfma_f32_16x16x32_bf16 v[224:227], a[164:167], a[64:67], v[224:227]
 ds_read_b64_tr_b16 a[184:185], v113 offset:46112
 buffer_load_dwordx4 a[228:231], v14, s[4:7], s18 offen offset:1024 sc1
 v_mfma_f32_16x16x32_bf16 v[232:235], a[164:167], a[80:83], v[232:235]
 s_waitcnt lgkmcnt(7)
 ds_read_b64_tr_b16 a[186:187], v113 offset:50720
 v_mfma_f32_16x16x32_bf16 v[240:243], a[168:171], a[64:67], v[240:243]
 ds_read_b64_tr_b16 a[188:189], v113 offset:46144
 v_mfma_f32_16x16x32_bf16 v[248:251], a[168:171], a[80:83], v[248:251]
 s_waitcnt lgkmcnt(7)
 ds_read_b64_tr_b16 a[190:191], v113 offset:50752
 v_mfma_f32_16x16x32_bf16 v[160:163], a[172:175], a[64:67], v[160:163]
 ds_read_b64_tr_b16 a[128:129], v113 offset:46176
 v_mfma_f32_16x16x32_bf16 v[168:171], a[172:175], a[80:83], v[168:171]
 s_waitcnt lgkmcnt(7)
 ds_read_b64_tr_b16 a[130:131], v113 offset:50784
 v_mfma_f32_16x16x32_bf16 v[176:179], a[176:179], a[64:67], v[176:179]
 ds_read_b64_tr_b16 a[132:133], v113 offset:46208
 buffer_load_dwordx4 a[244:247], v14, s[4:7], s65 offen offset:1024 sc1
 v_mfma_f32_16x16x32_bf16 v[184:187], a[176:179], a[80:83], v[184:187]
 s_waitcnt vmcnt(23) lgkmcnt(7)
 ds_read_b64_tr_b16 a[134:135], v113 offset:50816
 v_mfma_f32_16x16x32_bf16 v[32:35], a[180:183], a[68:71], v[32:35]
 s_waitcnt vmcnt(22)
 ds_read_b64_tr_b16 a[136:137], v113 offset:46240
 buffer_store_dwordx4 v[60:63], v14, s[4:7], s19 offen sc1
 s_add_u32 s19, s19, 8192
 v_mfma_f32_16x16x32_bf16 v[68:71], a[180:183], a[84:87], v[68:71]
 s_waitcnt lgkmcnt(7)
 ds_read_b64_tr_b16 a[138:139], v113 offset:50848
 v_mfma_f32_16x16x32_bf16 v[132:135], a[184:187], a[68:71], v[132:135]
 ds_read_b64_tr_b16 a[140:141], v113 offset:46272
 v_mfma_f32_16x16x32_bf16 v[196:199], a[184:187], a[84:87], v[196:199]
 s_waitcnt lgkmcnt(7)
 ds_read_b64_tr_b16 a[142:143], v113 offset:50880
 v_mfma_f32_16x16x32_bf16 v[40:43], a[188:191], a[68:71], v[40:43]
 ds_read_b64_tr_b16 a[144:145], v113 offset:46304
 buffer_load_dwordx4 a[232:235], v14, s[4:7], s18 offen offset:2048 sc1
 v_mfma_f32_16x16x32_bf16 v[76:79], a[188:191], a[84:87], v[76:79]
 s_waitcnt lgkmcnt(7)
 ds_read_b64_tr_b16 a[146:147], v113 offset:50912
 v_mfma_f32_16x16x32_bf16 v[140:143], a[128:131], a[68:71], v[140:143]
 ds_read_b64_tr_b16 a[148:149], v113 offset:46336
 v_mfma_f32_16x16x32_bf16 v[204:207], a[128:131], a[84:87], v[204:207]
 s_waitcnt lgkmcnt(7)
 ds_read_b64_tr_b16 a[150:151], v113 offset:50944
 v_mfma_f32_16x16x32_bf16 v[208:211], a[132:135], a[68:71], v[208:211]
 ds_read_b64_tr_b16 a[152:153], v113 offset:55296
 v_mfma_f32_16x16x32_bf16 v[216:219], a[132:135], a[84:87], v[216:219]
 s_waitcnt lgkmcnt(7)
 ds_read_b64_tr_b16 a[154:155], v113 offset:59904
 v_mfma_f32_16x16x32_bf16 v[224:227], a[136:139], a[68:71], v[224:227]
 ds_read_b64_tr_b16 a[156:157], v113 offset:55328
 buffer_load_dwordx4 a[248:251], v14, s[4:7], s65 offen offset:2048 sc1
 v_mfma_f32_16x16x32_bf16 v[232:235], a[136:139], a[84:87], v[232:235]
 s_waitcnt lgkmcnt(7)
 ds_read_b64_tr_b16 a[158:159], v113 offset:59936
 v_mfma_f32_16x16x32_bf16 v[240:243], a[140:143], a[68:71], v[240:243]
 ds_read_b64_tr_b16 a[160:161], v113 offset:55360
 v_mfma_f32_16x16x32_bf16 v[248:251], a[140:143], a[84:87], v[248:251]
 s_waitcnt lgkmcnt(7)
 ds_read_b64_tr_b16 a[162:163], v113 offset:59968
 v_mfma_f32_16x16x32_bf16 v[160:163], a[144:147], a[68:71], v[160:163]
 ds_read_b64_tr_b16 a[164:165], v113 offset:55392
 buffer_store_dwordx4 v[188:191], v14, s[4:7], s19 offen sc1
 s_add_u32 s19, s19, 8192
 v_mfma_f32_16x16x32_bf16 v[168:171], a[144:147], a[84:87], v[168:171]
 s_waitcnt lgkmcnt(7)
 ds_read_b64_tr_b16 a[166:167], v113 offset:60000
 v_mfma_f32_16x16x32_bf16 v[176:179], a[148:151], a[68:71], v[176:179]
 ds_read_b64_tr_b16 a[168:169], v113 offset:55424
 buffer_load_dwordx4 a[236:239], v14, s[4:7], s18 offen offset:3072 sc1
 v_mfma_f32_16x16x32_bf16 v[184:187], a[148:151], a[84:87], v[184:187]
 s_waitcnt vmcnt(25) lgkmcnt(7)
 ds_read_b64_tr_b16 a[170:171], v113 offset:60032
 v_mfma_f32_16x16x32_bf16 v[32:35], a[152:155], a[72:75], v[32:35]
 s_waitcnt vmcnt(24)
 ds_read_b64_tr_b16 a[172:173], v113 offset:55456
 v_mfma_f32_16x16x32_bf16 v[68:71], a[152:155], a[88:91], v[68:71]
 s_waitcnt lgkmcnt(7)
 ds_read_b64_tr_b16 a[174:175], v113 offset:60064
 v_mfma_f32_16x16x32_bf16 v[132:135], a[156:159], a[72:75], v[132:135]
 ds_read_b64_tr_b16 a[176:177], v113 offset:55488
 v_mfma_f32_16x16x32_bf16 v[196:199], a[156:159], a[88:91], v[196:199]
 s_waitcnt lgkmcnt(7)
 ds_read_b64_tr_b16 a[178:179], v113 offset:60096
 v_mfma_f32_16x16x32_bf16 v[40:43], a[160:163], a[72:75], v[40:43]
 ds_read_b64_tr_b16 a[180:181], v113 offset:55520
 buffer_load_dwordx4 a[252:255], v14, s[4:7], s65 offen offset:3072 sc1
 v_mfma_f32_16x16x32_bf16 v[76:79], a[160:163], a[88:91], v[76:79]
 s_waitcnt lgkmcnt(7)
 ds_read_b64_tr_b16 a[182:183], v113 offset:60128
 v_mfma_f32_16x16x32_bf16 v[140:143], a[164:167], a[72:75], v[140:143]
 ds_read_b64_tr_b16 a[184:185], v113 offset:55552
 v_mfma_f32_16x16x32_bf16 v[204:207], a[164:167], a[88:91], v[204:207]
 s_waitcnt lgkmcnt(7)
 ds_read_b64_tr_b16 a[186:187], v113 offset:60160
 v_mfma_f32_16x16x32_bf16 v[208:211], a[168:171], a[72:75], v[208:211]
 ds_read_b64_tr_b16 a[188:189], v114 offset:0
 v_mfma_f32_16x16x32_bf16 v[216:219], a[168:171], a[88:91], v[216:219]
 s_waitcnt lgkmcnt(7)
 ds_read_b64_tr_b16 a[190:191], v114 offset:4608
 v_mfma_f32_16x16x32_bf16 v[224:227], a[172:175], a[72:75], v[224:227]
 ds_read_b64_tr_b16 a[128:129], v114 offset:32
 v_mfma_f32_16x16x32_bf16 v[232:235], a[172:175], a[88:91], v[232:235]
 s_waitcnt lgkmcnt(7)
 ds_read_b64_tr_b16 a[130:131], v114 offset:4640
 v_mfma_f32_16x16x32_bf16 v[240:243], a[176:179], a[72:75], v[240:243]
 ds_read_b64_tr_b16 a[132:133], v114 offset:64
 buffer_store_dwordx4 v[192:195], v14, s[4:7], s19 offen sc1
 s_add_u32 s19, s19, 8192
 v_mfma_f32_16x16x32_bf16 v[248:251], a[176:179], a[88:91], v[248:251]
 s_waitcnt lgkmcnt(7)
 ds_read_b64_tr_b16 a[134:135], v114 offset:4672
 v_mfma_f32_16x16x32_bf16 v[160:163], a[180:183], a[72:75], v[160:163]
 ds_read_b64_tr_b16 a[136:137], v114 offset:96
 v_mfma_f32_16x16x32_bf16 v[168:171], a[180:183], a[88:91], v[168:171]
 s_waitcnt lgkmcnt(7)
 ds_read_b64_tr_b16 a[138:139], v114 offset:4704
 v_mfma_f32_16x16x32_bf16 v[176:179], a[184:187], a[72:75], v[176:179]
 ds_read_b64_tr_b16 a[140:141], v114 offset:128
 v_mfma_f32_16x16x32_bf16 v[184:187], a[184:187], a[88:91], v[184:187]
 s_waitcnt vmcnt(24) lgkmcnt(7)
 ds_read_b64_tr_b16 a[142:143], v114 offset:4736
 v_mfma_f32_16x16x32_bf16 v[32:35], a[188:191], a[76:79], v[32:35]
 s_waitcnt vmcnt(23)
 ds_read_b64_tr_b16 a[144:145], v114 offset:160
 v_mfma_f32_16x16x32_bf16 v[68:71], a[188:191], a[92:95], v[68:71]
 s_waitcnt lgkmcnt(7)
 ds_read_b64_tr_b16 a[146:147], v114 offset:4768
 v_mfma_f32_16x16x32_bf16 v[132:135], a[128:131], a[76:79], v[132:135]
 ds_read_b64_tr_b16 a[148:149], v114 offset:192
 v_mfma_f32_16x16x32_bf16 v[196:199], a[128:131], a[92:95], v[196:199]
 s_waitcnt lgkmcnt(7)
 ds_read_b64_tr_b16 a[150:151], v114 offset:4800
 v_mfma_f32_16x16x32_bf16 v[40:43], a[132:135], a[76:79], v[40:43]
 ds_read_b64_tr_b16 a[152:153], v114 offset:224
 v_mfma_f32_16x16x32_bf16 v[76:79], a[132:135], a[92:95], v[76:79]
 s_waitcnt lgkmcnt(7)
 ds_read_b64_tr_b16 a[154:155], v114 offset:4832
 s_movk_i32 s84, 0x4800
 v_mfma_f32_16x16x32_bf16 v[140:143], a[136:139], a[76:79], v[140:143]
 ds_read_b64_tr_b16 a[156:157], v114 offset:256
 v_bfe_u32 v64, v14, 4, 4
 s_mov_b32 s94, s63
 s_lshl_b32 s94, s94, 2
 s_lshr_b32 s95, s61, 1
 s_add_u32 s94, s94, s95
 s_lshl_b32 s94, s94, 5
 v_add_u32 v8, s94, v64
 v_lshlrev_b32 v64, 2, v8
 v_add_u32 v64, 71303168, v64
 v_mfma_f32_16x16x32_bf16 v[204:207], a[136:139], a[92:95], v[204:207]
 s_waitcnt lgkmcnt(7)
 ds_read_b64_tr_b16 a[158:159], v114 offset:4864
 buffer_load_dword v0, v64, s[4:7], 0 offen sc1
 v_mfma_f32_16x16x32_bf16 v[208:211], a[140:143], a[76:79], v[208:211]
 ds_read_b64_tr_b16 a[160:161], v114 offset:9216
 v_mfma_f32_16x16x32_bf16 v[216:219], a[140:143], a[92:95], v[216:219]
 s_waitcnt lgkmcnt(7)
 ds_read_b64_tr_b16 a[162:163], v114 offset:13824
 v_mfma_f32_16x16x32_bf16 v[224:227], a[144:147], a[76:79], v[224:227]
 ds_read_b64_tr_b16 a[164:165], v114 offset:18432
 buffer_load_dword v1, v64, s[4:7], 0 offen offset:64 sc1
 v_mfma_f32_16x16x32_bf16 v[232:235], a[144:147], a[92:95], v[232:235]
 s_waitcnt lgkmcnt(7)
 ds_read_b64_tr_b16 a[166:167], v114 offset:23040
 v_mfma_f32_16x16x32_bf16 v[240:243], a[148:151], a[76:79], v[240:243]
 ds_read_b64_tr_b16 a[168:169], v114 offset:27648
 v_mfma_f32_16x16x32_bf16 v[248:251], a[148:151], a[92:95], v[248:251]
 s_waitcnt lgkmcnt(7)
 ds_read_b64_tr_b16 a[170:171], v114 offset:32256
 v_mul_u32_u24 v64, 0x480, v8
 v_lshrrev_b32 v65, 8, v14
 v_mfma_f32_16x16x32_bf16 v[160:163], a[152:155], a[76:79], v[160:163]
 ds_read_b64_tr_b16 a[172:173], v114 offset:36864
 v_lshl_add_u32 v64, v65, 3, v64
 s_mul_i32 s94, s62, 288
 v_add_u32 v64, s94, v64
 s_and_b32 s95, s61, 1
 s_mul_i32 s94, s95, 5
 s_add_u32 s94, s94, s60
 s_lshl_b32 s94, s94, 5
 v_add_u32 v4, s94, v64
 v_mfma_f32_16x16x32_bf16 v[168:171], a[152:155], a[92:95], v[168:171]
 s_waitcnt lgkmcnt(7)
 ds_read_b64_tr_b16 a[174:175], v114 offset:41472
 buffer_load_dwordx2 v[120:121], v4, s[8:11], 0 offen
 v_mfma_f32_16x16x32_bf16 v[176:179], a[156:159], a[76:79], v[176:179]
 ds_read_b64_tr_b16 a[176:177], v114 offset:46080
 v_mfma_f32_16x16x32_bf16 v[184:187], a[156:159], a[92:95], v[184:187]
 s_waitcnt vmcnt(25) lgkmcnt(7)
 ds_read_b64_tr_b16 a[178:179], v114 offset:50688
 v_mfma_f32_16x16x32_bf16 v[32:35], a[160:163], a[96:99], v[32:35]
 s_waitcnt vmcnt(23)
 ds_read_b64_tr_b16 a[180:181], v114 offset:55296
 buffer_load_dwordx2 v[122:123], v4, s[8:11], s84 offen
 v_mfma_f32_16x16x32_bf16 v[68:71], a[160:163], a[112:115], v[68:71]
 s_waitcnt vmcnt(23) lgkmcnt(7)
 ds_read_b64_tr_b16 a[182:183], v114 offset:59904
 v_mfma_f32_16x16x32_bf16 v[32:35], a[164:167], a[100:103], v[32:35]
 s_waitcnt vmcnt(22)
 ds_read_b64_tr_b16 a[184:185], v115 offset:0
 s_and_b32 s95, s61, 1
 s_mul_i32 s94, s95, 5
 s_add_u32 s94, s94, 4
 s_lshl_b32 s94, s94, 5
 s_and_b32 s95, s61, 1
 s_xor_b32 s95, s95, 0
 s_or_b32 s95, s95, s60
 s_cmp_eq_u32 s95, 0
 s_cselect_b32 s94, s94, 0x40000000
 v_add_u32 v5, s94, v64
 v_mfma_f32_16x16x32_bf16 v[68:71], a[164:167], a[116:119], v[68:71]
 s_waitcnt vmcnt(20) lgkmcnt(7)
 ds_read_b64_tr_b16 a[186:187], v115 offset:4608
 buffer_load_dwordx2 v[128:129], v5, s[8:11], 0 offen
 v_mfma_f32_16x16x32_bf16 v[32:35], a[168:171], a[104:107], v[32:35]
 s_waitcnt vmcnt(20)
 ds_read_b64_tr_b16 a[188:189], v115 offset:9216
 v_mfma_f32_16x16x32_bf16 v[68:71], a[168:171], a[120:123], v[68:71]
 s_waitcnt vmcnt(18) lgkmcnt(7)
 ds_read_b64_tr_b16 a[190:191], v115 offset:13824
 v_mfma_f32_16x16x32_bf16 v[32:35], a[172:175], a[108:111], v[32:35]
 s_waitcnt vmcnt(17)
 ds_read_b64_tr_b16 a[128:129], v114 offset:9248
 buffer_load_dwordx2 v[130:131], v5, s[8:11], s84 offen
 v_mfma_f32_16x16x32_bf16 v[68:71], a[172:175], a[124:127], v[68:71]
 s_waitcnt vmcnt(17) lgkmcnt(7)
 ds_read_b64_tr_b16 a[130:131], v114 offset:13856
 v_mfma_f32_16x16x32_bf16 v[32:35], a[176:179], a[224:227], v[32:35]
 s_waitcnt vmcnt(15)
 ds_read_b64_tr_b16 a[132:133], v114 offset:18464
 v_mfma_f32_16x16x32_bf16 v[68:71], a[176:179], a[240:243], v[68:71]
 s_waitcnt vmcnt(14) lgkmcnt(7)
 ds_read_b64_tr_b16 a[134:135], v114 offset:23072
 v_bfe_u32 v64, v14, 4, 4
 s_sub_u32 s94, 15, s63
 s_lshl_b32 s94, s94, 2
 s_lshr_b32 s95, s61, 1
 s_add_u32 s94, s94, s95
 s_lshl_b32 s94, s94, 5
 v_add_u32 v9, s94, v64
 v_lshlrev_b32 v64, 2, v9
 v_add_u32 v64, 71303168, v64
 v_mfma_f32_16x16x32_bf16 v[32:35], a[180:183], a[228:231], v[32:35]
 s_waitcnt vmcnt(13)
 ds_read_b64_tr_b16 a[136:137], v114 offset:27680
 buffer_load_dword v2, v64, s[4:7], 0 offen sc1
 v_mfma_f32_16x16x32_bf16 v[68:71], a[180:183], a[244:247], v[68:71]
 s_waitcnt vmcnt(12) lgkmcnt(7)
 ds_read_b64_tr_b16 a[138:139], v114 offset:32288
 v_mfma_f32_16x16x32_bf16 v[32:35], a[184:187], a[232:235], v[32:35]
 s_waitcnt vmcnt(11)
 ds_read_b64_tr_b16 a[140:141], v114 offset:36896
 v_mfma_f32_16x16x32_bf16 v[68:71], a[184:187], a[248:251], v[68:71]
 s_waitcnt vmcnt(9) lgkmcnt(7)
 ds_read_b64_tr_b16 a[142:143], v114 offset:41504
 buffer_load_dword v3, v64, s[4:7], 0 offen offset:64 sc1
 v_mfma_f32_16x16x32_bf16 v[32:35], a[188:191], a[236:239], v[32:35]
 s_waitcnt vmcnt(9)
 ds_read_b64_tr_b16 a[144:145], v114 offset:46112
 v_mfma_f32_16x16x32_bf16 v[68:71], a[188:191], a[252:255], v[68:71]
 s_waitcnt lgkmcnt(7)
 ds_read_b64_tr_b16 a[146:147], v114 offset:50720
 v_mfma_f32_16x16x32_bf16 v[132:135], a[128:131], a[96:99], v[132:135]
 ds_read_b64_tr_b16 a[148:149], v114 offset:55328
 v_mul_u32_u24 v64, 0x480, v9
 v_lshrrev_b32 v65, 8, v14
 v_mfma_f32_16x16x32_bf16 v[196:199], a[128:131], a[112:115], v[196:199]
 s_waitcnt lgkmcnt(7)
 ds_read_b64_tr_b16 a[150:151], v114 offset:59936
 v_lshl_add_u32 v64, v65, 3, v64
 s_mul_i32 s94, s62, 288
 v_add_u32 v64, s94, v64
 s_and_b32 s95, s61, 1
 s_mul_i32 s94, s95, 4
 s_add_u32 s94, s94, s60
 s_lshl_b32 s94, s94, 5
 v_add_u32 v6, s94, v64
 v_mfma_f32_16x16x32_bf16 v[132:135], a[132:135], a[100:103], v[132:135]
 ds_read_b64_tr_b16 a[152:153], v115 offset:32
 buffer_load_dwordx2 v[136:137], v6, s[8:11], 0 offen
 v_mfma_f32_16x16x32_bf16 v[196:199], a[132:135], a[116:119], v[196:199]
 s_waitcnt lgkmcnt(7)
 ds_read_b64_tr_b16 a[154:155], v115 offset:4640
 v_mfma_f32_16x16x32_bf16 v[132:135], a[136:139], a[104:107], v[132:135]
 ds_read_b64_tr_b16 a[156:157], v115 offset:9248
 v_cvt_pk_bf16_f32 v32, v32, v33
 v_mfma_f32_16x16x32_bf16 v[196:199], a[136:139], a[120:123], v[196:199]
 s_waitcnt lgkmcnt(7)
 ds_read_b64_tr_b16 a[158:159], v115 offset:13856
 buffer_load_dwordx2 v[138:139], v6, s[8:11], s84 offen
 v_cvt_pk_bf16_f32 v33, v34, v35
 v_mfma_f32_16x16x32_bf16 v[132:135], a[140:143], a[108:111], v[132:135]
 ds_read_b64_tr_b16 a[160:161], v114 offset:9280
 v_cvt_pk_bf16_f32 v34, v68, v69
 v_mfma_f32_16x16x32_bf16 v[196:199], a[140:143], a[124:127], v[196:199]
 s_waitcnt lgkmcnt(7)
 ds_read_b64_tr_b16 a[162:163], v114 offset:13888
 v_cvt_pk_bf16_f32 v35, v70, v71
 v_mfma_f32_16x16x32_bf16 v[132:135], a[144:147], a[224:227], v[132:135]
 ds_read_b64_tr_b16 a[164:165], v114 offset:18496
 buffer_store_dwordx4 v[32:35], v14, s[4:7], s64 offen sc1
 s_add_u32 s64, s64, 8192
 v_mfma_f32_16x16x32_bf16 v[196:199], a[144:147], a[240:243], v[196:199]
 s_waitcnt lgkmcnt(7)
 ds_read_b64_tr_b16 a[166:167], v114 offset:23104
 s_and_b32 s95, s61, 1
 s_mul_i32 s94, s95, 4
 s_add_u32 s94, s94, 4
 s_lshl_b32 s94, s94, 5
 s_and_b32 s95, s61, 1
 s_xor_b32 s95, s95, 1
 s_or_b32 s95, s95, s60
 s_cmp_eq_u32 s95, 0
 s_cselect_b32 s94, s94, 0x40000000
 v_add_u32 v7, s94, v64
 v_mfma_f32_16x16x32_bf16 v[132:135], a[148:151], a[228:231], v[132:135]
 ds_read_b64_tr_b16 a[168:169], v114 offset:27712
 buffer_load_dwordx2 v[144:145], v7, s[8:11], 0 offen
 v_mfma_f32_16x16x32_bf16 v[196:199], a[148:151], a[244:247], v[196:199]
 s_waitcnt lgkmcnt(7)
 ds_read_b64_tr_b16 a[170:171], v114 offset:32320
 v_mfma_f32_16x16x32_bf16 v[132:135], a[152:155], a[232:235], v[132:135]
 ds_read_b64_tr_b16 a[172:173], v114 offset:36928
 v_mfma_f32_16x16x32_bf16 v[196:199], a[152:155], a[248:251], v[196:199]
 s_waitcnt lgkmcnt(7)
 ds_read_b64_tr_b16 a[174:175], v114 offset:41536
 buffer_load_dwordx2 v[146:147], v7, s[8:11], s84 offen
 v_mfma_f32_16x16x32_bf16 v[132:135], a[156:159], a[236:239], v[132:135]
 ds_read_b64_tr_b16 a[176:177], v114 offset:46144
 v_mfma_f32_16x16x32_bf16 v[196:199], a[156:159], a[252:255], v[196:199]
 s_waitcnt lgkmcnt(7)
 ds_read_b64_tr_b16 a[178:179], v114 offset:50752
 v_mfma_f32_16x16x32_bf16 v[40:43], a[160:163], a[96:99], v[40:43]
 ds_read_b64_tr_b16 a[180:181], v114 offset:55360
 v_mfma_f32_16x16x32_bf16 v[76:79], a[160:163], a[112:115], v[76:79]
 s_waitcnt lgkmcnt(7)
 ds_read_b64_tr_b16 a[182:183], v114 offset:59968
 v_mfma_f32_16x16x32_bf16 v[40:43], a[164:167], a[100:103], v[40:43]
 ds_read_b64_tr_b16 a[184:185], v115 offset:64
 v_mfma_f32_16x16x32_bf16 v[76:79], a[164:167], a[116:119], v[76:79]
 s_waitcnt lgkmcnt(7)
 ds_read_b64_tr_b16 a[186:187], v115 offset:4672
 v_mfma_f32_16x16x32_bf16 v[40:43], a[168:171], a[104:107], v[40:43]
 ds_read_b64_tr_b16 a[188:189], v115 offset:9280
 v_cvt_pk_bf16_f32 v132, v132, v133
 v_mfma_f32_16x16x32_bf16 v[76:79], a[168:171], a[120:123], v[76:79]
 s_waitcnt lgkmcnt(7)
 ds_read_b64_tr_b16 a[190:191], v115 offset:13888
 v_cvt_pk_bf16_f32 v133, v134, v135
 v_mfma_f32_16x16x32_bf16 v[40:43], a[172:175], a[108:111], v[40:43]
 ds_read_b64_tr_b16 a[128:129], v114 offset:9312
 v_cvt_pk_bf16_f32 v134, v196, v197
 v_mfma_f32_16x16x32_bf16 v[76:79], a[172:175], a[124:127], v[76:79]
 s_waitcnt lgkmcnt(7)
 ds_read_b64_tr_b16 a[130:131], v114 offset:13920
 v_cvt_pk_bf16_f32 v135, v198, v199
 v_mfma_f32_16x16x32_bf16 v[40:43], a[176:179], a[224:227], v[40:43]
 ds_read_b64_tr_b16 a[132:133], v114 offset:18528
 buffer_store_dwordx4 v[132:135], v14, s[4:7], s64 offen sc1
 s_add_u32 s64, s64, 8192
 v_mfma_f32_16x16x32_bf16 v[76:79], a[176:179], a[240:243], v[76:79]
 s_waitcnt lgkmcnt(7)
 ds_read_b64_tr_b16 a[134:135], v114 offset:23136
 v_mfma_f32_16x16x32_bf16 v[40:43], a[180:183], a[228:231], v[40:43]
 ds_read_b64_tr_b16 a[136:137], v114 offset:27744
 v_mfma_f32_16x16x32_bf16 v[76:79], a[180:183], a[244:247], v[76:79]
 s_waitcnt lgkmcnt(7)
 ds_read_b64_tr_b16 a[138:139], v114 offset:32352
 v_mfma_f32_16x16x32_bf16 v[40:43], a[184:187], a[232:235], v[40:43]
 ds_read_b64_tr_b16 a[140:141], v114 offset:36960
 v_mfma_f32_16x16x32_bf16 v[76:79], a[184:187], a[248:251], v[76:79]
 s_waitcnt lgkmcnt(7)
 ds_read_b64_tr_b16 a[142:143], v114 offset:41568
 v_mfma_f32_16x16x32_bf16 v[40:43], a[188:191], a[236:239], v[40:43]
 ds_read_b64_tr_b16 a[144:145], v114 offset:46176
 v_mfma_f32_16x16x32_bf16 v[76:79], a[188:191], a[252:255], v[76:79]
 s_waitcnt lgkmcnt(7)
 ds_read_b64_tr_b16 a[146:147], v114 offset:50784
 v_mfma_f32_16x16x32_bf16 v[140:143], a[128:131], a[96:99], v[140:143]
 ds_read_b64_tr_b16 a[148:149], v114 offset:55392
 v_mfma_f32_16x16x32_bf16 v[204:207], a[128:131], a[112:115], v[204:207]
 s_waitcnt lgkmcnt(7)
 ds_read_b64_tr_b16 a[150:151], v114 offset:60000
 v_mfma_f32_16x16x32_bf16 v[140:143], a[132:135], a[100:103], v[140:143]
 ds_read_b64_tr_b16 a[152:153], v115 offset:96
 v_mfma_f32_16x16x32_bf16 v[204:207], a[132:135], a[116:119], v[204:207]
 s_waitcnt lgkmcnt(7)
 ds_read_b64_tr_b16 a[154:155], v115 offset:4704
 v_mfma_f32_16x16x32_bf16 v[140:143], a[136:139], a[104:107], v[140:143]
 ds_read_b64_tr_b16 a[156:157], v115 offset:9312
 s_waitcnt vmcnt(14)
 s_barrier
 v_cvt_pk_bf16_f32 v40, v40, v41
 v_mfma_f32_16x16x32_bf16 v[204:207], a[136:139], a[120:123], v[204:207]
 s_waitcnt lgkmcnt(7)
 ds_read_b64_tr_b16 a[158:159], v115 offset:13920
 v_cvt_pk_bf16_f32 v41, v42, v43
 s_lshl_b32 s94, s2, 6
 s_add_u32 s94, s94, 71434240
 s_cmp_eq_u32 s60, 0
 s_cselect_b32 s94, s94, 0x8000000
 v_lshl_add_u32 v22, v14, 21, s94
 v_mov_b32 v23, 1
 v_mfma_f32_16x16x32_bf16 v[140:143], a[140:143], a[108:111], v[140:143]
 ds_read_b64_tr_b16 a[160:161], v114 offset:9344
 buffer_store_dword v23, v22, s[4:7], 0 offen sc1
 v_cvt_pk_bf16_f32 v42, v76, v77
 v_mfma_f32_16x16x32_bf16 v[204:207], a[140:143], a[124:127], v[204:207]
 s_waitcnt lgkmcnt(7)
 ds_read_b64_tr_b16 a[162:163], v114 offset:13952
 v_cvt_pk_bf16_f32 v43, v78, v79
 v_mfma_f32_16x16x32_bf16 v[140:143], a[144:147], a[224:227], v[140:143]
 ds_read_b64_tr_b16 a[164:165], v114 offset:18560
 buffer_store_dwordx4 v[40:43], v14, s[4:7], s64 offen sc1
 s_add_u32 s64, s64, 8192
 v_mfma_f32_16x16x32_bf16 v[204:207], a[144:147], a[240:243], v[204:207]
 s_waitcnt lgkmcnt(7)
 ds_read_b64_tr_b16 a[166:167], v114 offset:23168
 v_mfma_f32_16x16x32_bf16 v[140:143], a[148:151], a[228:231], v[140:143]
 ds_read_b64_tr_b16 a[168:169], v114 offset:27776
 v_mul_u32_u24 v19, 4, v14
 v_mfma_f32_16x16x32_bf16 v[204:207], a[148:151], a[244:247], v[204:207]
 s_waitcnt lgkmcnt(7)
 ds_read_b64_tr_b16 a[170:171], v114 offset:32384
 s_and_b32 s94, s2, 0xf8
 s_lshl_b32 s94, s94, 6
 s_add_u32 s94, s94, 71434240
 v_add_u32 v19, s94, v19
 v_mfma_f32_16x16x32_bf16 v[140:143], a[152:155], a[232:235], v[140:143]
 ds_read_b64_tr_b16 a[172:173], v114 offset:36992
 v_mov_b32 v23, 2147483632
 v_mfma_f32_16x16x32_bf16 v[204:207], a[152:155], a[248:251], v[204:207]
 s_waitcnt lgkmcnt(7)
 ds_read_b64_tr_b16 a[174:175], v114 offset:41600
 v_mfma_f32_16x16x32_bf16 v[140:143], a[156:159], a[236:239], v[140:143]
 ds_read_b64_tr_b16 a[176:177], v114 offset:46208
 v_mfma_f32_16x16x32_bf16 v[204:207], a[156:159], a[252:255], v[204:207]
 s_waitcnt lgkmcnt(7)
 ds_read_b64_tr_b16 a[178:179], v114 offset:50816
 v_mfma_f32_16x16x32_bf16 v[208:211], a[160:163], a[96:99], v[208:211]
 ds_read_b64_tr_b16 a[180:181], v114 offset:55424
 v_mfma_f32_16x16x32_bf16 v[216:219], a[160:163], a[112:115], v[216:219]
 s_waitcnt lgkmcnt(7)
 ds_read_b64_tr_b16 a[182:183], v114 offset:60032
 v_mfma_f32_16x16x32_bf16 v[208:211], a[164:167], a[100:103], v[208:211]
 ds_read_b64_tr_b16 a[184:185], v115 offset:128
 v_mfma_f32_16x16x32_bf16 v[216:219], a[164:167], a[116:119], v[216:219]
 s_waitcnt lgkmcnt(7)
 ds_read_b64_tr_b16 a[186:187], v115 offset:4736
 v_mfma_f32_16x16x32_bf16 v[208:211], a[168:171], a[104:107], v[208:211]
 ds_read_b64_tr_b16 a[188:189], v115 offset:9344
 v_cvt_pk_bf16_f32 v140, v140, v141
 v_mfma_f32_16x16x32_bf16 v[216:219], a[168:171], a[120:123], v[216:219]
 s_waitcnt lgkmcnt(7)
 ds_read_b64_tr_b16 a[190:191], v115 offset:13952
 v_cvt_pk_bf16_f32 v141, v142, v143
 v_mfma_f32_16x16x32_bf16 v[208:211], a[172:175], a[108:111], v[208:211]
 ds_read_b64_tr_b16 a[128:129], v114 offset:9376
 v_cvt_pk_bf16_f32 v142, v204, v205
 v_mfma_f32_16x16x32_bf16 v[216:219], a[172:175], a[124:127], v[216:219]
 s_waitcnt lgkmcnt(7)
 ds_read_b64_tr_b16 a[130:131], v114 offset:13984
 v_cvt_pk_bf16_f32 v143, v206, v207
 v_mfma_f32_16x16x32_bf16 v[208:211], a[176:179], a[224:227], v[208:211]
 ds_read_b64_tr_b16 a[132:133], v114 offset:18592
 buffer_store_dwordx4 v[140:143], v14, s[4:7], s64 offen sc1
 s_add_u32 s64, s64, 8192
 v_mfma_f32_16x16x32_bf16 v[216:219], a[176:179], a[240:243], v[216:219]
 s_waitcnt lgkmcnt(7)
 ds_read_b64_tr_b16 a[134:135], v114 offset:23200
 v_mfma_f32_16x16x32_bf16 v[208:211], a[180:183], a[228:231], v[208:211]
 ds_read_b64_tr_b16 a[136:137], v114 offset:27808
 v_mfma_f32_16x16x32_bf16 v[216:219], a[180:183], a[244:247], v[216:219]
 s_waitcnt lgkmcnt(7)
 ds_read_b64_tr_b16 a[138:139], v114 offset:32416
 v_mfma_f32_16x16x32_bf16 v[208:211], a[184:187], a[232:235], v[208:211]
 ds_read_b64_tr_b16 a[140:141], v114 offset:37024
 v_mfma_f32_16x16x32_bf16 v[216:219], a[184:187], a[248:251], v[216:219]
 s_waitcnt lgkmcnt(7)
 ds_read_b64_tr_b16 a[142:143], v114 offset:41632
 v_mfma_f32_16x16x32_bf16 v[208:211], a[188:191], a[236:239], v[208:211]
 ds_read_b64_tr_b16 a[144:145], v114 offset:46240
 v_mfma_f32_16x16x32_bf16 v[216:219], a[188:191], a[252:255], v[216:219]
 s_waitcnt lgkmcnt(7)
 ds_read_b64_tr_b16 a[146:147], v114 offset:50848
 v_mfma_f32_16x16x32_bf16 v[224:227], a[128:131], a[96:99], v[224:227]
 ds_read_b64_tr_b16 a[148:149], v114 offset:55456
 v_mfma_f32_16x16x32_bf16 v[232:235], a[128:131], a[112:115], v[232:235]
 s_waitcnt lgkmcnt(7)
 ds_read_b64_tr_b16 a[150:151], v114 offset:60064
 v_mfma_f32_16x16x32_bf16 v[224:227], a[132:135], a[100:103], v[224:227]
 ds_read_b64_tr_b16 a[152:153], v115 offset:160
 v_mfma_f32_16x16x32_bf16 v[232:235], a[132:135], a[116:119], v[232:235]
 s_waitcnt lgkmcnt(7)
 ds_read_b64_tr_b16 a[154:155], v115 offset:4768
 v_mfma_f32_16x16x32_bf16 v[224:227], a[136:139], a[104:107], v[224:227]
 ds_read_b64_tr_b16 a[156:157], v115 offset:9376
 v_cvt_pk_bf16_f32 v208, v208, v209
 v_mfma_f32_16x16x32_bf16 v[232:235], a[136:139], a[120:123], v[232:235]
 s_waitcnt lgkmcnt(7)
 ds_read_b64_tr_b16 a[158:159], v115 offset:13984
 v_cvt_pk_bf16_f32 v209, v210, v211
 v_mfma_f32_16x16x32_bf16 v[224:227], a[140:143], a[108:111], v[224:227]
 ds_read_b64_tr_b16 a[160:161], v114 offset:9408
 v_cvt_pk_bf16_f32 v210, v216, v217
 v_mfma_f32_16x16x32_bf16 v[232:235], a[140:143], a[124:127], v[232:235]
 s_waitcnt lgkmcnt(7)
 ds_read_b64_tr_b16 a[162:163], v114 offset:14016
 v_cvt_pk_bf16_f32 v211, v218, v219
 v_mfma_f32_16x16x32_bf16 v[224:227], a[144:147], a[224:227], v[224:227]
 ds_read_b64_tr_b16 a[164:165], v114 offset:18624
 buffer_store_dwordx4 v[208:211], v14, s[4:7], s64 offen sc1
 s_add_u32 s64, s64, 8192
 v_mfma_f32_16x16x32_bf16 v[232:235], a[144:147], a[240:243], v[232:235]
 s_waitcnt lgkmcnt(7)
 ds_read_b64_tr_b16 a[166:167], v114 offset:23232
 v_mfma_f32_16x16x32_bf16 v[224:227], a[148:151], a[228:231], v[224:227]
 ds_read_b64_tr_b16 a[168:169], v114 offset:27840
 v_mfma_f32_16x16x32_bf16 v[232:235], a[148:151], a[244:247], v[232:235]
 s_waitcnt lgkmcnt(7)
 ds_read_b64_tr_b16 a[170:171], v114 offset:32448
 v_mfma_f32_16x16x32_bf16 v[224:227], a[152:155], a[232:235], v[224:227]
 ds_read_b64_tr_b16 a[172:173], v114 offset:37056
 v_mfma_f32_16x16x32_bf16 v[232:235], a[152:155], a[248:251], v[232:235]
 s_waitcnt lgkmcnt(7)
 ds_read_b64_tr_b16 a[174:175], v114 offset:41664
 v_mfma_f32_16x16x32_bf16 v[224:227], a[156:159], a[236:239], v[224:227]
 ds_read_b64_tr_b16 a[176:177], v114 offset:46272
 v_mfma_f32_16x16x32_bf16 v[232:235], a[156:159], a[252:255], v[232:235]
 s_waitcnt lgkmcnt(7)
 ds_read_b64_tr_b16 a[178:179], v114 offset:50880
 v_mfma_f32_16x16x32_bf16 v[240:243], a[160:163], a[96:99], v[240:243]
 ds_read_b64_tr_b16 a[180:181], v114 offset:55488
 v_mfma_f32_16x16x32_bf16 v[248:251], a[160:163], a[112:115], v[248:251]
 s_waitcnt lgkmcnt(7)
 ds_read_b64_tr_b16 a[182:183], v114 offset:60096
 v_mfma_f32_16x16x32_bf16 v[240:243], a[164:167], a[100:103], v[240:243]
 ds_read_b64_tr_b16 a[184:185], v115 offset:192
 v_mfma_f32_16x16x32_bf16 v[248:251], a[164:167], a[116:119], v[248:251]
 s_waitcnt lgkmcnt(7)
 ds_read_b64_tr_b16 a[186:187], v115 offset:4800
 v_mfma_f32_16x16x32_bf16 v[240:243], a[168:171], a[104:107], v[240:243]
 ds_read_b64_tr_b16 a[188:189], v115 offset:9408
 v_cvt_pk_bf16_f32 v224, v224, v225
 v_mfma_f32_16x16x32_bf16 v[248:251], a[168:171], a[120:123], v[248:251]
 s_waitcnt lgkmcnt(7)
 ds_read_b64_tr_b16 a[190:191], v115 offset:14016
 v_cvt_pk_bf16_f32 v225, v226, v227
 v_mfma_f32_16x16x32_bf16 v[240:243], a[172:175], a[108:111], v[240:243]
 ds_read_b64_tr_b16 a[128:129], v114 offset:9440
 v_cvt_pk_bf16_f32 v226, v232, v233
 v_mfma_f32_16x16x32_bf16 v[248:251], a[172:175], a[124:127], v[248:251]
 s_waitcnt lgkmcnt(7)
 ds_read_b64_tr_b16 a[130:131], v114 offset:14048
 v_cvt_pk_bf16_f32 v227, v234, v235
 v_mfma_f32_16x16x32_bf16 v[240:243], a[176:179], a[224:227], v[240:243]
 ds_read_b64_tr_b16 a[132:133], v114 offset:18656
 buffer_store_dwordx4 v[224:227], v14, s[4:7], s64 offen sc1
 s_add_u32 s64, s64, 8192
 v_mfma_f32_16x16x32_bf16 v[248:251], a[176:179], a[240:243], v[248:251]
 s_waitcnt lgkmcnt(7)
 ds_read_b64_tr_b16 a[134:135], v114 offset:23264
 v_mfma_f32_16x16x32_bf16 v[240:243], a[180:183], a[228:231], v[240:243]
 ds_read_b64_tr_b16 a[136:137], v114 offset:27872
 v_mfma_f32_16x16x32_bf16 v[248:251], a[180:183], a[244:247], v[248:251]
 s_waitcnt lgkmcnt(7)
 ds_read_b64_tr_b16 a[138:139], v114 offset:32480
 v_mfma_f32_16x16x32_bf16 v[240:243], a[184:187], a[232:235], v[240:243]
 ds_read_b64_tr_b16 a[140:141], v114 offset:37088
 v_mfma_f32_16x16x32_bf16 v[248:251], a[184:187], a[248:251], v[248:251]
 s_waitcnt lgkmcnt(7)
 ds_read_b64_tr_b16 a[142:143], v114 offset:41696
 v_mfma_f32_16x16x32_bf16 v[240:243], a[188:191], a[236:239], v[240:243]
 ds_read_b64_tr_b16 a[144:145], v114 offset:46304
 v_mfma_f32_16x16x32_bf16 v[248:251], a[188:191], a[252:255], v[248:251]
 s_waitcnt lgkmcnt(7)
 ds_read_b64_tr_b16 a[146:147], v114 offset:50912
 v_mfma_f32_16x16x32_bf16 v[160:163], a[128:131], a[96:99], v[160:163]
 ds_read_b64_tr_b16 a[148:149], v114 offset:55520
 v_mfma_f32_16x16x32_bf16 v[168:171], a[128:131], a[112:115], v[168:171]
 s_waitcnt lgkmcnt(7)
 ds_read_b64_tr_b16 a[150:151], v114 offset:60128
 v_mfma_f32_16x16x32_bf16 v[160:163], a[132:135], a[100:103], v[160:163]
 ds_read_b64_tr_b16 a[152:153], v115 offset:224
 v_mfma_f32_16x16x32_bf16 v[168:171], a[132:135], a[116:119], v[168:171]
 s_waitcnt lgkmcnt(7)
 ds_read_b64_tr_b16 a[154:155], v115 offset:4832
 v_mfma_f32_16x16x32_bf16 v[160:163], a[136:139], a[104:107], v[160:163]
 ds_read_b64_tr_b16 a[156:157], v115 offset:9440
 v_cvt_pk_bf16_f32 v240, v240, v241
 v_mfma_f32_16x16x32_bf16 v[168:171], a[136:139], a[120:123], v[168:171]
 s_waitcnt lgkmcnt(7)
 ds_read_b64_tr_b16 a[158:159], v115 offset:14048
 v_cvt_pk_bf16_f32 v241, v242, v243
 v_mfma_f32_16x16x32_bf16 v[160:163], a[140:143], a[108:111], v[160:163]
 ds_read_b64_tr_b16 a[160:161], v114 offset:9472
 v_cvt_pk_bf16_f32 v242, v248, v249
 v_mfma_f32_16x16x32_bf16 v[168:171], a[140:143], a[124:127], v[168:171]
 s_waitcnt lgkmcnt(7)
 ds_read_b64_tr_b16 a[162:163], v114 offset:14080
 v_cvt_pk_bf16_f32 v243, v250, v251
 v_mfma_f32_16x16x32_bf16 v[160:163], a[144:147], a[224:227], v[160:163]
 ds_read_b64_tr_b16 a[164:165], v114 offset:18688
 buffer_store_dwordx4 v[240:243], v14, s[4:7], s64 offen sc1
 s_add_u32 s64, s64, 8192
 v_mfma_f32_16x16x32_bf16 v[168:171], a[144:147], a[240:243], v[168:171]
 s_waitcnt lgkmcnt(7)
 ds_read_b64_tr_b16 a[166:167], v114 offset:23296
 v_mfma_f32_16x16x32_bf16 v[160:163], a[148:151], a[228:231], v[160:163]
 ds_read_b64_tr_b16 a[168:169], v114 offset:27904
 v_mfma_f32_16x16x32_bf16 v[168:171], a[148:151], a[244:247], v[168:171]
 s_waitcnt lgkmcnt(7)
 ds_read_b64_tr_b16 a[170:171], v114 offset:32512
 v_mfma_f32_16x16x32_bf16 v[160:163], a[152:155], a[232:235], v[160:163]
 ds_read_b64_tr_b16 a[172:173], v114 offset:37120
 v_mfma_f32_16x16x32_bf16 v[168:171], a[152:155], a[248:251], v[168:171]
 s_waitcnt lgkmcnt(7)
 ds_read_b64_tr_b16 a[174:175], v114 offset:41728
 v_mfma_f32_16x16x32_bf16 v[160:163], a[156:159], a[236:239], v[160:163]
 ds_read_b64_tr_b16 a[176:177], v114 offset:46336
 v_mfma_f32_16x16x32_bf16 v[168:171], a[156:159], a[252:255], v[168:171]
 s_waitcnt lgkmcnt(7)
 ds_read_b64_tr_b16 a[178:179], v114 offset:50944
 v_mfma_f32_16x16x32_bf16 v[176:179], a[160:163], a[96:99], v[176:179]
 ds_read_b64_tr_b16 a[180:181], v114 offset:55552
 v_mfma_f32_16x16x32_bf16 v[184:187], a[160:163], a[112:115], v[184:187]
 s_waitcnt lgkmcnt(7)
 ds_read_b64_tr_b16 a[182:183], v114 offset:60160
 v_mfma_f32_16x16x32_bf16 v[176:179], a[164:167], a[100:103], v[176:179]
 ds_read_b64_tr_b16 a[184:185], v115 offset:256
 buffer_load_dword v15, v19, s[4:7], 0 offen sc1
 v_mfma_f32_16x16x32_bf16 v[184:187], a[164:167], a[116:119], v[184:187]
 s_waitcnt lgkmcnt(7)
 ds_read_b64_tr_b16 a[186:187], v115 offset:4864
 v_mfma_f32_16x16x32_bf16 v[176:179], a[168:171], a[104:107], v[176:179]
 ds_read_b64_tr_b16 a[188:189], v115 offset:9472
 v_cvt_pk_bf16_f32 v160, v160, v161
 v_mfma_f32_16x16x32_bf16 v[184:187], a[168:171], a[120:123], v[184:187]
 s_waitcnt lgkmcnt(7)
 ds_read_b64_tr_b16 a[190:191], v115 offset:14080
 v_cvt_pk_bf16_f32 v161, v162, v163
 v_mfma_f32_16x16x32_bf16 v[176:179], a[172:175], a[108:111], v[176:179]
 v_cvt_pk_bf16_f32 v162, v168, v169
 v_cvt_pk_bf16_f32 v163, v170, v171
 v_mfma_f32_16x16x32_bf16 v[184:187], a[172:175], a[124:127], v[184:187]
 s_waitcnt lgkmcnt(6)
 buffer_store_dwordx4 v[160:163], v14, s[4:7], s64 offen sc1
 s_add_u32 s64, s64, 8192
 v_mfma_f32_16x16x32_bf16 v[176:179], a[176:179], a[224:227], v[176:179]
 v_cmp_gt_u32 vcc, 128, v14
 s_nop 1
 v_cndmask_b32 v19, v23, v19, vcc
 v_mfma_f32_16x16x32_bf16 v[184:187], a[176:179], a[240:243], v[184:187]
 s_waitcnt lgkmcnt(4)
 v_mfma_f32_16x16x32_bf16 v[176:179], a[180:183], a[228:231], v[176:179]
 v_mfma_f32_16x16x32_bf16 v[184:187], a[180:183], a[244:247], v[184:187]
 s_waitcnt lgkmcnt(2)
 v_mfma_f32_16x16x32_bf16 v[176:179], a[184:187], a[232:235], v[176:179]
 v_mfma_f32_16x16x32_bf16 v[184:187], a[184:187], a[248:251], v[184:187]
 s_waitcnt lgkmcnt(0)
 v_mfma_f32_16x16x32_bf16 v[176:179], a[188:191], a[236:239], v[176:179]
 v_mfma_f32_16x16x32_bf16 v[184:187], a[188:191], a[252:255], v[184:187]
 s_nop 6
 v_cvt_pk_bf16_f32 v176, v176, v177
 v_cvt_pk_bf16_f32 v177, v178, v179
 v_cvt_pk_bf16_f32 v178, v184, v185
 v_cvt_pk_bf16_f32 v179, v186, v187
 buffer_store_dwordx4 v[176:179], v14, s[4:7], s64 offen sc1
 s_add_u32 s64, s64, 8192
 s_waitcnt vmcnt(2)
 v_cmp_eq_u32 vcc, 1, v15
 s_and_b32 s94, vcc_lo, 255
 s_cmp_eq_u32 s94, 255
 s_cbranch_scc0 L_spin_195
L_back_194:
 s_lshr_b32 s83, s61, 1
 s_and_b32 s95, s61, 1
 s_mul_i32 s94, s95, 5
 s_add_u32 s94, s94, s60
 s_lshl_b32 s85, s94, 13
 s_mov_b32 s94, s63
 s_lshl_b32 s94, s94, 2
 s_add_u32 s94, s94, s62
 s_lshl_b32 s94, s94, 2
 s_add_u32 s94, s94, s83
 s_mul_i32 s94, s94, 73728
 s_add_u32 s94, s94, 50331648
 s_add_u32 s85, s94, s85
 s_add_u32 s86, s85, 4096
 buffer_load_dwordx4 v[36:39], v14, s[4:7], s85 offen offset:0 sc1
 buffer_load_dwordx4 v[100:103], v14, s[4:7], s85 offen offset:1024 sc1
 buffer_load_dwordx4 v[164:167], v14, s[4:7], s85 offen offset:2048 sc1
 buffer_load_dwordx4 v[228:231], v14, s[4:7], s85 offen offset:3072 sc1
 buffer_load_dwordx4 v[44:47], v14, s[4:7], s86 offen offset:0 sc1
 buffer_load_dwordx4 v[108:111], v14, s[4:7], s86 offen offset:1024 sc1
 buffer_load_dwordx4 v[172:175], v14, s[4:7], s86 offen offset:2048 sc1
 buffer_load_dwordx4 v[236:239], v14, s[4:7], s86 offen offset:3072 sc1
 s_waitcnt vmcnt(8)
 s_barrier
 s_lshl_b32 s94, s2, 6
 s_add_u32 s94, s94, 71450624
 s_cmp_eq_u32 s60, 0
 s_cselect_b32 s94, s94, 0x8000000
 v_lshl_add_u32 v22, v14, 21, s94
 v_mov_b32 v23, 1
 buffer_store_dword v23, v22, s[4:7], 0 offen sc1
 s_and_b32 s95, s61, 1
 s_xor_b32 s95, s95, 0
 s_or_b32 s95, s95, s60
 s_cmp_eq_u32 s95, 0
 s_cbranch_scc0 L_skip_196
 s_and_b32 s95, s61, 1
 s_mul_i32 s94, s95, 5
 s_add_u32 s94, s94, 4
 s_lshl_b32 s85, s94, 13
 s_mov_b32 s94, s63
 s_lshl_b32 s94, s94, 2
 s_add_u32 s94, s94, s62
 s_lshl_b32 s94, s94, 2
 s_add_u32 s94, s94, s83
 s_mul_i32 s94, s94, 73728
 s_add_u32 s94, s94, 50331648
 s_add_u32 s85, s94, s85
 s_add_u32 s86, s85, 4096
 buffer_load_dwordx4 v[52:55], v14, s[4:7], s85 offen offset:0 sc1
 buffer_load_dwordx4 v[116:119], v14, s[4:7], s85 offen offset:1024 sc1
 buffer_load_dwordx4 v[180:183], v14, s[4:7], s85 offen offset:2048 sc1
 buffer_load_dwordx4 v[244:247], v14, s[4:7], s85 offen offset:3072 sc1
 buffer_load_dwordx4 v[60:63], v14, s[4:7], s86 offen offset:0 sc1
 buffer_load_dwordx4 v[124:127], v14, s[4:7], s86 offen offset:1024 sc1
 buffer_load_dwordx4 v[188:191], v14, s[4:7], s86 offen offset:2048 sc1
 buffer_load_dwordx4 v[252:255], v14, s[4:7], s86 offen offset:3072 sc1
L_skip_196:
 v_add_u32 v19, 0x4000, v19
 v_readfirstlane_b32 s94, v8
 s_sub_u32 s94, s93, s94
 s_cmp_lt_u32 s94, 32
 s_cbranch_scc1 L_ffq_197
L_back_198:
 v_readfirstlane_b32 s94, v9
 s_sub_u32 s94, s93, s94
 s_cmp_lt_u32 s94, 32
 s_cbranch_scc1 L_ffq_199
L_back_200:
 s_waitcnt vmcnt(0)
 buffer_load_dword v15, v19, s[4:7], 0 offen sc1
 v_mov_b32 v20, 0x3f80
 v_mov_b32 v21, 0x3f800000
 v_lshlrev_b32 v64, 16, v36
 v_and_b32 v65, 0xffff0000, v36
 v_lshlrev_b32 v66, 16, v37
 v_and_b32 v67, 0xffff0000, v37
 v_lshlrev_b32 v72, 16, v38
 v_and_b32 v73, 0xffff0000, v38
 v_lshlrev_b32 v74, 16, v39
 v_and_b32 v75, 0xffff0000, v39
 v_dot2_f32_bf16 v64, v100, v20, v64
 v_dot2_f32_bf16 v65, v100, v21, v65
 v_dot2_f32_bf16 v66, v101, v20, v66
 v_dot2_f32_bf16 v67, v101, v21, v67
 v_dot2_f32_bf16 v72, v102, v20, v72
 v_dot2_f32_bf16 v73, v102, v21, v73
 v_dot2_f32_bf16 v74, v103, v20, v74
 v_dot2_f32_bf16 v75, v103, v21, v75
 v_dot2_f32_bf16 v64, v164, v20, v64
 v_dot2_f32_bf16 v65, v164, v21, v65
 v_dot2_f32_bf16 v66, v165, v20, v66
 v_dot2_f32_bf16 v67, v165, v21, v67
 v_dot2_f32_bf16 v72, v166, v20, v72
 v_dot2_f32_bf16 v73, v166, v21, v73
 v_dot2_f32_bf16 v74, v167, v20, v74
 v_dot2_f32_bf16 v75, v167, v21, v75
 v_dot2_f32_bf16 v64, v228, v20, v64
 v_dot2_f32_bf16 v65, v228, v21, v65
 v_dot2_f32_bf16 v66, v229, v20, v66
 v_dot2_f32_bf16 v67, v229, v21, v67
 v_dot2_f32_bf16 v72, v230, v20, v72
 v_dot2_f32_bf16 v73, v230, v21, v73
 v_dot2_f32_bf16 v74, v231, v20, v74
 v_dot2_f32_bf16 v75, v231, v21, v75
 v_dot2_f32_bf16 v64, v44, v20, v64
 v_dot2_f32_bf16 v65, v44, v21, v65
 v_dot2_f32_bf16 v66, v45, v20, v66
 v_dot2_f32_bf16 v67, v45, v21, v67
 v_dot2_f32_bf16 v72, v46, v20, v72
 v_dot2_f32_bf16 v73, v46, v21, v73
 v_dot2_f32_bf16 v74, v47, v20, v74
 v_dot2_f32_bf16 v75, v47, v21, v75
 v_dot2_f32_bf16 v64, v108, v20, v64
 v_dot2_f32_bf16 v65, v108, v21, v65
 v_dot2_f32_bf16 v66, v109, v20, v66
 v_dot2_f32_bf16 v67, v109, v21, v67
 v_dot2_f32_bf16 v72, v110, v20, v72
 v_dot2_f32_bf16 v73, v110, v21, v73
 v_dot2_f32_bf16 v74, v111, v20, v74
 v_dot2_f32_bf16 v75, v111, v21, v75
 v_dot2_f32_bf16 v64, v172, v20, v64
 v_dot2_f32_bf16 v65, v172, v21, v65
 v_dot2_f32_bf16 v66, v173, v20, v66
 v_dot2_f32_bf16 v67, v173, v21, v67
 v_dot2_f32_bf16 v72, v174, v20, v72
 v_dot2_f32_bf16 v73, v174, v21, v73
 v_dot2_f32_bf16 v74, v175, v20, v74
 v_dot2_f32_bf16 v75, v175, v21, v75
 v_dot2_f32_bf16 v64, v236, v20, v64
 v_dot2_f32_bf16 v65, v236, v21, v65
 v_dot2_f32_bf16 v66, v237, v20, v66
 v_dot2_f32_bf16 v67, v237, v21, v67
 v_dot2_f32_bf16 v72, v238, v20, v72
 v_dot2_f32_bf16 v73, v238, v21, v73
 v_dot2_f32_bf16 v74, v239, v20, v74
 v_dot2_f32_bf16 v75, v239, v21, v75
 v_lshlrev_b32 v80, 16, v120
 v_and_b32 v81, 0xffff0000, v120
 v_lshlrev_b32 v82, 16, v121
 v_and_b32 v83, 0xffff0000, v121
 v_lshlrev_b32 v88, 16, v122
 v_and_b32 v89, 0xffff0000, v122
 v_lshlrev_b32 v90, 16, v123
 v_and_b32 v91, 0xffff0000, v123
 v_readfirstlane_b32 s94, v8
 s_sub_u32 s94, s93, s94
 s_cmp_lt_u32 s94, 32
 s_cbranch_scc1 L_ffa_204
L_back_205:
 v_sub_f32 v22, 1.0, v0
 v_mul_f32 v80, v22, v80
 v_fmac_f32 v80, v0, v64
 v_mul_f32 v81, v22, v81
 v_fmac_f32 v81, v0, v65
 v_mul_f32 v82, v22, v82
 v_fmac_f32 v82, v0, v66
 v_mul_f32 v83, v22, v83
 v_fmac_f32 v83, v0, v67
 v_sub_f32 v22, 1.0, v1
 v_mul_f32 v88, v22, v88
 v_fmac_f32 v88, v1, v72
 v_mul_f32 v89, v22, v89
 v_fmac_f32 v89, v1, v73
 v_mul_f32 v90, v22, v90
 v_fmac_f32 v90, v1, v74
 v_mul_f32 v91, v22, v91
 v_fmac_f32 v91, v1, v75
 v_cvt_pk_bf16_f32 v10, v80, v81
 v_cvt_pk_bf16_f32 v11, v82, v83
 v_cvt_pk_bf16_f32 v12, v88, v89
 v_cvt_pk_bf16_f32 v13, v90, v91
 buffer_store_dwordx2 v[10:11], v4, s[32:35], 0 offen
 buffer_store_dwordx2 v[12:13], v4, s[32:35], s84 offen
 s_and_b32 s95, s61, 1
 s_xor_b32 s95, s95, 0
 s_or_b32 s95, s95, s60
 s_cmp_eq_u32 s95, 0
 s_cbranch_scc0 L_skip_203
 v_lshlrev_b32 v64, 16, v52
 v_and_b32 v65, 0xffff0000, v52
 v_lshlrev_b32 v66, 16, v53
 v_and_b32 v67, 0xffff0000, v53
 v_lshlrev_b32 v72, 16, v54
 v_and_b32 v73, 0xffff0000, v54
 v_lshlrev_b32 v74, 16, v55
 v_and_b32 v75, 0xffff0000, v55
 v_dot2_f32_bf16 v64, v116, v20, v64
 v_dot2_f32_bf16 v65, v116, v21, v65
 v_dot2_f32_bf16 v66, v117, v20, v66
 v_dot2_f32_bf16 v67, v117, v21, v67
 v_dot2_f32_bf16 v72, v118, v20, v72
 v_dot2_f32_bf16 v73, v118, v21, v73
 v_dot2_f32_bf16 v74, v119, v20, v74
 v_dot2_f32_bf16 v75, v119, v21, v75
 v_dot2_f32_bf16 v64, v180, v20, v64
 v_dot2_f32_bf16 v65, v180, v21, v65
 v_dot2_f32_bf16 v66, v181, v20, v66
 v_dot2_f32_bf16 v67, v181, v21, v67
 v_dot2_f32_bf16 v72, v182, v20, v72
 v_dot2_f32_bf16 v73, v182, v21, v73
 v_dot2_f32_bf16 v74, v183, v20, v74
 v_dot2_f32_bf16 v75, v183, v21, v75
 v_dot2_f32_bf16 v64, v244, v20, v64
 v_dot2_f32_bf16 v65, v244, v21, v65
 v_dot2_f32_bf16 v66, v245, v20, v66
 v_dot2_f32_bf16 v67, v245, v21, v67
 v_dot2_f32_bf16 v72, v246, v20, v72
 v_dot2_f32_bf16 v73, v246, v21, v73
 v_dot2_f32_bf16 v74, v247, v20, v74
 v_dot2_f32_bf16 v75, v247, v21, v75
 v_dot2_f32_bf16 v64, v60, v20, v64
 v_dot2_f32_bf16 v65, v60, v21, v65
 v_dot2_f32_bf16 v66, v61, v20, v66
 v_dot2_f32_bf16 v67, v61, v21, v67
 v_dot2_f32_bf16 v72, v62, v20, v72
 v_dot2_f32_bf16 v73, v62, v21, v73
 v_dot2_f32_bf16 v74, v63, v20, v74
 v_dot2_f32_bf16 v75, v63, v21, v75
 v_dot2_f32_bf16 v64, v124, v20, v64
 v_dot2_f32_bf16 v65, v124, v21, v65
 v_dot2_f32_bf16 v66, v125, v20, v66
 v_dot2_f32_bf16 v67, v125, v21, v67
 v_dot2_f32_bf16 v72, v126, v20, v72
 v_dot2_f32_bf16 v73, v126, v21, v73
 v_dot2_f32_bf16 v74, v127, v20, v74
 v_dot2_f32_bf16 v75, v127, v21, v75
 v_dot2_f32_bf16 v64, v188, v20, v64
 v_dot2_f32_bf16 v65, v188, v21, v65
 v_dot2_f32_bf16 v66, v189, v20, v66
 v_dot2_f32_bf16 v67, v189, v21, v67
 v_dot2_f32_bf16 v72, v190, v20, v72
 v_dot2_f32_bf16 v73, v190, v21, v73
 v_dot2_f32_bf16 v74, v191, v20, v74
 v_dot2_f32_bf16 v75, v191, v21, v75
 v_dot2_f32_bf16 v64, v252, v20, v64
 v_dot2_f32_bf16 v65, v252, v21, v65
 v_dot2_f32_bf16 v66, v253, v20, v66
 v_dot2_f32_bf16 v67, v253, v21, v67
 v_dot2_f32_bf16 v72, v254, v20, v72
 v_dot2_f32_bf16 v73, v254, v21, v73
 v_dot2_f32_bf16 v74, v255, v20, v74
 v_dot2_f32_bf16 v75, v255, v21, v75
 v_lshlrev_b32 v80, 16, v128
 v_and_b32 v81, 0xffff0000, v128
 v_lshlrev_b32 v82, 16, v129
 v_and_b32 v83, 0xffff0000, v129
 v_lshlrev_b32 v88, 16, v130
 v_and_b32 v89, 0xffff0000, v130
 v_lshlrev_b32 v90, 16, v131
 v_and_b32 v91, 0xffff0000, v131
 v_readfirstlane_b32 s94, v8
 s_sub_u32 s94, s93, s94
 s_cmp_lt_u32 s94, 32
 s_cbranch_scc1 L_ffa_206
L_back_207:
 v_sub_f32 v22, 1.0, v0
 v_mul_f32 v80, v22, v80
 v_fmac_f32 v80, v0, v64
 v_mul_f32 v81, v22, v81
 v_fmac_f32 v81, v0, v65
 v_mul_f32 v82, v22, v82
 v_fmac_f32 v82, v0, v66
 v_mul_f32 v83, v22, v83
 v_fmac_f32 v83, v0, v67
 v_sub_f32 v22, 1.0, v1
 v_mul_f32 v88, v22, v88
 v_fmac_f32 v88, v1, v72
 v_mul_f32 v89, v22, v89
 v_fmac_f32 v89, v1, v73
 v_mul_f32 v90, v22, v90
 v_fmac_f32 v90, v1, v74
 v_mul_f32 v91, v22, v91
 v_fmac_f32 v91, v1, v75
 v_cvt_pk_bf16_f32 v10, v80, v81
 v_cvt_pk_bf16_f32 v11, v82, v83
 v_cvt_pk_bf16_f32 v12, v88, v89
 v_cvt_pk_bf16_f32 v13, v90, v91
 buffer_store_dwordx2 v[10:11], v5, s[32:35], 0 offen
 buffer_store_dwordx2 v[12:13], v5, s[32:35], s84 offen
L_skip_203:
 s_waitcnt vmcnt(2)
 v_cmp_eq_u32 vcc, 1, v15
 s_and_b32 s94, vcc_lo, 255
 s_cmp_eq_u32 s94, 255
 s_cbranch_scc0 L_spin_202
L_back_201:
 s_lshr_b32 s83, s61, 1
 s_and_b32 s95, s61, 1
 s_mul_i32 s94, s95, 4
 s_add_u32 s94, s94, s60
 s_lshl_b32 s85, s94, 13
 s_sub_u32 s94, 15, s63
 s_lshl_b32 s94, s94, 2
 s_add_u32 s94, s94, s62
 s_lshl_b32 s94, s94, 2
 s_add_u32 s94, s94, s83
 s_mul_i32 s94, s94, 73728
 s_add_u32 s94, s94, 50331648
 s_add_u32 s85, s94, s85
 s_add_u32 s86, s85, 4096
 buffer_load_dwordx4 v[36:39], v14, s[4:7], s85 offen offset:0 sc1
 buffer_load_dwordx4 v[100:103], v14, s[4:7], s85 offen offset:1024 sc1
 buffer_load_dwordx4 v[164:167], v14, s[4:7], s85 offen offset:2048 sc1
 buffer_load_dwordx4 v[228:231], v14, s[4:7], s85 offen offset:3072 sc1
 buffer_load_dwordx4 v[44:47], v14, s[4:7], s86 offen offset:0 sc1
 buffer_load_dwordx4 v[108:111], v14, s[4:7], s86 offen offset:1024 sc1
 buffer_load_dwordx4 v[172:175], v14, s[4:7], s86 offen offset:2048 sc1
 buffer_load_dwordx4 v[236:239], v14, s[4:7], s86 offen offset:3072 sc1
 s_and_b32 s95, s61, 1
 s_xor_b32 s95, s95, 1
 s_or_b32 s95, s95, s60
 s_cmp_eq_u32 s95, 0
 s_cbranch_scc0 L_skip_208
 s_and_b32 s95, s61, 1
 s_mul_i32 s94, s95, 4
 s_add_u32 s94, s94, 4
 s_lshl_b32 s85, s94, 13
 s_sub_u32 s94, 15, s63
 s_lshl_b32 s94, s94, 2
 s_add_u32 s94, s94, s62
 s_lshl_b32 s94, s94, 2
 s_add_u32 s94, s94, s83
 s_mul_i32 s94, s94, 73728
 s_add_u32 s94, s94, 50331648
 s_add_u32 s85, s94, s85
 s_add_u32 s86, s85, 4096
 buffer_load_dwordx4 v[52:55], v14, s[4:7], s85 offen offset:0 sc1
 buffer_load_dwordx4 v[116:119], v14, s[4:7], s85 offen offset:1024 sc1
 buffer_load_dwordx4 v[180:183], v14, s[4:7], s85 offen offset:2048 sc1
 buffer_load_dwordx4 v[244:247], v14, s[4:7], s85 offen offset:3072 sc1
 buffer_load_dwordx4 v[60:63], v14, s[4:7], s86 offen offset:0 sc1
 buffer_load_dwordx4 v[124:127], v14, s[4:7], s86 offen offset:1024 sc1
 buffer_load_dwordx4 v[188:191], v14, s[4:7], s86 offen offset:2048 sc1
 buffer_load_dwordx4 v[252:255], v14, s[4:7], s86 offen offset:3072 sc1
L_skip_208:
 s_waitcnt vmcnt(0)
 v_mov_b32 v20, 0x3f80
 v_mov_b32 v21, 0x3f800000
 v_lshlrev_b32 v64, 16, v36
 v_and_b32 v65, 0xffff0000, v36
 v_lshlrev_b32 v66, 16, v37
 v_and_b32 v67, 0xffff0000, v37
 v_lshlrev_b32 v72, 16, v38
 v_and_b32 v73, 0xffff0000, v38
 v_lshlrev_b32 v74, 16, v39
 v_and_b32 v75, 0xffff0000, v39
 v_dot2_f32_bf16 v64, v100, v20, v64
 v_dot2_f32_bf16 v65, v100, v21, v65
 v_dot2_f32_bf16 v66, v101, v20, v66
 v_dot2_f32_bf16 v67, v101, v21, v67
 v_dot2_f32_bf16 v72, v102, v20, v72
 v_dot2_f32_bf16 v73, v102, v21, v73
 v_dot2_f32_bf16 v74, v103, v20, v74
 v_dot2_f32_bf16 v75, v103, v21, v75
 v_dot2_f32_bf16 v64, v164, v20, v64
 v_dot2_f32_bf16 v65, v164, v21, v65
 v_dot2_f32_bf16 v66, v165, v20, v66
 v_dot2_f32_bf16 v67, v165, v21, v67
 v_dot2_f32_bf16 v72, v166, v20, v72
 v_dot2_f32_bf16 v73, v166, v21, v73
 v_dot2_f32_bf16 v74, v167, v20, v74
 v_dot2_f32_bf16 v75, v167, v21, v75
 v_dot2_f32_bf16 v64, v228, v20, v64
 v_dot2_f32_bf16 v65, v228, v21, v65
 v_dot2_f32_bf16 v66, v229, v20, v66
 v_dot2_f32_bf16 v67, v229, v21, v67
 v_dot2_f32_bf16 v72, v230, v20, v72
 v_dot2_f32_bf16 v73, v230, v21, v73
 v_dot2_f32_bf16 v74, v231, v20, v74
 v_dot2_f32_bf16 v75, v231, v21, v75
 v_dot2_f32_bf16 v64, v44, v20, v64
 v_dot2_f32_bf16 v65, v44, v21, v65
 v_dot2_f32_bf16 v66, v45, v20, v66
 v_dot2_f32_bf16 v67, v45, v21, v67
 v_dot2_f32_bf16 v72, v46, v20, v72
 v_dot2_f32_bf16 v73, v46, v21, v73
 v_dot2_f32_bf16 v74, v47, v20, v74
 v_dot2_f32_bf16 v75, v47, v21, v75
 v_dot2_f32_bf16 v64, v108, v20, v64
 v_dot2_f32_bf16 v65, v108, v21, v65
 v_dot2_f32_bf16 v66, v109, v20, v66
 v_dot2_f32_bf16 v67, v109, v21, v67
 v_dot2_f32_bf16 v72, v110, v20, v72
 v_dot2_f32_bf16 v73, v110, v21, v73
 v_dot2_f32_bf16 v74, v111, v20, v74
 v_dot2_f32_bf16 v75, v111, v21, v75
 v_dot2_f32_bf16 v64, v172, v20, v64
 v_dot2_f32_bf16 v65, v172, v21, v65
 v_dot2_f32_bf16 v66, v173, v20, v66
 v_dot2_f32_bf16 v67, v173, v21, v67
 v_dot2_f32_bf16 v72, v174, v20, v72
 v_dot2_f32_bf16 v73, v174, v21, v73
 v_dot2_f32_bf16 v74, v175, v20, v74
 v_dot2_f32_bf16 v75, v175, v21, v75
 v_dot2_f32_bf16 v64, v236, v20, v64
 v_dot2_f32_bf16 v65, v236, v21, v65
 v_dot2_f32_bf16 v66, v237, v20, v66
 v_dot2_f32_bf16 v67, v237, v21, v67
 v_dot2_f32_bf16 v72, v238, v20, v72
 v_dot2_f32_bf16 v73, v238, v21, v73
 v_dot2_f32_bf16 v74, v239, v20, v74
 v_dot2_f32_bf16 v75, v239, v21, v75
 v_lshlrev_b32 v80, 16, v136
 v_and_b32 v81, 0xffff0000, v136
 v_lshlrev_b32 v82, 16, v137
 v_and_b32 v83, 0xffff0000, v137
 v_lshlrev_b32 v88, 16, v138
 v_and_b32 v89, 0xffff0000, v138
 v_lshlrev_b32 v90, 16, v139
 v_and_b32 v91, 0xffff0000, v139
 v_readfirstlane_b32 s94, v9
 s_sub_u32 s94, s93, s94
 s_cmp_lt_u32 s94, 32
 s_cbranch_scc1 L_ffa_210
L_back_211:
 v_sub_f32 v22, 1.0, v2
 v_mul_f32 v80, v22, v80
 v_fmac_f32 v80, v2, v64
 v_mul_f32 v81, v22, v81
 v_fmac_f32 v81, v2, v65
 v_mul_f32 v82, v22, v82
 v_fmac_f32 v82, v2, v66
 v_mul_f32 v83, v22, v83
 v_fmac_f32 v83, v2, v67
 v_sub_f32 v22, 1.0, v3
 v_mul_f32 v88, v22, v88
 v_fmac_f32 v88, v3, v72
 v_mul_f32 v89, v22, v89
 v_fmac_f32 v89, v3, v73
 v_mul_f32 v90, v22, v90
 v_fmac_f32 v90, v3, v74
 v_mul_f32 v91, v22, v91
 v_fmac_f32 v91, v3, v75
 v_cvt_pk_bf16_f32 v10, v80, v81
 v_cvt_pk_bf16_f32 v11, v82, v83
 v_cvt_pk_bf16_f32 v12, v88, v89
 v_cvt_pk_bf16_f32 v13, v90, v91
 buffer_store_dwordx2 v[10:11], v6, s[32:35], 0 offen
 buffer_store_dwordx2 v[12:13], v6, s[32:35], s84 offen
 s_and_b32 s95, s61, 1
 s_xor_b32 s95, s95, 1
 s_or_b32 s95, s95, s60
 s_cmp_eq_u32 s95, 0
 s_cbranch_scc0 L_skip_209
 v_lshlrev_b32 v64, 16, v52
 v_and_b32 v65, 0xffff0000, v52
 v_lshlrev_b32 v66, 16, v53
 v_and_b32 v67, 0xffff0000, v53
 v_lshlrev_b32 v72, 16, v54
 v_and_b32 v73, 0xffff0000, v54
 v_lshlrev_b32 v74, 16, v55
 v_and_b32 v75, 0xffff0000, v55
 v_dot2_f32_bf16 v64, v116, v20, v64
 v_dot2_f32_bf16 v65, v116, v21, v65
 v_dot2_f32_bf16 v66, v117, v20, v66
 v_dot2_f32_bf16 v67, v117, v21, v67
 v_dot2_f32_bf16 v72, v118, v20, v72
 v_dot2_f32_bf16 v73, v118, v21, v73
 v_dot2_f32_bf16 v74, v119, v20, v74
 v_dot2_f32_bf16 v75, v119, v21, v75
 v_dot2_f32_bf16 v64, v180, v20, v64
 v_dot2_f32_bf16 v65, v180, v21, v65
 v_dot2_f32_bf16 v66, v181, v20, v66
 v_dot2_f32_bf16 v67, v181, v21, v67
 v_dot2_f32_bf16 v72, v182, v20, v72
 v_dot2_f32_bf16 v73, v182, v21, v73
 v_dot2_f32_bf16 v74, v183, v20, v74
 v_dot2_f32_bf16 v75, v183, v21, v75
 v_dot2_f32_bf16 v64, v244, v20, v64
 v_dot2_f32_bf16 v65, v244, v21, v65
 v_dot2_f32_bf16 v66, v245, v20, v66
 v_dot2_f32_bf16 v67, v245, v21, v67
 v_dot2_f32_bf16 v72, v246, v20, v72
 v_dot2_f32_bf16 v73, v246, v21, v73
 v_dot2_f32_bf16 v74, v247, v20, v74
 v_dot2_f32_bf16 v75, v247, v21, v75
 v_dot2_f32_bf16 v64, v60, v20, v64
 v_dot2_f32_bf16 v65, v60, v21, v65
 v_dot2_f32_bf16 v66, v61, v20, v66
 v_dot2_f32_bf16 v67, v61, v21, v67
 v_dot2_f32_bf16 v72, v62, v20, v72
 v_dot2_f32_bf16 v73, v62, v21, v73
 v_dot2_f32_bf16 v74, v63, v20, v74
 v_dot2_f32_bf16 v75, v63, v21, v75
 v_dot2_f32_bf16 v64, v124, v20, v64
 v_dot2_f32_bf16 v65, v124, v21, v65
 v_dot2_f32_bf16 v66, v125, v20, v66
 v_dot2_f32_bf16 v67, v125, v21, v67
 v_dot2_f32_bf16 v72, v126, v20, v72
 v_dot2_f32_bf16 v73, v126, v21, v73
 v_dot2_f32_bf16 v74, v127, v20, v74
 v_dot2_f32_bf16 v75, v127, v21, v75
 v_dot2_f32_bf16 v64, v188, v20, v64
 v_dot2_f32_bf16 v65, v188, v21, v65
 v_dot2_f32_bf16 v66, v189, v20, v66
 v_dot2_f32_bf16 v67, v189, v21, v67
 v_dot2_f32_bf16 v72, v190, v20, v72
 v_dot2_f32_bf16 v73, v190, v21, v73
 v_dot2_f32_bf16 v74, v191, v20, v74
 v_dot2_f32_bf16 v75, v191, v21, v75
 v_dot2_f32_bf16 v64, v252, v20, v64
 v_dot2_f32_bf16 v65, v252, v21, v65
 v_dot2_f32_bf16 v66, v253, v20, v66
 v_dot2_f32_bf16 v67, v253, v21, v67
 v_dot2_f32_bf16 v72, v254, v20, v72
 v_dot2_f32_bf16 v73, v254, v21, v73
 v_dot2_f32_bf16 v74, v255, v20, v74
 v_dot2_f32_bf16 v75, v255, v21, v75
 v_lshlrev_b32 v80, 16, v144
 v_and_b32 v81, 0xffff0000, v144
 v_lshlrev_b32 v82, 16, v145
 v_and_b32 v83, 0xffff0000, v145
 v_lshlrev_b32 v88, 16, v146
 v_and_b32 v89, 0xffff0000, v146
 v_lshlrev_b32 v90, 16, v147
 v_and_b32 v91, 0xffff0000, v147
 v_readfirstlane_b32 s94, v9
 s_sub_u32 s94, s93, s94
 s_cmp_lt_u32 s94, 32
 s_cbranch_scc1 L_ffa_212
L_back_213:
 v_sub_f32 v22, 1.0, v2
 v_mul_f32 v80, v22, v80
 v_fmac_f32 v80, v2, v64
 v_mul_f32 v81, v22, v81
 v_fmac_f32 v81, v2, v65
 v_mul_f32 v82, v22, v82
 v_fmac_f32 v82, v2, v66
 v_mul_f32 v83, v22, v83
 v_fmac_f32 v83, v2, v67
 v_sub_f32 v22, 1.0, v3
 v_mul_f32 v88, v22, v88
 v_fmac_f32 v88, v3, v72
 v_mul_f32 v89, v22, v89
 v_fmac_f32 v89, v3, v73
 v_mul_f32 v90, v22, v90
 v_fmac_f32 v90, v3, v74
 v_mul_f32 v91, v22, v91
 v_fmac_f32 v91, v3, v75
 v_cvt_pk_bf16_f32 v10, v80, v81
 v_cvt_pk_bf16_f32 v11, v82, v83
 v_cvt_pk_bf16_f32 v12, v88, v89
 v_cvt_pk_bf16_f32 v13, v90, v91
 buffer_store_dwordx2 v[10:11], v7, s[32:35], 0 offen
 buffer_store_dwordx2 v[12:13], v7, s[32:35], s84 offen
L_skip_209:
L_end:
 s_endpgm
L_fence_86:
 buffer_wbl2 sc1
 s_waitcnt vmcnt(0)
 s_branch L_back_87
L_spin_106:
 s_mov_b32 s69, 0x4000
L_spin_106_l:
 s_sleep 2
 v_lshrrev_b32 v15, 2, v14
 buffer_load_dword v15, v15, s[36:39], 0 offen sc1
 s_waitcnt vmcnt(0)
 v_and_b32 v22, 0x80808080, v15
 v_cmp_ne_u32 vcc, 0x80808080, v22
 s_cmp_eq_u64 vcc, 0
 s_cbranch_scc1 L_back_105
 s_sub_u32 s69, s69, 1
 s_cmp_lg_u32 s69, 0
 s_cbranch_scc1 L_spin_106_l
 s_branch L_back_105
L_spin_108:
 s_mov_b32 s69, 0x4000
L_spin_108_l:
 s_sleep 2
 buffer_load_dword v15, v19, s[4:7], 0 offen sc1
 s_waitcnt vmcnt(0)
 v_cmp_eq_u32 vcc, 1, v15
 s_and_b32 s94, vcc_lo, 255
 s_cmp_eq_u32 s94, 255
 s_cbranch_scc1 L_back_107
 s_sub_u32 s69, s69, 1
 s_cmp_lg_u32 s69, 0
 s_cbranch_scc1 L_spin_108_l
 s_branch L_back_107
L_fence_109:
 buffer_inv sc1
 s_waitcnt vmcnt(0)
 s_branch L_back_110
L_fence_111:
 buffer_wbl2 sc1
 s_waitcnt vmcnt(0)
 s_branch L_back_112
L_tr_115:
 s_call_b64 s[88:89], L_rare_d0d
 s_branch L_back_114
L_rare_d0d:
 s_nop 7
 s_nop 1
 v_max3_f32 v64, v36, v37, v38
 v_max3_f32 v64, v64, v39, v100
 v_max3_f32 v64, v64, v101, v102
 v_max_f32 v64, v64, v103
 v_mov_b32 v72, v64
 s_nop 1
 v_permlane32_swap_b32 v64, v72
 v_max_f32 v64, v64, v72
 v_mov_b32 v72, v64
 s_nop 1
 v_permlane16_swap_b32 v64, v72
 v_max_f32 v64, v64, v72
 v_add_f32 v64, 0x41a00000, v64
 v_max_f32 v64, 0, v64
 v_sub_f32 v65, 0, v64
 v_exp_f32 v65, v65
 v_sub_f32 v160, v160, v64
 v_sub_f32 v161, v161, v64
 v_sub_f32 v162, v162, v64
 v_sub_f32 v163, v163, v64
 v_mul_f32 v120, v120, v65
 v_mul_f32 v121, v121, v65
 v_mul_f32 v122, v122, v65
 v_mul_f32 v123, v123, v65
 v_accvgpr_read_b32 v72, a0
 v_accvgpr_read_b32 v73, a1
 v_accvgpr_read_b32 v74, a2
 v_accvgpr_read_b32 v75, a3
 v_mul_f32 v72, v72, v65
 v_mul_f32 v73, v73, v65
 v_mul_f32 v74, v74, v65
 v_mul_f32 v75, v75, v65
 v_accvgpr_write_b32 a0, v72
 v_accvgpr_write_b32 a1, v73
 v_accvgpr_write_b32 a2, v74
 v_accvgpr_write_b32 a3, v75
 v_accvgpr_read_b32 v72, a4
 v_accvgpr_read_b32 v73, a5
 v_accvgpr_read_b32 v74, a6
 v_accvgpr_read_b32 v75, a7
 v_mul_f32 v72, v72, v65
 v_mul_f32 v73, v73, v65
 v_mul_f32 v74, v74, v65
 v_mul_f32 v75, v75, v65
 v_accvgpr_write_b32 a4, v72
 v_accvgpr_write_b32 a5, v73
 v_accvgpr_write_b32 a6, v74
 v_accvgpr_write_b32 a7, v75
 v_accvgpr_read_b32 v72, a8
 v_accvgpr_read_b32 v73, a9
 v_accvgpr_read_b32 v74, a10
 v_accvgpr_read_b32 v75, a11
 v_mul_f32 v72, v72, v65
 v_mul_f32 v73, v73, v65
 v_mul_f32 v74, v74, v65
 v_mul_f32 v75, v75, v65
 v_accvgpr_write_b32 a8, v72
 v_accvgpr_write_b32 a9, v73
 v_accvgpr_write_b32 a10, v74
 v_accvgpr_write_b32 a11, v75
 v_accvgpr_read_b32 v72, a12
 v_accvgpr_read_b32 v73, a13
 v_accvgpr_read_b32 v74, a14
 v_accvgpr_read_b32 v75, a15
 v_mul_f32 v72, v72, v65
 v_mul_f32 v73, v73, v65
 v_mul_f32 v74, v74, v65
 v_mul_f32 v75, v75, v65
 v_accvgpr_write_b32 a12, v72
 v_accvgpr_write_b32 a13, v73
 v_accvgpr_write_b32 a14, v74
 v_accvgpr_write_b32 a15, v75
 v_accvgpr_read_b32 v72, a16
 v_accvgpr_read_b32 v73, a17
 v_accvgpr_read_b32 v74, a18
 v_accvgpr_read_b32 v75, a19
 v_mul_f32 v72, v72, v65
 v_mul_f32 v73, v73, v65
 v_mul_f32 v74, v74, v65
 v_mul_f32 v75, v75, v65
 v_accvgpr_write_b32 a16, v72
 v_accvgpr_write_b32 a17, v73
 v_accvgpr_write_b32 a18, v74
 v_accvgpr_write_b32 a19, v75
 v_accvgpr_read_b32 v72, a20
 v_accvgpr_read_b32 v73, a21
 v_accvgpr_read_b32 v74, a22
 v_accvgpr_read_b32 v75, a23
 v_mul_f32 v72, v72, v65
 v_mul_f32 v73, v73, v65
 v_mul_f32 v74, v74, v65
 v_mul_f32 v75, v75, v65
 v_accvgpr_write_b32 a20, v72
 v_accvgpr_write_b32 a21, v73
 v_accvgpr_write_b32 a22, v74
 v_accvgpr_write_b32 a23, v75
 v_accvgpr_read_b32 v72, a24
 v_accvgpr_read_b32 v73, a25
 v_accvgpr_read_b32 v74, a26
 v_accvgpr_read_b32 v75, a27
 v_mul_f32 v72, v72, v65
 v_mul_f32 v73, v73, v65
 v_mul_f32 v74, v74, v65
 v_mul_f32 v75, v75, v65
 v_accvgpr_write_b32 a24, v72
 v_accvgpr_write_b32 a25, v73
 v_accvgpr_write_b32 a26, v74
 v_accvgpr_write_b32 a27, v75
 v_accvgpr_read_b32 v72, a28
 v_accvgpr_read_b32 v73, a29
 v_accvgpr_read_b32 v74, a30
 v_accvgpr_read_b32 v75, a31
 v_mul_f32 v72, v72, v65
 v_mul_f32 v73, v73, v65
 v_mul_f32 v74, v74, v65
 v_mul_f32 v75, v75, v65
 v_accvgpr_write_b32 a28, v72
 v_accvgpr_write_b32 a29, v73
 v_accvgpr_write_b32 a30, v74
 v_accvgpr_write_b32 a31, v75
 v_sub_f32 v36, v36, v64
 v_sub_f32 v37, v37, v64
 v_sub_f32 v38, v38, v64
 v_sub_f32 v39, v39, v64
 v_sub_f32 v100, v100, v64
 v_sub_f32 v101, v101, v64
 v_sub_f32 v102, v102, v64
 v_sub_f32 v103, v103, v64
 v_sub_f32 v164, v164, v64
 v_sub_f32 v165, v165, v64
 v_sub_f32 v166, v166, v64
 v_sub_f32 v167, v167, v64
 v_sub_f32 v228, v228, v64
 v_sub_f32 v229, v229, v64
 v_sub_f32 v230, v230, v64
 v_sub_f32 v231, v231, v64
 v_max3_f32 v64, v44, v45, v46
 v_max3_f32 v64, v64, v47, v108
 v_max3_f32 v64, v64, v109, v110
 v_max_f32 v64, v64, v111
 v_mov_b32 v72, v64
 s_nop 1
 v_permlane32_swap_b32 v64, v72
 v_max_f32 v64, v64, v72
 v_mov_b32 v72, v64
 s_nop 1
 v_permlane16_swap_b32 v64, v72
 v_max_f32 v64, v64, v72
 v_add_f32 v64, 0x41a00000, v64
 v_max_f32 v64, 0, v64
 v_sub_f32 v65, 0, v64
 v_exp_f32 v65, v65
 v_sub_f32 v168, v168, v64
 v_sub_f32 v169, v169, v64
 v_sub_f32 v170, v170, v64
 v_sub_f32 v171, v171, v64
 v_mul_f32 v128, v128, v65
 v_mul_f32 v129, v129, v65
 v_mul_f32 v130, v130, v65
 v_mul_f32 v131, v131, v65
 v_accvgpr_read_b32 v72, a32
 v_accvgpr_read_b32 v73, a33
 v_accvgpr_read_b32 v74, a34
 v_accvgpr_read_b32 v75, a35
 v_mul_f32 v72, v72, v65
 v_mul_f32 v73, v73, v65
 v_mul_f32 v74, v74, v65
 v_mul_f32 v75, v75, v65
 v_accvgpr_write_b32 a32, v72
 v_accvgpr_write_b32 a33, v73
 v_accvgpr_write_b32 a34, v74
 v_accvgpr_write_b32 a35, v75
 v_accvgpr_read_b32 v72, a36
 v_accvgpr_read_b32 v73, a37
 v_accvgpr_read_b32 v74, a38
 v_accvgpr_read_b32 v75, a39
 v_mul_f32 v72, v72, v65
 v_mul_f32 v73, v73, v65
 v_mul_f32 v74, v74, v65
 v_mul_f32 v75, v75, v65
 v_accvgpr_write_b32 a36, v72
 v_accvgpr_write_b32 a37, v73
 v_accvgpr_write_b32 a38, v74
 v_accvgpr_write_b32 a39, v75
 v_accvgpr_read_b32 v72, a40
 v_accvgpr_read_b32 v73, a41
 v_accvgpr_read_b32 v74, a42
 v_accvgpr_read_b32 v75, a43
 v_mul_f32 v72, v72, v65
 v_mul_f32 v73, v73, v65
 v_mul_f32 v74, v74, v65
 v_mul_f32 v75, v75, v65
 v_accvgpr_write_b32 a40, v72
 v_accvgpr_write_b32 a41, v73
 v_accvgpr_write_b32 a42, v74
 v_accvgpr_write_b32 a43, v75
 v_accvgpr_read_b32 v72, a44
 v_accvgpr_read_b32 v73, a45
 v_accvgpr_read_b32 v74, a46
 v_accvgpr_read_b32 v75, a47
 v_mul_f32 v72, v72, v65
 v_mul_f32 v73, v73, v65
 v_mul_f32 v74, v74, v65
 v_mul_f32 v75, v75, v65
 v_accvgpr_write_b32 a44, v72
 v_accvgpr_write_b32 a45, v73
 v_accvgpr_write_b32 a46, v74
 v_accvgpr_write_b32 a47, v75
 v_accvgpr_read_b32 v72, a48
 v_accvgpr_read_b32 v73, a49
 v_accvgpr_read_b32 v74, a50
 v_accvgpr_read_b32 v75, a51
 v_mul_f32 v72, v72, v65
 v_mul_f32 v73, v73, v65
 v_mul_f32 v74, v74, v65
 v_mul_f32 v75, v75, v65
 v_accvgpr_write_b32 a48, v72
 v_accvgpr_write_b32 a49, v73
 v_accvgpr_write_b32 a50, v74
 v_accvgpr_write_b32 a51, v75
 v_accvgpr_read_b32 v72, a52
 v_accvgpr_read_b32 v73, a53
 v_accvgpr_read_b32 v74, a54
 v_accvgpr_read_b32 v75, a55
 v_mul_f32 v72, v72, v65
 v_mul_f32 v73, v73, v65
 v_mul_f32 v74, v74, v65
 v_mul_f32 v75, v75, v65
 v_accvgpr_write_b32 a52, v72
 v_accvgpr_write_b32 a53, v73
 v_accvgpr_write_b32 a54, v74
 v_accvgpr_write_b32 a55, v75
 v_accvgpr_read_b32 v72, a56
 v_accvgpr_read_b32 v73, a57
 v_accvgpr_read_b32 v74, a58
 v_accvgpr_read_b32 v75, a59
 v_mul_f32 v72, v72, v65
 v_mul_f32 v73, v73, v65
 v_mul_f32 v74, v74, v65
 v_mul_f32 v75, v75, v65
 v_accvgpr_write_b32 a56, v72
 v_accvgpr_write_b32 a57, v73
 v_accvgpr_write_b32 a58, v74
 v_accvgpr_write_b32 a59, v75
 v_accvgpr_read_b32 v72, a60
 v_accvgpr_read_b32 v73, a61
 v_accvgpr_read_b32 v74, a62
 v_accvgpr_read_b32 v75, a63
 v_mul_f32 v72, v72, v65
 v_mul_f32 v73, v73, v65
 v_mul_f32 v74, v74, v65
 v_mul_f32 v75, v75, v65
 v_accvgpr_write_b32 a60, v72
 v_accvgpr_write_b32 a61, v73
 v_accvgpr_write_b32 a62, v74
 v_accvgpr_write_b32 a63, v75
 v_sub_f32 v44, v44, v64
 v_sub_f32 v45, v45, v64
 v_sub_f32 v46, v46, v64
 v_sub_f32 v47, v47, v64
 v_sub_f32 v108, v108, v64
 v_sub_f32 v109, v109, v64
 v_sub_f32 v110, v110, v64
 v_sub_f32 v111, v111, v64
 v_sub_f32 v172, v172, v64
 v_sub_f32 v173, v173, v64
 v_sub_f32 v174, v174, v64
 v_sub_f32 v175, v175, v64
 v_sub_f32 v236, v236, v64
 v_sub_f32 v237, v237, v64
 v_sub_f32 v238, v238, v64
 v_sub_f32 v239, v239, v64
 v_max3_f32 v64, v52, v53, v54
 v_max3_f32 v64, v64, v55, v116
 v_max3_f32 v64, v64, v117, v118
 v_max_f32 v64, v64, v119
 v_mov_b32 v72, v64
 s_nop 1
 v_permlane32_swap_b32 v64, v72
 v_max_f32 v64, v64, v72
 v_mov_b32 v72, v64
 s_nop 1
 v_permlane16_swap_b32 v64, v72
 v_max_f32 v64, v64, v72
 v_add_f32 v64, 0x41a00000, v64
 v_max_f32 v64, 0, v64
 v_sub_f32 v65, 0, v64
 v_exp_f32 v65, v65
 v_sub_f32 v176, v176, v64
 v_sub_f32 v177, v177, v64
 v_sub_f32 v178, v178, v64
 v_sub_f32 v179, v179, v64
 v_mul_f32 v136, v136, v65
 v_mul_f32 v137, v137, v65
 v_mul_f32 v138, v138, v65
 v_mul_f32 v139, v139, v65
 v_accvgpr_read_b32 v72, a64
 v_accvgpr_read_b32 v73, a65
 v_accvgpr_read_b32 v74, a66
 v_accvgpr_read_b32 v75, a67
 v_mul_f32 v72, v72, v65
 v_mul_f32 v73, v73, v65
 v_mul_f32 v74, v74, v65
 v_mul_f32 v75, v75, v65
 v_accvgpr_write_b32 a64, v72
 v_accvgpr_write_b32 a65, v73
 v_accvgpr_write_b32 a66, v74
 v_accvgpr_write_b32 a67, v75
 v_accvgpr_read_b32 v72, a68
 v_accvgpr_read_b32 v73, a69
 v_accvgpr_read_b32 v74, a70
 v_accvgpr_read_b32 v75, a71
 v_mul_f32 v72, v72, v65
 v_mul_f32 v73, v73, v65
 v_mul_f32 v74, v74, v65
 v_mul_f32 v75, v75, v65
 v_accvgpr_write_b32 a68, v72
 v_accvgpr_write_b32 a69, v73
 v_accvgpr_write_b32 a70, v74
 v_accvgpr_write_b32 a71, v75
 v_accvgpr_read_b32 v72, a72
 v_accvgpr_read_b32 v73, a73
 v_accvgpr_read_b32 v74, a74
 v_accvgpr_read_b32 v75, a75
 v_mul_f32 v72, v72, v65
 v_mul_f32 v73, v73, v65
 v_mul_f32 v74, v74, v65
 v_mul_f32 v75, v75, v65
 v_accvgpr_write_b32 a72, v72
 v_accvgpr_write_b32 a73, v73
 v_accvgpr_write_b32 a74, v74
 v_accvgpr_write_b32 a75, v75
 v_accvgpr_read_b32 v72, a76
 v_accvgpr_read_b32 v73, a77
 v_accvgpr_read_b32 v74, a78
 v_accvgpr_read_b32 v75, a79
 v_mul_f32 v72, v72, v65
 v_mul_f32 v73, v73, v65
 v_mul_f32 v74, v74, v65
 v_mul_f32 v75, v75, v65
 v_accvgpr_write_b32 a76, v72
 v_accvgpr_write_b32 a77, v73
 v_accvgpr_write_b32 a78, v74
 v_accvgpr_write_b32 a79, v75
 v_accvgpr_read_b32 v72, a80
 v_accvgpr_read_b32 v73, a81
 v_accvgpr_read_b32 v74, a82
 v_accvgpr_read_b32 v75, a83
 v_mul_f32 v72, v72, v65
 v_mul_f32 v73, v73, v65
 v_mul_f32 v74, v74, v65
 v_mul_f32 v75, v75, v65
 v_accvgpr_write_b32 a80, v72
 v_accvgpr_write_b32 a81, v73
 v_accvgpr_write_b32 a82, v74
 v_accvgpr_write_b32 a83, v75
 v_accvgpr_read_b32 v72, a84
 v_accvgpr_read_b32 v73, a85
 v_accvgpr_read_b32 v74, a86
 v_accvgpr_read_b32 v75, a87
 v_mul_f32 v72, v72, v65
 v_mul_f32 v73, v73, v65
 v_mul_f32 v74, v74, v65
 v_mul_f32 v75, v75, v65
 v_accvgpr_write_b32 a84, v72
 v_accvgpr_write_b32 a85, v73
 v_accvgpr_write_b32 a86, v74
 v_accvgpr_write_b32 a87, v75
 v_accvgpr_read_b32 v72, a88
 v_accvgpr_read_b32 v73, a89
 v_accvgpr_read_b32 v74, a90
 v_accvgpr_read_b32 v75, a91
 v_mul_f32 v72, v72, v65
 v_mul_f32 v73, v73, v65
 v_mul_f32 v74, v74, v65
 v_mul_f32 v75, v75, v65
 v_accvgpr_write_b32 a88, v72
 v_accvgpr_write_b32 a89, v73
 v_accvgpr_write_b32 a90, v74
 v_accvgpr_write_b32 a91, v75
 v_accvgpr_read_b32 v72, a92
 v_accvgpr_read_b32 v73, a93
 v_accvgpr_read_b32 v74, a94
 v_accvgpr_read_b32 v75, a95
 v_mul_f32 v72, v72, v65
 v_mul_f32 v73, v73, v65
 v_mul_f32 v74, v74, v65
 v_mul_f32 v75, v75, v65
 v_accvgpr_write_b32 a92, v72
 v_accvgpr_write_b32 a93, v73
 v_accvgpr_write_b32 a94, v74
 v_accvgpr_write_b32 a95, v75
 v_sub_f32 v52, v52, v64
 v_sub_f32 v53, v53, v64
 v_sub_f32 v54, v54, v64
 v_sub_f32 v55, v55, v64
 v_sub_f32 v116, v116, v64
 v_sub_f32 v117, v117, v64
 v_sub_f32 v118, v118, v64
 v_sub_f32 v119, v119, v64
 v_sub_f32 v180, v180, v64
 v_sub_f32 v181, v181, v64
 v_sub_f32 v182, v182, v64
 v_sub_f32 v183, v183, v64
 v_sub_f32 v244, v244, v64
 v_sub_f32 v245, v245, v64
 v_sub_f32 v246, v246, v64
 v_sub_f32 v247, v247, v64
 v_max3_f32 v64, v60, v61, v62
 v_max3_f32 v64, v64, v63, v124
 v_max3_f32 v64, v64, v125, v126
 v_max_f32 v64, v64, v127
 v_mov_b32 v72, v64
 s_nop 1
 v_permlane32_swap_b32 v64, v72
 v_max_f32 v64, v64, v72
 v_mov_b32 v72, v64
 s_nop 1
 v_permlane16_swap_b32 v64, v72
 v_max_f32 v64, v64, v72
 v_add_f32 v64, 0x41a00000, v64
 v_max_f32 v64, 0, v64
 v_sub_f32 v65, 0, v64
 v_exp_f32 v65, v65
 v_sub_f32 v184, v184, v64
 v_sub_f32 v185, v185, v64
 v_sub_f32 v186, v186, v64
 v_sub_f32 v187, v187, v64
 v_mul_f32 v144, v144, v65
 v_mul_f32 v145, v145, v65
 v_mul_f32 v146, v146, v65
 v_mul_f32 v147, v147, v65
 v_accvgpr_read_b32 v72, a96
 v_accvgpr_read_b32 v73, a97
 v_accvgpr_read_b32 v74, a98
 v_accvgpr_read_b32 v75, a99
 v_mul_f32 v72, v72, v65
 v_mul_f32 v73, v73, v65
 v_mul_f32 v74, v74, v65
 v_mul_f32 v75, v75, v65
 v_accvgpr_write_b32 a96, v72
 v_accvgpr_write_b32 a97, v73
 v_accvgpr_write_b32 a98, v74
 v_accvgpr_write_b32 a99, v75
 v_accvgpr_read_b32 v72, a100
 v_accvgpr_read_b32 v73, a101
 v_accvgpr_read_b32 v74, a102
 v_accvgpr_read_b32 v75, a103
 v_mul_f32 v72, v72, v65
 v_mul_f32 v73, v73, v65
 v_mul_f32 v74, v74, v65
 v_mul_f32 v75, v75, v65
 v_accvgpr_write_b32 a100, v72
 v_accvgpr_write_b32 a101, v73
 v_accvgpr_write_b32 a102, v74
 v_accvgpr_write_b32 a103, v75
 v_accvgpr_read_b32 v72, a104
 v_accvgpr_read_b32 v73, a105
 v_accvgpr_read_b32 v74, a106
 v_accvgpr_read_b32 v75, a107
 v_mul_f32 v72, v72, v65
 v_mul_f32 v73, v73, v65
 v_mul_f32 v74, v74, v65
 v_mul_f32 v75, v75, v65
 v_accvgpr_write_b32 a104, v72
 v_accvgpr_write_b32 a105, v73
 v_accvgpr_write_b32 a106, v74
 v_accvgpr_write_b32 a107, v75
 v_accvgpr_read_b32 v72, a108
 v_accvgpr_read_b32 v73, a109
 v_accvgpr_read_b32 v74, a110
 v_accvgpr_read_b32 v75, a111
 v_mul_f32 v72, v72, v65
 v_mul_f32 v73, v73, v65
 v_mul_f32 v74, v74, v65
 v_mul_f32 v75, v75, v65
 v_accvgpr_write_b32 a108, v72
 v_accvgpr_write_b32 a109, v73
 v_accvgpr_write_b32 a110, v74
 v_accvgpr_write_b32 a111, v75
 v_accvgpr_read_b32 v72, a112
 v_accvgpr_read_b32 v73, a113
 v_accvgpr_read_b32 v74, a114
 v_accvgpr_read_b32 v75, a115
 v_mul_f32 v72, v72, v65
 v_mul_f32 v73, v73, v65
 v_mul_f32 v74, v74, v65
 v_mul_f32 v75, v75, v65
 v_accvgpr_write_b32 a112, v72
 v_accvgpr_write_b32 a113, v73
 v_accvgpr_write_b32 a114, v74
 v_accvgpr_write_b32 a115, v75
 v_accvgpr_read_b32 v72, a116
 v_accvgpr_read_b32 v73, a117
 v_accvgpr_read_b32 v74, a118
 v_accvgpr_read_b32 v75, a119
 v_mul_f32 v72, v72, v65
 v_mul_f32 v73, v73, v65
 v_mul_f32 v74, v74, v65
 v_mul_f32 v75, v75, v65
 v_accvgpr_write_b32 a116, v72
 v_accvgpr_write_b32 a117, v73
 v_accvgpr_write_b32 a118, v74
 v_accvgpr_write_b32 a119, v75
 v_accvgpr_read_b32 v72, a120
 v_accvgpr_read_b32 v73, a121
 v_accvgpr_read_b32 v74, a122
 v_accvgpr_read_b32 v75, a123
 v_mul_f32 v72, v72, v65
 v_mul_f32 v73, v73, v65
 v_mul_f32 v74, v74, v65
 v_mul_f32 v75, v75, v65
 v_accvgpr_write_b32 a120, v72
 v_accvgpr_write_b32 a121, v73
 v_accvgpr_write_b32 a122, v74
 v_accvgpr_write_b32 a123, v75
 v_accvgpr_read_b32 v72, a124
 v_accvgpr_read_b32 v73, a125
 v_accvgpr_read_b32 v74, a126
 v_accvgpr_read_b32 v75, a127
 v_mul_f32 v72, v72, v65
 v_mul_f32 v73, v73, v65
 v_mul_f32 v74, v74, v65
 v_mul_f32 v75, v75, v65
 v_accvgpr_write_b32 a124, v72
 v_accvgpr_write_b32 a125, v73
 v_accvgpr_write_b32 a126, v74
 v_accvgpr_write_b32 a127, v75
 v_sub_f32 v60, v60, v64
 v_sub_f32 v61, v61, v64
 v_sub_f32 v62, v62, v64
 v_sub_f32 v63, v63, v64
 v_sub_f32 v124, v124, v64
 v_sub_f32 v125, v125, v64
 v_sub_f32 v126, v126, v64
 v_sub_f32 v127, v127, v64
 v_sub_f32 v188, v188, v64
 v_sub_f32 v189, v189, v64
 v_sub_f32 v190, v190, v64
 v_sub_f32 v191, v191, v64
 v_sub_f32 v252, v252, v64
 v_sub_f32 v253, v253, v64
 v_sub_f32 v254, v254, v64
 v_sub_f32 v255, v255, v64
 v_exp_f32 v20, v36
 v_exp_f32 v21, v37
 s_nop 0
 v_cvt_pk_bf16_f32 v192, v20, v21
 v_exp_f32 v20, v38
 v_exp_f32 v21, v39
 s_nop 0
 v_cvt_pk_bf16_f32 v193, v20, v21
 v_exp_f32 v20, v100
 v_exp_f32 v21, v101
 s_nop 0
 v_cvt_pk_bf16_f32 v194, v20, v21
 v_exp_f32 v20, v102
 v_exp_f32 v21, v103
 s_nop 0
 v_cvt_pk_bf16_f32 v195, v20, v21
 v_exp_f32 v20, v44
 v_exp_f32 v21, v45
 s_nop 0
 v_cvt_pk_bf16_f32 v200, v20, v21
 v_exp_f32 v20, v46
 v_exp_f32 v21, v47
 s_nop 0
 v_cvt_pk_bf16_f32 v201, v20, v21
 v_exp_f32 v20, v108
 v_exp_f32 v21, v109
 s_nop 0
 v_cvt_pk_bf16_f32 v202, v20, v21
 v_exp_f32 v20, v110
 v_exp_f32 v21, v111
 s_nop 0
 v_cvt_pk_bf16_f32 v203, v20, v21
 v_exp_f32 v20, v52
 v_exp_f32 v21, v53
 s_nop 0
 v_cvt_pk_bf16_f32 v208, v20, v21
 v_exp_f32 v20, v54
 v_exp_f32 v21, v55
 s_nop 0
 v_cvt_pk_bf16_f32 v209, v20, v21
 v_exp_f32 v20, v116
 v_exp_f32 v21, v117
 s_nop 0
 v_cvt_pk_bf16_f32 v210, v20, v21
 v_exp_f32 v20, v118
 v_exp_f32 v21, v119
 s_nop 0
 v_cvt_pk_bf16_f32 v211, v20, v21
 v_exp_f32 v20, v60
 v_exp_f32 v21, v61
 s_nop 0
 v_cvt_pk_bf16_f32 v216, v20, v21
 v_exp_f32 v20, v62
 v_exp_f32 v21, v63
 s_nop 0
 v_cvt_pk_bf16_f32 v217, v20, v21
 v_exp_f32 v20, v124
 v_exp_f32 v21, v125
 s_nop 0
 v_cvt_pk_bf16_f32 v218, v20, v21
 v_exp_f32 v20, v126
 v_exp_f32 v21, v127
 s_nop 0
 v_cvt_pk_bf16_f32 v219, v20, v21
 s_nop 1
 s_setpc_b64 s[88:89]
L_tr_117:
 s_call_b64 s[88:89], L_rare_d1d
 s_branch L_back_116
L_rare_d1d:
 s_nop 7
 s_nop 1
 v_max3_f32 v64, v164, v165, v166
 v_max3_f32 v64, v64, v167, v228
 v_max3_f32 v64, v64, v229, v230
 v_max_f32 v64, v64, v231
 v_mov_b32 v72, v64
 s_nop 1
 v_permlane32_swap_b32 v64, v72
 v_max_f32 v64, v64, v72
 v_mov_b32 v72, v64
 s_nop 1
 v_permlane16_swap_b32 v64, v72
 v_max_f32 v64, v64, v72
 v_add_f32 v64, 0x41a00000, v64
 v_max_f32 v64, 0, v64
 v_sub_f32 v65, 0, v64
 v_exp_f32 v65, v65
 v_sub_f32 v160, v160, v64
 v_sub_f32 v161, v161, v64
 v_sub_f32 v162, v162, v64
 v_sub_f32 v163, v163, v64
 v_mul_f32 v120, v120, v65
 v_mul_f32 v121, v121, v65
 v_mul_f32 v122, v122, v65
 v_mul_f32 v123, v123, v65
 v_accvgpr_read_b32 v72, a0
 v_accvgpr_read_b32 v73, a1
 v_accvgpr_read_b32 v74, a2
 v_accvgpr_read_b32 v75, a3
 v_mul_f32 v72, v72, v65
 v_mul_f32 v73, v73, v65
 v_mul_f32 v74, v74, v65
 v_mul_f32 v75, v75, v65
 v_accvgpr_write_b32 a0, v72
 v_accvgpr_write_b32 a1, v73
 v_accvgpr_write_b32 a2, v74
 v_accvgpr_write_b32 a3, v75
 v_accvgpr_read_b32 v72, a4
 v_accvgpr_read_b32 v73, a5
 v_accvgpr_read_b32 v74, a6
 v_accvgpr_read_b32 v75, a7
 v_mul_f32 v72, v72, v65
 v_mul_f32 v73, v73, v65
 v_mul_f32 v74, v74, v65
 v_mul_f32 v75, v75, v65
 v_accvgpr_write_b32 a4, v72
 v_accvgpr_write_b32 a5, v73
 v_accvgpr_write_b32 a6, v74
 v_accvgpr_write_b32 a7, v75
 v_accvgpr_read_b32 v72, a8
 v_accvgpr_read_b32 v73, a9
 v_accvgpr_read_b32 v74, a10
 v_accvgpr_read_b32 v75, a11
 v_mul_f32 v72, v72, v65
 v_mul_f32 v73, v73, v65
 v_mul_f32 v74, v74, v65
 v_mul_f32 v75, v75, v65
 v_accvgpr_write_b32 a8, v72
 v_accvgpr_write_b32 a9, v73
 v_accvgpr_write_b32 a10, v74
 v_accvgpr_write_b32 a11, v75
 v_accvgpr_read_b32 v72, a12
 v_accvgpr_read_b32 v73, a13
 v_accvgpr_read_b32 v74, a14
 v_accvgpr_read_b32 v75, a15
 v_mul_f32 v72, v72, v65
 v_mul_f32 v73, v73, v65
 v_mul_f32 v74, v74, v65
 v_mul_f32 v75, v75, v65
 v_accvgpr_write_b32 a12, v72
 v_accvgpr_write_b32 a13, v73
 v_accvgpr_write_b32 a14, v74
 v_accvgpr_write_b32 a15, v75
 v_accvgpr_read_b32 v72, a16
 v_accvgpr_read_b32 v73, a17
 v_accvgpr_read_b32 v74, a18
 v_accvgpr_read_b32 v75, a19
 v_mul_f32 v72, v72, v65
 v_mul_f32 v73, v73, v65
 v_mul_f32 v74, v74, v65
 v_mul_f32 v75, v75, v65
 v_accvgpr_write_b32 a16, v72
 v_accvgpr_write_b32 a17, v73
 v_accvgpr_write_b32 a18, v74
 v_accvgpr_write_b32 a19, v75
 v_accvgpr_read_b32 v72, a20
 v_accvgpr_read_b32 v73, a21
 v_accvgpr_read_b32 v74, a22
 v_accvgpr_read_b32 v75, a23
 v_mul_f32 v72, v72, v65
 v_mul_f32 v73, v73, v65
 v_mul_f32 v74, v74, v65
 v_mul_f32 v75, v75, v65
 v_accvgpr_write_b32 a20, v72
 v_accvgpr_write_b32 a21, v73
 v_accvgpr_write_b32 a22, v74
 v_accvgpr_write_b32 a23, v75
 v_accvgpr_read_b32 v72, a24
 v_accvgpr_read_b32 v73, a25
 v_accvgpr_read_b32 v74, a26
 v_accvgpr_read_b32 v75, a27
 v_mul_f32 v72, v72, v65
 v_mul_f32 v73, v73, v65
 v_mul_f32 v74, v74, v65
 v_mul_f32 v75, v75, v65
 v_accvgpr_write_b32 a24, v72
 v_accvgpr_write_b32 a25, v73
 v_accvgpr_write_b32 a26, v74
 v_accvgpr_write_b32 a27, v75
 v_accvgpr_read_b32 v72, a28
 v_accvgpr_read_b32 v73, a29
 v_accvgpr_read_b32 v74, a30
 v_accvgpr_read_b32 v75, a31
 v_mul_f32 v72, v72, v65
 v_mul_f32 v73, v73, v65
 v_mul_f32 v74, v74, v65
 v_mul_f32 v75, v75, v65
 v_accvgpr_write_b32 a28, v72
 v_accvgpr_write_b32 a29, v73
 v_accvgpr_write_b32 a30, v74
 v_accvgpr_write_b32 a31, v75
 v_sub_f32 v164, v164, v64
 v_sub_f32 v165, v165, v64
 v_sub_f32 v166, v166, v64
 v_sub_f32 v167, v167, v64
 v_sub_f32 v228, v228, v64
 v_sub_f32 v229, v229, v64
 v_sub_f32 v230, v230, v64
 v_sub_f32 v231, v231, v64
 v_sub_f32 v36, v36, v64
 v_sub_f32 v37, v37, v64
 v_sub_f32 v38, v38, v64
 v_sub_f32 v39, v39, v64
 v_sub_f32 v100, v100, v64
 v_sub_f32 v101, v101, v64
 v_sub_f32 v102, v102, v64
 v_sub_f32 v103, v103, v64
 v_max3_f32 v64, v172, v173, v174
 v_max3_f32 v64, v64, v175, v236
 v_max3_f32 v64, v64, v237, v238
 v_max_f32 v64, v64, v239
 v_mov_b32 v72, v64
 s_nop 1
 v_permlane32_swap_b32 v64, v72
 v_max_f32 v64, v64, v72
 v_mov_b32 v72, v64
 s_nop 1
 v_permlane16_swap_b32 v64, v72
 v_max_f32 v64, v64, v72
 v_add_f32 v64, 0x41a00000, v64
 v_max_f32 v64, 0, v64
 v_sub_f32 v65, 0, v64
 v_exp_f32 v65, v65
 v_sub_f32 v168, v168, v64
 v_sub_f32 v169, v169, v64
 v_sub_f32 v170, v170, v64
 v_sub_f32 v171, v171, v64
 v_mul_f32 v128, v128, v65
 v_mul_f32 v129, v129, v65
 v_mul_f32 v130, v130, v65
 v_mul_f32 v131, v131, v65
 v_accvgpr_read_b32 v72, a32
 v_accvgpr_read_b32 v73, a33
 v_accvgpr_read_b32 v74, a34
 v_accvgpr_read_b32 v75, a35
 v_mul_f32 v72, v72, v65
 v_mul_f32 v73, v73, v65
 v_mul_f32 v74, v74, v65
 v_mul_f32 v75, v75, v65
 v_accvgpr_write_b32 a32, v72
 v_accvgpr_write_b32 a33, v73
 v_accvgpr_write_b32 a34, v74
 v_accvgpr_write_b32 a35, v75
 v_accvgpr_read_b32 v72, a36
 v_accvgpr_read_b32 v73, a37
 v_accvgpr_read_b32 v74, a38
 v_accvgpr_read_b32 v75, a39
 v_mul_f32 v72, v72, v65
 v_mul_f32 v73, v73, v65
 v_mul_f32 v74, v74, v65
 v_mul_f32 v75, v75, v65
 v_accvgpr_write_b32 a36, v72
 v_accvgpr_write_b32 a37, v73
 v_accvgpr_write_b32 a38, v74
 v_accvgpr_write_b32 a39, v75
 v_accvgpr_read_b32 v72, a40
 v_accvgpr_read_b32 v73, a41
 v_accvgpr_read_b32 v74, a42
 v_accvgpr_read_b32 v75, a43
 v_mul_f32 v72, v72, v65
 v_mul_f32 v73, v73, v65
 v_mul_f32 v74, v74, v65
 v_mul_f32 v75, v75, v65
 v_accvgpr_write_b32 a40, v72
 v_accvgpr_write_b32 a41, v73
 v_accvgpr_write_b32 a42, v74
 v_accvgpr_write_b32 a43, v75
 v_accvgpr_read_b32 v72, a44
 v_accvgpr_read_b32 v73, a45
 v_accvgpr_read_b32 v74, a46
 v_accvgpr_read_b32 v75, a47
 v_mul_f32 v72, v72, v65
 v_mul_f32 v73, v73, v65
 v_mul_f32 v74, v74, v65
 v_mul_f32 v75, v75, v65
 v_accvgpr_write_b32 a44, v72
 v_accvgpr_write_b32 a45, v73
 v_accvgpr_write_b32 a46, v74
 v_accvgpr_write_b32 a47, v75
 v_accvgpr_read_b32 v72, a48
 v_accvgpr_read_b32 v73, a49
 v_accvgpr_read_b32 v74, a50
 v_accvgpr_read_b32 v75, a51
 v_mul_f32 v72, v72, v65
 v_mul_f32 v73, v73, v65
 v_mul_f32 v74, v74, v65
 v_mul_f32 v75, v75, v65
 v_accvgpr_write_b32 a48, v72
 v_accvgpr_write_b32 a49, v73
 v_accvgpr_write_b32 a50, v74
 v_accvgpr_write_b32 a51, v75
 v_accvgpr_read_b32 v72, a52
 v_accvgpr_read_b32 v73, a53
 v_accvgpr_read_b32 v74, a54
 v_accvgpr_read_b32 v75, a55
 v_mul_f32 v72, v72, v65
 v_mul_f32 v73, v73, v65
 v_mul_f32 v74, v74, v65
 v_mul_f32 v75, v75, v65
 v_accvgpr_write_b32 a52, v72
 v_accvgpr_write_b32 a53, v73
 v_accvgpr_write_b32 a54, v74
 v_accvgpr_write_b32 a55, v75
 v_accvgpr_read_b32 v72, a56
 v_accvgpr_read_b32 v73, a57
 v_accvgpr_read_b32 v74, a58
 v_accvgpr_read_b32 v75, a59
 v_mul_f32 v72, v72, v65
 v_mul_f32 v73, v73, v65
 v_mul_f32 v74, v74, v65
 v_mul_f32 v75, v75, v65
 v_accvgpr_write_b32 a56, v72
 v_accvgpr_write_b32 a57, v73
 v_accvgpr_write_b32 a58, v74
 v_accvgpr_write_b32 a59, v75
 v_accvgpr_read_b32 v72, a60
 v_accvgpr_read_b32 v73, a61
 v_accvgpr_read_b32 v74, a62
 v_accvgpr_read_b32 v75, a63
 v_mul_f32 v72, v72, v65
 v_mul_f32 v73, v73, v65
 v_mul_f32 v74, v74, v65
 v_mul_f32 v75, v75, v65
 v_accvgpr_write_b32 a60, v72
 v_accvgpr_write_b32 a61, v73
 v_accvgpr_write_b32 a62, v74
 v_accvgpr_write_b32 a63, v75
 v_sub_f32 v172, v172, v64
 v_sub_f32 v173, v173, v64
 v_sub_f32 v174, v174, v64
 v_sub_f32 v175, v175, v64
 v_sub_f32 v236, v236, v64
 v_sub_f32 v237, v237, v64
 v_sub_f32 v238, v238, v64
 v_sub_f32 v239, v239, v64
 v_sub_f32 v44, v44, v64
 v_sub_f32 v45, v45, v64
 v_sub_f32 v46, v46, v64
 v_sub_f32 v47, v47, v64
 v_sub_f32 v108, v108, v64
 v_sub_f32 v109, v109, v64
 v_sub_f32 v110, v110, v64
 v_sub_f32 v111, v111, v64
 v_max3_f32 v64, v180, v181, v182
 v_max3_f32 v64, v64, v183, v244
 v_max3_f32 v64, v64, v245, v246
 v_max_f32 v64, v64, v247
 v_mov_b32 v72, v64
 s_nop 1
 v_permlane32_swap_b32 v64, v72
 v_max_f32 v64, v64, v72
 v_mov_b32 v72, v64
 s_nop 1
 v_permlane16_swap_b32 v64, v72
 v_max_f32 v64, v64, v72
 v_add_f32 v64, 0x41a00000, v64
 v_max_f32 v64, 0, v64
 v_sub_f32 v65, 0, v64
 v_exp_f32 v65, v65
 v_sub_f32 v176, v176, v64
 v_sub_f32 v177, v177, v64
 v_sub_f32 v178, v178, v64
 v_sub_f32 v179, v179, v64
 v_mul_f32 v136, v136, v65
 v_mul_f32 v137, v137, v65
 v_mul_f32 v138, v138, v65
 v_mul_f32 v139, v139, v65
 v_accvgpr_read_b32 v72, a64
 v_accvgpr_read_b32 v73, a65
 v_accvgpr_read_b32 v74, a66
 v_accvgpr_read_b32 v75, a67
 v_mul_f32 v72, v72, v65
 v_mul_f32 v73, v73, v65
 v_mul_f32 v74, v74, v65
 v_mul_f32 v75, v75, v65
 v_accvgpr_write_b32 a64, v72
 v_accvgpr_write_b32 a65, v73
 v_accvgpr_write_b32 a66, v74
 v_accvgpr_write_b32 a67, v75
 v_accvgpr_read_b32 v72, a68
 v_accvgpr_read_b32 v73, a69
 v_accvgpr_read_b32 v74, a70
 v_accvgpr_read_b32 v75, a71
 v_mul_f32 v72, v72, v65
 v_mul_f32 v73, v73, v65
 v_mul_f32 v74, v74, v65
 v_mul_f32 v75, v75, v65
 v_accvgpr_write_b32 a68, v72
 v_accvgpr_write_b32 a69, v73
 v_accvgpr_write_b32 a70, v74
 v_accvgpr_write_b32 a71, v75
 v_accvgpr_read_b32 v72, a72
 v_accvgpr_read_b32 v73, a73
 v_accvgpr_read_b32 v74, a74
 v_accvgpr_read_b32 v75, a75
 v_mul_f32 v72, v72, v65
 v_mul_f32 v73, v73, v65
 v_mul_f32 v74, v74, v65
 v_mul_f32 v75, v75, v65
 v_accvgpr_write_b32 a72, v72
 v_accvgpr_write_b32 a73, v73
 v_accvgpr_write_b32 a74, v74
 v_accvgpr_write_b32 a75, v75
 v_accvgpr_read_b32 v72, a76
 v_accvgpr_read_b32 v73, a77
 v_accvgpr_read_b32 v74, a78
 v_accvgpr_read_b32 v75, a79
 v_mul_f32 v72, v72, v65
 v_mul_f32 v73, v73, v65
 v_mul_f32 v74, v74, v65
 v_mul_f32 v75, v75, v65
 v_accvgpr_write_b32 a76, v72
 v_accvgpr_write_b32 a77, v73
 v_accvgpr_write_b32 a78, v74
 v_accvgpr_write_b32 a79, v75
 v_accvgpr_read_b32 v72, a80
 v_accvgpr_read_b32 v73, a81
 v_accvgpr_read_b32 v74, a82
 v_accvgpr_read_b32 v75, a83
 v_mul_f32 v72, v72, v65
 v_mul_f32 v73, v73, v65
 v_mul_f32 v74, v74, v65
 v_mul_f32 v75, v75, v65
 v_accvgpr_write_b32 a80, v72
 v_accvgpr_write_b32 a81, v73
 v_accvgpr_write_b32 a82, v74
 v_accvgpr_write_b32 a83, v75
 v_accvgpr_read_b32 v72, a84
 v_accvgpr_read_b32 v73, a85
 v_accvgpr_read_b32 v74, a86
 v_accvgpr_read_b32 v75, a87
 v_mul_f32 v72, v72, v65
 v_mul_f32 v73, v73, v65
 v_mul_f32 v74, v74, v65
 v_mul_f32 v75, v75, v65
 v_accvgpr_write_b32 a84, v72
 v_accvgpr_write_b32 a85, v73
 v_accvgpr_write_b32 a86, v74
 v_accvgpr_write_b32 a87, v75
 v_accvgpr_read_b32 v72, a88
 v_accvgpr_read_b32 v73, a89
 v_accvgpr_read_b32 v74, a90
 v_accvgpr_read_b32 v75, a91
 v_mul_f32 v72, v72, v65
 v_mul_f32 v73, v73, v65
 v_mul_f32 v74, v74, v65
 v_mul_f32 v75, v75, v65
 v_accvgpr_write_b32 a88, v72
 v_accvgpr_write_b32 a89, v73
 v_accvgpr_write_b32 a90, v74
 v_accvgpr_write_b32 a91, v75
 v_accvgpr_read_b32 v72, a92
 v_accvgpr_read_b32 v73, a93
 v_accvgpr_read_b32 v74, a94
 v_accvgpr_read_b32 v75, a95
 v_mul_f32 v72, v72, v65
 v_mul_f32 v73, v73, v65
 v_mul_f32 v74, v74, v65
 v_mul_f32 v75, v75, v65
 v_accvgpr_write_b32 a92, v72
 v_accvgpr_write_b32 a93, v73
 v_accvgpr_write_b32 a94, v74
 v_accvgpr_write_b32 a95, v75
 v_sub_f32 v180, v180, v64
 v_sub_f32 v181, v181, v64
 v_sub_f32 v182, v182, v64
 v_sub_f32 v183, v183, v64
 v_sub_f32 v244, v244, v64
 v_sub_f32 v245, v245, v64
 v_sub_f32 v246, v246, v64
 v_sub_f32 v247, v247, v64
 v_sub_f32 v52, v52, v64
 v_sub_f32 v53, v53, v64
 v_sub_f32 v54, v54, v64
 v_sub_f32 v55, v55, v64
 v_sub_f32 v116, v116, v64
 v_sub_f32 v117, v117, v64
 v_sub_f32 v118, v118, v64
 v_sub_f32 v119, v119, v64
 v_max3_f32 v64, v188, v189, v190
 v_max3_f32 v64, v64, v191, v252
 v_max3_f32 v64, v64, v253, v254
 v_max_f32 v64, v64, v255
 v_mov_b32 v72, v64
 s_nop 1
 v_permlane32_swap_b32 v64, v72
 v_max_f32 v64, v64, v72
 v_mov_b32 v72, v64
 s_nop 1
 v_permlane16_swap_b32 v64, v72
 v_max_f32 v64, v64, v72
 v_add_f32 v64, 0x41a00000, v64
 v_max_f32 v64, 0, v64
 v_sub_f32 v65, 0, v64
 v_exp_f32 v65, v65
 v_sub_f32 v184, v184, v64
 v_sub_f32 v185, v185, v64
 v_sub_f32 v186, v186, v64
 v_sub_f32 v187, v187, v64
 v_mul_f32 v144, v144, v65
 v_mul_f32 v145, v145, v65
 v_mul_f32 v146, v146, v65
 v_mul_f32 v147, v147, v65
 v_accvgpr_read_b32 v72, a96
 v_accvgpr_read_b32 v73, a97
 v_accvgpr_read_b32 v74, a98
 v_accvgpr_read_b32 v75, a99
 v_mul_f32 v72, v72, v65
 v_mul_f32 v73, v73, v65
 v_mul_f32 v74, v74, v65
 v_mul_f32 v75, v75, v65
 v_accvgpr_write_b32 a96, v72
 v_accvgpr_write_b32 a97, v73
 v_accvgpr_write_b32 a98, v74
 v_accvgpr_write_b32 a99, v75
 v_accvgpr_read_b32 v72, a100
 v_accvgpr_read_b32 v73, a101
 v_accvgpr_read_b32 v74, a102
 v_accvgpr_read_b32 v75, a103
 v_mul_f32 v72, v72, v65
 v_mul_f32 v73, v73, v65
 v_mul_f32 v74, v74, v65
 v_mul_f32 v75, v75, v65
 v_accvgpr_write_b32 a100, v72
 v_accvgpr_write_b32 a101, v73
 v_accvgpr_write_b32 a102, v74
 v_accvgpr_write_b32 a103, v75
 v_accvgpr_read_b32 v72, a104
 v_accvgpr_read_b32 v73, a105
 v_accvgpr_read_b32 v74, a106
 v_accvgpr_read_b32 v75, a107
 v_mul_f32 v72, v72, v65
 v_mul_f32 v73, v73, v65
 v_mul_f32 v74, v74, v65
 v_mul_f32 v75, v75, v65
 v_accvgpr_write_b32 a104, v72
 v_accvgpr_write_b32 a105, v73
 v_accvgpr_write_b32 a106, v74
 v_accvgpr_write_b32 a107, v75
 v_accvgpr_read_b32 v72, a108
 v_accvgpr_read_b32 v73, a109
 v_accvgpr_read_b32 v74, a110
 v_accvgpr_read_b32 v75, a111
 v_mul_f32 v72, v72, v65
 v_mul_f32 v73, v73, v65
 v_mul_f32 v74, v74, v65
 v_mul_f32 v75, v75, v65
 v_accvgpr_write_b32 a108, v72
 v_accvgpr_write_b32 a109, v73
 v_accvgpr_write_b32 a110, v74
 v_accvgpr_write_b32 a111, v75
 v_accvgpr_read_b32 v72, a112
 v_accvgpr_read_b32 v73, a113
 v_accvgpr_read_b32 v74, a114
 v_accvgpr_read_b32 v75, a115
 v_mul_f32 v72, v72, v65
 v_mul_f32 v73, v73, v65
 v_mul_f32 v74, v74, v65
 v_mul_f32 v75, v75, v65
 v_accvgpr_write_b32 a112, v72
 v_accvgpr_write_b32 a113, v73
 v_accvgpr_write_b32 a114, v74
 v_accvgpr_write_b32 a115, v75
 v_accvgpr_read_b32 v72, a116
 v_accvgpr_read_b32 v73, a117
 v_accvgpr_read_b32 v74, a118
 v_accvgpr_read_b32 v75, a119
 v_mul_f32 v72, v72, v65
 v_mul_f32 v73, v73, v65
 v_mul_f32 v74, v74, v65
 v_mul_f32 v75, v75, v65
 v_accvgpr_write_b32 a116, v72
 v_accvgpr_write_b32 a117, v73
 v_accvgpr_write_b32 a118, v74
 v_accvgpr_write_b32 a119, v75
 v_accvgpr_read_b32 v72, a120
 v_accvgpr_read_b32 v73, a121
 v_accvgpr_read_b32 v74, a122
 v_accvgpr_read_b32 v75, a123
 v_mul_f32 v72, v72, v65
 v_mul_f32 v73, v73, v65
 v_mul_f32 v74, v74, v65
 v_mul_f32 v75, v75, v65
 v_accvgpr_write_b32 a120, v72
 v_accvgpr_write_b32 a121, v73
 v_accvgpr_write_b32 a122, v74
 v_accvgpr_write_b32 a123, v75
 v_accvgpr_read_b32 v72, a124
 v_accvgpr_read_b32 v73, a125
 v_accvgpr_read_b32 v74, a126
 v_accvgpr_read_b32 v75, a127
 v_mul_f32 v72, v72, v65
 v_mul_f32 v73, v73, v65
 v_mul_f32 v74, v74, v65
 v_mul_f32 v75, v75, v65
 v_accvgpr_write_b32 a124, v72
 v_accvgpr_write_b32 a125, v73
 v_accvgpr_write_b32 a126, v74
 v_accvgpr_write_b32 a127, v75
 v_sub_f32 v188, v188, v64
 v_sub_f32 v189, v189, v64
 v_sub_f32 v190, v190, v64
 v_sub_f32 v191, v191, v64
 v_sub_f32 v252, v252, v64
 v_sub_f32 v253, v253, v64
 v_sub_f32 v254, v254, v64
 v_sub_f32 v255, v255, v64
 v_sub_f32 v60, v60, v64
 v_sub_f32 v61, v61, v64
 v_sub_f32 v62, v62, v64
 v_sub_f32 v63, v63, v64
 v_sub_f32 v124, v124, v64
 v_sub_f32 v125, v125, v64
 v_sub_f32 v126, v126, v64
 v_sub_f32 v127, v127, v64
 v_exp_f32 v20, v164
 v_exp_f32 v21, v165
 s_nop 0
 v_cvt_pk_bf16_f32 v224, v20, v21
 v_exp_f32 v20, v166
 v_exp_f32 v21, v167
 s_nop 0
 v_cvt_pk_bf16_f32 v225, v20, v21
 v_exp_f32 v20, v228
 v_exp_f32 v21, v229
 s_nop 0
 v_cvt_pk_bf16_f32 v226, v20, v21
 v_exp_f32 v20, v230
 v_exp_f32 v21, v231
 s_nop 0
 v_cvt_pk_bf16_f32 v227, v20, v21
 v_exp_f32 v20, v172
 v_exp_f32 v21, v173
 s_nop 0
 v_cvt_pk_bf16_f32 v232, v20, v21
 v_exp_f32 v20, v174
 v_exp_f32 v21, v175
 s_nop 0
 v_cvt_pk_bf16_f32 v233, v20, v21
 v_exp_f32 v20, v236
 v_exp_f32 v21, v237
 s_nop 0
 v_cvt_pk_bf16_f32 v234, v20, v21
 v_exp_f32 v20, v238
 v_exp_f32 v21, v239
 s_nop 0
 v_cvt_pk_bf16_f32 v235, v20, v21
 v_exp_f32 v20, v180
 v_exp_f32 v21, v181
 s_nop 0
 v_cvt_pk_bf16_f32 v240, v20, v21
 v_exp_f32 v20, v182
 v_exp_f32 v21, v183
 s_nop 0
 v_cvt_pk_bf16_f32 v241, v20, v21
 v_exp_f32 v20, v244
 v_exp_f32 v21, v245
 s_nop 0
 v_cvt_pk_bf16_f32 v242, v20, v21
 v_exp_f32 v20, v246
 v_exp_f32 v21, v247
 s_nop 0
 v_cvt_pk_bf16_f32 v243, v20, v21
 v_exp_f32 v20, v188
 v_exp_f32 v21, v189
 s_nop 0
 v_cvt_pk_bf16_f32 v248, v20, v21
 v_exp_f32 v20, v190
 v_exp_f32 v21, v191
 s_nop 0
 v_cvt_pk_bf16_f32 v249, v20, v21
 v_exp_f32 v20, v252
 v_exp_f32 v21, v253
 s_nop 0
 v_cvt_pk_bf16_f32 v250, v20, v21
 v_exp_f32 v20, v254
 v_exp_f32 v21, v255
 s_nop 0
 v_cvt_pk_bf16_f32 v251, v20, v21
 s_nop 1
 s_setpc_b64 s[88:89]
L_tr_119:
 s_call_b64 s[88:89], L_rare_d0d
 s_branch L_back_118
L_spin_124:
 s_mov_b32 s69, 0x4000
L_spin_124_l:
 s_sleep 2
 buffer_load_dword v15, v19, s[4:7], 0 offen sc1
 s_waitcnt vmcnt(0)
 v_cmp_eq_u32 vcc, 1, v15
 s_and_b32 s94, vcc_lo, 255
 s_cmp_eq_u32 s94, 255
 s_cbranch_scc1 L_back_123
 s_sub_u32 s69, s69, 1
 s_cmp_lg_u32 s69, 0
 s_cbranch_scc1 L_spin_124_l
 s_branch L_back_123
L_fence_125:
 buffer_inv sc1
 s_waitcnt vmcnt(0)
 s_branch L_back_126
L_tr_128:
 s_call_b64 s[88:89], L_rare_d1d
 s_branch L_back_127
L_tr_130:
 s_call_b64 s[88:89], L_rare_d0d
 s_branch L_back_129
L_spin_134:
 s_mov_b32 s69, 0x4000
L_spin_134_l:
 s_sleep 2
 buffer_load_dword v15, v19, s[4:7], 0 offen sc1
 s_waitcnt vmcnt(0)
 v_cmp_eq_u32 vcc, 1, v15
 s_and_b32 s94, vcc_lo, 255
 s_cmp_eq_u32 s94, 255
 s_cbranch_scc1 L_back_133
 s_sub_u32 s69, s69, 1
 s_cmp_lg_u32 s69, 0
 s_cbranch_scc1 L_spin_134_l
 s_branch L_back_133
L_fence_135:
 buffer_inv sc1
 s_waitcnt vmcnt(0)
 s_branch L_back_136
L_tr_138:
 s_call_b64 s[88:89], L_rare_d1d
 s_branch L_back_137
L_tr_140:
 s_call_b64 s[88:89], L_rare_d0d
 s_branch L_back_139
L_tr_150:
 s_call_b64 s[88:89], L_rare_d1s
 s_branch L_back_149
L_rare_d1s:
 s_nop 7
 s_nop 1
 v_max3_f32 v64, v164, v165, v166
 v_max3_f32 v64, v64, v167, v228
 v_max3_f32 v64, v64, v229, v230
 v_max_f32 v64, v64, v231
 v_mov_b32 v72, v64
 s_nop 1
 v_permlane32_swap_b32 v64, v72
 v_max_f32 v64, v64, v72
 v_mov_b32 v72, v64
 s_nop 1
 v_permlane16_swap_b32 v64, v72
 v_max_f32 v64, v64, v72
 v_add_f32 v64, 0x41a00000, v64
 v_max_f32 v64, 0, v64
 v_sub_f32 v65, 0, v64
 v_exp_f32 v65, v65
 v_sub_f32 v160, v160, v64
 v_sub_f32 v161, v161, v64
 v_sub_f32 v162, v162, v64
 v_sub_f32 v163, v163, v64
 v_mul_f32 v120, v120, v65
 v_mul_f32 v121, v121, v65
 v_mul_f32 v122, v122, v65
 v_mul_f32 v123, v123, v65
 v_accvgpr_read_b32 v72, a0
 v_accvgpr_read_b32 v73, a1
 v_accvgpr_read_b32 v74, a2
 v_accvgpr_read_b32 v75, a3
 v_mul_f32 v72, v72, v65
 v_mul_f32 v73, v73, v65
 v_mul_f32 v74, v74, v65
 v_mul_f32 v75, v75, v65
 v_accvgpr_write_b32 a0, v72
 v_accvgpr_write_b32 a1, v73
 v_accvgpr_write_b32 a2, v74
 v_accvgpr_write_b32 a3, v75
 v_accvgpr_read_b32 v72, a4
 v_accvgpr_read_b32 v73, a5
 v_accvgpr_read_b32 v74, a6
 v_accvgpr_read_b32 v75, a7
 v_mul_f32 v72, v72, v65
 v_mul_f32 v73, v73, v65
 v_mul_f32 v74, v74, v65
 v_mul_f32 v75, v75, v65
 v_accvgpr_write_b32 a4, v72
 v_accvgpr_write_b32 a5, v73
 v_accvgpr_write_b32 a6, v74
 v_accvgpr_write_b32 a7, v75
 v_accvgpr_read_b32 v72, a8
 v_accvgpr_read_b32 v73, a9
 v_accvgpr_read_b32 v74, a10
 v_accvgpr_read_b32 v75, a11
 v_mul_f32 v72, v72, v65
 v_mul_f32 v73, v73, v65
 v_mul_f32 v74, v74, v65
 v_mul_f32 v75, v75, v65
 v_accvgpr_write_b32 a8, v72
 v_accvgpr_write_b32 a9, v73
 v_accvgpr_write_b32 a10, v74
 v_accvgpr_write_b32 a11, v75
 v_accvgpr_read_b32 v72, a12
 v_accvgpr_read_b32 v73, a13
 v_accvgpr_read_b32 v74, a14
 v_accvgpr_read_b32 v75, a15
 v_mul_f32 v72, v72, v65
 v_mul_f32 v73, v73, v65
 v_mul_f32 v74, v74, v65
 v_mul_f32 v75, v75, v65
 v_accvgpr_write_b32 a12, v72
 v_accvgpr_write_b32 a13, v73
 v_accvgpr_write_b32 a14, v74
 v_accvgpr_write_b32 a15, v75
 v_accvgpr_read_b32 v72, a16
 v_accvgpr_read_b32 v73, a17
 v_accvgpr_read_b32 v74, a18
 v_accvgpr_read_b32 v75, a19
 v_mul_f32 v72, v72, v65
 v_mul_f32 v73, v73, v65
 v_mul_f32 v74, v74, v65
 v_mul_f32 v75, v75, v65
 v_accvgpr_write_b32 a16, v72
 v_accvgpr_write_b32 a17, v73
 v_accvgpr_write_b32 a18, v74
 v_accvgpr_write_b32 a19, v75
 v_accvgpr_read_b32 v72, a20
 v_accvgpr_read_b32 v73, a21
 v_accvgpr_read_b32 v74, a22
 v_accvgpr_read_b32 v75, a23
 v_mul_f32 v72, v72, v65
 v_mul_f32 v73, v73, v65
 v_mul_f32 v74, v74, v65
 v_mul_f32 v75, v75, v65
 v_accvgpr_write_b32 a20, v72
 v_accvgpr_write_b32 a21, v73
 v_accvgpr_write_b32 a22, v74
 v_accvgpr_write_b32 a23, v75
 v_accvgpr_read_b32 v72, a24
 v_accvgpr_read_b32 v73, a25
 v_accvgpr_read_b32 v74, a26
 v_accvgpr_read_b32 v75, a27
 v_mul_f32 v72, v72, v65
 v_mul_f32 v73, v73, v65
 v_mul_f32 v74, v74, v65
 v_mul_f32 v75, v75, v65
 v_accvgpr_write_b32 a24, v72
 v_accvgpr_write_b32 a25, v73
 v_accvgpr_write_b32 a26, v74
 v_accvgpr_write_b32 a27, v75
 v_accvgpr_read_b32 v72, a28
 v_accvgpr_read_b32 v73, a29
 v_accvgpr_read_b32 v74, a30
 v_accvgpr_read_b32 v75, a31
 v_mul_f32 v72, v72, v65
 v_mul_f32 v73, v73, v65
 v_mul_f32 v74, v74, v65
 v_mul_f32 v75, v75, v65
 v_accvgpr_write_b32 a28, v72
 v_accvgpr_write_b32 a29, v73
 v_accvgpr_write_b32 a30, v74
 v_accvgpr_write_b32 a31, v75
 v_sub_f32 v164, v164, v64
 v_sub_f32 v165, v165, v64
 v_sub_f32 v166, v166, v64
 v_sub_f32 v167, v167, v64
 v_sub_f32 v228, v228, v64
 v_sub_f32 v229, v229, v64
 v_sub_f32 v230, v230, v64
 v_sub_f32 v231, v231, v64
 v_max3_f32 v64, v172, v173, v174
 v_max3_f32 v64, v64, v175, v236
 v_max3_f32 v64, v64, v237, v238
 v_max_f32 v64, v64, v239
 v_mov_b32 v72, v64
 s_nop 1
 v_permlane32_swap_b32 v64, v72
 v_max_f32 v64, v64, v72
 v_mov_b32 v72, v64
 s_nop 1
 v_permlane16_swap_b32 v64, v72
 v_max_f32 v64, v64, v72
 v_add_f32 v64, 0x41a00000, v64
 v_max_f32 v64, 0, v64
 v_sub_f32 v65, 0, v64
 v_exp_f32 v65, v65
 v_sub_f32 v168, v168, v64
 v_sub_f32 v169, v169, v64
 v_sub_f32 v170, v170, v64
 v_sub_f32 v171, v171, v64
 v_mul_f32 v128, v128, v65
 v_mul_f32 v129, v129, v65
 v_mul_f32 v130, v130, v65
 v_mul_f32 v131, v131, v65
 v_accvgpr_read_b32 v72, a32
 v_accvgpr_read_b32 v73, a33
 v_accvgpr_read_b32 v74, a34
 v_accvgpr_read_b32 v75, a35
 v_mul_f32 v72, v72, v65
 v_mul_f32 v73, v73, v65
 v_mul_f32 v74, v74, v65
 v_mul_f32 v75, v75, v65
 v_accvgpr_write_b32 a32, v72
 v_accvgpr_write_b32 a33, v73
 v_accvgpr_write_b32 a34, v74
 v_accvgpr_write_b32 a35, v75
 v_accvgpr_read_b32 v72, a36
 v_accvgpr_read_b32 v73, a37
 v_accvgpr_read_b32 v74, a38
 v_accvgpr_read_b32 v75, a39
 v_mul_f32 v72, v72, v65
 v_mul_f32 v73, v73, v65
 v_mul_f32 v74, v74, v65
 v_mul_f32 v75, v75, v65
 v_accvgpr_write_b32 a36, v72
 v_accvgpr_write_b32 a37, v73
 v_accvgpr_write_b32 a38, v74
 v_accvgpr_write_b32 a39, v75
 v_accvgpr_read_b32 v72, a40
 v_accvgpr_read_b32 v73, a41
 v_accvgpr_read_b32 v74, a42
 v_accvgpr_read_b32 v75, a43
 v_mul_f32 v72, v72, v65
 v_mul_f32 v73, v73, v65
 v_mul_f32 v74, v74, v65
 v_mul_f32 v75, v75, v65
 v_accvgpr_write_b32 a40, v72
 v_accvgpr_write_b32 a41, v73
 v_accvgpr_write_b32 a42, v74
 v_accvgpr_write_b32 a43, v75
 v_accvgpr_read_b32 v72, a44
 v_accvgpr_read_b32 v73, a45
 v_accvgpr_read_b32 v74, a46
 v_accvgpr_read_b32 v75, a47
 v_mul_f32 v72, v72, v65
 v_mul_f32 v73, v73, v65
 v_mul_f32 v74, v74, v65
 v_mul_f32 v75, v75, v65
 v_accvgpr_write_b32 a44, v72
 v_accvgpr_write_b32 a45, v73
 v_accvgpr_write_b32 a46, v74
 v_accvgpr_write_b32 a47, v75
 v_accvgpr_read_b32 v72, a48
 v_accvgpr_read_b32 v73, a49
 v_accvgpr_read_b32 v74, a50
 v_accvgpr_read_b32 v75, a51
 v_mul_f32 v72, v72, v65
 v_mul_f32 v73, v73, v65
 v_mul_f32 v74, v74, v65
 v_mul_f32 v75, v75, v65
 v_accvgpr_write_b32 a48, v72
 v_accvgpr_write_b32 a49, v73
 v_accvgpr_write_b32 a50, v74
 v_accvgpr_write_b32 a51, v75
 v_accvgpr_read_b32 v72, a52
 v_accvgpr_read_b32 v73, a53
 v_accvgpr_read_b32 v74, a54
 v_accvgpr_read_b32 v75, a55
 v_mul_f32 v72, v72, v65
 v_mul_f32 v73, v73, v65
 v_mul_f32 v74, v74, v65
 v_mul_f32 v75, v75, v65
 v_accvgpr_write_b32 a52, v72
 v_accvgpr_write_b32 a53, v73
 v_accvgpr_write_b32 a54, v74
 v_accvgpr_write_b32 a55, v75
 v_accvgpr_read_b32 v72, a56
 v_accvgpr_read_b32 v73, a57
 v_accvgpr_read_b32 v74, a58
 v_accvgpr_read_b32 v75, a59
 v_mul_f32 v72, v72, v65
 v_mul_f32 v73, v73, v65
 v_mul_f32 v74, v74, v65
 v_mul_f32 v75, v75, v65
 v_accvgpr_write_b32 a56, v72
 v_accvgpr_write_b32 a57, v73
 v_accvgpr_write_b32 a58, v74
 v_accvgpr_write_b32 a59, v75
 v_accvgpr_read_b32 v72, a60
 v_accvgpr_read_b32 v73, a61
 v_accvgpr_read_b32 v74, a62
 v_accvgpr_read_b32 v75, a63
 v_mul_f32 v72, v72, v65
 v_mul_f32 v73, v73, v65
 v_mul_f32 v74, v74, v65
 v_mul_f32 v75, v75, v65
 v_accvgpr_write_b32 a60, v72
 v_accvgpr_write_b32 a61, v73
 v_accvgpr_write_b32 a62, v74
 v_accvgpr_write_b32 a63, v75
 v_sub_f32 v172, v172, v64
 v_sub_f32 v173, v173, v64
 v_sub_f32 v174, v174, v64
 v_sub_f32 v175, v175, v64
 v_sub_f32 v236, v236, v64
 v_sub_f32 v237, v237, v64
 v_sub_f32 v238, v238, v64
 v_sub_f32 v239, v239, v64
 v_max3_f32 v64, v180, v181, v182
 v_max3_f32 v64, v64, v183, v244
 v_max3_f32 v64, v64, v245, v246
 v_max_f32 v64, v64, v247
 v_mov_b32 v72, v64
 s_nop 1
 v_permlane32_swap_b32 v64, v72
 v_max_f32 v64, v64, v72
 v_mov_b32 v72, v64
 s_nop 1
 v_permlane16_swap_b32 v64, v72
 v_max_f32 v64, v64, v72
 v_add_f32 v64, 0x41a00000, v64
 v_max_f32 v64, 0, v64
 v_sub_f32 v65, 0, v64
 v_exp_f32 v65, v65
 v_sub_f32 v176, v176, v64
 v_sub_f32 v177, v177, v64
 v_sub_f32 v178, v178, v64
 v_sub_f32 v179, v179, v64
 v_mul_f32 v136, v136, v65
 v_mul_f32 v137, v137, v65
 v_mul_f32 v138, v138, v65
 v_mul_f32 v139, v139, v65
 v_accvgpr_read_b32 v72, a64
 v_accvgpr_read_b32 v73, a65
 v_accvgpr_read_b32 v74, a66
 v_accvgpr_read_b32 v75, a67
 v_mul_f32 v72, v72, v65
 v_mul_f32 v73, v73, v65
 v_mul_f32 v74, v74, v65
 v_mul_f32 v75, v75, v65
 v_accvgpr_write_b32 a64, v72
 v_accvgpr_write_b32 a65, v73
 v_accvgpr_write_b32 a66, v74
 v_accvgpr_write_b32 a67, v75
 v_accvgpr_read_b32 v72, a68
 v_accvgpr_read_b32 v73, a69
 v_accvgpr_read_b32 v74, a70
 v_accvgpr_read_b32 v75, a71
 v_mul_f32 v72, v72, v65
 v_mul_f32 v73, v73, v65
 v_mul_f32 v74, v74, v65
 v_mul_f32 v75, v75, v65
 v_accvgpr_write_b32 a68, v72
 v_accvgpr_write_b32 a69, v73
 v_accvgpr_write_b32 a70, v74
 v_accvgpr_write_b32 a71, v75
 v_accvgpr_read_b32 v72, a72
 v_accvgpr_read_b32 v73, a73
 v_accvgpr_read_b32 v74, a74
 v_accvgpr_read_b32 v75, a75
 v_mul_f32 v72, v72, v65
 v_mul_f32 v73, v73, v65
 v_mul_f32 v74, v74, v65
 v_mul_f32 v75, v75, v65
 v_accvgpr_write_b32 a72, v72
 v_accvgpr_write_b32 a73, v73
 v_accvgpr_write_b32 a74, v74
 v_accvgpr_write_b32 a75, v75
 v_accvgpr_read_b32 v72, a76
 v_accvgpr_read_b32 v73, a77
 v_accvgpr_read_b32 v74, a78
 v_accvgpr_read_b32 v75, a79
 v_mul_f32 v72, v72, v65
 v_mul_f32 v73, v73, v65
 v_mul_f32 v74, v74, v65
 v_mul_f32 v75, v75, v65
 v_accvgpr_write_b32 a76, v72
 v_accvgpr_write_b32 a77, v73
 v_accvgpr_write_b32 a78, v74
 v_accvgpr_write_b32 a79, v75
 v_accvgpr_read_b32 v72, a80
 v_accvgpr_read_b32 v73, a81
 v_accvgpr_read_b32 v74, a82
 v_accvgpr_read_b32 v75, a83
 v_mul_f32 v72, v72, v65
 v_mul_f32 v73, v73, v65
 v_mul_f32 v74, v74, v65
 v_mul_f32 v75, v75, v65
 v_accvgpr_write_b32 a80, v72
 v_accvgpr_write_b32 a81, v73
 v_accvgpr_write_b32 a82, v74
 v_accvgpr_write_b32 a83, v75
 v_accvgpr_read_b32 v72, a84
 v_accvgpr_read_b32 v73, a85
 v_accvgpr_read_b32 v74, a86
 v_accvgpr_read_b32 v75, a87
 v_mul_f32 v72, v72, v65
 v_mul_f32 v73, v73, v65
 v_mul_f32 v74, v74, v65
 v_mul_f32 v75, v75, v65
 v_accvgpr_write_b32 a84, v72
 v_accvgpr_write_b32 a85, v73
 v_accvgpr_write_b32 a86, v74
 v_accvgpr_write_b32 a87, v75
 v_accvgpr_read_b32 v72, a88
 v_accvgpr_read_b32 v73, a89
 v_accvgpr_read_b32 v74, a90
 v_accvgpr_read_b32 v75, a91
 v_mul_f32 v72, v72, v65
 v_mul_f32 v73, v73, v65
 v_mul_f32 v74, v74, v65
 v_mul_f32 v75, v75, v65
 v_accvgpr_write_b32 a88, v72
 v_accvgpr_write_b32 a89, v73
 v_accvgpr_write_b32 a90, v74
 v_accvgpr_write_b32 a91, v75
 v_accvgpr_read_b32 v72, a92
 v_accvgpr_read_b32 v73, a93
 v_accvgpr_read_b32 v74, a94
 v_accvgpr_read_b32 v75, a95
 v_mul_f32 v72, v72, v65
 v_mul_f32 v73, v73, v65
 v_mul_f32 v74, v74, v65
 v_mul_f32 v75, v75, v65
 v_accvgpr_write_b32 a92, v72
 v_accvgpr_write_b32 a93, v73
 v_accvgpr_write_b32 a94, v74
 v_accvgpr_write_b32 a95, v75
 v_sub_f32 v180, v180, v64
 v_sub_f32 v181, v181, v64
 v_sub_f32 v182, v182, v64
 v_sub_f32 v183, v183, v64
 v_sub_f32 v244, v244, v64
 v_sub_f32 v245, v245, v64
 v_sub_f32 v246, v246, v64
 v_sub_f32 v247, v247, v64
 v_sub_f32 v36, v36, v64
 v_sub_f32 v37, v37, v64
 v_sub_f32 v38, v38, v64
 v_sub_f32 v39, v39, v64
 v_sub_f32 v100, v100, v64
 v_sub_f32 v101, v101, v64
 v_sub_f32 v102, v102, v64
 v_sub_f32 v103, v103, v64
 v_sub_f32 v44, v44, v64
 v_sub_f32 v45, v45, v64
 v_sub_f32 v46, v46, v64
 v_sub_f32 v47, v47, v64
 v_sub_f32 v108, v108, v64
 v_sub_f32 v109, v109, v64
 v_sub_f32 v110, v110, v64
 v_sub_f32 v111, v111, v64
 v_max3_f32 v64, v188, v189, v190
 v_max3_f32 v64, v64, v191, v252
 v_max3_f32 v64, v64, v253, v254
 v_max_f32 v64, v64, v255
 v_mov_b32 v72, v64
 s_nop 1
 v_permlane32_swap_b32 v64, v72
 v_max_f32 v64, v64, v72
 v_mov_b32 v72, v64
 s_nop 1
 v_permlane16_swap_b32 v64, v72
 v_max_f32 v64, v64, v72
 v_add_f32 v64, 0x41a00000, v64
 v_max_f32 v64, 0, v64
 v_sub_f32 v65, 0, v64
 v_exp_f32 v65, v65
 v_sub_f32 v184, v184, v64
 v_sub_f32 v185, v185, v64
 v_sub_f32 v186, v186, v64
 v_sub_f32 v187, v187, v64
 v_mul_f32 v144, v144, v65
 v_mul_f32 v145, v145, v65
 v_mul_f32 v146, v146, v65
 v_mul_f32 v147, v147, v65
 v_accvgpr_read_b32 v72, a96
 v_accvgpr_read_b32 v73, a97
 v_accvgpr_read_b32 v74, a98
 v_accvgpr_read_b32 v75, a99
 v_mul_f32 v72, v72, v65
 v_mul_f32 v73, v73, v65
 v_mul_f32 v74, v74, v65
 v_mul_f32 v75, v75, v65
 v_accvgpr_write_b32 a96, v72
 v_accvgpr_write_b32 a97, v73
 v_accvgpr_write_b32 a98, v74
 v_accvgpr_write_b32 a99, v75
 v_accvgpr_read_b32 v72, a100
 v_accvgpr_read_b32 v73, a101
 v_accvgpr_read_b32 v74, a102
 v_accvgpr_read_b32 v75, a103
 v_mul_f32 v72, v72, v65
 v_mul_f32 v73, v73, v65
 v_mul_f32 v74, v74, v65
 v_mul_f32 v75, v75, v65
 v_accvgpr_write_b32 a100, v72
 v_accvgpr_write_b32 a101, v73
 v_accvgpr_write_b32 a102, v74
 v_accvgpr_write_b32 a103, v75
 v_accvgpr_read_b32 v72, a104
 v_accvgpr_read_b32 v73, a105
 v_accvgpr_read_b32 v74, a106
 v_accvgpr_read_b32 v75, a107
 v_mul_f32 v72, v72, v65
 v_mul_f32 v73, v73, v65
 v_mul_f32 v74, v74, v65
 v_mul_f32 v75, v75, v65
 v_accvgpr_write_b32 a104, v72
 v_accvgpr_write_b32 a105, v73
 v_accvgpr_write_b32 a106, v74
 v_accvgpr_write_b32 a107, v75
 v_accvgpr_read_b32 v72, a108
 v_accvgpr_read_b32 v73, a109
 v_accvgpr_read_b32 v74, a110
 v_accvgpr_read_b32 v75, a111
 v_mul_f32 v72, v72, v65
 v_mul_f32 v73, v73, v65
 v_mul_f32 v74, v74, v65
 v_mul_f32 v75, v75, v65
 v_accvgpr_write_b32 a108, v72
 v_accvgpr_write_b32 a109, v73
 v_accvgpr_write_b32 a110, v74
 v_accvgpr_write_b32 a111, v75
 v_accvgpr_read_b32 v72, a112
 v_accvgpr_read_b32 v73, a113
 v_accvgpr_read_b32 v74, a114
 v_accvgpr_read_b32 v75, a115
 v_mul_f32 v72, v72, v65
 v_mul_f32 v73, v73, v65
 v_mul_f32 v74, v74, v65
 v_mul_f32 v75, v75, v65
 v_accvgpr_write_b32 a112, v72
 v_accvgpr_write_b32 a113, v73
 v_accvgpr_write_b32 a114, v74
 v_accvgpr_write_b32 a115, v75
 v_accvgpr_read_b32 v72, a116
 v_accvgpr_read_b32 v73, a117
 v_accvgpr_read_b32 v74, a118
 v_accvgpr_read_b32 v75, a119
 v_mul_f32 v72, v72, v65
 v_mul_f32 v73, v73, v65
 v_mul_f32 v74, v74, v65
 v_mul_f32 v75, v75, v65
 v_accvgpr_write_b32 a116, v72
 v_accvgpr_write_b32 a117, v73
 v_accvgpr_write_b32 a118, v74
 v_accvgpr_write_b32 a119, v75
 v_accvgpr_read_b32 v72, a120
 v_accvgpr_read_b32 v73, a121
 v_accvgpr_read_b32 v74, a122
 v_accvgpr_read_b32 v75, a123
 v_mul_f32 v72, v72, v65
 v_mul_f32 v73, v73, v65
 v_mul_f32 v74, v74, v65
 v_mul_f32 v75, v75, v65
 v_accvgpr_write_b32 a120, v72
 v_accvgpr_write_b32 a121, v73
 v_accvgpr_write_b32 a122, v74
 v_accvgpr_write_b32 a123, v75
 v_accvgpr_read_b32 v72, a124
 v_accvgpr_read_b32 v73, a125
 v_accvgpr_read_b32 v74, a126
 v_accvgpr_read_b32 v75, a127
 v_mul_f32 v72, v72, v65
 v_mul_f32 v73, v73, v65
 v_mul_f32 v74, v74, v65
 v_mul_f32 v75, v75, v65
 v_accvgpr_write_b32 a124, v72
 v_accvgpr_write_b32 a125, v73
 v_accvgpr_write_b32 a126, v74
 v_accvgpr_write_b32 a127, v75
 v_sub_f32 v188, v188, v64
 v_sub_f32 v189, v189, v64
 v_sub_f32 v190, v190, v64
 v_sub_f32 v191, v191, v64
 v_sub_f32 v252, v252, v64
 v_sub_f32 v253, v253, v64
 v_sub_f32 v254, v254, v64
 v_sub_f32 v255, v255, v64
 v_sub_f32 v52, v52, v64
 v_sub_f32 v53, v53, v64
 v_sub_f32 v54, v54, v64
 v_sub_f32 v55, v55, v64
 v_sub_f32 v116, v116, v64
 v_sub_f32 v117, v117, v64
 v_sub_f32 v118, v118, v64
 v_sub_f32 v119, v119, v64
 v_sub_f32 v60, v60, v64
 v_sub_f32 v61, v61, v64
 v_sub_f32 v62, v62, v64
 v_sub_f32 v63, v63, v64
 v_sub_f32 v124, v124, v64
 v_sub_f32 v125, v125, v64
 v_sub_f32 v126, v126, v64
 v_sub_f32 v127, v127, v64
 v_exp_f32 v20, v164
 v_exp_f32 v21, v165
 s_nop 0
 v_cvt_pk_bf16_f32 v224, v20, v21
 v_exp_f32 v20, v166
 v_exp_f32 v21, v167
 s_nop 0
 v_cvt_pk_bf16_f32 v225, v20, v21
 v_exp_f32 v20, v228
 v_exp_f32 v21, v229
 s_nop 0
 v_cvt_pk_bf16_f32 v226, v20, v21
 v_exp_f32 v20, v230
 v_exp_f32 v21, v231
 s_nop 0
 v_cvt_pk_bf16_f32 v227, v20, v21
 v_exp_f32 v20, v172
 v_exp_f32 v21, v173
 s_nop 0
 v_cvt_pk_bf16_f32 v232, v20, v21
 v_exp_f32 v20, v174
 v_exp_f32 v21, v175
 s_nop 0
 v_cvt_pk_bf16_f32 v233, v20, v21
 v_exp_f32 v20, v236
 v_exp_f32 v21, v237
 s_nop 0
 v_cvt_pk_bf16_f32 v234, v20, v21
 v_exp_f32 v20, v238
 v_exp_f32 v21, v239
 s_nop 0
 v_cvt_pk_bf16_f32 v235, v20, v21
 v_exp_f32 v20, v180
 v_exp_f32 v21, v181
 s_nop 0
 v_cvt_pk_bf16_f32 v240, v20, v21
 v_exp_f32 v20, v182
 v_exp_f32 v21, v183
 s_nop 0
 v_cvt_pk_bf16_f32 v241, v20, v21
 v_exp_f32 v20, v244
 v_exp_f32 v21, v245
 s_nop 0
 v_cvt_pk_bf16_f32 v242, v20, v21
 v_exp_f32 v20, v246
 v_exp_f32 v21, v247
 s_nop 0
 v_cvt_pk_bf16_f32 v243, v20, v21
 v_exp_f32 v20, v188
 v_exp_f32 v21, v189
 s_nop 0
 v_cvt_pk_bf16_f32 v248, v20, v21
 v_exp_f32 v20, v190
 v_exp_f32 v21, v191
 s_nop 0
 v_cvt_pk_bf16_f32 v249, v20, v21
 v_exp_f32 v20, v252
 v_exp_f32 v21, v253
 s_nop 0
 v_cvt_pk_bf16_f32 v250, v20, v21
 v_exp_f32 v20, v254
 v_exp_f32 v21, v255
 s_nop 0
 v_cvt_pk_bf16_f32 v251, v20, v21
 s_nop 1
 s_setpc_b64 s[88:89]
L_spin_157:
 s_mov_b32 s69, 0x4000
L_spin_157_l:
 s_sleep 2
 buffer_load_dword v15, v19, s[4:7], 0 offen sc1
 s_waitcnt vmcnt(0)
 v_cmp_eq_u32 vcc, 1, v15
 s_and_b32 s94, vcc_lo, 255
 s_cmp_eq_u32 s94, 255
 s_cbranch_scc1 L_back_156
 s_sub_u32 s69, s69, 1
 s_cmp_lg_u32 s69, 0
 s_cbranch_scc1 L_spin_157_l
 s_branch L_back_156
L_fence_158:
 buffer_inv sc1
 s_waitcnt vmcnt(0)
 s_branch L_back_159
L_ffb_160:
 s_waitcnt lgkmcnt(0)
 s_barrier
 v_bfe_u32 v0, v14, 4, 5
 v_lshlrev_b32 v4, 2, v0
 v_add_u32 v4, 162816, v4
 ds_read_b32 v1, v4
 ds_read_b32 v2, v4 offset:128
 v_lshlrev_b32 v4, 1, v0
 v_add_u32 v4, s67, v4
 v_lshrrev_b32 v5, 8, v14
 v_lshlrev_b32 v6, 3, v5
 v_add_u32 v6, s67, v6
 v_lshlrev_b32 v7, 4, v5
 v_add_u32 v7, s67, v7
 s_waitcnt lgkmcnt(0)
 v_mul_f32 v3, 0xbfb8aa3b, v1
 v_exp_f32 v3, v3
 v_mul_f32 v1, v1, v2
 v_add_f32 v3, 1.0, v3
 v_rcp_f32 v3, v3
 s_nop 0
 v_mul_f32 v1, v1, v3
 v_cvt_pk_bf16_f32 v1, v1, v1
 ds_write_b16 v4, v1
 s_waitcnt lgkmcnt(0)
 ds_read_b64 v[64:65], v6
 ds_read_b64 v[66:67], v6 offset:32
 v_lshrrev_b32 v8, 2, v14
 v_add_u32 v9, s67, v8
 v_cmp_gt_u32 vcc, 64, v8
 v_mov_b32 v10, 2147483632
 s_and_b32 s94, s61, 1
 s_lshl_b32 s94, s94, 12
 s_mul_i32 s95, s60, 576
 s_add_u32 s94, s94, s95
 s_add_u32 s20, s94, 71319552
 v_cndmask_b32 v10, v10, v8, vcc
 s_waitcnt lgkmcnt(0)
 v_mfma_f32_16x16x32_bf16 v[164:167], a[224:227], v[64:67], 0
 v_mfma_f32_16x16x32_bf16 v[180:183], a[228:231], v[64:67], 0
 v_mfma_f32_16x16x32_bf16 v[228:231], a[232:235], v[64:67], 0
 v_mfma_f32_16x16x32_bf16 v[244:247], a[236:239], v[64:67], 0
 v_mfma_f32_16x16x32_bf16 v[172:175], a[240:243], v[64:67], 0
 v_mfma_f32_16x16x32_bf16 v[188:191], a[244:247], v[64:67], 0
 v_mfma_f32_16x16x32_bf16 v[236:239], a[248:251], v[64:67], 0
 v_mfma_f32_16x16x32_bf16 v[252:255], a[252:255], v[64:67], 0
 v_mfma_f32_16x16x32_bf16 v[72:75], v[152:155], v[64:67], 0
 ds_write_b128 v7, v[164:167] offset:256
 ds_write_b128 v7, v[180:183] offset:320
 ds_write_b128 v7, v[228:231] offset:384
 ds_write_b128 v7, v[244:247] offset:448
 ds_write_b128 v7, v[172:175] offset:512
 ds_write_b128 v7, v[188:191] offset:576
 ds_write_b128 v7, v[236:239] offset:640
 ds_write_b128 v7, v[252:255] offset:704
 ds_write_b128 v7, v[72:75] offset:768
 s_waitcnt lgkmcnt(0)
 ds_read_b32 v0, v9 offset:256
 ds_read_b32 v1, v9 offset:512
 ds_read_b32 v2, v9 offset:768
 s_waitcnt lgkmcnt(0)
 buffer_atomic_add_f32 v0, v8, s[4:7], s20 offen offset:0
 buffer_atomic_add_f32 v1, v8, s[4:7], s20 offen offset:256
 buffer_atomic_add_f32 v2, v10, s[4:7], s20 offen offset:512
 s_branch L_back_161
L_pub7:
 s_waitcnt vmcnt(0)
 s_barrier
 s_lshl_b32 s94, s2, 6
 s_add_u32 s94, s94, 71401472
 s_cmp_eq_u32 s60, 0
 s_cselect_b32 s94, s94, 0x8000000
 v_lshl_add_u32 v22, v14, 21, s94
 v_mov_b32 v23, 1
 buffer_store_dword v23, v22, s[4:7], 0 offen sc1
 s_lshl_b32 s94, s2, 6
 s_add_u32 s94, s94, 71467008
 s_cmp_eq_u32 s60, 0
 s_cselect_b32 s94, s94, 0x8000000
 v_lshl_add_u32 v22, v14, 21, s94
 v_mov_b32 v23, 1
 buffer_store_dword v23, v22, s[4:7], 0 offen sc1
 s_cmp_eq_i32 s68, 3
 s_cselect_b32 s71, 1.0, 0
 s_cmp_lt_i32 s68, 3
 s_cselect_b32 s76, 0xf1800000, 0
 s_cmp_eq_i32 s68, 2
 s_cselect_b32 s72, 1.0, 0
 s_cmp_lt_i32 s68, 2
 s_cselect_b32 s77, 0xf1800000, 0
 s_cmp_eq_i32 s68, 1
 s_cselect_b32 s73, 1.0, 0
 s_cmp_lt_i32 s68, 1
 s_cselect_b32 s78, 0xf1800000, 0
 s_cmp_eq_i32 s68, 0
 s_cselect_b32 s74, 1.0, 0
 s_cmp_lt_i32 s68, 0
 s_cselect_b32 s79, 0xf1800000, 0
 s_cmp_eq_i32 s68, -1
 s_cselect_b32 s75, 1.0, 0
 s_cmp_lt_i32 s68, -1
 s_cselect_b32 s80, 0xf1800000, 0
 s_branch L_s3
L_tr_165:
 s_call_b64 s[88:89], L_rare_s0s
 s_branch L_back_164
L_rare_s0s:
 s_nop 7
 s_nop 1
 v_max3_f32 v64, v36, v37, v38
 v_max3_f32 v64, v64, v39, v100
 v_max3_f32 v64, v64, v101, v102
 v_max3_f32 v64, v64, v103, v44
 v_max3_f32 v64, v64, v45, v46
 v_max3_f32 v64, v64, v47, v108
 v_max3_f32 v64, v64, v109, v110
 v_max_f32 v64, v64, v111
 v_mov_b32 v72, v64
 s_nop 1
 v_permlane32_swap_b32 v64, v72
 v_max_f32 v64, v64, v72
 v_mov_b32 v72, v64
 s_nop 1
 v_permlane16_swap_b32 v64, v72
 v_max_f32 v64, v64, v72
 v_add_f32 v64, 0x41a00000, v64
 v_max_f32 v64, 0, v64
 v_sub_f32 v65, 0, v64
 v_exp_f32 v65, v65
 v_sub_f32 v176, v176, v64
 v_sub_f32 v177, v177, v64
 v_sub_f32 v178, v178, v64
 v_sub_f32 v179, v179, v64
 v_mul_f32 v136, v136, v65
 v_mul_f32 v137, v137, v65
 v_mul_f32 v138, v138, v65
 v_mul_f32 v139, v139, v65
 v_accvgpr_read_b32 v72, a64
 v_accvgpr_read_b32 v73, a65
 v_accvgpr_read_b32 v74, a66
 v_accvgpr_read_b32 v75, a67
 v_mul_f32 v72, v72, v65
 v_mul_f32 v73, v73, v65
 v_mul_f32 v74, v74, v65
 v_mul_f32 v75, v75, v65
 v_accvgpr_write_b32 a64, v72
 v_accvgpr_write_b32 a65, v73
 v_accvgpr_write_b32 a66, v74
 v_accvgpr_write_b32 a67, v75
 v_accvgpr_read_b32 v72, a68
 v_accvgpr_read_b32 v73, a69
 v_accvgpr_read_b32 v74, a70
 v_accvgpr_read_b32 v75, a71
 v_mul_f32 v72, v72, v65
 v_mul_f32 v73, v73, v65
 v_mul_f32 v74, v74, v65
 v_mul_f32 v75, v75, v65
 v_accvgpr_write_b32 a68, v72
 v_accvgpr_write_b32 a69, v73
 v_accvgpr_write_b32 a70, v74
 v_accvgpr_write_b32 a71, v75
 v_accvgpr_read_b32 v72, a72
 v_accvgpr_read_b32 v73, a73
 v_accvgpr_read_b32 v74, a74
 v_accvgpr_read_b32 v75, a75
 v_mul_f32 v72, v72, v65
 v_mul_f32 v73, v73, v65
 v_mul_f32 v74, v74, v65
 v_mul_f32 v75, v75, v65
 v_accvgpr_write_b32 a72, v72
 v_accvgpr_write_b32 a73, v73
 v_accvgpr_write_b32 a74, v74
 v_accvgpr_write_b32 a75, v75
 v_accvgpr_read_b32 v72, a76
 v_accvgpr_read_b32 v73, a77
 v_accvgpr_read_b32 v74, a78
 v_accvgpr_read_b32 v75, a79
 v_mul_f32 v72, v72, v65
 v_mul_f32 v73, v73, v65
 v_mul_f32 v74, v74, v65
 v_mul_f32 v75, v75, v65
 v_accvgpr_write_b32 a76, v72
 v_accvgpr_write_b32 a77, v73
 v_accvgpr_write_b32 a78, v74
 v_accvgpr_write_b32 a79, v75
 v_accvgpr_read_b32 v72, a80
 v_accvgpr_read_b32 v73, a81
 v_accvgpr_read_b32 v74, a82
 v_accvgpr_read_b32 v75, a83
 v_mul_f32 v72, v72, v65
 v_mul_f32 v73, v73, v65
 v_mul_f32 v74, v74, v65
 v_mul_f32 v75, v75, v65
 v_accvgpr_write_b32 a80, v72
 v_accvgpr_write_b32 a81, v73
 v_accvgpr_write_b32 a82, v74
 v_accvgpr_write_b32 a83, v75
 v_accvgpr_read_b32 v72, a84
 v_accvgpr_read_b32 v73, a85
 v_accvgpr_read_b32 v74, a86
 v_accvgpr_read_b32 v75, a87
 v_mul_f32 v72, v72, v65
 v_mul_f32 v73, v73, v65
 v_mul_f32 v74, v74, v65
 v_mul_f32 v75, v75, v65
 v_accvgpr_write_b32 a84, v72
 v_accvgpr_write_b32 a85, v73
 v_accvgpr_write_b32 a86, v74
 v_accvgpr_write_b32 a87, v75
 v_accvgpr_read_b32 v72, a88
 v_accvgpr_read_b32 v73, a89
 v_accvgpr_read_b32 v74, a90
 v_accvgpr_read_b32 v75, a91
 v_mul_f32 v72, v72, v65
 v_mul_f32 v73, v73, v65
 v_mul_f32 v74, v74, v65
 v_mul_f32 v75, v75, v65
 v_accvgpr_write_b32 a88, v72
 v_accvgpr_write_b32 a89, v73
 v_accvgpr_write_b32 a90, v74
 v_accvgpr_write_b32 a91, v75
 v_accvgpr_read_b32 v72, a92
 v_accvgpr_read_b32 v73, a93
 v_accvgpr_read_b32 v74, a94
 v_accvgpr_read_b32 v75, a95
 v_mul_f32 v72, v72, v65
 v_mul_f32 v73, v73, v65
 v_mul_f32 v74, v74, v65
 v_mul_f32 v75, v75, v65
 v_accvgpr_write_b32 a92, v72
 v_accvgpr_write_b32 a93, v73
 v_accvgpr_write_b32 a94, v74
 v_accvgpr_write_b32 a95, v75
 v_sub_f32 v36, v36, v64
 v_sub_f32 v37, v37, v64
 v_sub_f32 v38, v38, v64
 v_sub_f32 v39, v39, v64
 v_sub_f32 v100, v100, v64
 v_sub_f32 v101, v101, v64
 v_sub_f32 v102, v102, v64
 v_sub_f32 v103, v103, v64
 v_sub_f32 v44, v44, v64
 v_sub_f32 v45, v45, v64
 v_sub_f32 v46, v46, v64
 v_sub_f32 v47, v47, v64
 v_sub_f32 v108, v108, v64
 v_sub_f32 v109, v109, v64
 v_sub_f32 v110, v110, v64
 v_sub_f32 v111, v111, v64
 v_sub_f32 v164, v164, v64
 v_sub_f32 v165, v165, v64
 v_sub_f32 v166, v166, v64
 v_sub_f32 v167, v167, v64
 v_sub_f32 v228, v228, v64
 v_sub_f32 v229, v229, v64
 v_sub_f32 v230, v230, v64
 v_sub_f32 v231, v231, v64
 v_sub_f32 v172, v172, v64
 v_sub_f32 v173, v173, v64
 v_sub_f32 v174, v174, v64
 v_sub_f32 v175, v175, v64
 v_sub_f32 v236, v236, v64
 v_sub_f32 v237, v237, v64
 v_sub_f32 v238, v238, v64
 v_sub_f32 v239, v239, v64
 v_max3_f32 v64, v52, v53, v54
 v_max3_f32 v64, v64, v55, v116
 v_max3_f32 v64, v64, v117, v118
 v_max3_f32 v64, v64, v119, v60
 v_max3_f32 v64, v64, v61, v62
 v_max3_f32 v64, v64, v63, v124
 v_max3_f32 v64, v64, v125, v126
 v_max_f32 v64, v64, v127
 v_mov_b32 v72, v64
 s_nop 1
 v_permlane32_swap_b32 v64, v72
 v_max_f32 v64, v64, v72
 v_mov_b32 v72, v64
 s_nop 1
 v_permlane16_swap_b32 v64, v72
 v_max_f32 v64, v64, v72
 v_add_f32 v64, 0x41a00000, v64
 v_max_f32 v64, 0, v64
 v_sub_f32 v65, 0, v64
 v_exp_f32 v65, v65
 v_sub_f32 v184, v184, v64
 v_sub_f32 v185, v185, v64
 v_sub_f32 v186, v186, v64
 v_sub_f32 v187, v187, v64
 v_mul_f32 v144, v144, v65
 v_mul_f32 v145, v145, v65
 v_mul_f32 v146, v146, v65
 v_mul_f32 v147, v147, v65
 v_accvgpr_read_b32 v72, a96
 v_accvgpr_read_b32 v73, a97
 v_accvgpr_read_b32 v74, a98
 v_accvgpr_read_b32 v75, a99
 v_mul_f32 v72, v72, v65
 v_mul_f32 v73, v73, v65
 v_mul_f32 v74, v74, v65
 v_mul_f32 v75, v75, v65
 v_accvgpr_write_b32 a96, v72
 v_accvgpr_write_b32 a97, v73
 v_accvgpr_write_b32 a98, v74
 v_accvgpr_write_b32 a99, v75
 v_accvgpr_read_b32 v72, a100
 v_accvgpr_read_b32 v73, a101
 v_accvgpr_read_b32 v74, a102
 v_accvgpr_read_b32 v75, a103
 v_mul_f32 v72, v72, v65
 v_mul_f32 v73, v73, v65
 v_mul_f32 v74, v74, v65
 v_mul_f32 v75, v75, v65
 v_accvgpr_write_b32 a100, v72
 v_accvgpr_write_b32 a101, v73
 v_accvgpr_write_b32 a102, v74
 v_accvgpr_write_b32 a103, v75
 v_accvgpr_read_b32 v72, a104
 v_accvgpr_read_b32 v73, a105
 v_accvgpr_read_b32 v74, a106
 v_accvgpr_read_b32 v75, a107
 v_mul_f32 v72, v72, v65
 v_mul_f32 v73, v73, v65
 v_mul_f32 v74, v74, v65
 v_mul_f32 v75, v75, v65
 v_accvgpr_write_b32 a104, v72
 v_accvgpr_write_b32 a105, v73
 v_accvgpr_write_b32 a106, v74
 v_accvgpr_write_b32 a107, v75
 v_accvgpr_read_b32 v72, a108
 v_accvgpr_read_b32 v73, a109
 v_accvgpr_read_b32 v74, a110
 v_accvgpr_read_b32 v75, a111
 v_mul_f32 v72, v72, v65
 v_mul_f32 v73, v73, v65
 v_mul_f32 v74, v74, v65
 v_mul_f32 v75, v75, v65
 v_accvgpr_write_b32 a108, v72
 v_accvgpr_write_b32 a109, v73
 v_accvgpr_write_b32 a110, v74
 v_accvgpr_write_b32 a111, v75
 v_accvgpr_read_b32 v72, a112
 v_accvgpr_read_b32 v73, a113
 v_accvgpr_read_b32 v74, a114
 v_accvgpr_read_b32 v75, a115
 v_mul_f32 v72, v72, v65
 v_mul_f32 v73, v73, v65
 v_mul_f32 v74, v74, v65
 v_mul_f32 v75, v75, v65
 v_accvgpr_write_b32 a112, v72
 v_accvgpr_write_b32 a113, v73
 v_accvgpr_write_b32 a114, v74
 v_accvgpr_write_b32 a115, v75
 v_accvgpr_read_b32 v72, a116
 v_accvgpr_read_b32 v73, a117
 v_accvgpr_read_b32 v74, a118
 v_accvgpr_read_b32 v75, a119
 v_mul_f32 v72, v72, v65
 v_mul_f32 v73, v73, v65
 v_mul_f32 v74, v74, v65
 v_mul_f32 v75, v75, v65
 v_accvgpr_write_b32 a116, v72
 v_accvgpr_write_b32 a117, v73
 v_accvgpr_write_b32 a118, v74
 v_accvgpr_write_b32 a119, v75
 v_accvgpr_read_b32 v72, a120
 v_accvgpr_read_b32 v73, a121
 v_accvgpr_read_b32 v74, a122
 v_accvgpr_read_b32 v75, a123
 v_mul_f32 v72, v72, v65
 v_mul_f32 v73, v73, v65
 v_mul_f32 v74, v74, v65
 v_mul_f32 v75, v75, v65
 v_accvgpr_write_b32 a120, v72
 v_accvgpr_write_b32 a121, v73
 v_accvgpr_write_b32 a122, v74
 v_accvgpr_write_b32 a123, v75
 v_accvgpr_read_b32 v72, a124
 v_accvgpr_read_b32 v73, a125
 v_accvgpr_read_b32 v74, a126
 v_accvgpr_read_b32 v75, a127
 v_mul_f32 v72, v72, v65
 v_mul_f32 v73, v73, v65
 v_mul_f32 v74, v74, v65
 v_mul_f32 v75, v75, v65
 v_accvgpr_write_b32 a124, v72
 v_accvgpr_write_b32 a125, v73
 v_accvgpr_write_b32 a126, v74
 v_accvgpr_write_b32 a127, v75
 v_sub_f32 v52, v52, v64
 v_sub_f32 v53, v53, v64
 v_sub_f32 v54, v54, v64
 v_sub_f32 v55, v55, v64
 v_sub_f32 v116, v116, v64
 v_sub_f32 v117, v117, v64
 v_sub_f32 v118, v118, v64
 v_sub_f32 v119, v119, v64
 v_sub_f32 v60, v60, v64
 v_sub_f32 v61, v61, v64
 v_sub_f32 v62, v62, v64
 v_sub_f32 v63, v63, v64
 v_sub_f32 v124, v124, v64
 v_sub_f32 v125, v125, v64
 v_sub_f32 v126, v126, v64
 v_sub_f32 v127, v127, v64
 v_sub_f32 v180, v180, v64
 v_sub_f32 v181, v181, v64
 v_sub_f32 v182, v182, v64
 v_sub_f32 v183, v183, v64
 v_sub_f32 v244, v244, v64
 v_sub_f32 v245, v245, v64
 v_sub_f32 v246, v246, v64
 v_sub_f32 v247, v247, v64
 v_sub_f32 v188, v188, v64
 v_sub_f32 v189, v189, v64
 v_sub_f32 v190, v190, v64
 v_sub_f32 v191, v191, v64
 v_sub_f32 v252, v252, v64
 v_sub_f32 v253, v253, v64
 v_sub_f32 v254, v254, v64
 v_sub_f32 v255, v255, v64
 v_exp_f32 v20, v36
 v_exp_f32 v21, v37
 s_nop 0
 v_cvt_pk_bf16_f32 v192, v20, v21
 v_exp_f32 v20, v38
 v_exp_f32 v21, v39
 s_nop 0
 v_cvt_pk_bf16_f32 v193, v20, v21
 v_exp_f32 v20, v100
 v_exp_f32 v21, v101
 s_nop 0
 v_cvt_pk_bf16_f32 v194, v20, v21
 v_exp_f32 v20, v102
 v_exp_f32 v21, v103
 s_nop 0
 v_cvt_pk_bf16_f32 v195, v20, v21
 v_exp_f32 v20, v44
 v_exp_f32 v21, v45
 s_nop 0
 v_cvt_pk_bf16_f32 v200, v20, v21
 v_exp_f32 v20, v46
 v_exp_f32 v21, v47
 s_nop 0
 v_cvt_pk_bf16_f32 v201, v20, v21
 v_exp_f32 v20, v108
 v_exp_f32 v21, v109
 s_nop 0
 v_cvt_pk_bf16_f32 v202, v20, v21
 v_exp_f32 v20, v110
 v_exp_f32 v21, v111
 s_nop 0
 v_cvt_pk_bf16_f32 v203, v20, v21
 v_exp_f32 v20, v52
 v_exp_f32 v21, v53
 s_nop 0
 v_cvt_pk_bf16_f32 v208, v20, v21
 v_exp_f32 v20, v54
 v_exp_f32 v21, v55
 s_nop 0
 v_cvt_pk_bf16_f32 v209, v20, v21
 v_exp_f32 v20, v116
 v_exp_f32 v21, v117
 s_nop 0
 v_cvt_pk_bf16_f32 v210, v20, v21
 v_exp_f32 v20, v118
 v_exp_f32 v21, v119
 s_nop 0
 v_cvt_pk_bf16_f32 v211, v20, v21
 v_exp_f32 v20, v60
 v_exp_f32 v21, v61
 s_nop 0
 v_cvt_pk_bf16_f32 v216, v20, v21
 v_exp_f32 v20, v62
 v_exp_f32 v21, v63
 s_nop 0
 v_cvt_pk_bf16_f32 v217, v20, v21
 v_exp_f32 v20, v124
 v_exp_f32 v21, v125
 s_nop 0
 v_cvt_pk_bf16_f32 v218, v20, v21
 v_exp_f32 v20, v126
 v_exp_f32 v21, v127
 s_nop 0
 v_cvt_pk_bf16_f32 v219, v20, v21
 s_nop 1
 s_setpc_b64 s[88:89]
L_tr_169:
 s_call_b64 s[88:89], L_rare_s1s
 s_branch L_back_168
L_rare_s1s:
 s_nop 7
 s_nop 1
 v_max3_f32 v64, v164, v165, v166
 v_max3_f32 v64, v64, v167, v228
 v_max3_f32 v64, v64, v229, v230
 v_max3_f32 v64, v64, v231, v172
 v_max3_f32 v64, v64, v173, v174
 v_max3_f32 v64, v64, v175, v236
 v_max3_f32 v64, v64, v237, v238
 v_max_f32 v64, v64, v239
 v_mov_b32 v72, v64
 s_nop 1
 v_permlane32_swap_b32 v64, v72
 v_max_f32 v64, v64, v72
 v_mov_b32 v72, v64
 s_nop 1
 v_permlane16_swap_b32 v64, v72
 v_max_f32 v64, v64, v72
 v_add_f32 v64, 0x41a00000, v64
 v_max_f32 v64, 0, v64
 v_sub_f32 v65, 0, v64
 v_exp_f32 v65, v65
 v_sub_f32 v176, v176, v64
 v_sub_f32 v177, v177, v64
 v_sub_f32 v178, v178, v64
 v_sub_f32 v179, v179, v64
 v_mul_f32 v136, v136, v65
 v_mul_f32 v137, v137, v65
 v_mul_f32 v138, v138, v65
 v_mul_f32 v139, v139, v65
 v_accvgpr_read_b32 v72, a64
 v_accvgpr_read_b32 v73, a65
 v_accvgpr_read_b32 v74, a66
 v_accvgpr_read_b32 v75, a67
 v_mul_f32 v72, v72, v65
 v_mul_f32 v73, v73, v65
 v_mul_f32 v74, v74, v65
 v_mul_f32 v75, v75, v65
 v_accvgpr_write_b32 a64, v72
 v_accvgpr_write_b32 a65, v73
 v_accvgpr_write_b32 a66, v74
 v_accvgpr_write_b32 a67, v75
 v_accvgpr_read_b32 v72, a68
 v_accvgpr_read_b32 v73, a69
 v_accvgpr_read_b32 v74, a70
 v_accvgpr_read_b32 v75, a71
 v_mul_f32 v72, v72, v65
 v_mul_f32 v73, v73, v65
 v_mul_f32 v74, v74, v65
 v_mul_f32 v75, v75, v65
 v_accvgpr_write_b32 a68, v72
 v_accvgpr_write_b32 a69, v73
 v_accvgpr_write_b32 a70, v74
 v_accvgpr_write_b32 a71, v75
 v_accvgpr_read_b32 v72, a72
 v_accvgpr_read_b32 v73, a73
 v_accvgpr_read_b32 v74, a74
 v_accvgpr_read_b32 v75, a75
 v_mul_f32 v72, v72, v65
 v_mul_f32 v73, v73, v65
 v_mul_f32 v74, v74, v65
 v_mul_f32 v75, v75, v65
 v_accvgpr_write_b32 a72, v72
 v_accvgpr_write_b32 a73, v73
 v_accvgpr_write_b32 a74, v74
 v_accvgpr_write_b32 a75, v75
 v_accvgpr_read_b32 v72, a76
 v_accvgpr_read_b32 v73, a77
 v_accvgpr_read_b32 v74, a78
 v_accvgpr_read_b32 v75, a79
 v_mul_f32 v72, v72, v65
 v_mul_f32 v73, v73, v65
 v_mul_f32 v74, v74, v65
 v_mul_f32 v75, v75, v65
 v_accvgpr_write_b32 a76, v72
 v_accvgpr_write_b32 a77, v73
 v_accvgpr_write_b32 a78, v74
 v_accvgpr_write_b32 a79, v75
 v_accvgpr_read_b32 v72, a80
 v_accvgpr_read_b32 v73, a81
 v_accvgpr_read_b32 v74, a82
 v_accvgpr_read_b32 v75, a83
 v_mul_f32 v72, v72, v65
 v_mul_f32 v73, v73, v65
 v_mul_f32 v74, v74, v65
 v_mul_f32 v75, v75, v65
 v_accvgpr_write_b32 a80, v72
 v_accvgpr_write_b32 a81, v73
 v_accvgpr_write_b32 a82, v74
 v_accvgpr_write_b32 a83, v75
 v_accvgpr_read_b32 v72, a84
 v_accvgpr_read_b32 v73, a85
 v_accvgpr_read_b32 v74, a86
 v_accvgpr_read_b32 v75, a87
 v_mul_f32 v72, v72, v65
 v_mul_f32 v73, v73, v65
 v_mul_f32 v74, v74, v65
 v_mul_f32 v75, v75, v65
 v_accvgpr_write_b32 a84, v72
 v_accvgpr_write_b32 a85, v73
 v_accvgpr_write_b32 a86, v74
 v_accvgpr_write_b32 a87, v75
 v_accvgpr_read_b32 v72, a88
 v_accvgpr_read_b32 v73, a89
 v_accvgpr_read_b32 v74, a90
 v_accvgpr_read_b32 v75, a91
 v_mul_f32 v72, v72, v65
 v_mul_f32 v73, v73, v65
 v_mul_f32 v74, v74, v65
 v_mul_f32 v75, v75, v65
 v_accvgpr_write_b32 a88, v72
 v_accvgpr_write_b32 a89, v73
 v_accvgpr_write_b32 a90, v74
 v_accvgpr_write_b32 a91, v75
 v_accvgpr_read_b32 v72, a92
 v_accvgpr_read_b32 v73, a93
 v_accvgpr_read_b32 v74, a94
 v_accvgpr_read_b32 v75, a95
 v_mul_f32 v72, v72, v65
 v_mul_f32 v73, v73, v65
 v_mul_f32 v74, v74, v65
 v_mul_f32 v75, v75, v65
 v_accvgpr_write_b32 a92, v72
 v_accvgpr_write_b32 a93, v73
 v_accvgpr_write_b32 a94, v74
 v_accvgpr_write_b32 a95, v75
 v_sub_f32 v164, v164, v64
 v_sub_f32 v165, v165, v64
 v_sub_f32 v166, v166, v64
 v_sub_f32 v167, v167, v64
 v_sub_f32 v228, v228, v64
 v_sub_f32 v229, v229, v64
 v_sub_f32 v230, v230, v64
 v_sub_f32 v231, v231, v64
 v_sub_f32 v172, v172, v64
 v_sub_f32 v173, v173, v64
 v_sub_f32 v174, v174, v64
 v_sub_f32 v175, v175, v64
 v_sub_f32 v236, v236, v64
 v_sub_f32 v237, v237, v64
 v_sub_f32 v238, v238, v64
 v_sub_f32 v239, v239, v64
 v_sub_f32 v36, v36, v64
 v_sub_f32 v37, v37, v64
 v_sub_f32 v38, v38, v64
 v_sub_f32 v39, v39, v64
 v_sub_f32 v100, v100, v64
 v_sub_f32 v101, v101, v64
 v_sub_f32 v102, v102, v64
 v_sub_f32 v103, v103, v64
 v_sub_f32 v44, v44, v64
 v_sub_f32 v45, v45, v64
 v_sub_f32 v46, v46, v64
 v_sub_f32 v47, v47, v64
 v_sub_f32 v108, v108, v64
 v_sub_f32 v109, v109, v64
 v_sub_f32 v110, v110, v64
 v_sub_f32 v111, v111, v64
 v_max3_f32 v64, v180, v181, v182
 v_max3_f32 v64, v64, v183, v244
 v_max3_f32 v64, v64, v245, v246
 v_max3_f32 v64, v64, v247, v188
 v_max3_f32 v64, v64, v189, v190
 v_max3_f32 v64, v64, v191, v252
 v_max3_f32 v64, v64, v253, v254
 v_max_f32 v64, v64, v255
 v_mov_b32 v72, v64
 s_nop 1
 v_permlane32_swap_b32 v64, v72
 v_max_f32 v64, v64, v72
 v_mov_b32 v72, v64
 s_nop 1
 v_permlane16_swap_b32 v64, v72
 v_max_f32 v64, v64, v72
 v_add_f32 v64, 0x41a00000, v64
 v_max_f32 v64, 0, v64
 v_sub_f32 v65, 0, v64
 v_exp_f32 v65, v65
 v_sub_f32 v184, v184, v64
 v_sub_f32 v185, v185, v64
 v_sub_f32 v186, v186, v64
 v_sub_f32 v187, v187, v64
 v_mul_f32 v144, v144, v65
 v_mul_f32 v145, v145, v65
 v_mul_f32 v146, v146, v65
 v_mul_f32 v147, v147, v65
 v_accvgpr_read_b32 v72, a96
 v_accvgpr_read_b32 v73, a97
 v_accvgpr_read_b32 v74, a98
 v_accvgpr_read_b32 v75, a99
 v_mul_f32 v72, v72, v65
 v_mul_f32 v73, v73, v65
 v_mul_f32 v74, v74, v65
 v_mul_f32 v75, v75, v65
 v_accvgpr_write_b32 a96, v72
 v_accvgpr_write_b32 a97, v73
 v_accvgpr_write_b32 a98, v74
 v_accvgpr_write_b32 a99, v75
 v_accvgpr_read_b32 v72, a100
 v_accvgpr_read_b32 v73, a101
 v_accvgpr_read_b32 v74, a102
 v_accvgpr_read_b32 v75, a103
 v_mul_f32 v72, v72, v65
 v_mul_f32 v73, v73, v65
 v_mul_f32 v74, v74, v65
 v_mul_f32 v75, v75, v65
 v_accvgpr_write_b32 a100, v72
 v_accvgpr_write_b32 a101, v73
 v_accvgpr_write_b32 a102, v74
 v_accvgpr_write_b32 a103, v75
 v_accvgpr_read_b32 v72, a104
 v_accvgpr_read_b32 v73, a105
 v_accvgpr_read_b32 v74, a106
 v_accvgpr_read_b32 v75, a107
 v_mul_f32 v72, v72, v65
 v_mul_f32 v73, v73, v65
 v_mul_f32 v74, v74, v65
 v_mul_f32 v75, v75, v65
 v_accvgpr_write_b32 a104, v72
 v_accvgpr_write_b32 a105, v73
 v_accvgpr_write_b32 a106, v74
 v_accvgpr_write_b32 a107, v75
 v_accvgpr_read_b32 v72, a108
 v_accvgpr_read_b32 v73, a109
 v_accvgpr_read_b32 v74, a110
 v_accvgpr_read_b32 v75, a111
 v_mul_f32 v72, v72, v65
 v_mul_f32 v73, v73, v65
 v_mul_f32 v74, v74, v65
 v_mul_f32 v75, v75, v65
 v_accvgpr_write_b32 a108, v72
 v_accvgpr_write_b32 a109, v73
 v_accvgpr_write_b32 a110, v74
 v_accvgpr_write_b32 a111, v75
 v_accvgpr_read_b32 v72, a112
 v_accvgpr_read_b32 v73, a113
 v_accvgpr_read_b32 v74, a114
 v_accvgpr_read_b32 v75, a115
 v_mul_f32 v72, v72, v65
 v_mul_f32 v73, v73, v65
 v_mul_f32 v74, v74, v65
 v_mul_f32 v75, v75, v65
 v_accvgpr_write_b32 a112, v72
 v_accvgpr_write_b32 a113, v73
 v_accvgpr_write_b32 a114, v74
 v_accvgpr_write_b32 a115, v75
 v_accvgpr_read_b32 v72, a116
 v_accvgpr_read_b32 v73, a117
 v_accvgpr_read_b32 v74, a118
 v_accvgpr_read_b32 v75, a119
 v_mul_f32 v72, v72, v65
 v_mul_f32 v73, v73, v65
 v_mul_f32 v74, v74, v65
 v_mul_f32 v75, v75, v65
 v_accvgpr_write_b32 a116, v72
 v_accvgpr_write_b32 a117, v73
 v_accvgpr_write_b32 a118, v74
 v_accvgpr_write_b32 a119, v75
 v_accvgpr_read_b32 v72, a120
 v_accvgpr_read_b32 v73, a121
 v_accvgpr_read_b32 v74, a122
 v_accvgpr_read_b32 v75, a123
 v_mul_f32 v72, v72, v65
 v_mul_f32 v73, v73, v65
 v_mul_f32 v74, v74, v65
 v_mul_f32 v75, v75, v65
 v_accvgpr_write_b32 a120, v72
 v_accvgpr_write_b32 a121, v73
 v_accvgpr_write_b32 a122, v74
 v_accvgpr_write_b32 a123, v75
 v_accvgpr_read_b32 v72, a124
 v_accvgpr_read_b32 v73, a125
 v_accvgpr_read_b32 v74, a126
 v_accvgpr_read_b32 v75, a127
 v_mul_f32 v72, v72, v65
 v_mul_f32 v73, v73, v65
 v_mul_f32 v74, v74, v65
 v_mul_f32 v75, v75, v65
 v_accvgpr_write_b32 a124, v72
 v_accvgpr_write_b32 a125, v73
 v_accvgpr_write_b32 a126, v74
 v_accvgpr_write_b32 a127, v75
 v_sub_f32 v180, v180, v64
 v_sub_f32 v181, v181, v64
 v_sub_f32 v182, v182, v64
 v_sub_f32 v183, v183, v64
 v_sub_f32 v244, v244, v64
 v_sub_f32 v245, v245, v64
 v_sub_f32 v246, v246, v64
 v_sub_f32 v247, v247, v64
 v_sub_f32 v188, v188, v64
 v_sub_f32 v189, v189, v64
 v_sub_f32 v190, v190, v64
 v_sub_f32 v191, v191, v64
 v_sub_f32 v252, v252, v64
 v_sub_f32 v253, v253, v64
 v_sub_f32 v254, v254, v64
 v_sub_f32 v255, v255, v64
 v_sub_f32 v52, v52, v64
 v_sub_f32 v53, v53, v64
 v_sub_f32 v54, v54, v64
 v_sub_f32 v55, v55, v64
 v_sub_f32 v116, v116, v64
 v_sub_f32 v117, v117, v64
 v_sub_f32 v118, v118, v64
 v_sub_f32 v119, v119, v64
 v_sub_f32 v60, v60, v64
 v_sub_f32 v61, v61, v64
 v_sub_f32 v62, v62, v64
 v_sub_f32 v63, v63, v64
 v_sub_f32 v124, v124, v64
 v_sub_f32 v125, v125, v64
 v_sub_f32 v126, v126, v64
 v_sub_f32 v127, v127, v64
 v_exp_f32 v20, v164
 v_exp_f32 v21, v165
 s_nop 0
 v_cvt_pk_bf16_f32 v224, v20, v21
 v_exp_f32 v20, v166
 v_exp_f32 v21, v167
 s_nop 0
 v_cvt_pk_bf16_f32 v225, v20, v21
 v_exp_f32 v20, v228
 v_exp_f32 v21, v229
 s_nop 0
 v_cvt_pk_bf16_f32 v226, v20, v21
 v_exp_f32 v20, v230
 v_exp_f32 v21, v231
 s_nop 0
 v_cvt_pk_bf16_f32 v227, v20, v21
 v_exp_f32 v20, v172
 v_exp_f32 v21, v173
 s_nop 0
 v_cvt_pk_bf16_f32 v232, v20, v21
 v_exp_f32 v20, v174
 v_exp_f32 v21, v175
 s_nop 0
 v_cvt_pk_bf16_f32 v233, v20, v21
 v_exp_f32 v20, v236
 v_exp_f32 v21, v237
 s_nop 0
 v_cvt_pk_bf16_f32 v234, v20, v21
 v_exp_f32 v20, v238
 v_exp_f32 v21, v239
 s_nop 0
 v_cvt_pk_bf16_f32 v235, v20, v21
 v_exp_f32 v20, v180
 v_exp_f32 v21, v181
 s_nop 0
 v_cvt_pk_bf16_f32 v240, v20, v21
 v_exp_f32 v20, v182
 v_exp_f32 v21, v183
 s_nop 0
 v_cvt_pk_bf16_f32 v241, v20, v21
 v_exp_f32 v20, v244
 v_exp_f32 v21, v245
 s_nop 0
 v_cvt_pk_bf16_f32 v242, v20, v21
 v_exp_f32 v20, v246
 v_exp_f32 v21, v247
 s_nop 0
 v_cvt_pk_bf16_f32 v243, v20, v21
 v_exp_f32 v20, v188
 v_exp_f32 v21, v189
 s_nop 0
 v_cvt_pk_bf16_f32 v248, v20, v21
 v_exp_f32 v20, v190
 v_exp_f32 v21, v191
 s_nop 0
 v_cvt_pk_bf16_f32 v249, v20, v21
 v_exp_f32 v20, v252
 v_exp_f32 v21, v253
 s_nop 0
 v_cvt_pk_bf16_f32 v250, v20, v21
 v_exp_f32 v20, v254
 v_exp_f32 v21, v255
 s_nop 0
 v_cvt_pk_bf16_f32 v251, v20, v21
 s_nop 1
 s_setpc_b64 s[88:89]
L_tr_173:
 s_call_b64 s[88:89], L_rare_s0s
 s_branch L_back_172
L_tr_176:
 s_call_b64 s[88:89], L_rare_s1s
 s_branch L_back_175
L_spin_178:
 s_mov_b32 s69, 0x4000
L_spin_178_l:
 s_sleep 2
 buffer_load_dword v15, v19, s[4:7], 0 offen sc1
 s_waitcnt vmcnt(0)
 v_cmp_eq_u32 vcc, 1, v15
 s_and_b32 s94, vcc_lo, 15
 s_cmp_eq_u32 s94, 15
 s_cbranch_scc1 L_back_177
 s_sub_u32 s69, s69, 1
 s_cmp_lg_u32 s69, 0
 s_cbranch_scc1 L_spin_178_l
 s_branch L_back_177
L_tr_180:
 s_call_b64 s[88:89], L_rare_s0s
 s_branch L_back_179
L_tr_182:
 s_call_b64 s[88:89], L_rare_s1n
 s_branch L_back_181
L_rare_s1n:
 s_nop 7
 s_nop 1
 v_max3_f32 v64, v164, v165, v166
 v_max3_f32 v64, v64, v167, v228
 v_max3_f32 v64, v64, v229, v230
 v_max3_f32 v64, v64, v231, v172
 v_max3_f32 v64, v64, v173, v174
 v_max3_f32 v64, v64, v175, v236
 v_max3_f32 v64, v64, v237, v238
 v_max_f32 v64, v64, v239
 v_mov_b32 v72, v64
 s_nop 1
 v_permlane32_swap_b32 v64, v72
 v_max_f32 v64, v64, v72
 v_mov_b32 v72, v64
 s_nop 1
 v_permlane16_swap_b32 v64, v72
 v_max_f32 v64, v64, v72
 v_add_f32 v64, 0x41a00000, v64
 v_max_f32 v64, 0, v64
 v_sub_f32 v65, 0, v64
 v_exp_f32 v65, v65
 v_sub_f32 v176, v176, v64
 v_sub_f32 v177, v177, v64
 v_sub_f32 v178, v178, v64
 v_sub_f32 v179, v179, v64
 v_mul_f32 v136, v136, v65
 v_mul_f32 v137, v137, v65
 v_mul_f32 v138, v138, v65
 v_mul_f32 v139, v139, v65
 v_accvgpr_read_b32 v72, a64
 v_accvgpr_read_b32 v73, a65
 v_accvgpr_read_b32 v74, a66
 v_accvgpr_read_b32 v75, a67
 v_mul_f32 v72, v72, v65
 v_mul_f32 v73, v73, v65
 v_mul_f32 v74, v74, v65
 v_mul_f32 v75, v75, v65
 v_accvgpr_write_b32 a64, v72
 v_accvgpr_write_b32 a65, v73
 v_accvgpr_write_b32 a66, v74
 v_accvgpr_write_b32 a67, v75
 v_accvgpr_read_b32 v72, a68
 v_accvgpr_read_b32 v73, a69
 v_accvgpr_read_b32 v74, a70
 v_accvgpr_read_b32 v75, a71
 v_mul_f32 v72, v72, v65
 v_mul_f32 v73, v73, v65
 v_mul_f32 v74, v74, v65
 v_mul_f32 v75, v75, v65
 v_accvgpr_write_b32 a68, v72
 v_accvgpr_write_b32 a69, v73
 v_accvgpr_write_b32 a70, v74
 v_accvgpr_write_b32 a71, v75
 v_accvgpr_read_b32 v72, a72
 v_accvgpr_read_b32 v73, a73
 v_accvgpr_read_b32 v74, a74
 v_accvgpr_read_b32 v75, a75
 v_mul_f32 v72, v72, v65
 v_mul_f32 v73, v73, v65
 v_mul_f32 v74, v74, v65
 v_mul_f32 v75, v75, v65
 v_accvgpr_write_b32 a72, v72
 v_accvgpr_write_b32 a73, v73
 v_accvgpr_write_b32 a74, v74
 v_accvgpr_write_b32 a75, v75
 v_accvgpr_read_b32 v72, a76
 v_accvgpr_read_b32 v73, a77
 v_accvgpr_read_b32 v74, a78
 v_accvgpr_read_b32 v75, a79
 v_mul_f32 v72, v72, v65
 v_mul_f32 v73, v73, v65
 v_mul_f32 v74, v74, v65
 v_mul_f32 v75, v75, v65
 v_accvgpr_write_b32 a76, v72
 v_accvgpr_write_b32 a77, v73
 v_accvgpr_write_b32 a78, v74
 v_accvgpr_write_b32 a79, v75
 v_accvgpr_read_b32 v72, a80
 v_accvgpr_read_b32 v73, a81
 v_accvgpr_read_b32 v74, a82
 v_accvgpr_read_b32 v75, a83
 v_mul_f32 v72, v72, v65
 v_mul_f32 v73, v73, v65
 v_mul_f32 v74, v74, v65
 v_mul_f32 v75, v75, v65
 v_accvgpr_write_b32 a80, v72
 v_accvgpr_write_b32 a81, v73
 v_accvgpr_write_b32 a82, v74
 v_accvgpr_write_b32 a83, v75
 v_accvgpr_read_b32 v72, a84
 v_accvgpr_read_b32 v73, a85
 v_accvgpr_read_b32 v74, a86
 v_accvgpr_read_b32 v75, a87
 v_mul_f32 v72, v72, v65
 v_mul_f32 v73, v73, v65
 v_mul_f32 v74, v74, v65
 v_mul_f32 v75, v75, v65
 v_accvgpr_write_b32 a84, v72
 v_accvgpr_write_b32 a85, v73
 v_accvgpr_write_b32 a86, v74
 v_accvgpr_write_b32 a87, v75
 v_accvgpr_read_b32 v72, a88
 v_accvgpr_read_b32 v73, a89
 v_accvgpr_read_b32 v74, a90
 v_accvgpr_read_b32 v75, a91
 v_mul_f32 v72, v72, v65
 v_mul_f32 v73, v73, v65
 v_mul_f32 v74, v74, v65
 v_mul_f32 v75, v75, v65
 v_accvgpr_write_b32 a88, v72
 v_accvgpr_write_b32 a89, v73
 v_accvgpr_write_b32 a90, v74
 v_accvgpr_write_b32 a91, v75
 v_accvgpr_read_b32 v72, a92
 v_accvgpr_read_b32 v73, a93
 v_accvgpr_read_b32 v74, a94
 v_accvgpr_read_b32 v75, a95
 v_mul_f32 v72, v72, v65
 v_mul_f32 v73, v73, v65
 v_mul_f32 v74, v74, v65
 v_mul_f32 v75, v75, v65
 v_accvgpr_write_b32 a92, v72
 v_accvgpr_write_b32 a93, v73
 v_accvgpr_write_b32 a94, v74
 v_accvgpr_write_b32 a95, v75
 v_sub_f32 v164, v164, v64
 v_sub_f32 v165, v165, v64
 v_sub_f32 v166, v166, v64
 v_sub_f32 v167, v167, v64
 v_sub_f32 v228, v228, v64
 v_sub_f32 v229, v229, v64
 v_sub_f32 v230, v230, v64
 v_sub_f32 v231, v231, v64
 v_sub_f32 v172, v172, v64
 v_sub_f32 v173, v173, v64
 v_sub_f32 v174, v174, v64
 v_sub_f32 v175, v175, v64
 v_sub_f32 v236, v236, v64
 v_sub_f32 v237, v237, v64
 v_sub_f32 v238, v238, v64
 v_sub_f32 v239, v239, v64
 v_max3_f32 v64, v180, v181, v182
 v_max3_f32 v64, v64, v183, v244
 v_max3_f32 v64, v64, v245, v246
 v_max3_f32 v64, v64, v247, v188
 v_max3_f32 v64, v64, v189, v190
 v_max3_f32 v64, v64, v191, v252
 v_max3_f32 v64, v64, v253, v254
 v_max_f32 v64, v64, v255
 v_mov_b32 v72, v64
 s_nop 1
 v_permlane32_swap_b32 v64, v72
 v_max_f32 v64, v64, v72
 v_mov_b32 v72, v64
 s_nop 1
 v_permlane16_swap_b32 v64, v72
 v_max_f32 v64, v64, v72
 v_add_f32 v64, 0x41a00000, v64
 v_max_f32 v64, 0, v64
 v_sub_f32 v65, 0, v64
 v_exp_f32 v65, v65
 v_sub_f32 v184, v184, v64
 v_sub_f32 v185, v185, v64
 v_sub_f32 v186, v186, v64
 v_sub_f32 v187, v187, v64
 v_mul_f32 v144, v144, v65
 v_mul_f32 v145, v145, v65
 v_mul_f32 v146, v146, v65
 v_mul_f32 v147, v147, v65
 v_accvgpr_read_b32 v72, a96
 v_accvgpr_read_b32 v73, a97
 v_accvgpr_read_b32 v74, a98
 v_accvgpr_read_b32 v75, a99
 v_mul_f32 v72, v72, v65
 v_mul_f32 v73, v73, v65
 v_mul_f32 v74, v74, v65
 v_mul_f32 v75, v75, v65
 v_accvgpr_write_b32 a96, v72
 v_accvgpr_write_b32 a97, v73
 v_accvgpr_write_b32 a98, v74
 v_accvgpr_write_b32 a99, v75
 v_accvgpr_read_b32 v72, a100
 v_accvgpr_read_b32 v73, a101
 v_accvgpr_read_b32 v74, a102
 v_accvgpr_read_b32 v75, a103
 v_mul_f32 v72, v72, v65
 v_mul_f32 v73, v73, v65
 v_mul_f32 v74, v74, v65
 v_mul_f32 v75, v75, v65
 v_accvgpr_write_b32 a100, v72
 v_accvgpr_write_b32 a101, v73
 v_accvgpr_write_b32 a102, v74
 v_accvgpr_write_b32 a103, v75
 v_accvgpr_read_b32 v72, a104
 v_accvgpr_read_b32 v73, a105
 v_accvgpr_read_b32 v74, a106
 v_accvgpr_read_b32 v75, a107
 v_mul_f32 v72, v72, v65
 v_mul_f32 v73, v73, v65
 v_mul_f32 v74, v74, v65
 v_mul_f32 v75, v75, v65
 v_accvgpr_write_b32 a104, v72
 v_accvgpr_write_b32 a105, v73
 v_accvgpr_write_b32 a106, v74
 v_accvgpr_write_b32 a107, v75
 v_accvgpr_read_b32 v72, a108
 v_accvgpr_read_b32 v73, a109
 v_accvgpr_read_b32 v74, a110
 v_accvgpr_read_b32 v75, a111
 v_mul_f32 v72, v72, v65
 v_mul_f32 v73, v73, v65
 v_mul_f32 v74, v74, v65
 v_mul_f32 v75, v75, v65
 v_accvgpr_write_b32 a108, v72
 v_accvgpr_write_b32 a109, v73
 v_accvgpr_write_b32 a110, v74
 v_accvgpr_write_b32 a111, v75
 v_accvgpr_read_b32 v72, a112
 v_accvgpr_read_b32 v73, a113
 v_accvgpr_read_b32 v74, a114
 v_accvgpr_read_b32 v75, a115
 v_mul_f32 v72, v72, v65
 v_mul_f32 v73, v73, v65
 v_mul_f32 v74, v74, v65
 v_mul_f32 v75, v75, v65
 v_accvgpr_write_b32 a112, v72
 v_accvgpr_write_b32 a113, v73
 v_accvgpr_write_b32 a114, v74
 v_accvgpr_write_b32 a115, v75
 v_accvgpr_read_b32 v72, a116
 v_accvgpr_read_b32 v73, a117
 v_accvgpr_read_b32 v74, a118
 v_accvgpr_read_b32 v75, a119
 v_mul_f32 v72, v72, v65
 v_mul_f32 v73, v73, v65
 v_mul_f32 v74, v74, v65
 v_mul_f32 v75, v75, v65
 v_accvgpr_write_b32 a116, v72
 v_accvgpr_write_b32 a117, v73
 v_accvgpr_write_b32 a118, v74
 v_accvgpr_write_b32 a119, v75
 v_accvgpr_read_b32 v72, a120
 v_accvgpr_read_b32 v73, a121
 v_accvgpr_read_b32 v74, a122
 v_accvgpr_read_b32 v75, a123
 v_mul_f32 v72, v72, v65
 v_mul_f32 v73, v73, v65
 v_mul_f32 v74, v74, v65
 v_mul_f32 v75, v75, v65
 v_accvgpr_write_b32 a120, v72
 v_accvgpr_write_b32 a121, v73
 v_accvgpr_write_b32 a122, v74
 v_accvgpr_write_b32 a123, v75
 v_accvgpr_read_b32 v72, a124
 v_accvgpr_read_b32 v73, a125
 v_accvgpr_read_b32 v74, a126
 v_accvgpr_read_b32 v75, a127
 v_mul_f32 v72, v72, v65
 v_mul_f32 v73, v73, v65
 v_mul_f32 v74, v74, v65
 v_mul_f32 v75, v75, v65
 v_accvgpr_write_b32 a124, v72
 v_accvgpr_write_b32 a125, v73
 v_accvgpr_write_b32 a126, v74
 v_accvgpr_write_b32 a127, v75
 v_sub_f32 v180, v180, v64
 v_sub_f32 v181, v181, v64
 v_sub_f32 v182, v182, v64
 v_sub_f32 v183, v183, v64
 v_sub_f32 v244, v244, v64
 v_sub_f32 v245, v245, v64
 v_sub_f32 v246, v246, v64
 v_sub_f32 v247, v247, v64
 v_sub_f32 v188, v188, v64
 v_sub_f32 v189, v189, v64
 v_sub_f32 v190, v190, v64
 v_sub_f32 v191, v191, v64
 v_sub_f32 v252, v252, v64
 v_sub_f32 v253, v253, v64
 v_sub_f32 v254, v254, v64
 v_sub_f32 v255, v255, v64
 v_exp_f32 v20, v164
 v_exp_f32 v21, v165
 s_nop 0
 v_cvt_pk_bf16_f32 v224, v20, v21
 v_exp_f32 v20, v166
 v_exp_f32 v21, v167
 s_nop 0
 v_cvt_pk_bf16_f32 v225, v20, v21
 v_exp_f32 v20, v228
 v_exp_f32 v21, v229
 s_nop 0
 v_cvt_pk_bf16_f32 v226, v20, v21
 v_exp_f32 v20, v230
 v_exp_f32 v21, v231
 s_nop 0
 v_cvt_pk_bf16_f32 v227, v20, v21
 v_exp_f32 v20, v172
 v_exp_f32 v21, v173
 s_nop 0
 v_cvt_pk_bf16_f32 v232, v20, v21
 v_exp_f32 v20, v174
 v_exp_f32 v21, v175
 s_nop 0
 v_cvt_pk_bf16_f32 v233, v20, v21
 v_exp_f32 v20, v236
 v_exp_f32 v21, v237
 s_nop 0
 v_cvt_pk_bf16_f32 v234, v20, v21
 v_exp_f32 v20, v238
 v_exp_f32 v21, v239
 s_nop 0
 v_cvt_pk_bf16_f32 v235, v20, v21
 v_exp_f32 v20, v180
 v_exp_f32 v21, v181
 s_nop 0
 v_cvt_pk_bf16_f32 v240, v20, v21
 v_exp_f32 v20, v182
 v_exp_f32 v21, v183
 s_nop 0
 v_cvt_pk_bf16_f32 v241, v20, v21
 v_exp_f32 v20, v244
 v_exp_f32 v21, v245
 s_nop 0
 v_cvt_pk_bf16_f32 v242, v20, v21
 v_exp_f32 v20, v246
 v_exp_f32 v21, v247
 s_nop 0
 v_cvt_pk_bf16_f32 v243, v20, v21
 v_exp_f32 v20, v188
 v_exp_f32 v21, v189
 s_nop 0
 v_cvt_pk_bf16_f32 v248, v20, v21
 v_exp_f32 v20, v190
 v_exp_f32 v21, v191
 s_nop 0
 v_cvt_pk_bf16_f32 v249, v20, v21
 v_exp_f32 v20, v252
 v_exp_f32 v21, v253
 s_nop 0
 v_cvt_pk_bf16_f32 v250, v20, v21
 v_exp_f32 v20, v254
 v_exp_f32 v21, v255
 s_nop 0
 v_cvt_pk_bf16_f32 v251, v20, v21
 s_nop 1
 s_setpc_b64 s[88:89]
L_spin_193:
 s_mov_b32 s69, 0x4000
L_spin_193_l:
 s_sleep 2
 buffer_load_dword v15, v19, s[4:7], 0 offen sc1
 s_waitcnt vmcnt(0)
 v_cmp_eq_u32 vcc, 1, v15
 s_and_b32 s94, vcc_lo, 15
 s_cmp_eq_u32 s94, 15
 s_cbranch_scc1 L_back_192
 s_sub_u32 s69, s69, 1
 s_cmp_lg_u32 s69, 0
 s_cbranch_scc1 L_spin_193_l
 s_branch L_back_192
L_spin_195:
 s_mov_b32 s69, 0x4000
L_spin_195_l:
 s_sleep 2
 buffer_load_dword v15, v19, s[4:7], 0 offen sc1
 s_waitcnt vmcnt(0)
 v_cmp_eq_u32 vcc, 1, v15
 s_and_b32 s94, vcc_lo, 255
 s_cmp_eq_u32 s94, 255
 s_cbranch_scc1 L_back_194
 s_sub_u32 s69, s69, 1
 s_cmp_lg_u32 s69, 0
 s_cbranch_scc1 L_spin_195_l
 s_branch L_back_194
L_ffq_197:
 v_lshlrev_b32 v16, 2, v14
 v_add_u32 v16, 71474176, v16
 s_mov_b32 s69, 0x4000
L_ffq_197_l:
 s_movk_i32 s94, 0x1000
 s_movk_i32 s95, 0x2000
 buffer_load_dword v17, v16, s[4:7], 0 offen sc1
 buffer_load_dword v18, v16, s[4:7], s94 offen sc1
 buffer_load_dword v23, v16, s[4:7], s95 offen sc1
 s_waitcnt vmcnt(0)
 v_and_b32 v17, v17, v18
 v_cmp_ne_u32 vcc, 1, v17
 s_mov_b64 s[88:89], vcc
 v_cmp_ne_u32 vcc, 1, v23
 s_and_b32 s94, vcc_lo, 0xffff
 s_or_b32 s94, s94, s88
 s_or_b32 s94, s94, s89
 s_cbranch_scc0 L_ffq_197_ok
 s_sleep 2
 s_sub_u32 s69, s69, 1
 s_cmp_lg_u32 s69, 0
 s_cbranch_scc1 L_ffq_197_l
L_ffq_197_ok:
 s_movk_i32 s94, 0x1000
 v_mul_u32_u24 v17, 0x480, v8
 v_sub_u32 v16, v4, v17
 v_lshlrev_b32 v16, 1, v16
 v_add_u32 v16, 71319552, v16
 buffer_load_dwordx4 v[48:51], v16, s[4:7], 0 offen sc1
 buffer_load_dwordx4 v[84:87], v16, s[4:7], s94 offen sc1
 v_sub_u32 v16, v5, v17
 v_lshlrev_b32 v16, 1, v16
 v_add_u32 v16, 71319552, v16
 buffer_load_dwordx4 v[56:59], v16, s[4:7], 0 offen sc1
 buffer_load_dwordx4 v[92:95], v16, s[4:7], s94 offen sc1
 s_branch L_back_198
L_ffq_199:
 v_lshlrev_b32 v16, 2, v14
 v_add_u32 v16, 71474176, v16
 s_mov_b32 s69, 0x4000
L_ffq_199_l:
 s_movk_i32 s94, 0x1000
 s_movk_i32 s95, 0x2000
 buffer_load_dword v17, v16, s[4:7], 0 offen sc1
 buffer_load_dword v18, v16, s[4:7], s94 offen sc1
 buffer_load_dword v23, v16, s[4:7], s95 offen sc1
 s_waitcnt vmcnt(0)
 v_and_b32 v17, v17, v18
 v_cmp_ne_u32 vcc, 1, v17
 s_mov_b64 s[88:89], vcc
 v_cmp_ne_u32 vcc, 1, v23
 s_and_b32 s94, vcc_lo, 0xffff
 s_or_b32 s94, s94, s88
 s_or_b32 s94, s94, s89
 s_cbranch_scc0 L_ffq_199_ok
 s_sleep 2
 s_sub_u32 s69, s69, 1
 s_cmp_lg_u32 s69, 0
 s_cbranch_scc1 L_ffq_199_l
L_ffq_199_ok:
 s_movk_i32 s94, 0x1000
 v_mul_u32_u24 v17, 0x480, v9
 v_sub_u32 v16, v6, v17
 v_lshlrev_b32 v16, 1, v16
 v_add_u32 v16, 71319552, v16
 buffer_load_dwordx4 v[48:51], v16, s[4:7], 0 offen sc1
 buffer_load_dwordx4 v[84:87], v16, s[4:7], s94 offen sc1
 v_sub_u32 v16, v7, v17
 v_lshlrev_b32 v16, 1, v16
 v_add_u32 v16, 71319552, v16
 buffer_load_dwordx4 v[56:59], v16, s[4:7], 0 offen sc1
 buffer_load_dwordx4 v[92:95], v16, s[4:7], s94 offen sc1
 s_branch L_back_200
L_spin_202:
 s_mov_b32 s69, 0x4000
L_spin_202_l:
 s_sleep 2
 buffer_load_dword v15, v19, s[4:7], 0 offen sc1
 s_waitcnt vmcnt(0)
 v_cmp_eq_u32 vcc, 1, v15
 s_and_b32 s94, vcc_lo, 255
 s_cmp_eq_u32 s94, 255
 s_cbranch_scc1 L_back_201
 s_sub_u32 s69, s69, 1
 s_cmp_lg_u32 s69, 0
 s_cbranch_scc1 L_spin_202_l
 s_branch L_back_201
L_ffa_204:
 v_add_f32 v48, v48, v84
 v_add_f32 v49, v49, v85
 v_add_f32 v50, v50, v86
 v_add_f32 v51, v51, v87
 v_add_u32 v17, 0, v8
 v_cmp_eq_u32 vcc, s93, v17
 v_mov_b32 v18, s23
 s_nop 0
 v_cndmask_b32 v18, 0, v18, vcc
 v_fmac_f32 v80, v18, v48
 v_fmac_f32 v81, v18, v49
 v_fmac_f32 v82, v18, v50
 v_fmac_f32 v83, v18, v51
 v_add_u32 v17, 16, v8
 v_cmp_eq_u32 vcc, s93, v17
 v_mov_b32 v18, s23
 s_nop 0
 v_cndmask_b32 v18, 0, v18, vcc
 v_fmac_f32 v88, v18, v48
 v_fmac_f32 v89, v18, v49
 v_fmac_f32 v90, v18, v50
 v_fmac_f32 v91, v18, v51
 s_branch L_back_205
L_ffa_206:
 v_add_f32 v56, v56, v92
 v_add_f32 v57, v57, v93
 v_add_f32 v58, v58, v94
 v_add_f32 v59, v59, v95
 v_add_u32 v17, 0, v8
 v_cmp_eq_u32 vcc, s93, v17
 v_mov_b32 v18, s23
 s_nop 0
 v_cndmask_b32 v18, 0, v18, vcc
 v_fmac_f32 v80, v18, v56
 v_fmac_f32 v81, v18, v57
 v_fmac_f32 v82, v18, v58
 v_fmac_f32 v83, v18, v59
 v_add_u32 v17, 16, v8
 v_cmp_eq_u32 vcc, s93, v17
 v_mov_b32 v18, s23
 s_nop 0
 v_cndmask_b32 v18, 0, v18, vcc
 v_fmac_f32 v88, v18, v56
 v_fmac_f32 v89, v18, v57
 v_fmac_f32 v90, v18, v58
 v_fmac_f32 v91, v18, v59
 s_branch L_back_207
L_ffa_210:
 v_add_f32 v48, v48, v84
 v_add_f32 v49, v49, v85
 v_add_f32 v50, v50, v86
 v_add_f32 v51, v51, v87
 v_add_u32 v17, 0, v9
 v_cmp_eq_u32 vcc, s93, v17
 v_mov_b32 v18, s23
 s_nop 0
 v_cndmask_b32 v18, 0, v18, vcc
 v_fmac_f32 v80, v18, v48
 v_fmac_f32 v81, v18, v49
 v_fmac_f32 v82, v18, v50
 v_fmac_f32 v83, v18, v51
 v_add_u32 v17, 16, v9
 v_cmp_eq_u32 vcc, s93, v17
 v_mov_b32 v18, s23
 s_nop 0
 v_cndmask_b32 v18, 0, v18, vcc
 v_fmac_f32 v88, v18, v48
 v_fmac_f32 v89, v18, v49
 v_fmac_f32 v90, v18, v50
 v_fmac_f32 v91, v18, v51
 s_branch L_back_211
L_ffa_212:
 v_add_f32 v56, v56, v92
 v_add_f32 v57, v57, v93
 v_add_f32 v58, v58, v94
 v_add_f32 v59, v59, v95
 v_add_u32 v17, 0, v9
 v_cmp_eq_u32 vcc, s93, v17
 v_mov_b32 v18, s23
 s_nop 0
 v_cndmask_b32 v18, 0, v18, vcc
 v_fmac_f32 v80, v18, v56
 v_fmac_f32 v81, v18, v57
 v_fmac_f32 v82, v18, v58
 v_fmac_f32 v83, v18, v59
 v_add_u32 v17, 16, v9
 v_cmp_eq_u32 vcc, s93, v17
 v_mov_b32 v18, s23
 s_nop 0
 v_cndmask_b32 v18, 0, v18, vcc
 v_fmac_f32 v88, v18, v56
 v_fmac_f32 v89, v18, v57
 v_fmac_f32 v90, v18, v58
 v_fmac_f32 v91, v18, v59
 s_branch L_back_213
.section .rodata,"a"
.p2align 6
.amdhsa_kernel gated_mix__compressed_kv_cla__moe_arch_mod__prompt_kernel
  .amdhsa_next_free_vgpr 512
  .amdhsa_next_free_sgpr 102
  .amdhsa_accum_offset 256
  .amdhsa_group_segment_fixed_size 0
  .amdhsa_kernarg_size 120
  .amdhsa_user_sgpr_count 2
  .amdhsa_user_sgpr_kernarg_segment_ptr 1
  .amdhsa_system_sgpr_workgroup_id_x 1
.end_amdhsa_kernel
```
